```python
import torch

def _softmax(x, axis=-1):
    return torch.softmax(x, dim=axis)
def _gelu(x):
    return torch.nn.functional.gelu(x, approximate="tanh")
def _silu(x):
    return torch.nn.functional.silu(x)
def _sigmoid(x):
    return torch.sigmoid(x)
def _layernorm(x, axis=-1, eps=1e-5):
    m = x.mean(dim=axis, keepdim=True)
    v = x.var(dim=axis, keepdim=True, unbiased=False)
    return (x - m) / torch.sqrt(v + eps)
def _scatter_add(tgt, idx, src, axis=0):
    return tgt.clone().index_add_(axis, idx, src)
def _segment_sum(src, seg, n):
    out = torch.zeros((n,) + src.shape[1:], dtype=src.dtype)
    return out.index_add_(0, seg, src)
def _pad(x, pw):
    flat = tuple(v for pair in reversed(pw) for v in pair)
    return torch.nn.functional.pad(x, flat)

kernel_name = 'standalone__standard_2d_1d_3d_conv__vision'

def setup_inputs():

    _w = (lambda a: (lambda t: t.to(torch.bfloat16) if t.is_floating_point() else t)(torch.as_tensor(a)))
    H = W = 384
    C = 384
    K = 1
    return {
        "x": _w((lambda *s: torch.randn(*s, dtype=torch.bfloat16) * 0.05)(1, H, W, C)),
        "w": _w((lambda *s: torch.randn(*s, dtype=torch.bfloat16) * 0.05)(K, K, C, C)),
        "b": _w((lambda *s: torch.randn(*s, dtype=torch.bfloat16) * 0.05)(C)),
    }

def reference(x, w, b):
    B, H, W, Cin = x.shape
    K = w.shape[0]
    pl = (K - 1) // 2
    pr = K // 2
    xp = _pad(x, ((0, 0), (pl, pr), (pl, pr), (0, 0)))
    out = sum(
        torch.einsum('bhwc,cd->bhwd', xp[:, i:i+H, j:j+W, :], w[i, j])
        for i in range(K) for j in range(K)
    )
    return out + b[None, None, None, :]
```

```asm
; @launch grid=(256,1,1) block=(256,1,1) lds=160256
.amdgcn_target "amdgcn-amd-amdhsa--gfx950"
.text
.globl standalone__standard_2d_1d_3d_conv__vision_kernel
.p2align 8
.type standalone__standard_2d_1d_3d_conv__vision_kernel,@function
standalone__standard_2d_1d_3d_conv__vision_kernel:
    s_cmp_ge_u32 s2, 256
    s_cbranch_scc1 L_done
    s_load_dwordx8 s[4:11], s[0:1], 0
    v_lshrrev_b32 v28, 6, v0
    v_and_b32 v29, 63, v0
    v_readfirstlane_b32 s28, v28
    v_and_b32 v30, 15, v0
    v_bfe_u32 v31, v0, 4, 2
    v_mul_u32_u24 v13, 6144, v31
    v_mul_u32_u24 v14, 12, v30
    v_add_u32 v13, v13, v14
    v_mul_u32_u24 v14, 192, v28
    v_add_u32 v13, v13, v14
    v_mul_u32_u24 v15, 48, v31
    v_add_u32 v15, v15, v14
    v_mul_u32_u24 v8, 784, v30
    v_add_u32 v8, v8, v15
    v_add_u32 v8, 135168, v8
    v_add_u32 v14, 3072, v13
    v_add_u32 v1, 0, v31
    v_xor_b32 v1, v1, v30
    v_lshlrev_b32 v1, 4, v1
    v_add_u32 v2, 4, v31
    v_xor_b32 v2, v2, v30
    v_lshlrev_b32 v2, 4, v2
    v_add_u32 v3, 8, v31
    v_xor_b32 v3, v3, v30
    v_lshlrev_b32 v3, 4, v3
    v_add_u32 v4, 12, v31
    v_xor_b32 v4, v4, v30
    v_lshlrev_b32 v4, 4, v4
    v_mul_u32_u24 v16, 768, v30
    v_add_u32 v1, v1, v16
    v_add_u32 v2, v2, v16
    v_add_u32 v3, v3, v16
    v_add_u32 v4, v4, v16
    v_mul_u32_u24 v12, 3072, v28
    v_lshlrev_b32 v16, 4, v29
    v_add_u32 v12, v12, v16
    v_mul_u32_u24 v16, 192, v28
    v_add_u32 v16, v16, v29
    v_add_u32 v16, 0, v16
    v_mul_u32_u24 v17, 1366, v16
    v_lshrrev_b32 v17, 16, v17
    v_mul_u32_u24 v18, 48, v17
    v_sub_u32 v18, v16, v18
    v_xor_b32 v19, v18, v17
    v_and_b32 v19, 15, v19
    v_and_b32 v18, 48, v18
    v_or_b32 v18, v18, v19
    v_lshlrev_b32 v18, 4, v18
    v_mul_u32_u24 v17, 768, v17
    v_add_u32 v18, v18, v17
    v_subrev_u32 v5, 0, v18
    v_add_u32 v16, 0, v29
    v_mul_u32_u24 v17, 1366, v16
    v_lshrrev_b32 v17, 16, v17
    v_add_u32 v16, v16, v17
    v_lshlrev_b32 v16, 4, v16
    v_mul_u32_u24 v17, 3136, v28
    v_add_u32 v16, v16, v17
    v_add_u32 v9, 147712, v16
    v_mul_u32_u24 v16, 192, v28
    v_add_u32 v16, v16, v29
    v_add_u32 v16, 64, v16
    v_mul_u32_u24 v17, 1366, v16
    v_lshrrev_b32 v17, 16, v17
    v_mul_u32_u24 v18, 48, v17
    v_sub_u32 v18, v16, v18
    v_xor_b32 v19, v18, v17
    v_and_b32 v19, 15, v19
    v_and_b32 v18, 48, v18
    v_or_b32 v18, v18, v19
    v_lshlrev_b32 v18, 4, v18
    v_mul_u32_u24 v17, 768, v17
    v_add_u32 v18, v18, v17
    v_subrev_u32 v6, 1024, v18
    v_add_u32 v16, 64, v29
    v_mul_u32_u24 v17, 1366, v16
    v_lshrrev_b32 v17, 16, v17
    v_add_u32 v16, v16, v17
    v_lshlrev_b32 v16, 4, v16
    v_mul_u32_u24 v17, 3136, v28
    v_add_u32 v16, v16, v17
    v_add_u32 v10, 147712, v16
    v_mul_u32_u24 v16, 192, v28
    v_add_u32 v16, v16, v29
    v_add_u32 v16, 128, v16
    v_mul_u32_u24 v17, 1366, v16
    v_lshrrev_b32 v17, 16, v17
    v_mul_u32_u24 v18, 48, v17
    v_sub_u32 v18, v16, v18
    v_xor_b32 v19, v18, v17
    v_and_b32 v19, 15, v19
    v_and_b32 v18, 48, v18
    v_or_b32 v18, v18, v19
    v_lshlrev_b32 v18, 4, v18
    v_mul_u32_u24 v17, 768, v17
    v_add_u32 v18, v18, v17
    v_subrev_u32 v7, 2048, v18
    v_add_u32 v16, 128, v29
    v_mul_u32_u24 v17, 1366, v16
    v_lshrrev_b32 v17, 16, v17
    v_add_u32 v16, v16, v17
    v_lshlrev_b32 v16, 4, v16
    v_mul_u32_u24 v17, 3136, v28
    v_add_u32 v16, v16, v17
    v_add_u32 v11, 147712, v16
    s_mul_i32 s30, s2, 12288
    s_sub_u32 s31, s30, 3145728
    s_mul_i32 s32, s28, 3072
    s_mov_b32 s36, 0x05040100
    s_mov_b32 s37, 0x07060302
    s_mov_b32 s40, 113246208
    s_mov_b32 s29, 0
    s_mov_b32 s38, 0
    s_mov_b32 s34, 12544
    s_mov_b32 s35, 0
    s_mov_b32 s42, 4294844416
    s_waitcnt lgkmcnt(0)
    s_mov_b32 s12, s4
    s_and_b32 s13, s5, 0xffff
    s_mov_b32 s14, 113246208
    s_mov_b32 s15, 0x20000
    s_mov_b32 s16, s6
    s_and_b32 s17, s7, 0xffff
    s_mov_b32 s18, 294912
    s_mov_b32 s19, 0x20000
    s_mov_b32 s20, s8
    s_and_b32 s21, s9, 0xffff
    s_mov_b32 s22, 768
    s_mov_b32 s23, 0x20000
    s_mov_b32 s24, s10
    s_and_b32 s25, s11, 0xffff
    s_mov_b32 s26, 0
    s_mov_b32 s27, 0x20000
    buffer_load_dwordx4 a[144:147], v15, s[20:23], 0 offen offset:0
    buffer_load_dwordx4 a[148:151], v15, s[20:23], 0 offen offset:16
    buffer_load_dwordx4 a[152:155], v15, s[20:23], 0 offen offset:32
    s_mov_b32 s35, 0
    buffer_load_dwordx3 v[32:34], v13, s[16:19], s35 offen offset:0
    buffer_load_dwordx3 v[36:38], v13, s[16:19], s35 offen offset:768
    buffer_load_dwordx3 v[40:42], v13, s[16:19], s35 offen offset:1536
    buffer_load_dwordx3 v[44:46], v13, s[16:19], s35 offen offset:2304
    buffer_load_dwordx3 v[48:50], v14, s[16:19], s35 offen offset:0
    buffer_load_dwordx3 v[52:54], v14, s[16:19], s35 offen offset:768
    buffer_load_dwordx3 v[56:58], v14, s[16:19], s35 offen offset:1536
    buffer_load_dwordx3 v[60:62], v14, s[16:19], s35 offen offset:2304
    s_mov_b32 m0, s32
    s_nop 0
    buffer_load_dwordx4 v5, s[12:15], s30 offen offset:0 lds
    buffer_load_dwordx4 v6, s[12:15], s30 offen offset:1024 lds
    buffer_load_dwordx4 v7, s[12:15], s30 offen offset:2048 lds
    s_add_u32 s30, s30, 3145728
    s_add_u32 s32, s32, 12288
    s_mov_b32 s35, 24576
    buffer_load_dwordx3 v[64:66], v13, s[16:19], s35 offen offset:0
    buffer_load_dwordx3 v[68:70], v13, s[16:19], s35 offen offset:768
    buffer_load_dwordx3 v[72:74], v13, s[16:19], s35 offen offset:1536
    buffer_load_dwordx3 v[76:78], v13, s[16:19], s35 offen offset:2304
    buffer_load_dwordx3 v[80:82], v14, s[16:19], s35 offen offset:0
    buffer_load_dwordx3 v[84:86], v14, s[16:19], s35 offen offset:768
    buffer_load_dwordx3 v[88:90], v14, s[16:19], s35 offen offset:1536
    buffer_load_dwordx3 v[92:94], v14, s[16:19], s35 offen offset:2304
    s_mov_b32 s35, 49152
    buffer_load_dwordx3 v[96:98], v13, s[16:19], s35 offen offset:0
    buffer_load_dwordx3 v[100:102], v13, s[16:19], s35 offen offset:768
    buffer_load_dwordx3 v[104:106], v13, s[16:19], s35 offen offset:1536
    buffer_load_dwordx3 v[108:110], v13, s[16:19], s35 offen offset:2304
    buffer_load_dwordx3 v[112:114], v14, s[16:19], s35 offen offset:0
    buffer_load_dwordx3 v[116:118], v14, s[16:19], s35 offen offset:768
    buffer_load_dwordx3 v[120:122], v14, s[16:19], s35 offen offset:1536
    buffer_load_dwordx3 v[124:126], v14, s[16:19], s35 offen offset:2304
    s_mov_b32 m0, s32
    s_nop 0
    buffer_load_dwordx4 v5, s[12:15], s30 offen offset:0 lds
    buffer_load_dwordx4 v6, s[12:15], s30 offen offset:1024 lds
    buffer_load_dwordx4 v7, s[12:15], s30 offen offset:2048 lds
    s_add_u32 s30, s30, 3145728
    s_add_u32 s32, s32, 12288
    s_mov_b32 s35, 73728
    buffer_load_dwordx3 v[128:130], v13, s[16:19], s35 offen offset:0
    buffer_load_dwordx3 v[132:134], v13, s[16:19], s35 offen offset:768
    buffer_load_dwordx3 v[136:138], v13, s[16:19], s35 offen offset:1536
    buffer_load_dwordx3 v[140:142], v13, s[16:19], s35 offen offset:2304
    buffer_load_dwordx3 v[144:146], v14, s[16:19], s35 offen offset:0
    buffer_load_dwordx3 v[148:150], v14, s[16:19], s35 offen offset:768
    buffer_load_dwordx3 v[152:154], v14, s[16:19], s35 offen offset:1536
    buffer_load_dwordx3 v[156:158], v14, s[16:19], s35 offen offset:2304
    s_mov_b32 s35, 98304
    buffer_load_dwordx3 v[160:162], v13, s[16:19], s35 offen offset:0
    buffer_load_dwordx3 v[164:166], v13, s[16:19], s35 offen offset:768
    buffer_load_dwordx3 v[168:170], v13, s[16:19], s35 offen offset:1536
    buffer_load_dwordx3 v[172:174], v13, s[16:19], s35 offen offset:2304
    buffer_load_dwordx3 v[176:178], v14, s[16:19], s35 offen offset:0
    buffer_load_dwordx3 v[180:182], v14, s[16:19], s35 offen offset:768
    buffer_load_dwordx3 v[184:186], v14, s[16:19], s35 offen offset:1536
    buffer_load_dwordx3 v[188:190], v14, s[16:19], s35 offen offset:2304
    s_mov_b32 m0, s32
    s_nop 0
    buffer_load_dwordx4 v5, s[12:15], s30 offen offset:0 lds
    buffer_load_dwordx4 v6, s[12:15], s30 offen offset:1024 lds
    buffer_load_dwordx4 v7, s[12:15], s30 offen offset:2048 lds
    s_add_u32 s30, s30, 3145728
    s_add_u32 s32, s32, 12288
    s_mov_b32 s35, 122880
    buffer_load_dwordx3 v[192:194], v13, s[16:19], s35 offen offset:0
    buffer_load_dwordx3 v[196:198], v13, s[16:19], s35 offen offset:768
    buffer_load_dwordx3 v[200:202], v13, s[16:19], s35 offen offset:1536
    buffer_load_dwordx3 v[204:206], v13, s[16:19], s35 offen offset:2304
    buffer_load_dwordx3 v[208:210], v14, s[16:19], s35 offen offset:0
    buffer_load_dwordx3 v[212:214], v14, s[16:19], s35 offen offset:768
    buffer_load_dwordx3 v[216:218], v14, s[16:19], s35 offen offset:1536
    buffer_load_dwordx3 v[220:222], v14, s[16:19], s35 offen offset:2304
    s_waitcnt vmcnt(49)
    v_perm_b32 v16, v36, v32, s36
    v_perm_b32 v17, v44, v40, s36
    v_perm_b32 v18, v52, v48, s36
    v_perm_b32 v19, v60, v56, s36
    v_accvgpr_write_b32 a0, v16
    v_accvgpr_write_b32 a1, v17
    v_accvgpr_write_b32 a2, v18
    v_accvgpr_write_b32 a3, v19
    v_perm_b32 v20, v36, v32, s37
    v_perm_b32 v21, v44, v40, s37
    v_perm_b32 v22, v52, v48, s37
    v_perm_b32 v23, v60, v56, s37
    v_accvgpr_write_b32 a4, v20
    v_accvgpr_write_b32 a5, v21
    v_accvgpr_write_b32 a6, v22
    v_accvgpr_write_b32 a7, v23
    v_perm_b32 v16, v37, v33, s36
    v_perm_b32 v17, v45, v41, s36
    v_perm_b32 v18, v53, v49, s36
    v_perm_b32 v19, v61, v57, s36
    v_accvgpr_write_b32 a8, v16
    v_accvgpr_write_b32 a9, v17
    v_accvgpr_write_b32 a10, v18
    v_accvgpr_write_b32 a11, v19
    v_perm_b32 v20, v37, v33, s37
    v_perm_b32 v21, v45, v41, s37
    v_perm_b32 v22, v53, v49, s37
    v_perm_b32 v23, v61, v57, s37
    v_accvgpr_write_b32 a12, v20
    v_accvgpr_write_b32 a13, v21
    v_accvgpr_write_b32 a14, v22
    v_accvgpr_write_b32 a15, v23
    v_perm_b32 v16, v38, v34, s36
    v_perm_b32 v17, v46, v42, s36
    v_perm_b32 v18, v54, v50, s36
    v_perm_b32 v19, v62, v58, s36
    v_accvgpr_write_b32 a16, v16
    v_accvgpr_write_b32 a17, v17
    v_accvgpr_write_b32 a18, v18
    v_accvgpr_write_b32 a19, v19
    v_perm_b32 v20, v38, v34, s37
    v_perm_b32 v21, v46, v42, s37
    v_perm_b32 v22, v54, v50, s37
    v_perm_b32 v23, v62, v58, s37
    v_accvgpr_write_b32 a20, v20
    v_accvgpr_write_b32 a21, v21
    v_accvgpr_write_b32 a22, v22
    v_accvgpr_write_b32 a23, v23
    s_mov_b32 s35, 147456
    buffer_load_dwordx3 v[224:226], v13, s[16:19], s35 offen offset:0
    buffer_load_dwordx3 v[228:230], v13, s[16:19], s35 offen offset:768
    buffer_load_dwordx3 v[232:234], v13, s[16:19], s35 offen offset:1536
    buffer_load_dwordx3 v[236:238], v13, s[16:19], s35 offen offset:2304
    buffer_load_dwordx3 v[240:242], v14, s[16:19], s35 offen offset:0
    buffer_load_dwordx3 v[244:246], v14, s[16:19], s35 offen offset:768
    buffer_load_dwordx3 v[248:250], v14, s[16:19], s35 offen offset:1536
    buffer_load_dwordx3 v[252:254], v14, s[16:19], s35 offen offset:2304
    s_mov_b32 m0, s32
    s_nop 0
    buffer_load_dwordx4 v5, s[12:15], s30 offen offset:0 lds
    buffer_load_dwordx4 v6, s[12:15], s30 offen offset:1024 lds
    buffer_load_dwordx4 v7, s[12:15], s30 offen offset:2048 lds
    s_add_u32 s30, s30, 3145728
    s_add_u32 s32, s32, 12288
    s_waitcnt vmcnt(49)
    v_perm_b32 v16, v68, v64, s36
    v_perm_b32 v17, v76, v72, s36
    v_perm_b32 v18, v84, v80, s36
    v_perm_b32 v19, v92, v88, s36
    v_accvgpr_write_b32 a24, v16
    v_accvgpr_write_b32 a25, v17
    v_accvgpr_write_b32 a26, v18
    v_accvgpr_write_b32 a27, v19
    v_perm_b32 v20, v68, v64, s37
    v_perm_b32 v21, v76, v72, s37
    v_perm_b32 v22, v84, v80, s37
    v_perm_b32 v23, v92, v88, s37
    v_accvgpr_write_b32 a28, v20
    v_accvgpr_write_b32 a29, v21
    v_accvgpr_write_b32 a30, v22
    v_accvgpr_write_b32 a31, v23
    v_perm_b32 v16, v69, v65, s36
    v_perm_b32 v17, v77, v73, s36
    v_perm_b32 v18, v85, v81, s36
    v_perm_b32 v19, v93, v89, s36
    v_accvgpr_write_b32 a32, v16
    v_accvgpr_write_b32 a33, v17
    v_accvgpr_write_b32 a34, v18
    v_accvgpr_write_b32 a35, v19
    v_perm_b32 v20, v69, v65, s37
    v_perm_b32 v21, v77, v73, s37
    v_perm_b32 v22, v85, v81, s37
    v_perm_b32 v23, v93, v89, s37
    v_accvgpr_write_b32 a36, v20
    v_accvgpr_write_b32 a37, v21
    v_accvgpr_write_b32 a38, v22
    v_accvgpr_write_b32 a39, v23
    v_perm_b32 v16, v70, v66, s36
    v_perm_b32 v17, v78, v74, s36
    v_perm_b32 v18, v86, v82, s36
    v_perm_b32 v19, v94, v90, s36
    v_accvgpr_write_b32 a40, v16
    v_accvgpr_write_b32 a41, v17
    v_accvgpr_write_b32 a42, v18
    v_accvgpr_write_b32 a43, v19
    v_perm_b32 v20, v70, v66, s37
    v_perm_b32 v21, v78, v74, s37
    v_perm_b32 v22, v86, v82, s37
    v_perm_b32 v23, v94, v90, s37
    v_accvgpr_write_b32 a44, v20
    v_accvgpr_write_b32 a45, v21
    v_accvgpr_write_b32 a46, v22
    v_accvgpr_write_b32 a47, v23
    s_mov_b32 s35, 172032
    buffer_load_dwordx3 v[32:34], v13, s[16:19], s35 offen offset:0
    buffer_load_dwordx3 v[36:38], v13, s[16:19], s35 offen offset:768
    buffer_load_dwordx3 v[40:42], v13, s[16:19], s35 offen offset:1536
    buffer_load_dwordx3 v[44:46], v13, s[16:19], s35 offen offset:2304
    buffer_load_dwordx3 v[48:50], v14, s[16:19], s35 offen offset:0
    buffer_load_dwordx3 v[52:54], v14, s[16:19], s35 offen offset:768
    buffer_load_dwordx3 v[56:58], v14, s[16:19], s35 offen offset:1536
    buffer_load_dwordx3 v[60:62], v14, s[16:19], s35 offen offset:2304
    s_waitcnt vmcnt(49)
    v_perm_b32 v16, v100, v96, s36
    v_perm_b32 v17, v108, v104, s36
    v_perm_b32 v18, v116, v112, s36
    v_perm_b32 v19, v124, v120, s36
    v_accvgpr_write_b32 a48, v16
    v_accvgpr_write_b32 a49, v17
    v_accvgpr_write_b32 a50, v18
    v_accvgpr_write_b32 a51, v19
    v_perm_b32 v20, v100, v96, s37
    v_perm_b32 v21, v108, v104, s37
    v_perm_b32 v22, v116, v112, s37
    v_perm_b32 v23, v124, v120, s37
    v_accvgpr_write_b32 a52, v20
    v_accvgpr_write_b32 a53, v21
    v_accvgpr_write_b32 a54, v22
    v_accvgpr_write_b32 a55, v23
    v_perm_b32 v16, v101, v97, s36
    v_perm_b32 v17, v109, v105, s36
    v_perm_b32 v18, v117, v113, s36
    v_perm_b32 v19, v125, v121, s36
    v_accvgpr_write_b32 a56, v16
    v_accvgpr_write_b32 a57, v17
    v_accvgpr_write_b32 a58, v18
    v_accvgpr_write_b32 a59, v19
    v_perm_b32 v20, v101, v97, s37
    v_perm_b32 v21, v109, v105, s37
    v_perm_b32 v22, v117, v113, s37
    v_perm_b32 v23, v125, v121, s37
    v_accvgpr_write_b32 a60, v20
    v_accvgpr_write_b32 a61, v21
    v_accvgpr_write_b32 a62, v22
    v_accvgpr_write_b32 a63, v23
    v_perm_b32 v16, v102, v98, s36
    v_perm_b32 v17, v110, v106, s36
    v_perm_b32 v18, v118, v114, s36
    v_perm_b32 v19, v126, v122, s36
    v_accvgpr_write_b32 a64, v16
    v_accvgpr_write_b32 a65, v17
    v_accvgpr_write_b32 a66, v18
    v_accvgpr_write_b32 a67, v19
    v_perm_b32 v20, v102, v98, s37
    v_perm_b32 v21, v110, v106, s37
    v_perm_b32 v22, v118, v114, s37
    v_perm_b32 v23, v126, v122, s37
    v_accvgpr_write_b32 a68, v20
    v_accvgpr_write_b32 a69, v21
    v_accvgpr_write_b32 a70, v22
    v_accvgpr_write_b32 a71, v23
    s_mov_b32 s35, 196608
    buffer_load_dwordx3 v[64:66], v13, s[16:19], s35 offen offset:0
    buffer_load_dwordx3 v[68:70], v13, s[16:19], s35 offen offset:768
    buffer_load_dwordx3 v[72:74], v13, s[16:19], s35 offen offset:1536
    buffer_load_dwordx3 v[76:78], v13, s[16:19], s35 offen offset:2304
    buffer_load_dwordx3 v[80:82], v14, s[16:19], s35 offen offset:0
    buffer_load_dwordx3 v[84:86], v14, s[16:19], s35 offen offset:768
    buffer_load_dwordx3 v[88:90], v14, s[16:19], s35 offen offset:1536
    buffer_load_dwordx3 v[92:94], v14, s[16:19], s35 offen offset:2304
    s_mov_b32 m0, s32
    s_nop 0
    buffer_load_dwordx4 v5, s[12:15], s30 offen offset:0 lds
    buffer_load_dwordx4 v6, s[12:15], s30 offen offset:1024 lds
    buffer_load_dwordx4 v7, s[12:15], s30 offen offset:2048 lds
    s_add_u32 s30, s30, 3145728
    s_add_u32 s32, s32, 12288
    s_waitcnt vmcnt(49)
    v_perm_b32 v16, v132, v128, s36
    v_perm_b32 v17, v140, v136, s36
    v_perm_b32 v18, v148, v144, s36
    v_perm_b32 v19, v156, v152, s36
    v_accvgpr_write_b32 a72, v16
    v_accvgpr_write_b32 a73, v17
    v_accvgpr_write_b32 a74, v18
    v_accvgpr_write_b32 a75, v19
    v_perm_b32 v20, v132, v128, s37
    v_perm_b32 v21, v140, v136, s37
    v_perm_b32 v22, v148, v144, s37
    v_perm_b32 v23, v156, v152, s37
    v_accvgpr_write_b32 a76, v20
    v_accvgpr_write_b32 a77, v21
    v_accvgpr_write_b32 a78, v22
    v_accvgpr_write_b32 a79, v23
    v_perm_b32 v16, v133, v129, s36
    v_perm_b32 v17, v141, v137, s36
    v_perm_b32 v18, v149, v145, s36
    v_perm_b32 v19, v157, v153, s36
    v_accvgpr_write_b32 a80, v16
    v_accvgpr_write_b32 a81, v17
    v_accvgpr_write_b32 a82, v18
    v_accvgpr_write_b32 a83, v19
    v_perm_b32 v20, v133, v129, s37
    v_perm_b32 v21, v141, v137, s37
    v_perm_b32 v22, v149, v145, s37
    v_perm_b32 v23, v157, v153, s37
    v_accvgpr_write_b32 a84, v20
    v_accvgpr_write_b32 a85, v21
    v_accvgpr_write_b32 a86, v22
    v_accvgpr_write_b32 a87, v23
    v_perm_b32 v16, v134, v130, s36
    v_perm_b32 v17, v142, v138, s36
    v_perm_b32 v18, v150, v146, s36
    v_perm_b32 v19, v158, v154, s36
    v_accvgpr_write_b32 a88, v16
    v_accvgpr_write_b32 a89, v17
    v_accvgpr_write_b32 a90, v18
    v_accvgpr_write_b32 a91, v19
    v_perm_b32 v20, v134, v130, s37
    v_perm_b32 v21, v142, v138, s37
    v_perm_b32 v22, v150, v146, s37
    v_perm_b32 v23, v158, v154, s37
    v_accvgpr_write_b32 a92, v20
    v_accvgpr_write_b32 a93, v21
    v_accvgpr_write_b32 a94, v22
    v_accvgpr_write_b32 a95, v23
    s_mov_b32 s35, 221184
    buffer_load_dwordx3 v[96:98], v13, s[16:19], s35 offen offset:0
    buffer_load_dwordx3 v[100:102], v13, s[16:19], s35 offen offset:768
    buffer_load_dwordx3 v[104:106], v13, s[16:19], s35 offen offset:1536
    buffer_load_dwordx3 v[108:110], v13, s[16:19], s35 offen offset:2304
    buffer_load_dwordx3 v[112:114], v14, s[16:19], s35 offen offset:0
    buffer_load_dwordx3 v[116:118], v14, s[16:19], s35 offen offset:768
    buffer_load_dwordx3 v[120:122], v14, s[16:19], s35 offen offset:1536
    buffer_load_dwordx3 v[124:126], v14, s[16:19], s35 offen offset:2304
    s_waitcnt vmcnt(49)
    v_perm_b32 v16, v164, v160, s36
    v_perm_b32 v17, v172, v168, s36
    v_perm_b32 v18, v180, v176, s36
    v_perm_b32 v19, v188, v184, s36
    v_accvgpr_write_b32 a96, v16
    v_accvgpr_write_b32 a97, v17
    v_accvgpr_write_b32 a98, v18
    v_accvgpr_write_b32 a99, v19
    v_perm_b32 v20, v164, v160, s37
    v_perm_b32 v21, v172, v168, s37
    v_perm_b32 v22, v180, v176, s37
    v_perm_b32 v23, v188, v184, s37
    v_accvgpr_write_b32 a100, v20
    v_accvgpr_write_b32 a101, v21
    v_accvgpr_write_b32 a102, v22
    v_accvgpr_write_b32 a103, v23
    v_perm_b32 v16, v165, v161, s36
    v_perm_b32 v17, v173, v169, s36
    v_perm_b32 v18, v181, v177, s36
    v_perm_b32 v19, v189, v185, s36
    v_accvgpr_write_b32 a104, v16
    v_accvgpr_write_b32 a105, v17
    v_accvgpr_write_b32 a106, v18
    v_accvgpr_write_b32 a107, v19
    v_perm_b32 v20, v165, v161, s37
    v_perm_b32 v21, v173, v169, s37
    v_perm_b32 v22, v181, v177, s37
    v_perm_b32 v23, v189, v185, s37
    v_accvgpr_write_b32 a108, v20
    v_accvgpr_write_b32 a109, v21
    v_accvgpr_write_b32 a110, v22
    v_accvgpr_write_b32 a111, v23
    v_perm_b32 v16, v166, v162, s36
    v_perm_b32 v17, v174, v170, s36
    v_perm_b32 v18, v182, v178, s36
    v_perm_b32 v19, v190, v186, s36
    v_accvgpr_write_b32 a112, v16
    v_accvgpr_write_b32 a113, v17
    v_accvgpr_write_b32 a114, v18
    v_accvgpr_write_b32 a115, v19
    v_perm_b32 v20, v166, v162, s37
    v_perm_b32 v21, v174, v170, s37
    v_perm_b32 v22, v182, v178, s37
    v_perm_b32 v23, v190, v186, s37
    v_accvgpr_write_b32 a116, v20
    v_accvgpr_write_b32 a117, v21
    v_accvgpr_write_b32 a118, v22
    v_accvgpr_write_b32 a119, v23
    s_mov_b32 s35, 245760
    buffer_load_dwordx3 v[128:130], v13, s[16:19], s35 offen offset:0
    buffer_load_dwordx3 v[132:134], v13, s[16:19], s35 offen offset:768
    buffer_load_dwordx3 v[136:138], v13, s[16:19], s35 offen offset:1536
    buffer_load_dwordx3 v[140:142], v13, s[16:19], s35 offen offset:2304
    buffer_load_dwordx3 v[144:146], v14, s[16:19], s35 offen offset:0
    buffer_load_dwordx3 v[148:150], v14, s[16:19], s35 offen offset:768
    buffer_load_dwordx3 v[152:154], v14, s[16:19], s35 offen offset:1536
    buffer_load_dwordx3 v[156:158], v14, s[16:19], s35 offen offset:2304
    s_waitcnt vmcnt(46)
    v_perm_b32 v16, v196, v192, s36
    v_perm_b32 v17, v204, v200, s36
    v_perm_b32 v18, v212, v208, s36
    v_perm_b32 v19, v220, v216, s36
    v_accvgpr_write_b32 a120, v16
    v_accvgpr_write_b32 a121, v17
    v_accvgpr_write_b32 a122, v18
    v_accvgpr_write_b32 a123, v19
    v_perm_b32 v20, v196, v192, s37
    v_perm_b32 v21, v204, v200, s37
    v_perm_b32 v22, v212, v208, s37
    v_perm_b32 v23, v220, v216, s37
    v_accvgpr_write_b32 a124, v20
    v_accvgpr_write_b32 a125, v21
    v_accvgpr_write_b32 a126, v22
    v_accvgpr_write_b32 a127, v23
    v_perm_b32 v16, v197, v193, s36
    v_perm_b32 v17, v205, v201, s36
    v_perm_b32 v18, v213, v209, s36
    v_perm_b32 v19, v221, v217, s36
    v_accvgpr_write_b32 a128, v16
    v_accvgpr_write_b32 a129, v17
    v_accvgpr_write_b32 a130, v18
    v_accvgpr_write_b32 a131, v19
    v_perm_b32 v20, v197, v193, s37
    v_perm_b32 v21, v205, v201, s37
    v_perm_b32 v22, v213, v209, s37
    v_perm_b32 v23, v221, v217, s37
    v_accvgpr_write_b32 a132, v20
    v_accvgpr_write_b32 a133, v21
    v_accvgpr_write_b32 a134, v22
    v_accvgpr_write_b32 a135, v23
    v_perm_b32 v16, v198, v194, s36
    v_perm_b32 v17, v206, v202, s36
    v_perm_b32 v18, v214, v210, s36
    v_perm_b32 v19, v222, v218, s36
    v_accvgpr_write_b32 a136, v16
    v_accvgpr_write_b32 a137, v17
    v_accvgpr_write_b32 a138, v18
    v_accvgpr_write_b32 a139, v19
    v_perm_b32 v20, v198, v194, s37
    v_perm_b32 v21, v206, v202, s37
    v_perm_b32 v22, v214, v210, s37
    v_perm_b32 v23, v222, v218, s37
    v_accvgpr_write_b32 a140, v20
    v_accvgpr_write_b32 a141, v21
    v_accvgpr_write_b32 a142, v22
    v_accvgpr_write_b32 a143, v23
    s_mov_b32 s35, 270336
    buffer_load_dwordx3 v[160:162], v13, s[16:19], s35 offen offset:0
    buffer_load_dwordx3 v[164:166], v13, s[16:19], s35 offen offset:768
    buffer_load_dwordx3 v[168:170], v13, s[16:19], s35 offen offset:1536
    buffer_load_dwordx3 v[172:174], v13, s[16:19], s35 offen offset:2304
    buffer_load_dwordx3 v[176:178], v14, s[16:19], s35 offen offset:0
    buffer_load_dwordx3 v[180:182], v14, s[16:19], s35 offen offset:768
    buffer_load_dwordx3 v[184:186], v14, s[16:19], s35 offen offset:1536
    buffer_load_dwordx3 v[188:190], v14, s[16:19], s35 offen offset:2304
    s_mov_b32 m0, s32
    s_nop 0
    buffer_load_dwordx4 v5, s[12:15], s30 offen offset:0 lds
    buffer_load_dwordx4 v6, s[12:15], s30 offen offset:1024 lds
    buffer_load_dwordx4 v7, s[12:15], s30 offen offset:2048 lds
    s_add_u32 s30, s30, 3145728
    s_add_u32 s32, s32, 12288
    buffer_store_dwordx4 a[192:195], v12, s[24:27], 0 offen offset:0
    buffer_store_dwordx4 a[196:199], v12, s[24:27], 0 offen offset:1024
    buffer_store_dwordx4 a[200:203], v12, s[24:27], 0 offen offset:2048
    s_waitcnt vmcnt(52)
    v_perm_b32 v192, v228, v224, s36
    v_perm_b32 v193, v236, v232, s36
    v_perm_b32 v194, v244, v240, s36
    v_perm_b32 v195, v252, v248, s36
    v_perm_b32 v196, v228, v224, s37
    v_perm_b32 v197, v236, v232, s37
    v_perm_b32 v198, v244, v240, s37
    v_perm_b32 v199, v252, v248, s37
    v_perm_b32 v200, v229, v225, s36
    v_perm_b32 v201, v237, v233, s36
    v_perm_b32 v202, v245, v241, s36
    v_perm_b32 v203, v253, v249, s36
    v_perm_b32 v204, v229, v225, s37
    v_perm_b32 v205, v237, v233, s37
    v_perm_b32 v206, v245, v241, s37
    v_perm_b32 v207, v253, v249, s37
    v_perm_b32 v208, v230, v226, s36
    v_perm_b32 v209, v238, v234, s36
    v_perm_b32 v210, v246, v242, s36
    v_perm_b32 v211, v254, v250, s36
    v_perm_b32 v212, v230, v226, s37
    v_perm_b32 v213, v238, v234, s37
    v_perm_b32 v214, v246, v242, s37
    v_perm_b32 v215, v254, v250, s37
    s_mov_b32 m0, s32
    s_nop 0
    buffer_load_dwordx4 v5, s[12:15], s30 offen offset:0 lds
    buffer_load_dwordx4 v6, s[12:15], s30 offen offset:1024 lds
    buffer_load_dwordx4 v7, s[12:15], s30 offen offset:2048 lds
    s_add_u32 s30, s30, 3145728
    s_add_u32 s32, s32, 12288
    buffer_store_dwordx4 a[192:195], v12, s[24:27], 0 offen offset:0
    buffer_store_dwordx4 a[196:199], v12, s[24:27], 0 offen offset:1024
    buffer_store_dwordx4 a[200:203], v12, s[24:27], 0 offen offset:2048
    s_waitcnt vmcnt(47)
    v_perm_b32 v224, v36, v32, s36
    v_perm_b32 v225, v44, v40, s36
    v_perm_b32 v226, v52, v48, s36
    v_perm_b32 v227, v60, v56, s36
    v_perm_b32 v228, v36, v32, s37
    v_perm_b32 v229, v44, v40, s37
    v_perm_b32 v230, v52, v48, s37
    v_perm_b32 v231, v60, v56, s37
    v_perm_b32 v232, v37, v33, s36
    v_perm_b32 v233, v45, v41, s36
    v_perm_b32 v234, v53, v49, s36
    v_perm_b32 v235, v61, v57, s36
    v_perm_b32 v236, v37, v33, s37
    v_perm_b32 v237, v45, v41, s37
    v_perm_b32 v238, v53, v49, s37
    v_perm_b32 v239, v61, v57, s37
    v_perm_b32 v240, v38, v34, s36
    v_perm_b32 v241, v46, v42, s36
    v_perm_b32 v242, v54, v50, s36
    v_perm_b32 v243, v62, v58, s36
    v_perm_b32 v244, v38, v34, s37
    v_perm_b32 v245, v46, v42, s37
    v_perm_b32 v246, v54, v50, s37
    v_perm_b32 v247, v62, v58, s37
    s_mov_b32 m0, s32
    s_nop 0
    buffer_load_dwordx4 v5, s[12:15], s30 offen offset:0 lds
    buffer_load_dwordx4 v6, s[12:15], s30 offen offset:1024 lds
    buffer_load_dwordx4 v7, s[12:15], s30 offen offset:2048 lds
    s_add_u32 s30, s30, 3145728
    s_add_u32 s32, s32, 12288
    buffer_store_dwordx4 a[192:195], v12, s[24:27], 0 offen offset:0
    buffer_store_dwordx4 a[196:199], v12, s[24:27], 0 offen offset:1024
    buffer_store_dwordx4 a[200:203], v12, s[24:27], 0 offen offset:2048
    s_mov_b32 m0, s32
    s_nop 0
    buffer_load_dwordx4 v5, s[12:15], s30 offen offset:0 lds
    buffer_load_dwordx4 v6, s[12:15], s30 offen offset:1024 lds
    buffer_load_dwordx4 v7, s[12:15], s30 offen offset:2048 lds
    s_add_u32 s30, s30, 3145728
    s_add_u32 s32, s32, 12288
    buffer_store_dwordx4 a[192:195], v12, s[24:27], 0 offen offset:0
    buffer_store_dwordx4 a[196:199], v12, s[24:27], 0 offen offset:1024
    buffer_store_dwordx4 a[200:203], v12, s[24:27], 0 offen offset:2048
    s_waitcnt vmcnt(51)
    v_perm_b32 v32, v68, v64, s36
    v_perm_b32 v33, v76, v72, s36
    v_perm_b32 v34, v84, v80, s36
    v_perm_b32 v35, v92, v88, s36
    v_perm_b32 v36, v68, v64, s37
    v_perm_b32 v37, v76, v72, s37
    v_perm_b32 v38, v84, v80, s37
    v_perm_b32 v39, v92, v88, s37
    v_perm_b32 v40, v69, v65, s36
    v_perm_b32 v41, v77, v73, s36
    v_perm_b32 v42, v85, v81, s36
    v_perm_b32 v43, v93, v89, s36
    v_perm_b32 v44, v69, v65, s37
    v_perm_b32 v45, v77, v73, s37
    v_perm_b32 v46, v85, v81, s37
    v_perm_b32 v47, v93, v89, s37
    v_perm_b32 v48, v70, v66, s36
    v_perm_b32 v49, v78, v74, s36
    v_perm_b32 v50, v86, v82, s36
    v_perm_b32 v51, v94, v90, s36
    v_perm_b32 v52, v70, v66, s37
    v_perm_b32 v53, v78, v74, s37
    v_perm_b32 v54, v86, v82, s37
    v_perm_b32 v55, v94, v90, s37
    s_mov_b32 m0, s32
    s_nop 0
    buffer_load_dwordx4 v5, s[12:15], s30 offen offset:0 lds
    buffer_load_dwordx4 v6, s[12:15], s30 offen offset:1024 lds
    buffer_load_dwordx4 v7, s[12:15], s30 offen offset:2048 lds
    s_add_u32 s30, s30, 3145728
    s_add_u32 s32, s32, 12288
    buffer_store_dwordx4 a[192:195], v12, s[24:27], 0 offen offset:0
    buffer_store_dwordx4 a[196:199], v12, s[24:27], 0 offen offset:1024
    buffer_store_dwordx4 a[200:203], v12, s[24:27], 0 offen offset:2048
    s_waitcnt vmcnt(46)
    v_perm_b32 v64, v100, v96, s36
    v_perm_b32 v65, v108, v104, s36
    v_perm_b32 v66, v116, v112, s36
    v_perm_b32 v67, v124, v120, s36
    v_perm_b32 v68, v100, v96, s37
    v_perm_b32 v69, v108, v104, s37
    v_perm_b32 v70, v116, v112, s37
    v_perm_b32 v71, v124, v120, s37
    v_perm_b32 v72, v101, v97, s36
    v_perm_b32 v73, v109, v105, s36
    v_perm_b32 v74, v117, v113, s36
    v_perm_b32 v75, v125, v121, s36
    v_perm_b32 v76, v101, v97, s37
    v_perm_b32 v77, v109, v105, s37
    v_perm_b32 v78, v117, v113, s37
    v_perm_b32 v79, v125, v121, s37
    v_perm_b32 v80, v102, v98, s36
    v_perm_b32 v81, v110, v106, s36
    v_perm_b32 v82, v118, v114, s36
    v_perm_b32 v83, v126, v122, s36
    v_perm_b32 v84, v102, v98, s37
    v_perm_b32 v85, v110, v106, s37
    v_perm_b32 v86, v118, v114, s37
    v_perm_b32 v87, v126, v122, s37
    s_waitcnt vmcnt(38)
    v_perm_b32 v96, v132, v128, s36
    v_perm_b32 v97, v140, v136, s36
    v_perm_b32 v98, v148, v144, s36
    v_perm_b32 v99, v156, v152, s36
    v_perm_b32 v100, v132, v128, s37
    v_perm_b32 v101, v140, v136, s37
    v_perm_b32 v102, v148, v144, s37
    v_perm_b32 v103, v156, v152, s37
    v_perm_b32 v104, v133, v129, s36
    v_perm_b32 v105, v141, v137, s36
    v_perm_b32 v106, v149, v145, s36
    v_perm_b32 v107, v157, v153, s36
    v_perm_b32 v108, v133, v129, s37
    v_perm_b32 v109, v141, v137, s37
    v_perm_b32 v110, v149, v145, s37
    v_perm_b32 v111, v157, v153, s37
    v_perm_b32 v112, v134, v130, s36
    v_perm_b32 v113, v142, v138, s36
    v_perm_b32 v114, v150, v146, s36
    v_perm_b32 v115, v158, v154, s36
    v_perm_b32 v116, v134, v130, s37
    v_perm_b32 v117, v142, v138, s37
    v_perm_b32 v118, v150, v146, s37
    v_perm_b32 v119, v158, v154, s37
    s_waitcnt vmcnt(30)
    v_perm_b32 v128, v164, v160, s36
    v_perm_b32 v129, v172, v168, s36
    v_perm_b32 v130, v180, v176, s36
    v_perm_b32 v131, v188, v184, s36
    v_perm_b32 v132, v164, v160, s37
    v_perm_b32 v133, v172, v168, s37
    v_perm_b32 v134, v180, v176, s37
    v_perm_b32 v135, v188, v184, s37
    v_perm_b32 v136, v165, v161, s36
    v_perm_b32 v137, v173, v169, s36
    v_perm_b32 v138, v181, v177, s36
    v_perm_b32 v139, v189, v185, s36
    v_perm_b32 v140, v165, v161, s37
    v_perm_b32 v141, v173, v169, s37
    v_perm_b32 v142, v181, v177, s37
    v_perm_b32 v143, v189, v185, s37
    v_perm_b32 v144, v166, v162, s36
    v_perm_b32 v145, v174, v170, s36
    v_perm_b32 v146, v182, v178, s36
    v_perm_b32 v147, v190, v186, s36
    v_perm_b32 v148, v166, v162, s37
    v_perm_b32 v149, v174, v170, s37
    v_perm_b32 v150, v182, v178, s37
    v_perm_b32 v151, v190, v186, s37
    v_accvgpr_read_b32 v16, a144
    v_accvgpr_read_b32 v17, a145
    v_accvgpr_read_b32 v18, a146
    v_accvgpr_read_b32 v19, a147
    v_accvgpr_read_b32 v20, a148
    v_accvgpr_read_b32 v21, a149
    v_accvgpr_read_b32 v22, a150
    v_accvgpr_read_b32 v23, a151
    v_accvgpr_read_b32 v24, a152
    v_accvgpr_read_b32 v25, a153
    v_accvgpr_read_b32 v26, a154
    v_accvgpr_read_b32 v27, a155
    v_lshlrev_b32 v160, 16, v16
    v_and_b32 v164, 0xffff0000, v16
    v_lshlrev_b32 v168, 16, v17
    v_and_b32 v172, 0xffff0000, v17
    v_lshlrev_b32 v176, 16, v18
    v_and_b32 v180, 0xffff0000, v18
    v_lshlrev_b32 v161, 16, v19
    v_and_b32 v165, 0xffff0000, v19
    v_lshlrev_b32 v169, 16, v20
    v_and_b32 v173, 0xffff0000, v20
    v_lshlrev_b32 v177, 16, v21
    v_and_b32 v181, 0xffff0000, v21
    v_lshlrev_b32 v162, 16, v22
    v_and_b32 v166, 0xffff0000, v22
    v_lshlrev_b32 v170, 16, v23
    v_and_b32 v174, 0xffff0000, v23
    v_lshlrev_b32 v178, 16, v24
    v_and_b32 v182, 0xffff0000, v24
    v_lshlrev_b32 v163, 16, v25
    v_and_b32 v167, 0xffff0000, v25
    v_lshlrev_b32 v171, 16, v26
    v_and_b32 v175, 0xffff0000, v26
    v_lshlrev_b32 v179, 16, v27
    v_and_b32 v183, 0xffff0000, v27
    s_mov_b32 s41, 10
.p2align 6
L_loop:
    s_waitcnt vmcnt(57) lgkmcnt(0)
    s_barrier
    ds_read_b128 a[144:147], v1 offset:0
    ds_read_b128 a[148:151], v2 offset:0
    ds_read_b128 a[152:155], v3 offset:0
    ds_read_b128 a[192:195], v9
    ds_read_b128 a[196:199], v10
    ds_read_b128 a[200:203], v11
    s_cmp_lt_u32 s29, 26
    s_cselect_b32 s14, s40, 0
    s_mov_b32 m0, s32
    s_nop 0
    buffer_load_dwordx4 v5, s[12:15], s30 offen offset:0 lds
    buffer_load_dwordx4 v6, s[12:15], s30 offen offset:1024 lds
    buffer_load_dwordx4 v7, s[12:15], s30 offen offset:2048 lds
    s_waitcnt lgkmcnt(5)
    v_mfma_f32_16x16x32_bf16 v[216:219], a[0:3], a[144:147], v[160:163]
    ds_read_b128 a[156:159], v4 offset:0
    v_mfma_f32_16x16x32_bf16 v[220:223], a[4:7], a[144:147], v[164:167]
    v_mfma_f32_16x16x32_bf16 v[248:251], a[8:11], a[144:147], v[168:171]
    s_add_u32 s30, s30, 3145728
    v_mfma_f32_16x16x32_bf16 v[252:255], a[12:15], a[144:147], v[172:175]
    v_mfma_f32_16x16x32_bf16 v[56:59], a[16:19], a[144:147], v[176:179]
    v_mfma_f32_16x16x32_bf16 v[60:63], a[20:23], a[144:147], v[180:183]
    s_waitcnt lgkmcnt(5)
    v_mfma_f32_16x16x32_bf16 v[216:219], a[24:27], a[148:151], v[216:219]
    ds_read_b128 a[160:163], v1 offset:256
    v_mfma_f32_16x16x32_bf16 v[220:223], a[28:31], a[148:151], v[220:223]
    v_mfma_f32_16x16x32_bf16 v[248:251], a[32:35], a[148:151], v[248:251]
    s_add_u32 s41, s41, 1
    v_mfma_f32_16x16x32_bf16 v[252:255], a[36:39], a[148:151], v[252:255]
    v_mfma_f32_16x16x32_bf16 v[56:59], a[40:43], a[148:151], v[56:59]
    v_mfma_f32_16x16x32_bf16 v[60:63], a[44:47], a[148:151], v[60:63]
    s_waitcnt lgkmcnt(5)
    v_mfma_f32_16x16x32_bf16 v[216:219], a[48:51], a[152:155], v[216:219]
    ds_read_b128 a[164:167], v2 offset:256
    v_mfma_f32_16x16x32_bf16 v[220:223], a[52:55], a[152:155], v[220:223]
    v_mfma_f32_16x16x32_bf16 v[248:251], a[56:59], a[152:155], v[248:251]
    s_add_u32 s32, s32, 12288
    v_mfma_f32_16x16x32_bf16 v[252:255], a[60:63], a[152:155], v[252:255]
    s_waitcnt lgkmcnt(3)
    buffer_store_dwordx4 a[192:195], v12, s[24:27], s31 offen offset:0
    buffer_store_dwordx4 a[196:199], v12, s[24:27], s31 offen offset:1024
    buffer_store_dwordx4 a[200:203], v12, s[24:27], s31 offen offset:2048
    v_mfma_f32_16x16x32_bf16 v[56:59], a[64:67], a[152:155], v[56:59]
    v_mfma_f32_16x16x32_bf16 v[60:63], a[68:71], a[152:155], v[60:63]
    s_waitcnt lgkmcnt(2)
    v_mfma_f32_16x16x32_bf16 v[216:219], a[72:75], a[156:159], v[216:219]
    ds_read_b128 a[168:171], v3 offset:256
    v_mfma_f32_16x16x32_bf16 v[220:223], a[76:79], a[156:159], v[220:223]
    v_mfma_f32_16x16x32_bf16 v[248:251], a[80:83], a[156:159], v[248:251]
    s_cmp_eq_u32 s41, 11
    s_cselect_b32 s39, 135168, 0
    s_cselect_b32 s41, 0, s41
    s_sub_u32 s32, s32, s39
    v_mfma_f32_16x16x32_bf16 v[252:255], a[84:87], a[156:159], v[252:255]
    v_mfma_f32_16x16x32_bf16 v[56:59], a[88:91], a[156:159], v[56:59]
    v_mfma_f32_16x16x32_bf16 v[60:63], a[92:95], a[156:159], v[60:63]
    s_waitcnt lgkmcnt(2)
    v_mfma_f32_16x16x32_bf16 v[216:219], a[96:99], a[160:163], v[216:219]
    ds_read_b128 a[172:175], v4 offset:256
    v_mfma_f32_16x16x32_bf16 v[220:223], a[100:103], a[160:163], v[220:223]
    v_mfma_f32_16x16x32_bf16 v[248:251], a[104:107], a[160:163], v[248:251]
    s_add_u32 s38, s38, 1
    v_mfma_f32_16x16x32_bf16 v[252:255], a[108:111], a[160:163], v[252:255]
    v_subrev_u32 v9, s34, v9
    v_mfma_f32_16x16x32_bf16 v[56:59], a[112:115], a[160:163], v[56:59]
    v_subrev_u32 v10, s34, v10
    v_mfma_f32_16x16x32_bf16 v[60:63], a[116:119], a[160:163], v[60:63]
    v_subrev_u32 v11, s34, v11
    s_waitcnt lgkmcnt(2)
    v_mfma_f32_16x16x32_bf16 v[216:219], a[120:123], a[164:167], v[216:219]
    ds_read_b128 a[176:179], v1 offset:512
    v_mfma_f32_16x16x32_bf16 v[220:223], a[124:127], a[164:167], v[220:223]
    v_mfma_f32_16x16x32_bf16 v[248:251], a[128:131], a[164:167], v[248:251]
    s_cmp_eq_u32 s38, 11
    s_cselect_b32 s33, s42, 12288
    s_cselect_b32 s38, 0, s38
    v_mfma_f32_16x16x32_bf16 v[252:255], a[132:135], a[164:167], v[252:255]
    v_mfma_f32_16x16x32_bf16 v[56:59], a[136:139], a[164:167], v[56:59]
    v_mfma_f32_16x16x32_bf16 v[60:63], a[140:143], a[164:167], v[60:63]
    s_waitcnt lgkmcnt(2)
    v_mfma_f32_16x16x32_bf16 v[216:219], v[192:195], a[168:171], v[216:219]
    ds_read_b128 a[180:183], v2 offset:512
    v_mfma_f32_16x16x32_bf16 v[220:223], v[196:199], a[168:171], v[220:223]
    v_mfma_f32_16x16x32_bf16 v[248:251], v[200:203], a[168:171], v[248:251]
    v_mfma_f32_16x16x32_bf16 v[252:255], v[204:207], a[168:171], v[252:255]
    v_mfma_f32_16x16x32_bf16 v[56:59], v[208:211], a[168:171], v[56:59]
    v_mfma_f32_16x16x32_bf16 v[60:63], v[212:215], a[168:171], v[60:63]
    s_waitcnt lgkmcnt(2)
    v_mfma_f32_16x16x32_bf16 v[216:219], v[224:227], a[172:175], v[216:219]
    ds_read_b128 a[184:187], v3 offset:512
    v_mfma_f32_16x16x32_bf16 v[220:223], v[228:231], a[172:175], v[220:223]
    v_mfma_f32_16x16x32_bf16 v[248:251], v[232:235], a[172:175], v[248:251]
    v_mfma_f32_16x16x32_bf16 v[252:255], v[236:239], a[172:175], v[252:255]
    v_mfma_f32_16x16x32_bf16 v[56:59], v[240:243], a[172:175], v[56:59]
    v_mfma_f32_16x16x32_bf16 v[60:63], v[244:247], a[172:175], v[60:63]
    s_waitcnt lgkmcnt(2)
    v_mfma_f32_16x16x32_bf16 v[216:219], v[32:35], a[176:179], v[216:219]
    ds_read_b128 a[188:191], v4 offset:512
    v_mfma_f32_16x16x32_bf16 v[220:223], v[36:39], a[176:179], v[220:223]
    v_mfma_f32_16x16x32_bf16 v[248:251], v[40:43], a[176:179], v[248:251]
    v_mfma_f32_16x16x32_bf16 v[252:255], v[44:47], a[176:179], v[252:255]
    v_mfma_f32_16x16x32_bf16 v[56:59], v[48:51], a[176:179], v[56:59]
    v_mfma_f32_16x16x32_bf16 v[60:63], v[52:55], a[176:179], v[60:63]
    s_waitcnt lgkmcnt(2)
    v_mfma_f32_16x16x32_bf16 v[216:219], v[64:67], a[180:183], v[216:219]
    v_mfma_f32_16x16x32_bf16 v[220:223], v[68:71], a[180:183], v[220:223]
    v_mfma_f32_16x16x32_bf16 v[248:251], v[72:75], a[180:183], v[248:251]
    v_add_u32 v1, s33, v1
    v_mfma_f32_16x16x32_bf16 v[252:255], v[76:79], a[180:183], v[252:255]
    v_add_u32 v2, s33, v2
    v_mfma_f32_16x16x32_bf16 v[56:59], v[80:83], a[180:183], v[56:59]
    v_add_u32 v3, s33, v3
    v_mfma_f32_16x16x32_bf16 v[60:63], v[84:87], a[180:183], v[60:63]
    v_add_u32 v4, s33, v4
    s_waitcnt lgkmcnt(1)
    v_mfma_f32_16x16x32_bf16 v[216:219], v[96:99], a[184:187], v[216:219]
    v_mfma_f32_16x16x32_bf16 v[220:223], v[100:103], a[184:187], v[220:223]
    v_mfma_f32_16x16x32_bf16 v[248:251], v[104:107], a[184:187], v[248:251]
    v_mfma_f32_16x16x32_bf16 v[252:255], v[108:111], a[184:187], v[252:255]
    v_mfma_f32_16x16x32_bf16 v[56:59], v[112:115], a[184:187], v[56:59]
    v_mfma_f32_16x16x32_bf16 v[60:63], v[116:119], a[184:187], v[60:63]
    s_waitcnt lgkmcnt(0)
    v_mfma_f32_16x16x32_bf16 v[216:219], v[128:131], a[188:191], v[216:219]
    v_mfma_f32_16x16x32_bf16 v[220:223], v[132:135], a[188:191], v[220:223]
    v_mfma_f32_16x16x32_bf16 v[248:251], v[136:139], a[188:191], v[248:251]
    v_mfma_f32_16x16x32_bf16 v[252:255], v[140:143], a[188:191], v[252:255]
    v_mfma_f32_16x16x32_bf16 v[56:59], v[144:147], a[188:191], v[56:59]
    v_mfma_f32_16x16x32_bf16 v[60:63], v[148:151], a[188:191], v[60:63]
    s_add_u32 s31, s31, 3145728
    s_mov_b32 s26, 113246208
    s_add_u32 s29, s29, 1
    s_nop 4
    v_cvt_pk_bf16_f32 v16, v216, v220
    v_cvt_pk_bf16_f32 v19, v217, v221
    v_cvt_pk_bf16_f32 v22, v218, v222
    v_cvt_pk_bf16_f32 v25, v219, v223
    v_cvt_pk_bf16_f32 v17, v248, v252
    v_cvt_pk_bf16_f32 v20, v249, v253
    v_cvt_pk_bf16_f32 v23, v250, v254
    v_cvt_pk_bf16_f32 v26, v251, v255
    v_cvt_pk_bf16_f32 v18, v56, v60
    v_cvt_pk_bf16_f32 v21, v57, v61
    v_cvt_pk_bf16_f32 v24, v58, v62
    v_cvt_pk_bf16_f32 v27, v59, v63
    ds_write_b128 v8, v[16:19] offset:0
    ds_write_b128 v8, v[20:23] offset:16
    ds_write_b128 v8, v[24:27] offset:32
    v_add_u32 v8, s34, v8
    s_sub_u32 s34, 0, s34
    s_cmp_lt_u32 s29, 36
    s_cbranch_scc1 L_loop
    s_waitcnt lgkmcnt(0)
    s_barrier
    ds_read_b128 a[192:195], v9
    ds_read_b128 a[196:199], v10
    ds_read_b128 a[200:203], v11
    s_waitcnt lgkmcnt(2)
    buffer_store_dwordx4 a[192:195], v12, s[24:27], s31 offen offset:0
    s_waitcnt lgkmcnt(1)
    buffer_store_dwordx4 a[196:199], v12, s[24:27], s31 offen offset:1024
    s_waitcnt lgkmcnt(0)
    buffer_store_dwordx4 a[200:203], v12, s[24:27], s31 offen offset:2048
L_done:
    s_endpgm
.section .rodata,"a"
.p2align 6
.amdhsa_kernel standalone__standard_2d_1d_3d_conv__vision_kernel
  .amdhsa_next_free_vgpr 512
  .amdhsa_next_free_sgpr 96
  .amdhsa_accum_offset 256
  .amdhsa_group_segment_fixed_size 0
  .amdhsa_kernarg_size 48
  .amdhsa_user_sgpr_count 2
  .amdhsa_user_sgpr_kernarg_segment_ptr 1
  .amdhsa_system_sgpr_workgroup_id_x 1
.end_amdhsa_kernel
```

```asm
; @launch grid=(256,1,1) block=(256,1,1) lds=160256
.amdgcn_target "amdgcn-amd-amdhsa--gfx950"
.text
.globl standalone__standard_2d_1d_3d_conv__vision_kernel
.p2align 8
.type standalone__standard_2d_1d_3d_conv__vision_kernel,@function
standalone__standard_2d_1d_3d_conv__vision_kernel:
    s_load_dwordx8 s[4:11], s[0:1], 0
    s_cmp_ge_u32 s2, 256
    s_cbranch_scc1 L_done
    v_lshrrev_b32 v28, 6, v0
    v_and_b32 v29, 63, v0
    v_readfirstlane_b32 s28, v28
    v_and_b32 v30, 15, v0
    v_bfe_u32 v31, v0, 4, 2
    v_mul_u32_u24 v13, 6144, v31
    v_mul_u32_u24 v14, 12, v30
    v_add_u32 v13, v13, v14
    v_mul_u32_u24 v14, 192, v28
    v_add_u32 v13, v13, v14
    v_add_u32 v14, 3072, v13
    v_mul_u32_u24 v16, 3072, v28
    v_add_u32 v17, 16, v29
    v_lshrrev_b32 v17, 6, v17
    v_lshl_add_u32 v17, v28, 2, v17
    v_xor_b32 v17, v17, v29
    v_lshl_add_u32 v5, v17, 4, v16
    v_lshrrev_b32 v17, 5, v29
    v_add_u32 v17, 1, v17
    v_lshl_add_u32 v17, v28, 2, v17
    v_xor_b32 v17, v17, v29
    v_lshl_add_u32 v6, v17, 4, v16
    v_add_u32 v17, 48, v29
    v_lshrrev_b32 v17, 6, v17
    v_add_u32 v17, 2, v17
    v_lshl_add_u32 v17, v28, 2, v17
    v_xor_b32 v17, v17, v29
    v_lshl_add_u32 v7, v17, 4, v16
    s_mul_i32 s30, s2, 12288
    s_mov_b32 s31, s30
    s_mul_i32 s41, s28, 3072
    s_mov_b32 s42, 0
    s_mov_b32 s36, 0x05040100
    s_mov_b32 s37, 0x07060302
    s_mov_b32 s14, 113246208
    s_mov_b32 s15, 0x20000
    s_mov_b32 s18, 294912
    s_mov_b32 s19, 0x20000
    s_mov_b32 s26, 0
    s_mov_b32 s27, 0x20000
    s_waitcnt lgkmcnt(0)
    s_mov_b32 s12, s4
    s_and_b32 s13, s5, 0xffff
    s_mov_b32 s16, s6
    s_and_b32 s17, s7, 0xffff
    s_mov_b32 s24, s10
    s_and_b32 s25, s11, 0xffff
L_g0:
    s_mov_b32 s35, 0
    buffer_load_dwordx3 v[32:34], v13, s[16:19], s35 offen offset:0
    buffer_load_dwordx3 v[36:38], v13, s[16:19], s35 offen offset:768
    buffer_load_dwordx3 v[40:42], v13, s[16:19], s35 offen offset:1536
    buffer_load_dwordx3 v[44:46], v13, s[16:19], s35 offen offset:2304
    buffer_load_dwordx3 v[48:50], v14, s[16:19], s35 offen offset:0
    buffer_load_dwordx3 v[52:54], v14, s[16:19], s35 offen offset:768
    buffer_load_dwordx3 v[56:58], v14, s[16:19], s35 offen offset:1536
    buffer_load_dwordx3 v[60:62], v14, s[16:19], s35 offen offset:2304
    v_mul_u32_u24 v15, 48, v31
    v_mul_u32_u24 v16, 192, v28
    v_add_u32 v15, v15, v16
    s_mov_b32 s20, s8
    s_and_b32 s21, s9, 0xffff
    s_mov_b32 s22, 768
    s_mov_b32 s23, 0x20000
    buffer_load_dwordx4 a[192:195], v15, s[20:23], 0 offen offset:0
    buffer_load_dwordx4 a[196:199], v15, s[20:23], 0 offen offset:16
    buffer_load_dwordx4 a[200:203], v15, s[20:23], 0 offen offset:32
    v_mul_u32_u24 v8, 784, v30
    v_add_u32 v8, v8, v15
    v_add_u32 v8, 135168, v8
    v_mul_u32_u24 v16, 768, v30
    v_add_u32 v1, 0, v31
    v_xor_b32 v1, v1, v30
    v_lshl_add_u32 v1, v1, 4, v16
    v_add_u32 v2, 4, v31
    v_xor_b32 v2, v2, v30
    v_lshl_add_u32 v2, v2, 4, v16
    v_add_u32 v3, 8, v31
    v_xor_b32 v3, v3, v30
    v_lshl_add_u32 v3, v3, 4, v16
    v_add_u32 v4, 12, v31
    v_xor_b32 v4, v4, v30
    v_lshl_add_u32 v4, v4, 4, v16
    v_mul_u32_u24 v12, 3072, v28
    v_lshl_add_u32 v12, v29, 4, v12
    v_mul_u32_u24 v16, 3136, v28
    v_add_u32 v16, 135168, v16
    v_add_u32 v17, 16, v29
    v_lshrrev_b32 v17, 6, v17
    v_add_u32 v17, v17, v29
    v_lshl_add_u32 v17, v17, 4, v16
    v_add_u32 v9, 0, v17
    v_lshrrev_b32 v17, 5, v29
    v_add_u32 v17, 1, v17
    v_add_u32 v17, v17, v29
    v_lshl_add_u32 v17, v17, 4, v16
    v_add_u32 v10, 1024, v17
    v_add_u32 v17, 48, v29
    v_lshrrev_b32 v17, 6, v17
    v_add_u32 v17, 2, v17
    v_add_u32 v17, v17, v29
    v_lshl_add_u32 v17, v17, 4, v16
    v_add_u32 v11, 2048, v17
    s_sub_u32 s31, s31, 9437184
    s_mov_b32 s43, 0
    s_mov_b32 s40, 113246208
    s_mov_b32 s29, 0
    s_mov_b32 s34, 0
    s_mov_b32 s35, 24576
    buffer_load_dwordx3 v[64:66], v13, s[16:19], s35 offen offset:0
    buffer_load_dwordx3 v[68:70], v13, s[16:19], s35 offen offset:768
    buffer_load_dwordx3 v[72:74], v13, s[16:19], s35 offen offset:1536
    buffer_load_dwordx3 v[76:78], v13, s[16:19], s35 offen offset:2304
    buffer_load_dwordx3 v[80:82], v14, s[16:19], s35 offen offset:0
    buffer_load_dwordx3 v[84:86], v14, s[16:19], s35 offen offset:768
    buffer_load_dwordx3 v[88:90], v14, s[16:19], s35 offen offset:1536
    buffer_load_dwordx3 v[92:94], v14, s[16:19], s35 offen offset:2304
    s_mov_b32 s35, 49152
    buffer_load_dwordx3 v[96:98], v13, s[16:19], s35 offen offset:0
    buffer_load_dwordx3 v[100:102], v13, s[16:19], s35 offen offset:768
    buffer_load_dwordx3 v[104:106], v13, s[16:19], s35 offen offset:1536
    buffer_load_dwordx3 v[108:110], v13, s[16:19], s35 offen offset:2304
    buffer_load_dwordx3 v[112:114], v14, s[16:19], s35 offen offset:0
    buffer_load_dwordx3 v[116:118], v14, s[16:19], s35 offen offset:768
    buffer_load_dwordx3 v[120:122], v14, s[16:19], s35 offen offset:1536
    buffer_load_dwordx3 v[124:126], v14, s[16:19], s35 offen offset:2304
    s_mov_b32 s35, 73728
    buffer_load_dwordx3 v[128:130], v13, s[16:19], s35 offen offset:0
    buffer_load_dwordx3 v[132:134], v13, s[16:19], s35 offen offset:768
    buffer_load_dwordx3 v[136:138], v13, s[16:19], s35 offen offset:1536
    buffer_load_dwordx3 v[140:142], v13, s[16:19], s35 offen offset:2304
    buffer_load_dwordx3 v[144:146], v14, s[16:19], s35 offen offset:0
    buffer_load_dwordx3 v[148:150], v14, s[16:19], s35 offen offset:768
    buffer_load_dwordx3 v[152:154], v14, s[16:19], s35 offen offset:1536
    buffer_load_dwordx3 v[156:158], v14, s[16:19], s35 offen offset:2304
    s_waitcnt vmcnt(27)
    v_perm_b32 v16, v36, v32, s36
    v_perm_b32 v17, v44, v40, s36
    v_perm_b32 v18, v52, v48, s36
    v_perm_b32 v19, v60, v56, s36
    v_accvgpr_write_b32 a0, v16
    v_accvgpr_write_b32 a1, v17
    v_accvgpr_write_b32 a2, v18
    v_accvgpr_write_b32 a3, v19
    v_perm_b32 v20, v36, v32, s37
    v_perm_b32 v21, v44, v40, s37
    v_perm_b32 v22, v52, v48, s37
    v_perm_b32 v23, v60, v56, s37
    v_accvgpr_write_b32 a4, v20
    v_accvgpr_write_b32 a5, v21
    v_accvgpr_write_b32 a6, v22
    v_accvgpr_write_b32 a7, v23
    v_perm_b32 v16, v37, v33, s36
    v_perm_b32 v17, v45, v41, s36
    v_perm_b32 v18, v53, v49, s36
    v_perm_b32 v19, v61, v57, s36
    v_accvgpr_write_b32 a8, v16
    v_accvgpr_write_b32 a9, v17
    v_accvgpr_write_b32 a10, v18
    v_accvgpr_write_b32 a11, v19
    v_perm_b32 v20, v37, v33, s37
    v_perm_b32 v21, v45, v41, s37
    v_perm_b32 v22, v53, v49, s37
    v_perm_b32 v23, v61, v57, s37
    v_accvgpr_write_b32 a12, v20
    v_accvgpr_write_b32 a13, v21
    v_accvgpr_write_b32 a14, v22
    v_accvgpr_write_b32 a15, v23
    v_perm_b32 v16, v38, v34, s36
    v_perm_b32 v17, v46, v42, s36
    v_perm_b32 v18, v54, v50, s36
    v_perm_b32 v19, v62, v58, s36
    v_accvgpr_write_b32 a16, v16
    v_accvgpr_write_b32 a17, v17
    v_accvgpr_write_b32 a18, v18
    v_accvgpr_write_b32 a19, v19
    v_perm_b32 v20, v38, v34, s37
    v_perm_b32 v21, v46, v42, s37
    v_perm_b32 v22, v54, v50, s37
    v_perm_b32 v23, v62, v58, s37
    v_accvgpr_write_b32 a20, v20
    v_accvgpr_write_b32 a21, v21
    v_accvgpr_write_b32 a22, v22
    v_accvgpr_write_b32 a23, v23
    s_mov_b32 s35, 98304
    buffer_load_dwordx3 v[160:162], v13, s[16:19], s35 offen offset:0
    buffer_load_dwordx3 v[164:166], v13, s[16:19], s35 offen offset:768
    buffer_load_dwordx3 v[168:170], v13, s[16:19], s35 offen offset:1536
    buffer_load_dwordx3 v[172:174], v13, s[16:19], s35 offen offset:2304
    buffer_load_dwordx3 v[176:178], v14, s[16:19], s35 offen offset:0
    buffer_load_dwordx3 v[180:182], v14, s[16:19], s35 offen offset:768
    buffer_load_dwordx3 v[184:186], v14, s[16:19], s35 offen offset:1536
    buffer_load_dwordx3 v[188:190], v14, s[16:19], s35 offen offset:2304
    s_waitcnt vmcnt(24)
    v_perm_b32 v16, v68, v64, s36
    v_perm_b32 v17, v76, v72, s36
    v_perm_b32 v18, v84, v80, s36
    v_perm_b32 v19, v92, v88, s36
    v_accvgpr_write_b32 a24, v16
    v_accvgpr_write_b32 a25, v17
    v_accvgpr_write_b32 a26, v18
    v_accvgpr_write_b32 a27, v19
    v_perm_b32 v20, v68, v64, s37
    v_perm_b32 v21, v76, v72, s37
    v_perm_b32 v22, v84, v80, s37
    v_perm_b32 v23, v92, v88, s37
    v_accvgpr_write_b32 a28, v20
    v_accvgpr_write_b32 a29, v21
    v_accvgpr_write_b32 a30, v22
    v_accvgpr_write_b32 a31, v23
    v_perm_b32 v16, v69, v65, s36
    v_perm_b32 v17, v77, v73, s36
    v_perm_b32 v18, v85, v81, s36
    v_perm_b32 v19, v93, v89, s36
    v_accvgpr_write_b32 a32, v16
    v_accvgpr_write_b32 a33, v17
    v_accvgpr_write_b32 a34, v18
    v_accvgpr_write_b32 a35, v19
    v_perm_b32 v20, v69, v65, s37
    v_perm_b32 v21, v77, v73, s37
    v_perm_b32 v22, v85, v81, s37
    v_perm_b32 v23, v93, v89, s37
    v_accvgpr_write_b32 a36, v20
    v_accvgpr_write_b32 a37, v21
    v_accvgpr_write_b32 a38, v22
    v_accvgpr_write_b32 a39, v23
    v_perm_b32 v16, v70, v66, s36
    v_perm_b32 v17, v78, v74, s36
    v_perm_b32 v18, v86, v82, s36
    v_perm_b32 v19, v94, v90, s36
    v_accvgpr_write_b32 a40, v16
    v_accvgpr_write_b32 a41, v17
    v_accvgpr_write_b32 a42, v18
    v_accvgpr_write_b32 a43, v19
    v_perm_b32 v20, v70, v66, s37
    v_perm_b32 v21, v78, v74, s37
    v_perm_b32 v22, v86, v82, s37
    v_perm_b32 v23, v94, v90, s37
    v_accvgpr_write_b32 a44, v20
    v_accvgpr_write_b32 a45, v21
    v_accvgpr_write_b32 a46, v22
    v_accvgpr_write_b32 a47, v23
    s_mov_b32 s35, 122880
    buffer_load_dwordx3 v[192:194], v13, s[16:19], s35 offen offset:0
    buffer_load_dwordx3 v[196:198], v13, s[16:19], s35 offen offset:768
    buffer_load_dwordx3 v[200:202], v13, s[16:19], s35 offen offset:1536
    buffer_load_dwordx3 v[204:206], v13, s[16:19], s35 offen offset:2304
    buffer_load_dwordx3 v[208:210], v14, s[16:19], s35 offen offset:0
    buffer_load_dwordx3 v[212:214], v14, s[16:19], s35 offen offset:768
    buffer_load_dwordx3 v[216:218], v14, s[16:19], s35 offen offset:1536
    buffer_load_dwordx3 v[220:222], v14, s[16:19], s35 offen offset:2304
    s_waitcnt vmcnt(24)
    v_perm_b32 v16, v100, v96, s36
    v_perm_b32 v17, v108, v104, s36
    v_perm_b32 v18, v116, v112, s36
    v_perm_b32 v19, v124, v120, s36
    v_accvgpr_write_b32 a48, v16
    v_accvgpr_write_b32 a49, v17
    v_accvgpr_write_b32 a50, v18
    v_accvgpr_write_b32 a51, v19
    v_perm_b32 v20, v100, v96, s37
    v_perm_b32 v21, v108, v104, s37
    v_perm_b32 v22, v116, v112, s37
    v_perm_b32 v23, v124, v120, s37
    v_accvgpr_write_b32 a52, v20
    v_accvgpr_write_b32 a53, v21
    v_accvgpr_write_b32 a54, v22
    v_accvgpr_write_b32 a55, v23
    v_perm_b32 v16, v101, v97, s36
    v_perm_b32 v17, v109, v105, s36
    v_perm_b32 v18, v117, v113, s36
    v_perm_b32 v19, v125, v121, s36
    v_accvgpr_write_b32 a56, v16
    v_accvgpr_write_b32 a57, v17
    v_accvgpr_write_b32 a58, v18
    v_accvgpr_write_b32 a59, v19
    v_perm_b32 v20, v101, v97, s37
    v_perm_b32 v21, v109, v105, s37
    v_perm_b32 v22, v117, v113, s37
    v_perm_b32 v23, v125, v121, s37
    v_accvgpr_write_b32 a60, v20
    v_accvgpr_write_b32 a61, v21
    v_accvgpr_write_b32 a62, v22
    v_accvgpr_write_b32 a63, v23
    v_perm_b32 v16, v102, v98, s36
    v_perm_b32 v17, v110, v106, s36
    v_perm_b32 v18, v118, v114, s36
    v_perm_b32 v19, v126, v122, s36
    v_accvgpr_write_b32 a64, v16
    v_accvgpr_write_b32 a65, v17
    v_accvgpr_write_b32 a66, v18
    v_accvgpr_write_b32 a67, v19
    v_perm_b32 v20, v102, v98, s37
    v_perm_b32 v21, v110, v106, s37
    v_perm_b32 v22, v118, v114, s37
    v_perm_b32 v23, v126, v122, s37
    v_accvgpr_write_b32 a68, v20
    v_accvgpr_write_b32 a69, v21
    v_accvgpr_write_b32 a70, v22
    v_accvgpr_write_b32 a71, v23
    s_mov_b32 s35, 147456
    buffer_load_dwordx3 v[224:226], v13, s[16:19], s35 offen offset:0
    buffer_load_dwordx3 v[228:230], v13, s[16:19], s35 offen offset:768
    buffer_load_dwordx3 v[232:234], v13, s[16:19], s35 offen offset:1536
    buffer_load_dwordx3 v[236:238], v13, s[16:19], s35 offen offset:2304
    buffer_load_dwordx3 v[240:242], v14, s[16:19], s35 offen offset:0
    buffer_load_dwordx3 v[244:246], v14, s[16:19], s35 offen offset:768
    buffer_load_dwordx3 v[248:250], v14, s[16:19], s35 offen offset:1536
    buffer_load_dwordx3 v[252:254], v14, s[16:19], s35 offen offset:2304
    s_waitcnt vmcnt(24)
    v_perm_b32 v16, v132, v128, s36
    v_perm_b32 v17, v140, v136, s36
    v_perm_b32 v18, v148, v144, s36
    v_perm_b32 v19, v156, v152, s36
    v_accvgpr_write_b32 a72, v16
    v_accvgpr_write_b32 a73, v17
    v_accvgpr_write_b32 a74, v18
    v_accvgpr_write_b32 a75, v19
    v_perm_b32 v20, v132, v128, s37
    v_perm_b32 v21, v140, v136, s37
    v_perm_b32 v22, v148, v144, s37
    v_perm_b32 v23, v156, v152, s37
    v_accvgpr_write_b32 a76, v20
    v_accvgpr_write_b32 a77, v21
    v_accvgpr_write_b32 a78, v22
    v_accvgpr_write_b32 a79, v23
    v_perm_b32 v16, v133, v129, s36
    v_perm_b32 v17, v141, v137, s36
    v_perm_b32 v18, v149, v145, s36
    v_perm_b32 v19, v157, v153, s36
    v_accvgpr_write_b32 a80, v16
    v_accvgpr_write_b32 a81, v17
    v_accvgpr_write_b32 a82, v18
    v_accvgpr_write_b32 a83, v19
    v_perm_b32 v20, v133, v129, s37
    v_perm_b32 v21, v141, v137, s37
    v_perm_b32 v22, v149, v145, s37
    v_perm_b32 v23, v157, v153, s37
    v_accvgpr_write_b32 a84, v20
    v_accvgpr_write_b32 a85, v21
    v_accvgpr_write_b32 a86, v22
    v_accvgpr_write_b32 a87, v23
    v_perm_b32 v16, v134, v130, s36
    v_perm_b32 v17, v142, v138, s36
    v_perm_b32 v18, v150, v146, s36
    v_perm_b32 v19, v158, v154, s36
    v_accvgpr_write_b32 a88, v16
    v_accvgpr_write_b32 a89, v17
    v_accvgpr_write_b32 a90, v18
    v_accvgpr_write_b32 a91, v19
    v_perm_b32 v20, v134, v130, s37
    v_perm_b32 v21, v142, v138, s37
    v_perm_b32 v22, v150, v146, s37
    v_perm_b32 v23, v158, v154, s37
    v_accvgpr_write_b32 a92, v20
    v_accvgpr_write_b32 a93, v21
    v_accvgpr_write_b32 a94, v22
    v_accvgpr_write_b32 a95, v23
    s_mov_b32 s35, 172032
    buffer_load_dwordx3 v[32:34], v13, s[16:19], s35 offen offset:0
    buffer_load_dwordx3 v[36:38], v13, s[16:19], s35 offen offset:768
    buffer_load_dwordx3 v[40:42], v13, s[16:19], s35 offen offset:1536
    buffer_load_dwordx3 v[44:46], v13, s[16:19], s35 offen offset:2304
    buffer_load_dwordx3 v[48:50], v14, s[16:19], s35 offen offset:0
    buffer_load_dwordx3 v[52:54], v14, s[16:19], s35 offen offset:768
    buffer_load_dwordx3 v[56:58], v14, s[16:19], s35 offen offset:1536
    buffer_load_dwordx3 v[60:62], v14, s[16:19], s35 offen offset:2304
    s_waitcnt vmcnt(24)
    v_perm_b32 v16, v164, v160, s36
    v_perm_b32 v17, v172, v168, s36
    v_perm_b32 v18, v180, v176, s36
    v_perm_b32 v19, v188, v184, s36
    v_accvgpr_write_b32 a96, v16
    v_accvgpr_write_b32 a97, v17
    v_accvgpr_write_b32 a98, v18
    v_accvgpr_write_b32 a99, v19
    v_perm_b32 v20, v164, v160, s37
    v_perm_b32 v21, v172, v168, s37
    v_perm_b32 v22, v180, v176, s37
    v_perm_b32 v23, v188, v184, s37
    v_accvgpr_write_b32 a100, v20
    v_accvgpr_write_b32 a101, v21
    v_accvgpr_write_b32 a102, v22
    v_accvgpr_write_b32 a103, v23
    v_perm_b32 v16, v165, v161, s36
    v_perm_b32 v17, v173, v169, s36
    v_perm_b32 v18, v181, v177, s36
    v_perm_b32 v19, v189, v185, s36
    v_accvgpr_write_b32 a104, v16
    v_accvgpr_write_b32 a105, v17
    v_accvgpr_write_b32 a106, v18
    v_accvgpr_write_b32 a107, v19
    v_perm_b32 v20, v165, v161, s37
    v_perm_b32 v21, v173, v169, s37
    v_perm_b32 v22, v181, v177, s37
    v_perm_b32 v23, v189, v185, s37
    v_accvgpr_write_b32 a108, v20
    v_accvgpr_write_b32 a109, v21
    v_accvgpr_write_b32 a110, v22
    v_accvgpr_write_b32 a111, v23
    v_perm_b32 v16, v166, v162, s36
    v_perm_b32 v17, v174, v170, s36
    v_perm_b32 v18, v182, v178, s36
    v_perm_b32 v19, v190, v186, s36
    v_accvgpr_write_b32 a112, v16
    v_accvgpr_write_b32 a113, v17
    v_accvgpr_write_b32 a114, v18
    v_accvgpr_write_b32 a115, v19
    v_perm_b32 v20, v166, v162, s37
    v_perm_b32 v21, v174, v170, s37
    v_perm_b32 v22, v182, v178, s37
    v_perm_b32 v23, v190, v186, s37
    v_accvgpr_write_b32 a116, v20
    v_accvgpr_write_b32 a117, v21
    v_accvgpr_write_b32 a118, v22
    v_accvgpr_write_b32 a119, v23
    s_mov_b32 s35, 196608
    buffer_load_dwordx3 v[64:66], v13, s[16:19], s35 offen offset:0
    buffer_load_dwordx3 v[68:70], v13, s[16:19], s35 offen offset:768
    buffer_load_dwordx3 v[72:74], v13, s[16:19], s35 offen offset:1536
    buffer_load_dwordx3 v[76:78], v13, s[16:19], s35 offen offset:2304
    buffer_load_dwordx3 v[80:82], v14, s[16:19], s35 offen offset:0
    buffer_load_dwordx3 v[84:86], v14, s[16:19], s35 offen offset:768
    buffer_load_dwordx3 v[88:90], v14, s[16:19], s35 offen offset:1536
    buffer_load_dwordx3 v[92:94], v14, s[16:19], s35 offen offset:2304
    s_waitcnt vmcnt(24)
    v_perm_b32 v16, v196, v192, s36
    v_perm_b32 v17, v204, v200, s36
    v_perm_b32 v18, v212, v208, s36
    v_perm_b32 v19, v220, v216, s36
    v_accvgpr_write_b32 a120, v16
    v_accvgpr_write_b32 a121, v17
    v_accvgpr_write_b32 a122, v18
    v_accvgpr_write_b32 a123, v19
    v_perm_b32 v20, v196, v192, s37
    v_perm_b32 v21, v204, v200, s37
    v_perm_b32 v22, v212, v208, s37
    v_perm_b32 v23, v220, v216, s37
    v_accvgpr_write_b32 a124, v20
    v_accvgpr_write_b32 a125, v21
    v_accvgpr_write_b32 a126, v22
    v_accvgpr_write_b32 a127, v23
    v_perm_b32 v16, v197, v193, s36
    v_perm_b32 v17, v205, v201, s36
    v_perm_b32 v18, v213, v209, s36
    v_perm_b32 v19, v221, v217, s36
    v_accvgpr_write_b32 a128, v16
    v_accvgpr_write_b32 a129, v17
    v_accvgpr_write_b32 a130, v18
    v_accvgpr_write_b32 a131, v19
    v_perm_b32 v20, v197, v193, s37
    v_perm_b32 v21, v205, v201, s37
    v_perm_b32 v22, v213, v209, s37
    v_perm_b32 v23, v221, v217, s37
    v_accvgpr_write_b32 a132, v20
    v_accvgpr_write_b32 a133, v21
    v_accvgpr_write_b32 a134, v22
    v_accvgpr_write_b32 a135, v23
    v_perm_b32 v16, v198, v194, s36
    v_perm_b32 v17, v206, v202, s36
    v_perm_b32 v18, v214, v210, s36
    v_perm_b32 v19, v222, v218, s36
    v_accvgpr_write_b32 a136, v16
    v_accvgpr_write_b32 a137, v17
    v_accvgpr_write_b32 a138, v18
    v_accvgpr_write_b32 a139, v19
    v_perm_b32 v20, v198, v194, s37
    v_perm_b32 v21, v206, v202, s37
    v_perm_b32 v22, v214, v210, s37
    v_perm_b32 v23, v222, v218, s37
    v_accvgpr_write_b32 a140, v20
    v_accvgpr_write_b32 a141, v21
    v_accvgpr_write_b32 a142, v22
    v_accvgpr_write_b32 a143, v23
    s_mov_b32 s35, 221184
    buffer_load_dwordx3 v[96:98], v13, s[16:19], s35 offen offset:0
    buffer_load_dwordx3 v[100:102], v13, s[16:19], s35 offen offset:768
    buffer_load_dwordx3 v[104:106], v13, s[16:19], s35 offen offset:1536
    buffer_load_dwordx3 v[108:110], v13, s[16:19], s35 offen offset:2304
    buffer_load_dwordx3 v[112:114], v14, s[16:19], s35 offen offset:0
    buffer_load_dwordx3 v[116:118], v14, s[16:19], s35 offen offset:768
    buffer_load_dwordx3 v[120:122], v14, s[16:19], s35 offen offset:1536
    buffer_load_dwordx3 v[124:126], v14, s[16:19], s35 offen offset:2304
    s_waitcnt vmcnt(24)
    v_perm_b32 v192, v228, v224, s36
    v_perm_b32 v193, v236, v232, s36
    v_perm_b32 v194, v244, v240, s36
    v_perm_b32 v195, v252, v248, s36
    v_perm_b32 v196, v228, v224, s37
    v_perm_b32 v197, v236, v232, s37
    v_perm_b32 v198, v244, v240, s37
    v_perm_b32 v199, v252, v248, s37
    v_perm_b32 v200, v229, v225, s36
    v_perm_b32 v201, v237, v233, s36
    v_perm_b32 v202, v245, v241, s36
    v_perm_b32 v203, v253, v249, s36
    v_perm_b32 v204, v229, v225, s37
    v_perm_b32 v205, v237, v233, s37
    v_perm_b32 v206, v245, v241, s37
    v_perm_b32 v207, v253, v249, s37
    v_perm_b32 v208, v230, v226, s36
    v_perm_b32 v209, v238, v234, s36
    v_perm_b32 v210, v246, v242, s36
    v_perm_b32 v211, v254, v250, s36
    v_perm_b32 v212, v230, v226, s37
    v_perm_b32 v213, v238, v234, s37
    v_perm_b32 v214, v246, v242, s37
    v_perm_b32 v215, v254, v250, s37
    s_mov_b32 s35, 245760
    buffer_load_dwordx3 v[128:130], v13, s[16:19], s35 offen offset:0
    buffer_load_dwordx3 v[132:134], v13, s[16:19], s35 offen offset:768
    buffer_load_dwordx3 v[136:138], v13, s[16:19], s35 offen offset:1536
    buffer_load_dwordx3 v[140:142], v13, s[16:19], s35 offen offset:2304
    buffer_load_dwordx3 v[144:146], v14, s[16:19], s35 offen offset:0
    buffer_load_dwordx3 v[148:150], v14, s[16:19], s35 offen offset:768
    buffer_load_dwordx3 v[152:154], v14, s[16:19], s35 offen offset:1536
    buffer_load_dwordx3 v[156:158], v14, s[16:19], s35 offen offset:2304
    s_waitcnt vmcnt(24)
    v_perm_b32 v224, v36, v32, s36
    v_perm_b32 v225, v44, v40, s36
    v_perm_b32 v226, v52, v48, s36
    v_perm_b32 v227, v60, v56, s36
    v_perm_b32 v228, v36, v32, s37
    v_perm_b32 v229, v44, v40, s37
    v_perm_b32 v230, v52, v48, s37
    v_perm_b32 v231, v60, v56, s37
    v_perm_b32 v232, v37, v33, s36
    v_perm_b32 v233, v45, v41, s36
    v_perm_b32 v234, v53, v49, s36
    v_perm_b32 v235, v61, v57, s36
    v_perm_b32 v236, v37, v33, s37
    v_perm_b32 v237, v45, v41, s37
    v_perm_b32 v238, v53, v49, s37
    v_perm_b32 v239, v61, v57, s37
    v_perm_b32 v240, v38, v34, s36
    v_perm_b32 v241, v46, v42, s36
    v_perm_b32 v242, v54, v50, s36
    v_perm_b32 v243, v62, v58, s36
    v_perm_b32 v244, v38, v34, s37
    v_perm_b32 v245, v46, v42, s37
    v_perm_b32 v246, v54, v50, s37
    v_perm_b32 v247, v62, v58, s37
    s_mov_b32 s35, 270336
    buffer_load_dwordx3 v[160:162], v13, s[16:19], s35 offen offset:0
    buffer_load_dwordx3 v[164:166], v13, s[16:19], s35 offen offset:768
    buffer_load_dwordx3 v[168:170], v13, s[16:19], s35 offen offset:1536
    buffer_load_dwordx3 v[172:174], v13, s[16:19], s35 offen offset:2304
    buffer_load_dwordx3 v[176:178], v14, s[16:19], s35 offen offset:0
    buffer_load_dwordx3 v[180:182], v14, s[16:19], s35 offen offset:768
    buffer_load_dwordx3 v[184:186], v14, s[16:19], s35 offen offset:1536
    buffer_load_dwordx3 v[188:190], v14, s[16:19], s35 offen offset:2304
    s_waitcnt vmcnt(24)
    v_perm_b32 v32, v68, v64, s36
    v_perm_b32 v33, v76, v72, s36
    v_perm_b32 v34, v84, v80, s36
    v_perm_b32 v35, v92, v88, s36
    v_perm_b32 v36, v68, v64, s37
    v_perm_b32 v37, v76, v72, s37
    v_perm_b32 v38, v84, v80, s37
    v_perm_b32 v39, v92, v88, s37
    v_perm_b32 v40, v69, v65, s36
    v_perm_b32 v41, v77, v73, s36
    v_perm_b32 v42, v85, v81, s36
    v_perm_b32 v43, v93, v89, s36
    v_perm_b32 v44, v69, v65, s37
    v_perm_b32 v45, v77, v73, s37
    v_perm_b32 v46, v85, v81, s37
    v_perm_b32 v47, v93, v89, s37
    v_perm_b32 v48, v70, v66, s36
    v_perm_b32 v49, v78, v74, s36
    v_perm_b32 v50, v86, v82, s36
    v_perm_b32 v51, v94, v90, s36
    v_perm_b32 v52, v70, v66, s37
    v_perm_b32 v53, v78, v74, s37
    v_perm_b32 v54, v86, v82, s37
    v_perm_b32 v55, v94, v90, s37
    s_waitcnt vmcnt(16)
    v_perm_b32 v64, v100, v96, s36
    v_perm_b32 v65, v108, v104, s36
    v_perm_b32 v66, v116, v112, s36
    v_perm_b32 v67, v124, v120, s36
    v_perm_b32 v68, v100, v96, s37
    v_perm_b32 v69, v108, v104, s37
    v_perm_b32 v70, v116, v112, s37
    v_perm_b32 v71, v124, v120, s37
    v_perm_b32 v72, v101, v97, s36
    v_perm_b32 v73, v109, v105, s36
    v_perm_b32 v74, v117, v113, s36
    v_perm_b32 v75, v125, v121, s36
    v_perm_b32 v76, v101, v97, s37
    v_perm_b32 v77, v109, v105, s37
    v_perm_b32 v78, v117, v113, s37
    v_perm_b32 v79, v125, v121, s37
    v_perm_b32 v80, v102, v98, s36
    v_perm_b32 v81, v110, v106, s36
    v_perm_b32 v82, v118, v114, s36
    v_perm_b32 v83, v126, v122, s36
    v_perm_b32 v84, v102, v98, s37
    v_perm_b32 v85, v110, v106, s37
    v_perm_b32 v86, v118, v114, s37
    v_perm_b32 v87, v126, v122, s37
    s_add_u32 s32, s42, s41
    s_mov_b32 m0, s32
    s_add_u32 s42, s42, 12288
    buffer_load_dwordx4 v5, s[12:15], s30 offen offset:0 nt lds
    buffer_load_dwordx4 v6, s[12:15], s30 offen offset:1024 nt lds
    buffer_load_dwordx4 v7, s[12:15], s30 offen offset:2048 nt lds
    buffer_store_dwordx4 a[240:243], v12, s[24:27], 0 offen offset:0 sc0 sc1
    buffer_store_dwordx4 a[244:247], v12, s[24:27], 0 offen offset:1024 sc0 sc1
    buffer_store_dwordx4 a[248:251], v12, s[24:27], 0 offen offset:2048 sc0 sc1
    s_add_u32 s30, s30, 3145728
    s_waitcnt vmcnt(14)
    v_perm_b32 v96, v132, v128, s36
    v_perm_b32 v97, v140, v136, s36
    v_perm_b32 v98, v148, v144, s36
    v_perm_b32 v99, v156, v152, s36
    v_perm_b32 v100, v132, v128, s37
    v_perm_b32 v101, v140, v136, s37
    v_perm_b32 v102, v148, v144, s37
    v_perm_b32 v103, v156, v152, s37
    v_perm_b32 v104, v133, v129, s36
    v_perm_b32 v105, v141, v137, s36
    v_perm_b32 v106, v149, v145, s36
    v_perm_b32 v107, v157, v153, s36
    v_perm_b32 v108, v133, v129, s37
    v_perm_b32 v109, v141, v137, s37
    v_perm_b32 v110, v149, v145, s37
    v_perm_b32 v111, v157, v153, s37
    v_perm_b32 v112, v134, v130, s36
    v_perm_b32 v113, v142, v138, s36
    v_perm_b32 v114, v150, v146, s36
    v_perm_b32 v115, v158, v154, s36
    v_perm_b32 v116, v134, v130, s37
    v_perm_b32 v117, v142, v138, s37
    v_perm_b32 v118, v150, v146, s37
    v_perm_b32 v119, v158, v154, s37
    s_add_u32 s32, s42, s41
    s_mov_b32 m0, s32
    s_add_u32 s42, s42, 12288
    buffer_load_dwordx4 v5, s[12:15], s30 offen offset:0 nt lds
    buffer_load_dwordx4 v6, s[12:15], s30 offen offset:1024 nt lds
    buffer_load_dwordx4 v7, s[12:15], s30 offen offset:2048 nt lds
    buffer_store_dwordx4 a[240:243], v12, s[24:27], 0 offen offset:0 sc0 sc1
    buffer_store_dwordx4 a[244:247], v12, s[24:27], 0 offen offset:1024 sc0 sc1
    buffer_store_dwordx4 a[248:251], v12, s[24:27], 0 offen offset:2048 sc0 sc1
    s_add_u32 s30, s30, 3145728
    s_waitcnt vmcnt(12)
    v_perm_b32 v128, v164, v160, s36
    v_perm_b32 v129, v172, v168, s36
    v_perm_b32 v130, v180, v176, s36
    v_perm_b32 v131, v188, v184, s36
    v_perm_b32 v132, v164, v160, s37
    v_perm_b32 v133, v172, v168, s37
    v_perm_b32 v134, v180, v176, s37
    v_perm_b32 v135, v188, v184, s37
    v_perm_b32 v136, v165, v161, s36
    v_perm_b32 v137, v173, v169, s36
    v_perm_b32 v138, v181, v177, s36
    v_perm_b32 v139, v189, v185, s36
    v_perm_b32 v140, v165, v161, s37
    v_perm_b32 v141, v173, v169, s37
    v_perm_b32 v142, v181, v177, s37
    v_perm_b32 v143, v189, v185, s37
    v_perm_b32 v144, v166, v162, s36
    v_perm_b32 v145, v174, v170, s36
    v_perm_b32 v146, v182, v178, s36
    v_perm_b32 v147, v190, v186, s36
    v_perm_b32 v148, v166, v162, s37
    v_perm_b32 v149, v174, v170, s37
    v_perm_b32 v150, v182, v178, s37
    v_perm_b32 v151, v190, v186, s37
    s_add_u32 s32, s42, s41
    s_mov_b32 m0, s32
    s_add_u32 s42, s42, 12288
    buffer_load_dwordx4 v5, s[12:15], s30 offen offset:0 nt lds
    buffer_load_dwordx4 v6, s[12:15], s30 offen offset:1024 nt lds
    buffer_load_dwordx4 v7, s[12:15], s30 offen offset:2048 nt lds
    buffer_store_dwordx4 a[240:243], v12, s[24:27], 0 offen offset:0 sc0 sc1
    buffer_store_dwordx4 a[244:247], v12, s[24:27], 0 offen offset:1024 sc0 sc1
    buffer_store_dwordx4 a[248:251], v12, s[24:27], 0 offen offset:2048 sc0 sc1
    s_add_u32 s30, s30, 3145728
    v_accvgpr_read_b32 v16, a192
    v_accvgpr_read_b32 v17, a193
    v_accvgpr_read_b32 v18, a194
    v_accvgpr_read_b32 v19, a195
    v_accvgpr_read_b32 v20, a196
    v_accvgpr_read_b32 v21, a197
    v_accvgpr_read_b32 v22, a198
    v_accvgpr_read_b32 v23, a199
    v_accvgpr_read_b32 v24, a200
    v_accvgpr_read_b32 v25, a201
    v_accvgpr_read_b32 v26, a202
    v_accvgpr_read_b32 v27, a203
    v_lshlrev_b32 v160, 16, v16
    v_and_b32 v164, 0xffff0000, v16
    v_lshlrev_b32 v168, 16, v17
    v_and_b32 v172, 0xffff0000, v17
    v_lshlrev_b32 v176, 16, v18
    v_and_b32 v180, 0xffff0000, v18
    v_lshlrev_b32 v161, 16, v19
    v_and_b32 v165, 0xffff0000, v19
    v_lshlrev_b32 v169, 16, v20
    v_and_b32 v173, 0xffff0000, v20
    v_lshlrev_b32 v177, 16, v21
    v_and_b32 v181, 0xffff0000, v21
    v_lshlrev_b32 v162, 16, v22
    v_and_b32 v166, 0xffff0000, v22
    v_lshlrev_b32 v170, 16, v23
    v_and_b32 v174, 0xffff0000, v23
    v_lshlrev_b32 v178, 16, v24
    v_and_b32 v182, 0xffff0000, v24
    v_lshlrev_b32 v163, 16, v25
    v_and_b32 v167, 0xffff0000, v25
    v_lshlrev_b32 v171, 16, v26
    v_and_b32 v175, 0xffff0000, v26
    v_lshlrev_b32 v179, 16, v27
    v_and_b32 v183, 0xffff0000, v27
    s_waitcnt vmcnt(15)
    s_barrier
    ds_read_b128 a[144:147], v1 offset:0
    ds_read_b128 a[148:151], v2 offset:0
    ds_read_b128 a[152:155], v3 offset:0
    ds_read_b128 a[156:159], v4 offset:0
    ds_read_b128 a[160:163], v1 offset:256
    ds_read_b128 a[164:167], v2 offset:256
    ds_read_b128 a[168:171], v3 offset:256
    ds_read_b128 a[172:175], v4 offset:256
    ds_read_b128 a[176:179], v1 offset:512
    ds_read_b128 a[180:183], v2 offset:512
    ds_read_b128 a[184:187], v3 offset:512
    ds_read_b128 a[188:191], v4 offset:512
    v_add_u32 v1, 12288, v1
    v_add_u32 v2, 12288, v2
    v_add_u32 v3, 12288, v3
    v_add_u32 v4, 12288, v4
    s_mov_b32 s34, 12288
    s_waitcnt lgkmcnt(0)
    s_add_u32 m0, s42, s41
    s_cmp_eq_u32 s28, 1
    s_cbranch_scc1 L_g0_loop1
    s_cmp_eq_u32 s28, 2
    s_cbranch_scc1 L_g0_loop2
    s_cmp_eq_u32 s28, 3
    s_cbranch_scc1 L_g0_loop3
.p2align 6
L_g0_loop0:
    s_waitcnt vmcnt(9) lgkmcnt(0)
    s_barrier
    v_mfma_f32_16x16x32_bf16 v[216:219], a[0:3], a[144:147], v[160:163]
    buffer_load_dwordx4 v5, s[12:15], s30 offen offset:0 nt lds
    v_mfma_f32_16x16x32_bf16 v[216:219], a[24:27], a[148:151], v[216:219]
    ds_read_b128 a[192:195], v1 offset:0
    v_mfma_f32_16x16x32_bf16 v[216:219], a[48:51], a[152:155], v[216:219]
    s_add_u32 s31, s31, 3145728
    v_mfma_f32_16x16x32_bf16 v[216:219], a[72:75], a[156:159], v[216:219]
    s_mov_b32 s26, s43
    v_mfma_f32_16x16x32_bf16 v[216:219], a[96:99], a[160:163], v[216:219]
    s_mov_b32 s43, 113246208
    v_mfma_f32_16x16x32_bf16 v[216:219], a[120:123], a[164:167], v[216:219]
    ds_read_b128 a[196:199], v2 offset:0
    v_mfma_f32_16x16x32_bf16 v[216:219], v[192:195], a[168:171], v[216:219]
    v_cvt_pk_bf16_f32 v16, v88, v92
    v_mfma_f32_16x16x32_bf16 v[216:219], v[224:227], a[172:175], v[216:219]
    v_cvt_pk_bf16_f32 v17, v120, v124
    v_mfma_f32_16x16x32_bf16 v[216:219], v[32:35], a[176:179], v[216:219]
    buffer_load_dwordx4 v6, s[12:15], s30 offen offset:1024 nt lds
    v_mfma_f32_16x16x32_bf16 v[216:219], v[64:67], a[180:183], v[216:219]
    v_cvt_pk_bf16_f32 v18, v152, v156
    v_mfma_f32_16x16x32_bf16 v[216:219], v[96:99], a[184:187], v[216:219]
    ds_read_b128 a[200:203], v3 offset:0
    v_mfma_f32_16x16x32_bf16 v[216:219], v[128:131], a[188:191], v[216:219]
    v_cvt_pk_bf16_f32 v19, v89, v93
    v_mfma_f32_16x16x32_bf16 v[220:223], a[4:7], a[144:147], v[164:167]
    s_add_u32 s38, s34, 12288
    v_mfma_f32_16x16x32_bf16 v[220:223], a[28:31], a[148:151], v[220:223]
    s_cmp_eq_u32 s38, 135168
    s_cselect_b32 s38, 0, s38
    v_mfma_f32_16x16x32_bf16 v[220:223], a[52:55], a[152:155], v[220:223]
    ds_read_b128 a[240:243], v9 offset:0
    v_mfma_f32_16x16x32_bf16 v[220:223], a[76:79], a[156:159], v[220:223]
    ds_read_b128 a[204:207], v4 offset:0
    v_mfma_f32_16x16x32_bf16 v[220:223], a[100:103], a[160:163], v[220:223]
    ds_write_b128 v8, v[16:19] offset:12544
    v_mfma_f32_16x16x32_bf16 v[220:223], a[124:127], a[164:167], v[220:223]
    s_sub_u32 s33, s38, s34
    v_mfma_f32_16x16x32_bf16 v[220:223], v[196:199], a[168:171], v[220:223]
    s_mov_b32 s34, s38
    v_mfma_f32_16x16x32_bf16 v[220:223], v[228:231], a[172:175], v[220:223]
    v_mfma_f32_16x16x32_bf16 v[220:223], v[36:39], a[176:179], v[220:223]
    ds_read_b128 a[208:211], v1 offset:256
    v_mfma_f32_16x16x32_bf16 v[220:223], v[68:71], a[180:183], v[220:223]
    v_mfma_f32_16x16x32_bf16 v[220:223], v[100:103], a[184:187], v[220:223]
    v_mfma_f32_16x16x32_bf16 v[220:223], v[132:135], a[188:191], v[220:223]
    v_mfma_f32_16x16x32_bf16 v[248:251], a[8:11], a[144:147], v[168:171]
    buffer_load_dwordx4 v7, s[12:15], s30 offen offset:2048 nt lds
    v_mfma_f32_16x16x32_bf16 v[248:251], a[32:35], a[148:151], v[248:251]
    ds_read_b128 a[212:215], v2 offset:256
    v_mfma_f32_16x16x32_bf16 v[248:251], a[56:59], a[152:155], v[248:251]
    s_add_u32 s30, s30, 3145728
    v_mfma_f32_16x16x32_bf16 v[248:251], a[80:83], a[156:159], v[248:251]
    s_add_u32 s42, s42, 12288
    v_mfma_f32_16x16x32_bf16 v[248:251], a[104:107], a[160:163], v[248:251]
    s_cmp_eq_u32 s42, 135168
    s_cselect_b32 s42, 0, s42
    v_mfma_f32_16x16x32_bf16 v[248:251], a[128:131], a[164:167], v[248:251]
    s_add_u32 m0, s42, s41
    v_mfma_f32_16x16x32_bf16 v[248:251], v[200:203], a[168:171], v[248:251]
    ds_read_b128 a[216:219], v3 offset:256
    v_mfma_f32_16x16x32_bf16 v[248:251], v[232:235], a[172:175], v[248:251]
    ds_read_b128 a[244:247], v10 offset:0
    v_mfma_f32_16x16x32_bf16 v[248:251], v[40:43], a[176:179], v[248:251]
    s_waitcnt lgkmcnt(6)
    buffer_store_dwordx4 a[240:243], v12, s[24:27], s31 offen offset:0 sc0 sc1
    v_mfma_f32_16x16x32_bf16 v[248:251], v[72:75], a[180:183], v[248:251]
    v_cvt_pk_bf16_f32 v20, v121, v125
    v_mfma_f32_16x16x32_bf16 v[248:251], v[104:107], a[184:187], v[248:251]
    v_cvt_pk_bf16_f32 v21, v153, v157
    v_mfma_f32_16x16x32_bf16 v[248:251], v[136:139], a[188:191], v[248:251]
    ds_read_b128 a[220:223], v4 offset:256
    v_mfma_f32_16x16x32_bf16 v[252:255], a[12:15], a[144:147], v[172:175]
    v_cvt_pk_bf16_f32 v22, v90, v94
    v_mfma_f32_16x16x32_bf16 v[252:255], a[36:39], a[148:151], v[252:255]
    v_cvt_pk_bf16_f32 v23, v122, v126
    v_mfma_f32_16x16x32_bf16 v[252:255], a[60:63], a[152:155], v[252:255]
    v_mfma_f32_16x16x32_bf16 v[252:255], a[84:87], a[156:159], v[252:255]
    v_mfma_f32_16x16x32_bf16 v[252:255], a[108:111], a[160:163], v[252:255]
    ds_write_b128 v8, v[20:23] offset:12560
    v_mfma_f32_16x16x32_bf16 v[252:255], a[132:135], a[164:167], v[252:255]
    ds_read_b128 a[224:227], v1 offset:512
    v_mfma_f32_16x16x32_bf16 v[252:255], v[204:207], a[168:171], v[252:255]
    s_add_u32 s29, s29, 1
    v_mfma_f32_16x16x32_bf16 v[252:255], v[236:239], a[172:175], v[252:255]
    s_cmp_lt_u32 s29, 33
    s_cselect_b32 s14, s40, 0
    v_mfma_f32_16x16x32_bf16 v[252:255], v[44:47], a[176:179], v[252:255]
    v_cvt_pk_bf16_f32 v24, v154, v158
    v_mfma_f32_16x16x32_bf16 v[252:255], v[76:79], a[180:183], v[252:255]
    ds_read_b128 a[228:231], v2 offset:512
    v_mfma_f32_16x16x32_bf16 v[252:255], v[108:111], a[184:187], v[252:255]
    ds_read_b128 a[248:251], v11 offset:0
    v_mfma_f32_16x16x32_bf16 v[252:255], v[140:143], a[188:191], v[252:255]
    v_cvt_pk_bf16_f32 v25, v91, v95
    v_mfma_f32_16x16x32_bf16 v[56:59], a[16:19], a[144:147], v[176:179]
    s_waitcnt lgkmcnt(5)
    buffer_store_dwordx4 a[244:247], v12, s[24:27], s31 offen offset:1024 sc0 sc1
    v_mfma_f32_16x16x32_bf16 v[56:59], a[40:43], a[148:151], v[56:59]
    v_cvt_pk_bf16_f32 v26, v123, v127
    v_mfma_f32_16x16x32_bf16 v[56:59], a[64:67], a[152:155], v[56:59]
    ds_read_b128 a[232:235], v3 offset:512
    v_mfma_f32_16x16x32_bf16 v[56:59], a[88:91], a[156:159], v[56:59]
    v_cvt_pk_bf16_f32 v27, v155, v159
    v_mfma_f32_16x16x32_bf16 v[56:59], a[112:115], a[160:163], v[56:59]
    v_add_u32 v1, s33, v1
    v_mfma_f32_16x16x32_bf16 v[56:59], a[136:139], a[164:167], v[56:59]
    v_add_u32 v2, s33, v2
    v_mfma_f32_16x16x32_bf16 v[56:59], v[208:211], a[168:171], v[56:59]
    v_add_u32 v3, s33, v3
    v_mfma_f32_16x16x32_bf16 v[56:59], v[240:243], a[172:175], v[56:59]
    ds_read_b128 a[236:239], v4 offset:512
    v_mfma_f32_16x16x32_bf16 v[56:59], v[48:51], a[176:179], v[56:59]
    ds_write_b128 v8, v[24:27] offset:12576
    v_mfma_f32_16x16x32_bf16 v[56:59], v[80:83], a[180:183], v[56:59]
    v_add_u32 v4, s33, v4
    v_mfma_f32_16x16x32_bf16 v[56:59], v[112:115], a[184:187], v[56:59]
    v_mfma_f32_16x16x32_bf16 v[56:59], v[144:147], a[188:191], v[56:59]
    v_mfma_f32_16x16x32_bf16 v[60:63], a[20:23], a[144:147], v[180:183]
    v_mfma_f32_16x16x32_bf16 v[60:63], a[44:47], a[148:151], v[60:63]
    v_mfma_f32_16x16x32_bf16 v[60:63], a[68:71], a[152:155], v[60:63]
    v_mfma_f32_16x16x32_bf16 v[60:63], a[92:95], a[156:159], v[60:63]
    v_mfma_f32_16x16x32_bf16 v[60:63], a[116:119], a[160:163], v[60:63]
    s_waitcnt lgkmcnt(3)
    buffer_store_dwordx4 a[248:251], v12, s[24:27], s31 offen offset:2048 sc0 sc1
    v_mfma_f32_16x16x32_bf16 v[60:63], a[140:143], a[164:167], v[60:63]
    v_mfma_f32_16x16x32_bf16 v[60:63], v[212:215], a[168:171], v[60:63]
    v_mfma_f32_16x16x32_bf16 v[60:63], v[244:247], a[172:175], v[60:63]
    v_mfma_f32_16x16x32_bf16 v[60:63], v[52:55], a[176:179], v[60:63]
    v_mfma_f32_16x16x32_bf16 v[60:63], v[84:87], a[180:183], v[60:63]
    v_mfma_f32_16x16x32_bf16 v[60:63], v[116:119], a[184:187], v[60:63]
    v_mfma_f32_16x16x32_bf16 v[60:63], v[148:151], a[188:191], v[60:63]
    s_waitcnt vmcnt(9) lgkmcnt(0)
    s_barrier
    v_mfma_f32_16x16x32_bf16 v[88:91], a[0:3], a[192:195], v[160:163]
    buffer_load_dwordx4 v5, s[12:15], s30 offen offset:0 nt lds
    v_mfma_f32_16x16x32_bf16 v[88:91], a[24:27], a[196:199], v[88:91]
    ds_read_b128 a[144:147], v1 offset:0
    v_mfma_f32_16x16x32_bf16 v[88:91], a[48:51], a[200:203], v[88:91]
    s_add_u32 s31, s31, 3145728
    v_mfma_f32_16x16x32_bf16 v[88:91], a[72:75], a[204:207], v[88:91]
    v_mfma_f32_16x16x32_bf16 v[88:91], a[96:99], a[208:211], v[88:91]
    v_mfma_f32_16x16x32_bf16 v[88:91], a[120:123], a[212:215], v[88:91]
    ds_read_b128 a[148:151], v2 offset:0
    v_mfma_f32_16x16x32_bf16 v[88:91], v[192:195], a[216:219], v[88:91]
    v_cvt_pk_bf16_f32 v16, v216, v220
    v_mfma_f32_16x16x32_bf16 v[88:91], v[224:227], a[220:223], v[88:91]
    v_cvt_pk_bf16_f32 v17, v248, v252
    v_mfma_f32_16x16x32_bf16 v[88:91], v[32:35], a[224:227], v[88:91]
    buffer_load_dwordx4 v6, s[12:15], s30 offen offset:1024 nt lds
    v_mfma_f32_16x16x32_bf16 v[88:91], v[64:67], a[228:231], v[88:91]
    v_cvt_pk_bf16_f32 v18, v56, v60
    v_mfma_f32_16x16x32_bf16 v[88:91], v[96:99], a[232:235], v[88:91]
    ds_read_b128 a[152:155], v3 offset:0
    v_mfma_f32_16x16x32_bf16 v[88:91], v[128:131], a[236:239], v[88:91]
    v_cvt_pk_bf16_f32 v19, v217, v221
    v_mfma_f32_16x16x32_bf16 v[92:95], a[4:7], a[192:195], v[164:167]
    s_add_u32 s38, s34, 12288
    v_mfma_f32_16x16x32_bf16 v[92:95], a[28:31], a[196:199], v[92:95]
    s_cmp_eq_u32 s38, 135168
    s_cselect_b32 s38, 0, s38
    v_mfma_f32_16x16x32_bf16 v[92:95], a[52:55], a[200:203], v[92:95]
    ds_read_b128 a[240:243], v9 offset:12544
    v_mfma_f32_16x16x32_bf16 v[92:95], a[76:79], a[204:207], v[92:95]
    ds_read_b128 a[156:159], v4 offset:0
    v_mfma_f32_16x16x32_bf16 v[92:95], a[100:103], a[208:211], v[92:95]
    ds_write_b128 v8, v[16:19] offset:0
    v_mfma_f32_16x16x32_bf16 v[92:95], a[124:127], a[212:215], v[92:95]
    s_sub_u32 s33, s38, s34
    v_mfma_f32_16x16x32_bf16 v[92:95], v[196:199], a[216:219], v[92:95]
    s_mov_b32 s34, s38
    v_mfma_f32_16x16x32_bf16 v[92:95], v[228:231], a[220:223], v[92:95]
    v_mfma_f32_16x16x32_bf16 v[92:95], v[36:39], a[224:227], v[92:95]
    ds_read_b128 a[160:163], v1 offset:256
    v_mfma_f32_16x16x32_bf16 v[92:95], v[68:71], a[228:231], v[92:95]
    v_mfma_f32_16x16x32_bf16 v[92:95], v[100:103], a[232:235], v[92:95]
    v_mfma_f32_16x16x32_bf16 v[92:95], v[132:135], a[236:239], v[92:95]
    v_mfma_f32_16x16x32_bf16 v[120:123], a[8:11], a[192:195], v[168:171]
    buffer_load_dwordx4 v7, s[12:15], s30 offen offset:2048 nt lds
    v_mfma_f32_16x16x32_bf16 v[120:123], a[32:35], a[196:199], v[120:123]
    ds_read_b128 a[164:167], v2 offset:256
    v_mfma_f32_16x16x32_bf16 v[120:123], a[56:59], a[200:203], v[120:123]
    s_add_u32 s30, s30, 3145728
    v_mfma_f32_16x16x32_bf16 v[120:123], a[80:83], a[204:207], v[120:123]
    s_add_u32 s42, s42, 12288
    v_mfma_f32_16x16x32_bf16 v[120:123], a[104:107], a[208:211], v[120:123]
    s_cmp_eq_u32 s42, 135168
    s_cselect_b32 s42, 0, s42
    v_mfma_f32_16x16x32_bf16 v[120:123], a[128:131], a[212:215], v[120:123]
    s_add_u32 m0, s42, s41
    v_mfma_f32_16x16x32_bf16 v[120:123], v[200:203], a[216:219], v[120:123]
    ds_read_b128 a[168:171], v3 offset:256
    v_mfma_f32_16x16x32_bf16 v[120:123], v[232:235], a[220:223], v[120:123]
    ds_read_b128 a[244:247], v10 offset:12544
    v_mfma_f32_16x16x32_bf16 v[120:123], v[40:43], a[224:227], v[120:123]
    s_waitcnt lgkmcnt(6)
    buffer_store_dwordx4 a[240:243], v12, s[24:27], s31 offen offset:0 sc0 sc1
    v_mfma_f32_16x16x32_bf16 v[120:123], v[72:75], a[228:231], v[120:123]
    v_cvt_pk_bf16_f32 v20, v249, v253
    v_mfma_f32_16x16x32_bf16 v[120:123], v[104:107], a[232:235], v[120:123]
    v_cvt_pk_bf16_f32 v21, v57, v61
    v_mfma_f32_16x16x32_bf16 v[120:123], v[136:139], a[236:239], v[120:123]
    ds_read_b128 a[172:175], v4 offset:256
    v_mfma_f32_16x16x32_bf16 v[124:127], a[12:15], a[192:195], v[172:175]
    v_cvt_pk_bf16_f32 v22, v218, v222
    v_mfma_f32_16x16x32_bf16 v[124:127], a[36:39], a[196:199], v[124:127]
    v_cvt_pk_bf16_f32 v23, v250, v254
    v_mfma_f32_16x16x32_bf16 v[124:127], a[60:63], a[200:203], v[124:127]
    v_mfma_f32_16x16x32_bf16 v[124:127], a[84:87], a[204:207], v[124:127]
    v_mfma_f32_16x16x32_bf16 v[124:127], a[108:111], a[208:211], v[124:127]
    ds_write_b128 v8, v[20:23] offset:16
    v_mfma_f32_16x16x32_bf16 v[124:127], a[132:135], a[212:215], v[124:127]
    ds_read_b128 a[176:179], v1 offset:512
    v_mfma_f32_16x16x32_bf16 v[124:127], v[204:207], a[216:219], v[124:127]
    s_add_u32 s29, s29, 1
    v_mfma_f32_16x16x32_bf16 v[124:127], v[236:239], a[220:223], v[124:127]
    s_cmp_lt_u32 s29, 33
    s_cselect_b32 s14, s40, 0
    v_mfma_f32_16x16x32_bf16 v[124:127], v[44:47], a[224:227], v[124:127]
    v_cvt_pk_bf16_f32 v24, v58, v62
    v_mfma_f32_16x16x32_bf16 v[124:127], v[76:79], a[228:231], v[124:127]
    ds_read_b128 a[180:183], v2 offset:512
    v_mfma_f32_16x16x32_bf16 v[124:127], v[108:111], a[232:235], v[124:127]
    ds_read_b128 a[248:251], v11 offset:12544
    v_mfma_f32_16x16x32_bf16 v[124:127], v[140:143], a[236:239], v[124:127]
    v_cvt_pk_bf16_f32 v25, v219, v223
    v_mfma_f32_16x16x32_bf16 v[152:155], a[16:19], a[192:195], v[176:179]
    s_waitcnt lgkmcnt(5)
    buffer_store_dwordx4 a[244:247], v12, s[24:27], s31 offen offset:1024 sc0 sc1
    v_mfma_f32_16x16x32_bf16 v[152:155], a[40:43], a[196:199], v[152:155]
    v_cvt_pk_bf16_f32 v26, v251, v255
    v_mfma_f32_16x16x32_bf16 v[152:155], a[64:67], a[200:203], v[152:155]
    ds_read_b128 a[184:187], v3 offset:512
    v_mfma_f32_16x16x32_bf16 v[152:155], a[88:91], a[204:207], v[152:155]
    v_cvt_pk_bf16_f32 v27, v59, v63
    v_mfma_f32_16x16x32_bf16 v[152:155], a[112:115], a[208:211], v[152:155]
    v_add_u32 v1, s33, v1
    v_mfma_f32_16x16x32_bf16 v[152:155], a[136:139], a[212:215], v[152:155]
    v_add_u32 v2, s33, v2
    v_mfma_f32_16x16x32_bf16 v[152:155], v[208:211], a[216:219], v[152:155]
    v_add_u32 v3, s33, v3
    v_mfma_f32_16x16x32_bf16 v[152:155], v[240:243], a[220:223], v[152:155]
    ds_read_b128 a[188:191], v4 offset:512
    v_mfma_f32_16x16x32_bf16 v[152:155], v[48:51], a[224:227], v[152:155]
    ds_write_b128 v8, v[24:27] offset:32
    v_mfma_f32_16x16x32_bf16 v[152:155], v[80:83], a[228:231], v[152:155]
    v_add_u32 v4, s33, v4
    v_mfma_f32_16x16x32_bf16 v[152:155], v[112:115], a[232:235], v[152:155]
    v_mfma_f32_16x16x32_bf16 v[152:155], v[144:147], a[236:239], v[152:155]
    v_mfma_f32_16x16x32_bf16 v[156:159], a[20:23], a[192:195], v[180:183]
    v_mfma_f32_16x16x32_bf16 v[156:159], a[44:47], a[196:199], v[156:159]
    v_mfma_f32_16x16x32_bf16 v[156:159], a[68:71], a[200:203], v[156:159]
    v_mfma_f32_16x16x32_bf16 v[156:159], a[92:95], a[204:207], v[156:159]
    v_mfma_f32_16x16x32_bf16 v[156:159], a[116:119], a[208:211], v[156:159]
    s_waitcnt lgkmcnt(3)
    buffer_store_dwordx4 a[248:251], v12, s[24:27], s31 offen offset:2048 sc0 sc1
    v_mfma_f32_16x16x32_bf16 v[156:159], a[140:143], a[212:215], v[156:159]
    v_mfma_f32_16x16x32_bf16 v[156:159], v[212:215], a[216:219], v[156:159]
    v_mfma_f32_16x16x32_bf16 v[156:159], v[244:247], a[220:223], v[156:159]
    v_mfma_f32_16x16x32_bf16 v[156:159], v[52:55], a[224:227], v[156:159]
    v_mfma_f32_16x16x32_bf16 v[156:159], v[84:87], a[228:231], v[156:159]
    v_mfma_f32_16x16x32_bf16 v[156:159], v[116:119], a[232:235], v[156:159]
    v_mfma_f32_16x16x32_bf16 v[156:159], v[148:151], a[236:239], v[156:159]
    s_cmp_lt_u32 s29, 36
    s_cbranch_scc1 L_g0_loop0
    s_branch L_drain
.p2align 6
L_g0_loop1:
    s_waitcnt vmcnt(9) lgkmcnt(0)
    s_barrier
    v_mfma_f32_16x16x32_bf16 v[216:219], a[0:3], a[144:147], v[160:163]
    ds_read_b128 a[192:195], v1 offset:0
    v_mfma_f32_16x16x32_bf16 v[216:219], a[24:27], a[148:151], v[216:219]
    buffer_load_dwordx4 v5, s[12:15], s30 offen offset:0 nt lds
    v_mfma_f32_16x16x32_bf16 v[216:219], a[48:51], a[152:155], v[216:219]
    s_add_u32 s31, s31, 3145728
    v_mfma_f32_16x16x32_bf16 v[216:219], a[72:75], a[156:159], v[216:219]
    s_mov_b32 s26, s43
    v_mfma_f32_16x16x32_bf16 v[216:219], a[96:99], a[160:163], v[216:219]
    s_mov_b32 s43, 113246208
    v_mfma_f32_16x16x32_bf16 v[216:219], a[120:123], a[164:167], v[216:219]
    ds_read_b128 a[196:199], v2 offset:0
    v_mfma_f32_16x16x32_bf16 v[216:219], v[192:195], a[168:171], v[216:219]
    v_cvt_pk_bf16_f32 v16, v88, v92
    v_mfma_f32_16x16x32_bf16 v[216:219], v[224:227], a[172:175], v[216:219]
    v_cvt_pk_bf16_f32 v17, v120, v124
    v_mfma_f32_16x16x32_bf16 v[216:219], v[32:35], a[176:179], v[216:219]
    v_cvt_pk_bf16_f32 v18, v152, v156
    v_mfma_f32_16x16x32_bf16 v[216:219], v[64:67], a[180:183], v[216:219]
    buffer_load_dwordx4 v6, s[12:15], s30 offen offset:1024 nt lds
    v_mfma_f32_16x16x32_bf16 v[216:219], v[96:99], a[184:187], v[216:219]
    ds_read_b128 a[200:203], v3 offset:0
    v_mfma_f32_16x16x32_bf16 v[216:219], v[128:131], a[188:191], v[216:219]
    v_cvt_pk_bf16_f32 v19, v89, v93
    v_mfma_f32_16x16x32_bf16 v[220:223], a[4:7], a[144:147], v[164:167]
    s_add_u32 s38, s34, 12288
    v_mfma_f32_16x16x32_bf16 v[220:223], a[28:31], a[148:151], v[220:223]
    s_cmp_eq_u32 s38, 135168
    s_cselect_b32 s38, 0, s38
    v_mfma_f32_16x16x32_bf16 v[220:223], a[52:55], a[152:155], v[220:223]
    s_sub_u32 s33, s38, s34
    v_mfma_f32_16x16x32_bf16 v[220:223], a[76:79], a[156:159], v[220:223]
    ds_read_b128 a[204:207], v4 offset:0
    v_mfma_f32_16x16x32_bf16 v[220:223], a[100:103], a[160:163], v[220:223]
    ds_read_b128 a[240:243], v9 offset:0
    v_mfma_f32_16x16x32_bf16 v[220:223], a[124:127], a[164:167], v[220:223]
    ds_write_b128 v8, v[16:19] offset:12544
    v_mfma_f32_16x16x32_bf16 v[220:223], v[196:199], a[168:171], v[220:223]
    s_mov_b32 s34, s38
    v_mfma_f32_16x16x32_bf16 v[220:223], v[228:231], a[172:175], v[220:223]
    v_mfma_f32_16x16x32_bf16 v[220:223], v[36:39], a[176:179], v[220:223]
    ds_read_b128 a[208:211], v1 offset:256
    v_mfma_f32_16x16x32_bf16 v[220:223], v[68:71], a[180:183], v[220:223]
    v_mfma_f32_16x16x32_bf16 v[220:223], v[100:103], a[184:187], v[220:223]
    v_mfma_f32_16x16x32_bf16 v[220:223], v[132:135], a[188:191], v[220:223]
    v_mfma_f32_16x16x32_bf16 v[248:251], a[8:11], a[144:147], v[168:171]
    v_mfma_f32_16x16x32_bf16 v[248:251], a[32:35], a[148:151], v[248:251]
    buffer_load_dwordx4 v7, s[12:15], s30 offen offset:2048 nt lds
    v_mfma_f32_16x16x32_bf16 v[248:251], a[56:59], a[152:155], v[248:251]
    ds_read_b128 a[212:215], v2 offset:256
    v_mfma_f32_16x16x32_bf16 v[248:251], a[80:83], a[156:159], v[248:251]
    s_add_u32 s30, s30, 3145728
    v_mfma_f32_16x16x32_bf16 v[248:251], a[104:107], a[160:163], v[248:251]
    s_add_u32 s42, s42, 12288
    v_mfma_f32_16x16x32_bf16 v[248:251], a[128:131], a[164:167], v[248:251]
    s_cmp_eq_u32 s42, 135168
    s_cselect_b32 s42, 0, s42
    v_mfma_f32_16x16x32_bf16 v[248:251], v[200:203], a[168:171], v[248:251]
    ds_read_b128 a[216:219], v3 offset:256
    v_mfma_f32_16x16x32_bf16 v[248:251], v[232:235], a[172:175], v[248:251]
    s_add_u32 m0, s42, s41
    v_mfma_f32_16x16x32_bf16 v[248:251], v[40:43], a[176:179], v[248:251]
    ds_read_b128 a[244:247], v10 offset:0
    v_mfma_f32_16x16x32_bf16 v[248:251], v[72:75], a[180:183], v[248:251]
    s_waitcnt lgkmcnt(5)
    buffer_store_dwordx4 a[240:243], v12, s[24:27], s31 offen offset:0 sc0 sc1
    v_mfma_f32_16x16x32_bf16 v[248:251], v[104:107], a[184:187], v[248:251]
    v_cvt_pk_bf16_f32 v20, v121, v125
    v_mfma_f32_16x16x32_bf16 v[248:251], v[136:139], a[188:191], v[248:251]
    ds_read_b128 a[220:223], v4 offset:256
    v_mfma_f32_16x16x32_bf16 v[252:255], a[12:15], a[144:147], v[172:175]
    v_cvt_pk_bf16_f32 v21, v153, v157
    v_mfma_f32_16x16x32_bf16 v[252:255], a[36:39], a[148:151], v[252:255]
    v_cvt_pk_bf16_f32 v22, v90, v94
    v_mfma_f32_16x16x32_bf16 v[252:255], a[60:63], a[152:155], v[252:255]
    v_cvt_pk_bf16_f32 v23, v122, v126
    v_mfma_f32_16x16x32_bf16 v[252:255], a[84:87], a[156:159], v[252:255]
    v_mfma_f32_16x16x32_bf16 v[252:255], a[108:111], a[160:163], v[252:255]
    ds_read_b128 a[224:227], v1 offset:512
    v_mfma_f32_16x16x32_bf16 v[252:255], a[132:135], a[164:167], v[252:255]
    ds_write_b128 v8, v[20:23] offset:12560
    v_mfma_f32_16x16x32_bf16 v[252:255], v[204:207], a[168:171], v[252:255]
    s_add_u32 s29, s29, 1
    v_mfma_f32_16x16x32_bf16 v[252:255], v[236:239], a[172:175], v[252:255]
    s_cmp_lt_u32 s29, 33
    s_cselect_b32 s14, s40, 0
    v_mfma_f32_16x16x32_bf16 v[252:255], v[44:47], a[176:179], v[252:255]
    v_cvt_pk_bf16_f32 v24, v154, v158
    v_mfma_f32_16x16x32_bf16 v[252:255], v[76:79], a[180:183], v[252:255]
    ds_read_b128 a[228:231], v2 offset:512
    v_mfma_f32_16x16x32_bf16 v[252:255], v[108:111], a[184:187], v[252:255]
    v_cvt_pk_bf16_f32 v25, v91, v95
    v_mfma_f32_16x16x32_bf16 v[252:255], v[140:143], a[188:191], v[252:255]
    ds_read_b128 a[248:251], v11 offset:0
    v_mfma_f32_16x16x32_bf16 v[56:59], a[16:19], a[144:147], v[176:179]
    v_cvt_pk_bf16_f32 v26, v123, v127
    v_mfma_f32_16x16x32_bf16 v[56:59], a[40:43], a[148:151], v[56:59]
    s_waitcnt lgkmcnt(5)
    buffer_store_dwordx4 a[244:247], v12, s[24:27], s31 offen offset:1024 sc0 sc1
    v_mfma_f32_16x16x32_bf16 v[56:59], a[64:67], a[152:155], v[56:59]
    ds_read_b128 a[232:235], v3 offset:512
    v_mfma_f32_16x16x32_bf16 v[56:59], a[88:91], a[156:159], v[56:59]
    v_cvt_pk_bf16_f32 v27, v155, v159
    v_mfma_f32_16x16x32_bf16 v[56:59], a[112:115], a[160:163], v[56:59]
    v_add_u32 v1, s33, v1
    v_mfma_f32_16x16x32_bf16 v[56:59], a[136:139], a[164:167], v[56:59]
    v_add_u32 v2, s33, v2
    v_mfma_f32_16x16x32_bf16 v[56:59], v[208:211], a[168:171], v[56:59]
    v_add_u32 v3, s33, v3
    v_mfma_f32_16x16x32_bf16 v[56:59], v[240:243], a[172:175], v[56:59]
    ds_read_b128 a[236:239], v4 offset:512
    v_mfma_f32_16x16x32_bf16 v[56:59], v[48:51], a[176:179], v[56:59]
    v_add_u32 v4, s33, v4
    v_mfma_f32_16x16x32_bf16 v[56:59], v[80:83], a[180:183], v[56:59]
    ds_write_b128 v8, v[24:27] offset:12576
    v_mfma_f32_16x16x32_bf16 v[56:59], v[112:115], a[184:187], v[56:59]
    v_mfma_f32_16x16x32_bf16 v[56:59], v[144:147], a[188:191], v[56:59]
    v_mfma_f32_16x16x32_bf16 v[60:63], a[20:23], a[144:147], v[180:183]
    v_mfma_f32_16x16x32_bf16 v[60:63], a[44:47], a[148:151], v[60:63]
    v_mfma_f32_16x16x32_bf16 v[60:63], a[68:71], a[152:155], v[60:63]
    v_mfma_f32_16x16x32_bf16 v[60:63], a[92:95], a[156:159], v[60:63]
    v_mfma_f32_16x16x32_bf16 v[60:63], a[116:119], a[160:163], v[60:63]
    v_mfma_f32_16x16x32_bf16 v[60:63], a[140:143], a[164:167], v[60:63]
    s_waitcnt lgkmcnt(3)
    buffer_store_dwordx4 a[248:251], v12, s[24:27], s31 offen offset:2048 sc0 sc1
    v_mfma_f32_16x16x32_bf16 v[60:63], v[212:215], a[168:171], v[60:63]
    v_mfma_f32_16x16x32_bf16 v[60:63], v[244:247], a[172:175], v[60:63]
    v_mfma_f32_16x16x32_bf16 v[60:63], v[52:55], a[176:179], v[60:63]
    v_mfma_f32_16x16x32_bf16 v[60:63], v[84:87], a[180:183], v[60:63]
    v_mfma_f32_16x16x32_bf16 v[60:63], v[116:119], a[184:187], v[60:63]
    v_mfma_f32_16x16x32_bf16 v[60:63], v[148:151], a[188:191], v[60:63]
    s_waitcnt vmcnt(9) lgkmcnt(0)
    s_barrier
    v_mfma_f32_16x16x32_bf16 v[88:91], a[0:3], a[192:195], v[160:163]
    ds_read_b128 a[144:147], v1 offset:0
    v_mfma_f32_16x16x32_bf16 v[88:91], a[24:27], a[196:199], v[88:91]
    buffer_load_dwordx4 v5, s[12:15], s30 offen offset:0 nt lds
    v_mfma_f32_16x16x32_bf16 v[88:91], a[48:51], a[200:203], v[88:91]
    s_add_u32 s31, s31, 3145728
    v_mfma_f32_16x16x32_bf16 v[88:91], a[72:75], a[204:207], v[88:91]
    v_mfma_f32_16x16x32_bf16 v[88:91], a[96:99], a[208:211], v[88:91]
    v_mfma_f32_16x16x32_bf16 v[88:91], a[120:123], a[212:215], v[88:91]
    ds_read_b128 a[148:151], v2 offset:0
    v_mfma_f32_16x16x32_bf16 v[88:91], v[192:195], a[216:219], v[88:91]
    v_cvt_pk_bf16_f32 v16, v216, v220
    v_mfma_f32_16x16x32_bf16 v[88:91], v[224:227], a[220:223], v[88:91]
    v_cvt_pk_bf16_f32 v17, v248, v252
    v_mfma_f32_16x16x32_bf16 v[88:91], v[32:35], a[224:227], v[88:91]
    v_cvt_pk_bf16_f32 v18, v56, v60
    v_mfma_f32_16x16x32_bf16 v[88:91], v[64:67], a[228:231], v[88:91]
    buffer_load_dwordx4 v6, s[12:15], s30 offen offset:1024 nt lds
    v_mfma_f32_16x16x32_bf16 v[88:91], v[96:99], a[232:235], v[88:91]
    ds_read_b128 a[152:155], v3 offset:0
    v_mfma_f32_16x16x32_bf16 v[88:91], v[128:131], a[236:239], v[88:91]
    v_cvt_pk_bf16_f32 v19, v217, v221
    v_mfma_f32_16x16x32_bf16 v[92:95], a[4:7], a[192:195], v[164:167]
    s_add_u32 s38, s34, 12288
    v_mfma_f32_16x16x32_bf16 v[92:95], a[28:31], a[196:199], v[92:95]
    s_cmp_eq_u32 s38, 135168
    s_cselect_b32 s38, 0, s38
    v_mfma_f32_16x16x32_bf16 v[92:95], a[52:55], a[200:203], v[92:95]
    s_sub_u32 s33, s38, s34
    v_mfma_f32_16x16x32_bf16 v[92:95], a[76:79], a[204:207], v[92:95]
    ds_read_b128 a[156:159], v4 offset:0
    v_mfma_f32_16x16x32_bf16 v[92:95], a[100:103], a[208:211], v[92:95]
    ds_read_b128 a[240:243], v9 offset:12544
    v_mfma_f32_16x16x32_bf16 v[92:95], a[124:127], a[212:215], v[92:95]
    ds_write_b128 v8, v[16:19] offset:0
    v_mfma_f32_16x16x32_bf16 v[92:95], v[196:199], a[216:219], v[92:95]
    s_mov_b32 s34, s38
    v_mfma_f32_16x16x32_bf16 v[92:95], v[228:231], a[220:223], v[92:95]
    v_mfma_f32_16x16x32_bf16 v[92:95], v[36:39], a[224:227], v[92:95]
    ds_read_b128 a[160:163], v1 offset:256
    v_mfma_f32_16x16x32_bf16 v[92:95], v[68:71], a[228:231], v[92:95]
    v_mfma_f32_16x16x32_bf16 v[92:95], v[100:103], a[232:235], v[92:95]
    v_mfma_f32_16x16x32_bf16 v[92:95], v[132:135], a[236:239], v[92:95]
    v_mfma_f32_16x16x32_bf16 v[120:123], a[8:11], a[192:195], v[168:171]
    v_mfma_f32_16x16x32_bf16 v[120:123], a[32:35], a[196:199], v[120:123]
    buffer_load_dwordx4 v7, s[12:15], s30 offen offset:2048 nt lds
    v_mfma_f32_16x16x32_bf16 v[120:123], a[56:59], a[200:203], v[120:123]
    ds_read_b128 a[164:167], v2 offset:256
    v_mfma_f32_16x16x32_bf16 v[120:123], a[80:83], a[204:207], v[120:123]
    s_add_u32 s30, s30, 3145728
    v_mfma_f32_16x16x32_bf16 v[120:123], a[104:107], a[208:211], v[120:123]
    s_add_u32 s42, s42, 12288
    v_mfma_f32_16x16x32_bf16 v[120:123], a[128:131], a[212:215], v[120:123]
    s_cmp_eq_u32 s42, 135168
    s_cselect_b32 s42, 0, s42
    v_mfma_f32_16x16x32_bf16 v[120:123], v[200:203], a[216:219], v[120:123]
    ds_read_b128 a[168:171], v3 offset:256
    v_mfma_f32_16x16x32_bf16 v[120:123], v[232:235], a[220:223], v[120:123]
    s_add_u32 m0, s42, s41
    v_mfma_f32_16x16x32_bf16 v[120:123], v[40:43], a[224:227], v[120:123]
    ds_read_b128 a[244:247], v10 offset:12544
    v_mfma_f32_16x16x32_bf16 v[120:123], v[72:75], a[228:231], v[120:123]
    s_waitcnt lgkmcnt(5)
    buffer_store_dwordx4 a[240:243], v12, s[24:27], s31 offen offset:0 sc0 sc1
    v_mfma_f32_16x16x32_bf16 v[120:123], v[104:107], a[232:235], v[120:123]
    v_cvt_pk_bf16_f32 v20, v249, v253
    v_mfma_f32_16x16x32_bf16 v[120:123], v[136:139], a[236:239], v[120:123]
    ds_read_b128 a[172:175], v4 offset:256
    v_mfma_f32_16x16x32_bf16 v[124:127], a[12:15], a[192:195], v[172:175]
    v_cvt_pk_bf16_f32 v21, v57, v61
    v_mfma_f32_16x16x32_bf16 v[124:127], a[36:39], a[196:199], v[124:127]
    v_cvt_pk_bf16_f32 v22, v218, v222
    v_mfma_f32_16x16x32_bf16 v[124:127], a[60:63], a[200:203], v[124:127]
    v_cvt_pk_bf16_f32 v23, v250, v254
    v_mfma_f32_16x16x32_bf16 v[124:127], a[84:87], a[204:207], v[124:127]
    v_mfma_f32_16x16x32_bf16 v[124:127], a[108:111], a[208:211], v[124:127]
    ds_read_b128 a[176:179], v1 offset:512
    v_mfma_f32_16x16x32_bf16 v[124:127], a[132:135], a[212:215], v[124:127]
    ds_write_b128 v8, v[20:23] offset:16
    v_mfma_f32_16x16x32_bf16 v[124:127], v[204:207], a[216:219], v[124:127]
    s_add_u32 s29, s29, 1
    v_mfma_f32_16x16x32_bf16 v[124:127], v[236:239], a[220:223], v[124:127]
    s_cmp_lt_u32 s29, 33
    s_cselect_b32 s14, s40, 0
    v_mfma_f32_16x16x32_bf16 v[124:127], v[44:47], a[224:227], v[124:127]
    v_cvt_pk_bf16_f32 v24, v58, v62
    v_mfma_f32_16x16x32_bf16 v[124:127], v[76:79], a[228:231], v[124:127]
    ds_read_b128 a[180:183], v2 offset:512
    v_mfma_f32_16x16x32_bf16 v[124:127], v[108:111], a[232:235], v[124:127]
    v_cvt_pk_bf16_f32 v25, v219, v223
    v_mfma_f32_16x16x32_bf16 v[124:127], v[140:143], a[236:239], v[124:127]
    ds_read_b128 a[248:251], v11 offset:12544
    v_mfma_f32_16x16x32_bf16 v[152:155], a[16:19], a[192:195], v[176:179]
    v_cvt_pk_bf16_f32 v26, v251, v255
    v_mfma_f32_16x16x32_bf16 v[152:155], a[40:43], a[196:199], v[152:155]
    s_waitcnt lgkmcnt(5)
    buffer_store_dwordx4 a[244:247], v12, s[24:27], s31 offen offset:1024 sc0 sc1
    v_mfma_f32_16x16x32_bf16 v[152:155], a[64:67], a[200:203], v[152:155]
    ds_read_b128 a[184:187], v3 offset:512
    v_mfma_f32_16x16x32_bf16 v[152:155], a[88:91], a[204:207], v[152:155]
    v_cvt_pk_bf16_f32 v27, v59, v63
    v_mfma_f32_16x16x32_bf16 v[152:155], a[112:115], a[208:211], v[152:155]
    v_add_u32 v1, s33, v1
    v_mfma_f32_16x16x32_bf16 v[152:155], a[136:139], a[212:215], v[152:155]
    v_add_u32 v2, s33, v2
    v_mfma_f32_16x16x32_bf16 v[152:155], v[208:211], a[216:219], v[152:155]
    v_add_u32 v3, s33, v3
    v_mfma_f32_16x16x32_bf16 v[152:155], v[240:243], a[220:223], v[152:155]
    ds_read_b128 a[188:191], v4 offset:512
    v_mfma_f32_16x16x32_bf16 v[152:155], v[48:51], a[224:227], v[152:155]
    v_add_u32 v4, s33, v4
    v_mfma_f32_16x16x32_bf16 v[152:155], v[80:83], a[228:231], v[152:155]
    ds_write_b128 v8, v[24:27] offset:32
    v_mfma_f32_16x16x32_bf16 v[152:155], v[112:115], a[232:235], v[152:155]
    v_mfma_f32_16x16x32_bf16 v[152:155], v[144:147], a[236:239], v[152:155]
    v_mfma_f32_16x16x32_bf16 v[156:159], a[20:23], a[192:195], v[180:183]
    v_mfma_f32_16x16x32_bf16 v[156:159], a[44:47], a[196:199], v[156:159]
    v_mfma_f32_16x16x32_bf16 v[156:159], a[68:71], a[200:203], v[156:159]
    v_mfma_f32_16x16x32_bf16 v[156:159], a[92:95], a[204:207], v[156:159]
    v_mfma_f32_16x16x32_bf16 v[156:159], a[116:119], a[208:211], v[156:159]
    v_mfma_f32_16x16x32_bf16 v[156:159], a[140:143], a[212:215], v[156:159]
    s_waitcnt lgkmcnt(3)
    buffer_store_dwordx4 a[248:251], v12, s[24:27], s31 offen offset:2048 sc0 sc1
    v_mfma_f32_16x16x32_bf16 v[156:159], v[212:215], a[216:219], v[156:159]
    v_mfma_f32_16x16x32_bf16 v[156:159], v[244:247], a[220:223], v[156:159]
    v_mfma_f32_16x16x32_bf16 v[156:159], v[52:55], a[224:227], v[156:159]
    v_mfma_f32_16x16x32_bf16 v[156:159], v[84:87], a[228:231], v[156:159]
    v_mfma_f32_16x16x32_bf16 v[156:159], v[116:119], a[232:235], v[156:159]
    v_mfma_f32_16x16x32_bf16 v[156:159], v[148:151], a[236:239], v[156:159]
    s_cmp_lt_u32 s29, 36
    s_cbranch_scc1 L_g0_loop1
    s_branch L_drain
.p2align 6
L_g0_loop2:
    s_waitcnt vmcnt(9) lgkmcnt(0)
    s_barrier
    v_mfma_f32_16x16x32_bf16 v[216:219], a[0:3], a[144:147], v[160:163]
    ds_read_b128 a[192:195], v1 offset:0
    v_mfma_f32_16x16x32_bf16 v[216:219], a[24:27], a[148:151], v[216:219]
    s_add_u32 s31, s31, 3145728
    v_mfma_f32_16x16x32_bf16 v[216:219], a[48:51], a[152:155], v[216:219]
    buffer_load_dwordx4 v5, s[12:15], s30 offen offset:0 nt lds
    v_mfma_f32_16x16x32_bf16 v[216:219], a[72:75], a[156:159], v[216:219]
    s_mov_b32 s26, s43
    v_mfma_f32_16x16x32_bf16 v[216:219], a[96:99], a[160:163], v[216:219]
    s_mov_b32 s43, 113246208
    v_mfma_f32_16x16x32_bf16 v[216:219], a[120:123], a[164:167], v[216:219]
    ds_read_b128 a[196:199], v2 offset:0
    v_mfma_f32_16x16x32_bf16 v[216:219], v[192:195], a[168:171], v[216:219]
    v_cvt_pk_bf16_f32 v16, v88, v92
    v_mfma_f32_16x16x32_bf16 v[216:219], v[224:227], a[172:175], v[216:219]
    v_cvt_pk_bf16_f32 v17, v120, v124
    v_mfma_f32_16x16x32_bf16 v[216:219], v[32:35], a[176:179], v[216:219]
    v_cvt_pk_bf16_f32 v18, v152, v156
    v_mfma_f32_16x16x32_bf16 v[216:219], v[64:67], a[180:183], v[216:219]
    v_cvt_pk_bf16_f32 v19, v89, v93
    v_mfma_f32_16x16x32_bf16 v[216:219], v[96:99], a[184:187], v[216:219]
    buffer_load_dwordx4 v6, s[12:15], s30 offen offset:1024 nt lds
    v_mfma_f32_16x16x32_bf16 v[216:219], v[128:131], a[188:191], v[216:219]
    ds_read_b128 a[200:203], v3 offset:0
    v_mfma_f32_16x16x32_bf16 v[220:223], a[4:7], a[144:147], v[164:167]
    s_add_u32 s38, s34, 12288
    v_mfma_f32_16x16x32_bf16 v[220:223], a[28:31], a[148:151], v[220:223]
    s_cmp_eq_u32 s38, 135168
    s_cselect_b32 s38, 0, s38
    v_mfma_f32_16x16x32_bf16 v[220:223], a[52:55], a[152:155], v[220:223]
    s_sub_u32 s33, s38, s34
    v_mfma_f32_16x16x32_bf16 v[220:223], a[76:79], a[156:159], v[220:223]
    ds_read_b128 a[204:207], v4 offset:0
    v_mfma_f32_16x16x32_bf16 v[220:223], a[100:103], a[160:163], v[220:223]
    ds_read_b128 a[240:243], v9 offset:0
    v_mfma_f32_16x16x32_bf16 v[220:223], a[124:127], a[164:167], v[220:223]
    s_mov_b32 s34, s38
    v_mfma_f32_16x16x32_bf16 v[220:223], v[196:199], a[168:171], v[220:223]
    ds_write_b128 v8, v[16:19] offset:12544
    v_mfma_f32_16x16x32_bf16 v[220:223], v[228:231], a[172:175], v[220:223]
    v_mfma_f32_16x16x32_bf16 v[220:223], v[36:39], a[176:179], v[220:223]
    ds_read_b128 a[208:211], v1 offset:256
    v_mfma_f32_16x16x32_bf16 v[220:223], v[68:71], a[180:183], v[220:223]
    v_mfma_f32_16x16x32_bf16 v[220:223], v[100:103], a[184:187], v[220:223]
    v_mfma_f32_16x16x32_bf16 v[220:223], v[132:135], a[188:191], v[220:223]
    v_mfma_f32_16x16x32_bf16 v[248:251], a[8:11], a[144:147], v[168:171]
    v_mfma_f32_16x16x32_bf16 v[248:251], a[32:35], a[148:151], v[248:251]
    ds_read_b128 a[212:215], v2 offset:256
    v_mfma_f32_16x16x32_bf16 v[248:251], a[56:59], a[152:155], v[248:251]
    buffer_load_dwordx4 v7, s[12:15], s30 offen offset:2048 nt lds
    v_mfma_f32_16x16x32_bf16 v[248:251], a[80:83], a[156:159], v[248:251]
    s_add_u32 s30, s30, 3145728
    v_mfma_f32_16x16x32_bf16 v[248:251], a[104:107], a[160:163], v[248:251]
    s_add_u32 s42, s42, 12288
    v_mfma_f32_16x16x32_bf16 v[248:251], a[128:131], a[164:167], v[248:251]
    s_cmp_eq_u32 s42, 135168
    s_cselect_b32 s42, 0, s42
    v_mfma_f32_16x16x32_bf16 v[248:251], v[200:203], a[168:171], v[248:251]
    ds_read_b128 a[216:219], v3 offset:256
    v_mfma_f32_16x16x32_bf16 v[248:251], v[232:235], a[172:175], v[248:251]
    s_add_u32 m0, s42, s41
    v_mfma_f32_16x16x32_bf16 v[248:251], v[40:43], a[176:179], v[248:251]
    ds_read_b128 a[244:247], v10 offset:0
    v_mfma_f32_16x16x32_bf16 v[248:251], v[72:75], a[180:183], v[248:251]
    v_cvt_pk_bf16_f32 v20, v121, v125
    v_mfma_f32_16x16x32_bf16 v[248:251], v[104:107], a[184:187], v[248:251]
    s_waitcnt lgkmcnt(5)
    buffer_store_dwordx4 a[240:243], v12, s[24:27], s31 offen offset:0 sc0 sc1
    v_mfma_f32_16x16x32_bf16 v[248:251], v[136:139], a[188:191], v[248:251]
    ds_read_b128 a[220:223], v4 offset:256
    v_mfma_f32_16x16x32_bf16 v[252:255], a[12:15], a[144:147], v[172:175]
    v_cvt_pk_bf16_f32 v21, v153, v157
    v_mfma_f32_16x16x32_bf16 v[252:255], a[36:39], a[148:151], v[252:255]
    v_cvt_pk_bf16_f32 v22, v90, v94
    v_mfma_f32_16x16x32_bf16 v[252:255], a[60:63], a[152:155], v[252:255]
    v_cvt_pk_bf16_f32 v23, v122, v126
    v_mfma_f32_16x16x32_bf16 v[252:255], a[84:87], a[156:159], v[252:255]
    v_mfma_f32_16x16x32_bf16 v[252:255], a[108:111], a[160:163], v[252:255]
    ds_read_b128 a[224:227], v1 offset:512
    v_mfma_f32_16x16x32_bf16 v[252:255], a[132:135], a[164:167], v[252:255]
    s_add_u32 s29, s29, 1
    v_mfma_f32_16x16x32_bf16 v[252:255], v[204:207], a[168:171], v[252:255]
    ds_write_b128 v8, v[20:23] offset:12560
    v_mfma_f32_16x16x32_bf16 v[252:255], v[236:239], a[172:175], v[252:255]
    s_cmp_lt_u32 s29, 33
    s_cselect_b32 s14, s40, 0
    v_mfma_f32_16x16x32_bf16 v[252:255], v[44:47], a[176:179], v[252:255]
    v_add_u32 v1, s33, v1
    v_mfma_f32_16x16x32_bf16 v[252:255], v[76:79], a[180:183], v[252:255]
    ds_read_b128 a[228:231], v2 offset:512
    v_mfma_f32_16x16x32_bf16 v[252:255], v[108:111], a[184:187], v[252:255]
    v_cvt_pk_bf16_f32 v24, v154, v158
    v_mfma_f32_16x16x32_bf16 v[252:255], v[140:143], a[188:191], v[252:255]
    v_cvt_pk_bf16_f32 v25, v91, v95
    v_mfma_f32_16x16x32_bf16 v[56:59], a[16:19], a[144:147], v[176:179]
    ds_read_b128 a[248:251], v11 offset:0
    v_mfma_f32_16x16x32_bf16 v[56:59], a[40:43], a[148:151], v[56:59]
    v_cvt_pk_bf16_f32 v26, v123, v127
    v_mfma_f32_16x16x32_bf16 v[56:59], a[64:67], a[152:155], v[56:59]
    s_waitcnt lgkmcnt(5)
    buffer_store_dwordx4 a[244:247], v12, s[24:27], s31 offen offset:1024 sc0 sc1
    v_mfma_f32_16x16x32_bf16 v[56:59], a[88:91], a[156:159], v[56:59]
    ds_read_b128 a[232:235], v3 offset:512
    v_mfma_f32_16x16x32_bf16 v[56:59], a[112:115], a[160:163], v[56:59]
    v_cvt_pk_bf16_f32 v27, v155, v159
    v_mfma_f32_16x16x32_bf16 v[56:59], a[136:139], a[164:167], v[56:59]
    v_add_u32 v2, s33, v2
    v_mfma_f32_16x16x32_bf16 v[56:59], v[208:211], a[168:171], v[56:59]
    v_add_u32 v3, s33, v3
    v_mfma_f32_16x16x32_bf16 v[56:59], v[240:243], a[172:175], v[56:59]
    ds_read_b128 a[236:239], v4 offset:512
    v_mfma_f32_16x16x32_bf16 v[56:59], v[48:51], a[176:179], v[56:59]
    v_add_u32 v4, s33, v4
    v_mfma_f32_16x16x32_bf16 v[56:59], v[80:83], a[180:183], v[56:59]
    v_mfma_f32_16x16x32_bf16 v[56:59], v[112:115], a[184:187], v[56:59]
    ds_write_b128 v8, v[24:27] offset:12576
    v_mfma_f32_16x16x32_bf16 v[56:59], v[144:147], a[188:191], v[56:59]
    v_mfma_f32_16x16x32_bf16 v[60:63], a[20:23], a[144:147], v[180:183]
    v_mfma_f32_16x16x32_bf16 v[60:63], a[44:47], a[148:151], v[60:63]
    v_mfma_f32_16x16x32_bf16 v[60:63], a[68:71], a[152:155], v[60:63]
    v_mfma_f32_16x16x32_bf16 v[60:63], a[92:95], a[156:159], v[60:63]
    v_mfma_f32_16x16x32_bf16 v[60:63], a[116:119], a[160:163], v[60:63]
    v_mfma_f32_16x16x32_bf16 v[60:63], a[140:143], a[164:167], v[60:63]
    v_mfma_f32_16x16x32_bf16 v[60:63], v[212:215], a[168:171], v[60:63]
    s_waitcnt lgkmcnt(3)
    buffer_store_dwordx4 a[248:251], v12, s[24:27], s31 offen offset:2048 sc0 sc1
    v_mfma_f32_16x16x32_bf16 v[60:63], v[244:247], a[172:175], v[60:63]
    v_mfma_f32_16x16x32_bf16 v[60:63], v[52:55], a[176:179], v[60:63]
    v_mfma_f32_16x16x32_bf16 v[60:63], v[84:87], a[180:183], v[60:63]
    v_mfma_f32_16x16x32_bf16 v[60:63], v[116:119], a[184:187], v[60:63]
    v_mfma_f32_16x16x32_bf16 v[60:63], v[148:151], a[188:191], v[60:63]
    s_waitcnt vmcnt(9) lgkmcnt(0)
    s_barrier
    v_mfma_f32_16x16x32_bf16 v[88:91], a[0:3], a[192:195], v[160:163]
    ds_read_b128 a[144:147], v1 offset:0
    v_mfma_f32_16x16x32_bf16 v[88:91], a[24:27], a[196:199], v[88:91]
    s_add_u32 s31, s31, 3145728
    v_mfma_f32_16x16x32_bf16 v[88:91], a[48:51], a[200:203], v[88:91]
    buffer_load_dwordx4 v5, s[12:15], s30 offen offset:0 nt lds
    v_mfma_f32_16x16x32_bf16 v[88:91], a[72:75], a[204:207], v[88:91]
    v_mfma_f32_16x16x32_bf16 v[88:91], a[96:99], a[208:211], v[88:91]
    v_mfma_f32_16x16x32_bf16 v[88:91], a[120:123], a[212:215], v[88:91]
    ds_read_b128 a[148:151], v2 offset:0
    v_mfma_f32_16x16x32_bf16 v[88:91], v[192:195], a[216:219], v[88:91]
    v_cvt_pk_bf16_f32 v16, v216, v220
    v_mfma_f32_16x16x32_bf16 v[88:91], v[224:227], a[220:223], v[88:91]
    v_cvt_pk_bf16_f32 v17, v248, v252
    v_mfma_f32_16x16x32_bf16 v[88:91], v[32:35], a[224:227], v[88:91]
    v_cvt_pk_bf16_f32 v18, v56, v60
    v_mfma_f32_16x16x32_bf16 v[88:91], v[64:67], a[228:231], v[88:91]
    v_cvt_pk_bf16_f32 v19, v217, v221
    v_mfma_f32_16x16x32_bf16 v[88:91], v[96:99], a[232:235], v[88:91]
    buffer_load_dwordx4 v6, s[12:15], s30 offen offset:1024 nt lds
    v_mfma_f32_16x16x32_bf16 v[88:91], v[128:131], a[236:239], v[88:91]
    ds_read_b128 a[152:155], v3 offset:0
    v_mfma_f32_16x16x32_bf16 v[92:95], a[4:7], a[192:195], v[164:167]
    s_add_u32 s38, s34, 12288
    v_mfma_f32_16x16x32_bf16 v[92:95], a[28:31], a[196:199], v[92:95]
    s_cmp_eq_u32 s38, 135168
    s_cselect_b32 s38, 0, s38
    v_mfma_f32_16x16x32_bf16 v[92:95], a[52:55], a[200:203], v[92:95]
    s_sub_u32 s33, s38, s34
    v_mfma_f32_16x16x32_bf16 v[92:95], a[76:79], a[204:207], v[92:95]
    ds_read_b128 a[156:159], v4 offset:0
    v_mfma_f32_16x16x32_bf16 v[92:95], a[100:103], a[208:211], v[92:95]
    ds_read_b128 a[240:243], v9 offset:12544
    v_mfma_f32_16x16x32_bf16 v[92:95], a[124:127], a[212:215], v[92:95]
    s_mov_b32 s34, s38
    v_mfma_f32_16x16x32_bf16 v[92:95], v[196:199], a[216:219], v[92:95]
    ds_write_b128 v8, v[16:19] offset:0
    v_mfma_f32_16x16x32_bf16 v[92:95], v[228:231], a[220:223], v[92:95]
    v_mfma_f32_16x16x32_bf16 v[92:95], v[36:39], a[224:227], v[92:95]
    ds_read_b128 a[160:163], v1 offset:256
    v_mfma_f32_16x16x32_bf16 v[92:95], v[68:71], a[228:231], v[92:95]
    v_mfma_f32_16x16x32_bf16 v[92:95], v[100:103], a[232:235], v[92:95]
    v_mfma_f32_16x16x32_bf16 v[92:95], v[132:135], a[236:239], v[92:95]
    v_mfma_f32_16x16x32_bf16 v[120:123], a[8:11], a[192:195], v[168:171]
    v_mfma_f32_16x16x32_bf16 v[120:123], a[32:35], a[196:199], v[120:123]
    ds_read_b128 a[164:167], v2 offset:256
    v_mfma_f32_16x16x32_bf16 v[120:123], a[56:59], a[200:203], v[120:123]
    buffer_load_dwordx4 v7, s[12:15], s30 offen offset:2048 nt lds
    v_mfma_f32_16x16x32_bf16 v[120:123], a[80:83], a[204:207], v[120:123]
    s_add_u32 s30, s30, 3145728
    v_mfma_f32_16x16x32_bf16 v[120:123], a[104:107], a[208:211], v[120:123]
    s_add_u32 s42, s42, 12288
    v_mfma_f32_16x16x32_bf16 v[120:123], a[128:131], a[212:215], v[120:123]
    s_cmp_eq_u32 s42, 135168
    s_cselect_b32 s42, 0, s42
    v_mfma_f32_16x16x32_bf16 v[120:123], v[200:203], a[216:219], v[120:123]
    ds_read_b128 a[168:171], v3 offset:256
    v_mfma_f32_16x16x32_bf16 v[120:123], v[232:235], a[220:223], v[120:123]
    s_add_u32 m0, s42, s41
    v_mfma_f32_16x16x32_bf16 v[120:123], v[40:43], a[224:227], v[120:123]
    ds_read_b128 a[244:247], v10 offset:12544
    v_mfma_f32_16x16x32_bf16 v[120:123], v[72:75], a[228:231], v[120:123]
    v_cvt_pk_bf16_f32 v20, v249, v253
    v_mfma_f32_16x16x32_bf16 v[120:123], v[104:107], a[232:235], v[120:123]
    s_waitcnt lgkmcnt(5)
    buffer_store_dwordx4 a[240:243], v12, s[24:27], s31 offen offset:0 sc0 sc1
    v_mfma_f32_16x16x32_bf16 v[120:123], v[136:139], a[236:239], v[120:123]
    ds_read_b128 a[172:175], v4 offset:256
    v_mfma_f32_16x16x32_bf16 v[124:127], a[12:15], a[192:195], v[172:175]
    v_cvt_pk_bf16_f32 v21, v57, v61
    v_mfma_f32_16x16x32_bf16 v[124:127], a[36:39], a[196:199], v[124:127]
    v_cvt_pk_bf16_f32 v22, v218, v222
    v_mfma_f32_16x16x32_bf16 v[124:127], a[60:63], a[200:203], v[124:127]
    v_cvt_pk_bf16_f32 v23, v250, v254
    v_mfma_f32_16x16x32_bf16 v[124:127], a[84:87], a[204:207], v[124:127]
    v_mfma_f32_16x16x32_bf16 v[124:127], a[108:111], a[208:211], v[124:127]
    ds_read_b128 a[176:179], v1 offset:512
    v_mfma_f32_16x16x32_bf16 v[124:127], a[132:135], a[212:215], v[124:127]
    s_add_u32 s29, s29, 1
    v_mfma_f32_16x16x32_bf16 v[124:127], v[204:207], a[216:219], v[124:127]
    ds_write_b128 v8, v[20:23] offset:16
    v_mfma_f32_16x16x32_bf16 v[124:127], v[236:239], a[220:223], v[124:127]
    s_cmp_lt_u32 s29, 33
    s_cselect_b32 s14, s40, 0
    v_mfma_f32_16x16x32_bf16 v[124:127], v[44:47], a[224:227], v[124:127]
    v_add_u32 v1, s33, v1
    v_mfma_f32_16x16x32_bf16 v[124:127], v[76:79], a[228:231], v[124:127]
    ds_read_b128 a[180:183], v2 offset:512
    v_mfma_f32_16x16x32_bf16 v[124:127], v[108:111], a[232:235], v[124:127]
    v_cvt_pk_bf16_f32 v24, v58, v62
    v_mfma_f32_16x16x32_bf16 v[124:127], v[140:143], a[236:239], v[124:127]
    v_cvt_pk_bf16_f32 v25, v219, v223
    v_mfma_f32_16x16x32_bf16 v[152:155], a[16:19], a[192:195], v[176:179]
    ds_read_b128 a[248:251], v11 offset:12544
    v_mfma_f32_16x16x32_bf16 v[152:155], a[40:43], a[196:199], v[152:155]
    v_cvt_pk_bf16_f32 v26, v251, v255
    v_mfma_f32_16x16x32_bf16 v[152:155], a[64:67], a[200:203], v[152:155]
    s_waitcnt lgkmcnt(5)
    buffer_store_dwordx4 a[244:247], v12, s[24:27], s31 offen offset:1024 sc0 sc1
    v_mfma_f32_16x16x32_bf16 v[152:155], a[88:91], a[204:207], v[152:155]
    ds_read_b128 a[184:187], v3 offset:512
    v_mfma_f32_16x16x32_bf16 v[152:155], a[112:115], a[208:211], v[152:155]
    v_cvt_pk_bf16_f32 v27, v59, v63
    v_mfma_f32_16x16x32_bf16 v[152:155], a[136:139], a[212:215], v[152:155]
    v_add_u32 v2, s33, v2
    v_mfma_f32_16x16x32_bf16 v[152:155], v[208:211], a[216:219], v[152:155]
    v_add_u32 v3, s33, v3
    v_mfma_f32_16x16x32_bf16 v[152:155], v[240:243], a[220:223], v[152:155]
    ds_read_b128 a[188:191], v4 offset:512
    v_mfma_f32_16x16x32_bf16 v[152:155], v[48:51], a[224:227], v[152:155]
    v_add_u32 v4, s33, v4
    v_mfma_f32_16x16x32_bf16 v[152:155], v[80:83], a[228:231], v[152:155]
    v_mfma_f32_16x16x32_bf16 v[152:155], v[112:115], a[232:235], v[152:155]
    ds_write_b128 v8, v[24:27] offset:32
    v_mfma_f32_16x16x32_bf16 v[152:155], v[144:147], a[236:239], v[152:155]
    v_mfma_f32_16x16x32_bf16 v[156:159], a[20:23], a[192:195], v[180:183]
    v_mfma_f32_16x16x32_bf16 v[156:159], a[44:47], a[196:199], v[156:159]
    v_mfma_f32_16x16x32_bf16 v[156:159], a[68:71], a[200:203], v[156:159]
    v_mfma_f32_16x16x32_bf16 v[156:159], a[92:95], a[204:207], v[156:159]
    v_mfma_f32_16x16x32_bf16 v[156:159], a[116:119], a[208:211], v[156:159]
    v_mfma_f32_16x16x32_bf16 v[156:159], a[140:143], a[212:215], v[156:159]
    v_mfma_f32_16x16x32_bf16 v[156:159], v[212:215], a[216:219], v[156:159]
    s_waitcnt lgkmcnt(3)
    buffer_store_dwordx4 a[248:251], v12, s[24:27], s31 offen offset:2048 sc0 sc1
    v_mfma_f32_16x16x32_bf16 v[156:159], v[244:247], a[220:223], v[156:159]
    v_mfma_f32_16x16x32_bf16 v[156:159], v[52:55], a[224:227], v[156:159]
    v_mfma_f32_16x16x32_bf16 v[156:159], v[84:87], a[228:231], v[156:159]
    v_mfma_f32_16x16x32_bf16 v[156:159], v[116:119], a[232:235], v[156:159]
    v_mfma_f32_16x16x32_bf16 v[156:159], v[148:151], a[236:239], v[156:159]
    s_cmp_lt_u32 s29, 36
    s_cbranch_scc1 L_g0_loop2
    s_branch L_drain
.p2align 6
L_g0_loop3:
    s_waitcnt vmcnt(9) lgkmcnt(0)
    s_barrier
    v_mfma_f32_16x16x32_bf16 v[216:219], a[0:3], a[144:147], v[160:163]
    ds_read_b128 a[192:195], v1 offset:0
    v_mfma_f32_16x16x32_bf16 v[216:219], a[24:27], a[148:151], v[216:219]
    s_add_u32 s31, s31, 3145728
    v_mfma_f32_16x16x32_bf16 v[216:219], a[48:51], a[152:155], v[216:219]
    s_mov_b32 s26, s43
    v_mfma_f32_16x16x32_bf16 v[216:219], a[72:75], a[156:159], v[216:219]
    buffer_load_dwordx4 v5, s[12:15], s30 offen offset:0 nt lds
    v_mfma_f32_16x16x32_bf16 v[216:219], a[96:99], a[160:163], v[216:219]
    s_mov_b32 s43, 113246208
    v_mfma_f32_16x16x32_bf16 v[216:219], a[120:123], a[164:167], v[216:219]
    ds_read_b128 a[196:199], v2 offset:0
    v_mfma_f32_16x16x32_bf16 v[216:219], v[192:195], a[168:171], v[216:219]
    v_cvt_pk_bf16_f32 v16, v88, v92
    v_mfma_f32_16x16x32_bf16 v[216:219], v[224:227], a[172:175], v[216:219]
    v_cvt_pk_bf16_f32 v17, v120, v124
    v_mfma_f32_16x16x32_bf16 v[216:219], v[32:35], a[176:179], v[216:219]
    v_cvt_pk_bf16_f32 v18, v152, v156
    v_mfma_f32_16x16x32_bf16 v[216:219], v[64:67], a[180:183], v[216:219]
    v_cvt_pk_bf16_f32 v19, v89, v93
    v_mfma_f32_16x16x32_bf16 v[216:219], v[96:99], a[184:187], v[216:219]
    ds_read_b128 a[200:203], v3 offset:0
    v_mfma_f32_16x16x32_bf16 v[216:219], v[128:131], a[188:191], v[216:219]
    buffer_load_dwordx4 v6, s[12:15], s30 offen offset:1024 nt lds
    v_mfma_f32_16x16x32_bf16 v[220:223], a[4:7], a[144:147], v[164:167]
    s_add_u32 s38, s34, 12288
    v_mfma_f32_16x16x32_bf16 v[220:223], a[28:31], a[148:151], v[220:223]
    s_cmp_eq_u32 s38, 135168
    s_cselect_b32 s38, 0, s38
    v_mfma_f32_16x16x32_bf16 v[220:223], a[52:55], a[152:155], v[220:223]
    s_sub_u32 s33, s38, s34
    v_mfma_f32_16x16x32_bf16 v[220:223], a[76:79], a[156:159], v[220:223]
    ds_read_b128 a[204:207], v4 offset:0
    v_mfma_f32_16x16x32_bf16 v[220:223], a[100:103], a[160:163], v[220:223]
    s_mov_b32 s34, s38
    v_mfma_f32_16x16x32_bf16 v[220:223], a[124:127], a[164:167], v[220:223]
    ds_read_b128 a[240:243], v9 offset:0
    v_mfma_f32_16x16x32_bf16 v[220:223], v[196:199], a[168:171], v[220:223]
    v_mfma_f32_16x16x32_bf16 v[220:223], v[228:231], a[172:175], v[220:223]
    ds_write_b128 v8, v[16:19] offset:12544
    v_mfma_f32_16x16x32_bf16 v[220:223], v[36:39], a[176:179], v[220:223]
    ds_read_b128 a[208:211], v1 offset:256
    v_mfma_f32_16x16x32_bf16 v[220:223], v[68:71], a[180:183], v[220:223]
    v_mfma_f32_16x16x32_bf16 v[220:223], v[100:103], a[184:187], v[220:223]
    v_mfma_f32_16x16x32_bf16 v[220:223], v[132:135], a[188:191], v[220:223]
    v_mfma_f32_16x16x32_bf16 v[248:251], a[8:11], a[144:147], v[168:171]
    v_mfma_f32_16x16x32_bf16 v[248:251], a[32:35], a[148:151], v[248:251]
    ds_read_b128 a[212:215], v2 offset:256
    v_mfma_f32_16x16x32_bf16 v[248:251], a[56:59], a[152:155], v[248:251]
    v_mfma_f32_16x16x32_bf16 v[248:251], a[80:83], a[156:159], v[248:251]
    buffer_load_dwordx4 v7, s[12:15], s30 offen offset:2048 nt lds
    v_mfma_f32_16x16x32_bf16 v[248:251], a[104:107], a[160:163], v[248:251]
    s_add_u32 s30, s30, 3145728
    v_mfma_f32_16x16x32_bf16 v[248:251], a[128:131], a[164:167], v[248:251]
    s_add_u32 s42, s42, 12288
    v_mfma_f32_16x16x32_bf16 v[248:251], v[200:203], a[168:171], v[248:251]
    ds_read_b128 a[216:219], v3 offset:256
    v_mfma_f32_16x16x32_bf16 v[248:251], v[232:235], a[172:175], v[248:251]
    s_cmp_eq_u32 s42, 135168
    s_cselect_b32 s42, 0, s42
    v_mfma_f32_16x16x32_bf16 v[248:251], v[40:43], a[176:179], v[248:251]
    s_add_u32 m0, s42, s41
    v_mfma_f32_16x16x32_bf16 v[248:251], v[72:75], a[180:183], v[248:251]
    ds_read_b128 a[244:247], v10 offset:0
    v_mfma_f32_16x16x32_bf16 v[248:251], v[104:107], a[184:187], v[248:251]
    v_cvt_pk_bf16_f32 v20, v121, v125
    v_mfma_f32_16x16x32_bf16 v[248:251], v[136:139], a[188:191], v[248:251]
    s_waitcnt lgkmcnt(5)
    buffer_store_dwordx4 a[240:243], v12, s[24:27], s31 offen offset:0 sc0 sc1
    v_mfma_f32_16x16x32_bf16 v[252:255], a[12:15], a[144:147], v[172:175]
    ds_read_b128 a[220:223], v4 offset:256
    v_mfma_f32_16x16x32_bf16 v[252:255], a[36:39], a[148:151], v[252:255]
    v_cvt_pk_bf16_f32 v21, v153, v157
    v_mfma_f32_16x16x32_bf16 v[252:255], a[60:63], a[152:155], v[252:255]
    v_cvt_pk_bf16_f32 v22, v90, v94
    v_mfma_f32_16x16x32_bf16 v[252:255], a[84:87], a[156:159], v[252:255]
    v_cvt_pk_bf16_f32 v23, v122, v126
    v_mfma_f32_16x16x32_bf16 v[252:255], a[108:111], a[160:163], v[252:255]
    ds_read_b128 a[224:227], v1 offset:512
    v_mfma_f32_16x16x32_bf16 v[252:255], a[132:135], a[164:167], v[252:255]
    s_add_u32 s29, s29, 1
    v_mfma_f32_16x16x32_bf16 v[252:255], v[204:207], a[168:171], v[252:255]
    s_cmp_lt_u32 s29, 33
    s_cselect_b32 s14, s40, 0
    v_mfma_f32_16x16x32_bf16 v[252:255], v[236:239], a[172:175], v[252:255]
    ds_write_b128 v8, v[20:23] offset:12560
    v_mfma_f32_16x16x32_bf16 v[252:255], v[44:47], a[176:179], v[252:255]
    v_add_u32 v1, s33, v1
    v_mfma_f32_16x16x32_bf16 v[252:255], v[76:79], a[180:183], v[252:255]
    ds_read_b128 a[228:231], v2 offset:512
    v_mfma_f32_16x16x32_bf16 v[252:255], v[108:111], a[184:187], v[252:255]
    v_cvt_pk_bf16_f32 v24, v154, v158
    v_mfma_f32_16x16x32_bf16 v[252:255], v[140:143], a[188:191], v[252:255]
    v_cvt_pk_bf16_f32 v25, v91, v95
    v_mfma_f32_16x16x32_bf16 v[56:59], a[16:19], a[144:147], v[176:179]
    v_cvt_pk_bf16_f32 v26, v123, v127
    v_mfma_f32_16x16x32_bf16 v[56:59], a[40:43], a[148:151], v[56:59]
    ds_read_b128 a[248:251], v11 offset:0
    v_mfma_f32_16x16x32_bf16 v[56:59], a[64:67], a[152:155], v[56:59]
    ds_read_b128 a[232:235], v3 offset:512
    v_mfma_f32_16x16x32_bf16 v[56:59], a[88:91], a[156:159], v[56:59]
    s_waitcnt lgkmcnt(6)
    buffer_store_dwordx4 a[244:247], v12, s[24:27], s31 offen offset:1024 sc0 sc1
    v_mfma_f32_16x16x32_bf16 v[56:59], a[112:115], a[160:163], v[56:59]
    v_cvt_pk_bf16_f32 v27, v155, v159
    v_mfma_f32_16x16x32_bf16 v[56:59], a[136:139], a[164:167], v[56:59]
    v_add_u32 v2, s33, v2
    v_mfma_f32_16x16x32_bf16 v[56:59], v[208:211], a[168:171], v[56:59]
    v_add_u32 v3, s33, v3
    v_mfma_f32_16x16x32_bf16 v[56:59], v[240:243], a[172:175], v[56:59]
    ds_read_b128 a[236:239], v4 offset:512
    v_mfma_f32_16x16x32_bf16 v[56:59], v[48:51], a[176:179], v[56:59]
    v_add_u32 v4, s33, v4
    v_mfma_f32_16x16x32_bf16 v[56:59], v[80:83], a[180:183], v[56:59]
    v_mfma_f32_16x16x32_bf16 v[56:59], v[112:115], a[184:187], v[56:59]
    v_mfma_f32_16x16x32_bf16 v[56:59], v[144:147], a[188:191], v[56:59]
    ds_write_b128 v8, v[24:27] offset:12576
    v_mfma_f32_16x16x32_bf16 v[60:63], a[20:23], a[144:147], v[180:183]
    v_mfma_f32_16x16x32_bf16 v[60:63], a[44:47], a[148:151], v[60:63]
    v_mfma_f32_16x16x32_bf16 v[60:63], a[68:71], a[152:155], v[60:63]
    v_mfma_f32_16x16x32_bf16 v[60:63], a[92:95], a[156:159], v[60:63]
    v_mfma_f32_16x16x32_bf16 v[60:63], a[116:119], a[160:163], v[60:63]
    v_mfma_f32_16x16x32_bf16 v[60:63], a[140:143], a[164:167], v[60:63]
    v_mfma_f32_16x16x32_bf16 v[60:63], v[212:215], a[168:171], v[60:63]
    v_mfma_f32_16x16x32_bf16 v[60:63], v[244:247], a[172:175], v[60:63]
    s_waitcnt lgkmcnt(3)
    buffer_store_dwordx4 a[248:251], v12, s[24:27], s31 offen offset:2048 sc0 sc1
    v_mfma_f32_16x16x32_bf16 v[60:63], v[52:55], a[176:179], v[60:63]
    v_mfma_f32_16x16x32_bf16 v[60:63], v[84:87], a[180:183], v[60:63]
    v_mfma_f32_16x16x32_bf16 v[60:63], v[116:119], a[184:187], v[60:63]
    v_mfma_f32_16x16x32_bf16 v[60:63], v[148:151], a[188:191], v[60:63]
    s_waitcnt vmcnt(9) lgkmcnt(0)
    s_barrier
    v_mfma_f32_16x16x32_bf16 v[88:91], a[0:3], a[192:195], v[160:163]
    ds_read_b128 a[144:147], v1 offset:0
    v_mfma_f32_16x16x32_bf16 v[88:91], a[24:27], a[196:199], v[88:91]
    s_add_u32 s31, s31, 3145728
    v_mfma_f32_16x16x32_bf16 v[88:91], a[48:51], a[200:203], v[88:91]
    v_mfma_f32_16x16x32_bf16 v[88:91], a[72:75], a[204:207], v[88:91]
    buffer_load_dwordx4 v5, s[12:15], s30 offen offset:0 nt lds
    v_mfma_f32_16x16x32_bf16 v[88:91], a[96:99], a[208:211], v[88:91]
    v_mfma_f32_16x16x32_bf16 v[88:91], a[120:123], a[212:215], v[88:91]
    ds_read_b128 a[148:151], v2 offset:0
    v_mfma_f32_16x16x32_bf16 v[88:91], v[192:195], a[216:219], v[88:91]
    v_cvt_pk_bf16_f32 v16, v216, v220
    v_mfma_f32_16x16x32_bf16 v[88:91], v[224:227], a[220:223], v[88:91]
    v_cvt_pk_bf16_f32 v17, v248, v252
    v_mfma_f32_16x16x32_bf16 v[88:91], v[32:35], a[224:227], v[88:91]
    v_cvt_pk_bf16_f32 v18, v56, v60
    v_mfma_f32_16x16x32_bf16 v[88:91], v[64:67], a[228:231], v[88:91]
    v_cvt_pk_bf16_f32 v19, v217, v221
    v_mfma_f32_16x16x32_bf16 v[88:91], v[96:99], a[232:235], v[88:91]
    ds_read_b128 a[152:155], v3 offset:0
    v_mfma_f32_16x16x32_bf16 v[88:91], v[128:131], a[236:239], v[88:91]
    buffer_load_dwordx4 v6, s[12:15], s30 offen offset:1024 nt lds
    v_mfma_f32_16x16x32_bf16 v[92:95], a[4:7], a[192:195], v[164:167]
    s_add_u32 s38, s34, 12288
    v_mfma_f32_16x16x32_bf16 v[92:95], a[28:31], a[196:199], v[92:95]
    s_cmp_eq_u32 s38, 135168
    s_cselect_b32 s38, 0, s38
    v_mfma_f32_16x16x32_bf16 v[92:95], a[52:55], a[200:203], v[92:95]
    s_sub_u32 s33, s38, s34
    v_mfma_f32_16x16x32_bf16 v[92:95], a[76:79], a[204:207], v[92:95]
    ds_read_b128 a[156:159], v4 offset:0
    v_mfma_f32_16x16x32_bf16 v[92:95], a[100:103], a[208:211], v[92:95]
    s_mov_b32 s34, s38
    v_mfma_f32_16x16x32_bf16 v[92:95], a[124:127], a[212:215], v[92:95]
    ds_read_b128 a[240:243], v9 offset:12544
    v_mfma_f32_16x16x32_bf16 v[92:95], v[196:199], a[216:219], v[92:95]
    v_mfma_f32_16x16x32_bf16 v[92:95], v[228:231], a[220:223], v[92:95]
    ds_write_b128 v8, v[16:19] offset:0
    v_mfma_f32_16x16x32_bf16 v[92:95], v[36:39], a[224:227], v[92:95]
    ds_read_b128 a[160:163], v1 offset:256
    v_mfma_f32_16x16x32_bf16 v[92:95], v[68:71], a[228:231], v[92:95]
    v_mfma_f32_16x16x32_bf16 v[92:95], v[100:103], a[232:235], v[92:95]
    v_mfma_f32_16x16x32_bf16 v[92:95], v[132:135], a[236:239], v[92:95]
    v_mfma_f32_16x16x32_bf16 v[120:123], a[8:11], a[192:195], v[168:171]
    v_mfma_f32_16x16x32_bf16 v[120:123], a[32:35], a[196:199], v[120:123]
    ds_read_b128 a[164:167], v2 offset:256
    v_mfma_f32_16x16x32_bf16 v[120:123], a[56:59], a[200:203], v[120:123]
    v_mfma_f32_16x16x32_bf16 v[120:123], a[80:83], a[204:207], v[120:123]
    buffer_load_dwordx4 v7, s[12:15], s30 offen offset:2048 nt lds
    v_mfma_f32_16x16x32_bf16 v[120:123], a[104:107], a[208:211], v[120:123]
    s_add_u32 s30, s30, 3145728
    v_mfma_f32_16x16x32_bf16 v[120:123], a[128:131], a[212:215], v[120:123]
    s_add_u32 s42, s42, 12288
    v_mfma_f32_16x16x32_bf16 v[120:123], v[200:203], a[216:219], v[120:123]
    ds_read_b128 a[168:171], v3 offset:256
    v_mfma_f32_16x16x32_bf16 v[120:123], v[232:235], a[220:223], v[120:123]
    s_cmp_eq_u32 s42, 135168
    s_cselect_b32 s42, 0, s42
    v_mfma_f32_16x16x32_bf16 v[120:123], v[40:43], a[224:227], v[120:123]
    s_add_u32 m0, s42, s41
    v_mfma_f32_16x16x32_bf16 v[120:123], v[72:75], a[228:231], v[120:123]
    ds_read_b128 a[244:247], v10 offset:12544
    v_mfma_f32_16x16x32_bf16 v[120:123], v[104:107], a[232:235], v[120:123]
    v_cvt_pk_bf16_f32 v20, v249, v253
    v_mfma_f32_16x16x32_bf16 v[120:123], v[136:139], a[236:239], v[120:123]
    s_waitcnt lgkmcnt(5)
    buffer_store_dwordx4 a[240:243], v12, s[24:27], s31 offen offset:0 sc0 sc1
    v_mfma_f32_16x16x32_bf16 v[124:127], a[12:15], a[192:195], v[172:175]
    ds_read_b128 a[172:175], v4 offset:256
    v_mfma_f32_16x16x32_bf16 v[124:127], a[36:39], a[196:199], v[124:127]
    v_cvt_pk_bf16_f32 v21, v57, v61
    v_mfma_f32_16x16x32_bf16 v[124:127], a[60:63], a[200:203], v[124:127]
    v_cvt_pk_bf16_f32 v22, v218, v222
    v_mfma_f32_16x16x32_bf16 v[124:127], a[84:87], a[204:207], v[124:127]
    v_cvt_pk_bf16_f32 v23, v250, v254
    v_mfma_f32_16x16x32_bf16 v[124:127], a[108:111], a[208:211], v[124:127]
    ds_read_b128 a[176:179], v1 offset:512
    v_mfma_f32_16x16x32_bf16 v[124:127], a[132:135], a[212:215], v[124:127]
    s_add_u32 s29, s29, 1
    v_mfma_f32_16x16x32_bf16 v[124:127], v[204:207], a[216:219], v[124:127]
    s_cmp_lt_u32 s29, 33
    s_cselect_b32 s14, s40, 0
    v_mfma_f32_16x16x32_bf16 v[124:127], v[236:239], a[220:223], v[124:127]
    ds_write_b128 v8, v[20:23] offset:16
    v_mfma_f32_16x16x32_bf16 v[124:127], v[44:47], a[224:227], v[124:127]
    v_add_u32 v1, s33, v1
    v_mfma_f32_16x16x32_bf16 v[124:127], v[76:79], a[228:231], v[124:127]
    ds_read_b128 a[180:183], v2 offset:512
    v_mfma_f32_16x16x32_bf16 v[124:127], v[108:111], a[232:235], v[124:127]
    v_cvt_pk_bf16_f32 v24, v58, v62
    v_mfma_f32_16x16x32_bf16 v[124:127], v[140:143], a[236:239], v[124:127]
    v_cvt_pk_bf16_f32 v25, v219, v223
    v_mfma_f32_16x16x32_bf16 v[152:155], a[16:19], a[192:195], v[176:179]
    v_cvt_pk_bf16_f32 v26, v251, v255
    v_mfma_f32_16x16x32_bf16 v[152:155], a[40:43], a[196:199], v[152:155]
    ds_read_b128 a[248:251], v11 offset:12544
    v_mfma_f32_16x16x32_bf16 v[152:155], a[64:67], a[200:203], v[152:155]
    ds_read_b128 a[184:187], v3 offset:512
    v_mfma_f32_16x16x32_bf16 v[152:155], a[88:91], a[204:207], v[152:155]
    s_waitcnt lgkmcnt(6)
    buffer_store_dwordx4 a[244:247], v12, s[24:27], s31 offen offset:1024 sc0 sc1
    v_mfma_f32_16x16x32_bf16 v[152:155], a[112:115], a[208:211], v[152:155]
    v_cvt_pk_bf16_f32 v27, v59, v63
    v_mfma_f32_16x16x32_bf16 v[152:155], a[136:139], a[212:215], v[152:155]
    v_add_u32 v2, s33, v2
    v_mfma_f32_16x16x32_bf16 v[152:155], v[208:211], a[216:219], v[152:155]
    v_add_u32 v3, s33, v3
    v_mfma_f32_16x16x32_bf16 v[152:155], v[240:243], a[220:223], v[152:155]
    ds_read_b128 a[188:191], v4 offset:512
    v_mfma_f32_16x16x32_bf16 v[152:155], v[48:51], a[224:227], v[152:155]
    v_add_u32 v4, s33, v4
    v_mfma_f32_16x16x32_bf16 v[152:155], v[80:83], a[228:231], v[152:155]
    v_mfma_f32_16x16x32_bf16 v[152:155], v[112:115], a[232:235], v[152:155]
    v_mfma_f32_16x16x32_bf16 v[152:155], v[144:147], a[236:239], v[152:155]
    ds_write_b128 v8, v[24:27] offset:32
    v_mfma_f32_16x16x32_bf16 v[156:159], a[20:23], a[192:195], v[180:183]
    v_mfma_f32_16x16x32_bf16 v[156:159], a[44:47], a[196:199], v[156:159]
    v_mfma_f32_16x16x32_bf16 v[156:159], a[68:71], a[200:203], v[156:159]
    v_mfma_f32_16x16x32_bf16 v[156:159], a[92:95], a[204:207], v[156:159]
    v_mfma_f32_16x16x32_bf16 v[156:159], a[116:119], a[208:211], v[156:159]
    v_mfma_f32_16x16x32_bf16 v[156:159], a[140:143], a[212:215], v[156:159]
    v_mfma_f32_16x16x32_bf16 v[156:159], v[212:215], a[216:219], v[156:159]
    v_mfma_f32_16x16x32_bf16 v[156:159], v[244:247], a[220:223], v[156:159]
    s_waitcnt lgkmcnt(3)
    buffer_store_dwordx4 a[248:251], v12, s[24:27], s31 offen offset:2048 sc0 sc1
    v_mfma_f32_16x16x32_bf16 v[156:159], v[52:55], a[224:227], v[156:159]
    v_mfma_f32_16x16x32_bf16 v[156:159], v[84:87], a[228:231], v[156:159]
    v_mfma_f32_16x16x32_bf16 v[156:159], v[116:119], a[232:235], v[156:159]
    v_mfma_f32_16x16x32_bf16 v[156:159], v[148:151], a[236:239], v[156:159]
    s_cmp_lt_u32 s29, 36
    s_cbranch_scc1 L_g0_loop3
    s_branch L_drain
L_drain:
    s_waitcnt lgkmcnt(0)
    s_barrier
    s_add_u32 s31, s31, 3145728
    s_nop 4
    ds_read_b128 a[240:243], v9 offset:0
    ds_read_b128 a[244:247], v10 offset:0
    ds_read_b128 a[248:251], v11 offset:0
    v_cvt_pk_bf16_f32 v16, v88, v92
    v_cvt_pk_bf16_f32 v17, v120, v124
    v_cvt_pk_bf16_f32 v18, v152, v156
    v_cvt_pk_bf16_f32 v19, v89, v93
    ds_write_b128 v8, v[16:19] offset:12544
    v_cvt_pk_bf16_f32 v20, v121, v125
    v_cvt_pk_bf16_f32 v21, v153, v157
    v_cvt_pk_bf16_f32 v22, v90, v94
    v_cvt_pk_bf16_f32 v23, v122, v126
    ds_write_b128 v8, v[20:23] offset:12560
    v_cvt_pk_bf16_f32 v24, v154, v158
    v_cvt_pk_bf16_f32 v25, v91, v95
    v_cvt_pk_bf16_f32 v26, v123, v127
    v_cvt_pk_bf16_f32 v27, v155, v159
    ds_write_b128 v8, v[24:27] offset:12576
    s_waitcnt lgkmcnt(5)
    buffer_store_dwordx4 a[240:243], v12, s[24:27], s31 offen offset:0 sc0 sc1
    s_waitcnt lgkmcnt(4)
    buffer_store_dwordx4 a[244:247], v12, s[24:27], s31 offen offset:1024 sc0 sc1
    s_waitcnt lgkmcnt(3)
    buffer_store_dwordx4 a[248:251], v12, s[24:27], s31 offen offset:2048 sc0 sc1
    s_add_u32 s31, s31, 3145728
    s_waitcnt lgkmcnt(0)
    s_barrier
    ds_read_b128 a[144:147], v9 offset:12544
    ds_read_b128 a[148:151], v10 offset:12544
    ds_read_b128 a[152:155], v11 offset:12544
    s_waitcnt lgkmcnt(2)
    buffer_store_dwordx4 a[144:147], v12, s[24:27], s31 offen offset:0 sc0 sc1
    s_waitcnt lgkmcnt(1)
    buffer_store_dwordx4 a[148:151], v12, s[24:27], s31 offen offset:1024 sc0 sc1
    s_waitcnt lgkmcnt(0)
    buffer_store_dwordx4 a[152:155], v12, s[24:27], s31 offen offset:2048 sc0 sc1
L_done:
    s_endpgm
.section .rodata,"a"
.p2align 6
.amdhsa_kernel standalone__standard_2d_1d_3d_conv__vision_kernel
  .amdhsa_next_free_vgpr 512
  .amdhsa_next_free_sgpr 96
  .amdhsa_accum_offset 256
  .amdhsa_group_segment_fixed_size 0
  .amdhsa_kernarg_size 48
  .amdhsa_user_sgpr_count 2
  .amdhsa_user_sgpr_kernarg_segment_ptr 1
  .amdhsa_system_sgpr_workgroup_id_x 1
.end_amdhsa_kernel
```

```asm
; @launch grid=(256,1,1) block=(256,1,1) lds=159744
.amdgcn_target "amdgcn-amd-amdhsa--gfx950"
.text
.globl standalone__standard_2d_1d_3d_conv__vision_kernel
.p2align 8
.type standalone__standard_2d_1d_3d_conv__vision_kernel,@function
standalone__standard_2d_1d_3d_conv__vision_kernel:
    s_load_dwordx8 s[4:11], s[0:1], 0
    s_cmp_ge_u32 s2, 256
    s_cbranch_scc1 L_done
    v_lshrrev_b32 v18, 6, v0
    v_and_b32 v19, 63, v0
    v_readfirstlane_b32 s28, v18
    v_and_b32 v20, 15, v0
    v_bfe_u32 v21, v0, 4, 2
    v_mul_u32_u24 v22, 3072, v18
    v_add_u32 v23, 16, v19
    v_lshrrev_b32 v23, 6, v23
    v_lshl_add_u32 v23, v18, 2, v23
    v_xor_b32 v23, v23, v19
    v_lshl_add_u32 v4, v23, 4, v22
    v_lshrrev_b32 v23, 5, v19
    v_add_u32 v23, 1, v23
    v_lshl_add_u32 v23, v18, 2, v23
    v_xor_b32 v23, v23, v19
    v_lshl_add_u32 v5, v23, 4, v22
    v_add_u32 v23, 48, v19
    v_lshrrev_b32 v23, 6, v23
    v_add_u32 v23, 2, v23
    v_lshl_add_u32 v23, v18, 2, v23
    v_xor_b32 v23, v23, v19
    v_lshl_add_u32 v6, v23, 4, v22
    s_and_b32 s39, s2, 7
    s_mul_i32 s39, s39, 1152
    s_lshr_b32 s30, s2, 3
    s_add_u32 s30, s30, s39
    s_mul_i32 s30, s30, 12288
    s_sub_u32 s31, s30, 393216
    s_mul_i32 s41, s28, 3072
    s_mul_i32 s32, s28, 6144
    s_mov_b32 s42, 0
    s_mov_b32 s14, 113246208
    s_mov_b32 s15, 0x20000
    s_mov_b32 s18, 294912
    s_mov_b32 s19, 0x20000
    s_mov_b32 s26, 0
    s_mov_b32 s27, 0x20000
    v_mul_u32_u24 v22, 192, v18
    v_add_u32 v240, 0, v19
    v_mul_u32_u24 v241, 171, v240
    v_lshrrev_b32 v241, 11, v241
    v_mul_u32_u24 v242, 12, v241
    v_sub_u32 v240, v240, v242
    v_bfe_u32 v242, v241, 3, 1
    v_lshlrev_b32 v242, 1, v242
    v_xor_b32 v240, v240, v242
    v_lshl_add_u32 v240, v240, 4, v22
    v_mul_u32_u24 v241, 768, v241
    v_add_u32 v240, v240, v241
    v_subrev_u32 v7, 0, v240
    v_add_u32 v240, 64, v19
    v_mul_u32_u24 v241, 171, v240
    v_lshrrev_b32 v241, 11, v241
    v_mul_u32_u24 v242, 12, v241
    v_sub_u32 v240, v240, v242
    v_bfe_u32 v242, v241, 3, 1
    v_lshlrev_b32 v242, 1, v242
    v_xor_b32 v240, v240, v242
    v_lshl_add_u32 v240, v240, 4, v22
    v_mul_u32_u24 v241, 768, v241
    v_add_u32 v240, v240, v241
    v_subrev_u32 v8, 1024, v240
    v_add_u32 v240, 128, v19
    v_mul_u32_u24 v241, 171, v240
    v_lshrrev_b32 v241, 11, v241
    v_mul_u32_u24 v242, 12, v241
    v_sub_u32 v240, v240, v242
    v_bfe_u32 v242, v241, 3, 1
    v_lshlrev_b32 v242, 1, v242
    v_xor_b32 v240, v240, v242
    v_lshl_add_u32 v240, v240, 4, v22
    v_mul_u32_u24 v241, 768, v241
    v_add_u32 v240, v240, v241
    v_subrev_u32 v9, 2048, v240
    s_waitcnt lgkmcnt(0)
    s_mov_b32 s12, s4
    s_and_b32 s13, s5, 0xffff
    s_mov_b32 s16, s6
    s_and_b32 s17, s7, 0xffff
    s_mov_b32 s24, s10
    s_and_b32 s25, s11, 0xffff
L_g0:
    s_add_u32 m0, s42, s41
    s_add_u32 s42, s42, 12288
    buffer_load_dwordx4 v4, s[12:15], s30 offen offset:0 nt lds
    buffer_load_dwordx4 v5, s[12:15], s30 offen offset:1024 nt lds
    buffer_load_dwordx4 v6, s[12:15], s30 offen offset:2048 nt lds
    s_add_u32 s30, s30, 393216
    s_add_u32 m0, s42, s41
    s_add_u32 s42, s42, 12288
    buffer_load_dwordx4 v4, s[12:15], s30 offen offset:0 nt lds
    buffer_load_dwordx4 v5, s[12:15], s30 offen offset:1024 nt lds
    buffer_load_dwordx4 v6, s[12:15], s30 offen offset:2048 nt lds
    s_add_u32 s30, s30, 393216
    s_add_u32 m0, s32, 86016
    s_mov_b32 s35, 0
    buffer_load_dwordx4 v7, s[16:19], s35 offen offset:0 lds
    buffer_load_dwordx4 v8, s[16:19], s35 offen offset:1024 lds
    buffer_load_dwordx4 v9, s[16:19], s35 offen offset:2048 lds
    s_add_u32 m0, s32, 89088
    s_mov_b32 s35, 12288
    buffer_load_dwordx4 v7, s[16:19], s35 offen offset:0 lds
    buffer_load_dwordx4 v8, s[16:19], s35 offen offset:1024 lds
    buffer_load_dwordx4 v9, s[16:19], s35 offen offset:2048 lds
    v_mul_u32_u24 v22, 192, v18
    v_lshl_add_u32 v17, v21, 3, v22
    s_mov_b32 s20, s8
    s_and_b32 s21, s9, 0xffff
    s_mov_b32 s22, 768
    s_mov_b32 s23, 0x20000
    buffer_load_dwordx2 a[240:241], v17, s[20:23], 0 offen offset:0
    buffer_load_dwordx2 a[242:243], v17, s[20:23], 0 offen offset:32
    buffer_load_dwordx2 a[244:245], v17, s[20:23], 0 offen offset:64
    buffer_load_dwordx2 a[246:247], v17, s[20:23], 0 offen offset:96
    buffer_load_dwordx2 a[248:249], v17, s[20:23], 0 offen offset:128
    buffer_load_dwordx2 a[250:251], v17, s[20:23], 0 offen offset:160
    v_mul_u32_u24 v22, 768, v20
    v_add_u32 v23, 0, v21
    v_xor_b32 v23, v23, v20
    v_lshl_add_u32 v0, v23, 4, v22
    v_add_u32 v23, 4, v21
    v_xor_b32 v23, v23, v20
    v_lshl_add_u32 v1, v23, 4, v22
    v_add_u32 v23, 8, v21
    v_xor_b32 v23, v23, v20
    v_lshl_add_u32 v2, v23, 4, v22
    v_add_u32 v23, 12, v21
    v_xor_b32 v23, v23, v20
    v_lshl_add_u32 v3, v23, 4, v22
    v_lshrrev_b32 v22, 2, v20
    v_lshl_add_u32 v22, v21, 3, v22
    v_mul_u32_u24 v22, 192, v22
    v_and_b32 v23, 3, v20
    v_lshl_add_u32 v22, v23, 3, v22
    v_mul_u32_u24 v23, 6144, v18
    v_add_u32 v22, v22, v23
    v_add_u32 v22, 61440, v22
    v_and_b32 v23, 1, v21
    v_lshlrev_b32 v23, 5, v23
    v_add_u32 v10, v22, v23
    v_sub_u32 v11, v22, v23
    v_add_u32 v252, 49152, v10
    v_add_u32 v253, 49152, v11
    v_mul_u32_u24 v12, 784, v20
    v_add_u32 v12, v12, v17
    v_add_u32 v12, 86016, v12
    v_mul_u32_u24 v16, 3072, v18
    v_lshl_add_u32 v16, v19, 4, v16
    v_mul_u32_u24 v22, 3136, v18
    v_add_u32 v22, 86016, v22
    v_add_u32 v23, 16, v19
    v_lshrrev_b32 v23, 6, v23
    v_add_u32 v23, v23, v19
    v_lshl_add_u32 v23, v23, 4, v22
    v_add_u32 v13, 0, v23
    v_lshrrev_b32 v23, 5, v19
    v_add_u32 v23, 1, v23
    v_add_u32 v23, v23, v19
    v_lshl_add_u32 v23, v23, 4, v22
    v_add_u32 v14, 1024, v23
    v_add_u32 v23, 48, v19
    v_lshrrev_b32 v23, 6, v23
    v_add_u32 v23, 2, v23
    v_add_u32 v23, v23, v19
    v_lshl_add_u32 v23, v23, 4, v22
    v_add_u32 v15, 2048, v23
    s_mov_b32 s40, 113246208
    s_add_u32 m0, s32, 110592
    s_mov_b32 s35, 24576
    buffer_load_dwordx4 v7, s[16:19], s35 offen offset:0 lds
    buffer_load_dwordx4 v8, s[16:19], s35 offen offset:1024 lds
    buffer_load_dwordx4 v9, s[16:19], s35 offen offset:2048 lds
    s_add_u32 m0, s32, 113664
    s_mov_b32 s35, 36864
    buffer_load_dwordx4 v7, s[16:19], s35 offen offset:0 lds
    buffer_load_dwordx4 v8, s[16:19], s35 offen offset:1024 lds
    buffer_load_dwordx4 v9, s[16:19], s35 offen offset:2048 lds
    s_add_u32 m0, s32, 135168
    s_mov_b32 s35, 49152
    buffer_load_dwordx4 v7, s[16:19], s35 offen offset:0 lds
    buffer_load_dwordx4 v8, s[16:19], s35 offen offset:1024 lds
    buffer_load_dwordx4 v9, s[16:19], s35 offen offset:2048 lds
    s_add_u32 m0, s32, 138240
    s_mov_b32 s35, 61440
    buffer_load_dwordx4 v7, s[16:19], s35 offen offset:0 lds
    buffer_load_dwordx4 v8, s[16:19], s35 offen offset:1024 lds
    buffer_load_dwordx4 v9, s[16:19], s35 offen offset:2048 lds
    s_add_u32 m0, s32, 61440
    s_mov_b32 s35, 73728
    buffer_load_dwordx4 v7, s[16:19], s35 offen offset:0 lds
    buffer_load_dwordx4 v8, s[16:19], s35 offen offset:1024 lds
    buffer_load_dwordx4 v9, s[16:19], s35 offen offset:2048 lds
    s_add_u32 m0, s32, 64512
    s_mov_b32 s35, 86016
    buffer_load_dwordx4 v7, s[16:19], s35 offen offset:0 lds
    buffer_load_dwordx4 v8, s[16:19], s35 offen offset:1024 lds
    buffer_load_dwordx4 v9, s[16:19], s35 offen offset:2048 lds
    s_waitcnt vmcnt(30)
    s_barrier
    ds_read_b128 a[144:147], v0 offset:0
    ds_read_b128 a[192:195], v0 offset:12288
    s_waitcnt vmcnt(24)
    ds_read_b64_tr_b16 a[0:1], v10 offset:24576
    ds_read_b64_tr_b16 a[2:3], v10 offset:25344
    ds_read_b64_tr_b16 a[4:5], v11 offset:24608
    ds_read_b64_tr_b16 a[6:7], v11 offset:25376
    ds_read_b64_tr_b16 a[8:9], v10 offset:24640
    ds_read_b64_tr_b16 a[10:11], v10 offset:25408
    ds_read_b64_tr_b16 a[12:13], v11 offset:24672
    ds_read_b64_tr_b16 a[14:15], v11 offset:25440
    ds_read_b64_tr_b16 a[16:17], v10 offset:24704
    ds_read_b64_tr_b16 a[18:19], v10 offset:25472
    ds_read_b64_tr_b16 a[20:21], v11 offset:24736
    ds_read_b64_tr_b16 a[22:23], v11 offset:25504
    s_waitcnt vmcnt(18)
    v_accvgpr_read_b32 v240, a240
    v_accvgpr_read_b32 v241, a241
    v_accvgpr_read_b32 v242, a242
    v_accvgpr_read_b32 v243, a243
    v_accvgpr_read_b32 v244, a244
    v_accvgpr_read_b32 v245, a245
    v_accvgpr_read_b32 v246, a246
    v_accvgpr_read_b32 v247, a247
    v_accvgpr_read_b32 v248, a248
    v_accvgpr_read_b32 v249, a249
    v_accvgpr_read_b32 v250, a250
    v_accvgpr_read_b32 v251, a251
    v_lshlrev_b32 v24, 16, v240
    v_and_b32 v25, 0xffff0000, v240
    v_lshlrev_b32 v26, 16, v241
    v_and_b32 v27, 0xffff0000, v241
    v_lshlrev_b32 v28, 16, v242
    v_and_b32 v29, 0xffff0000, v242
    v_lshlrev_b32 v30, 16, v243
    v_and_b32 v31, 0xffff0000, v243
    v_lshlrev_b32 v32, 16, v244
    v_and_b32 v33, 0xffff0000, v244
    v_lshlrev_b32 v34, 16, v245
    v_and_b32 v35, 0xffff0000, v245
    v_lshlrev_b32 v36, 16, v246
    v_and_b32 v37, 0xffff0000, v246
    v_lshlrev_b32 v38, 16, v247
    v_and_b32 v39, 0xffff0000, v247
    v_lshlrev_b32 v40, 16, v248
    v_and_b32 v41, 0xffff0000, v248
    v_lshlrev_b32 v42, 16, v249
    v_and_b32 v43, 0xffff0000, v249
    v_lshlrev_b32 v44, 16, v250
    v_and_b32 v45, 0xffff0000, v250
    v_lshlrev_b32 v46, 16, v251
    v_and_b32 v47, 0xffff0000, v251
    s_waitcnt lgkmcnt(0)
    s_waitcnt vmcnt(12)
    v_mfma_f32_16x16x32_bf16 v[48:51], a[0:3], a[144:147], v[24:27]
    ds_read_b128 a[148:151], v1 offset:0
    ds_read_b128 a[196:199], v1 offset:12288
    s_add_u32 m0, s32, 86016
    s_mov_b32 s35, 98304
    buffer_load_dwordx4 v7, s[16:19], s35 offen offset:0 lds
    v_mfma_f32_16x16x32_bf16 v[52:55], a[4:7], a[144:147], v[28:31]
    ds_read_b64_tr_b16 a[24:25], v252 offset:0
    ds_read_b64_tr_b16 a[26:27], v252 offset:768
    v_mfma_f32_16x16x32_bf16 v[56:59], a[8:11], a[144:147], v[32:35]
    ds_read_b64_tr_b16 a[28:29], v253 offset:32
    ds_read_b64_tr_b16 a[30:31], v253 offset:800
    buffer_load_dwordx4 v8, s[16:19], s35 offen offset:1024 lds
    v_mfma_f32_16x16x32_bf16 v[60:63], a[12:15], a[144:147], v[36:39]
    ds_read_b64_tr_b16 a[32:33], v252 offset:64
    ds_read_b64_tr_b16 a[34:35], v252 offset:832
    v_mfma_f32_16x16x32_bf16 v[64:67], a[16:19], a[144:147], v[40:43]
    ds_read_b64_tr_b16 a[36:37], v253 offset:96
    ds_read_b64_tr_b16 a[38:39], v253 offset:864
    buffer_load_dwordx4 v9, s[16:19], s35 offen offset:2048 lds
    v_mfma_f32_16x16x32_bf16 v[68:71], a[20:23], a[144:147], v[44:47]
    ds_read_b64_tr_b16 a[40:41], v252 offset:128
    ds_read_b64_tr_b16 a[42:43], v252 offset:896
    v_mfma_f32_16x16x32_bf16 v[72:75], a[0:3], a[192:195], v[24:27]
    ds_read_b64_tr_b16 a[44:45], v253 offset:160
    ds_read_b64_tr_b16 a[46:47], v253 offset:928
    s_add_u32 m0, s32, 89088
    s_mov_b32 s35, 110592
    buffer_load_dwordx4 v7, s[16:19], s35 offen offset:0 lds
    v_mfma_f32_16x16x32_bf16 v[76:79], a[4:7], a[192:195], v[28:31]
    v_mfma_f32_16x16x32_bf16 v[80:83], a[8:11], a[192:195], v[32:35]
    buffer_load_dwordx4 v8, s[16:19], s35 offen offset:1024 lds
    v_mfma_f32_16x16x32_bf16 v[84:87], a[12:15], a[192:195], v[36:39]
    v_mfma_f32_16x16x32_bf16 v[88:91], a[16:19], a[192:195], v[40:43]
    buffer_load_dwordx4 v9, s[16:19], s35 offen offset:2048 lds
    v_mfma_f32_16x16x32_bf16 v[92:95], a[20:23], a[192:195], v[44:47]
    s_waitcnt lgkmcnt(0)
    s_waitcnt vmcnt(12)
    v_mfma_f32_16x16x32_bf16 v[48:51], a[24:27], a[148:151], v[48:51]
    ds_read_b128 a[152:155], v2 offset:0
    ds_read_b128 a[200:203], v2 offset:12288
    s_add_u32 m0, s32, 110592
    s_mov_b32 s35, 122880
    buffer_load_dwordx4 v7, s[16:19], s35 offen offset:0 lds
    v_mfma_f32_16x16x32_bf16 v[52:55], a[28:31], a[148:151], v[52:55]
    ds_read_b64_tr_b16 a[48:49], v252 offset:24576
    ds_read_b64_tr_b16 a[50:51], v252 offset:25344
    v_mfma_f32_16x16x32_bf16 v[56:59], a[32:35], a[148:151], v[56:59]
    ds_read_b64_tr_b16 a[52:53], v253 offset:24608
    ds_read_b64_tr_b16 a[54:55], v253 offset:25376
    buffer_load_dwordx4 v8, s[16:19], s35 offen offset:1024 lds
    v_mfma_f32_16x16x32_bf16 v[60:63], a[36:39], a[148:151], v[60:63]
    ds_read_b64_tr_b16 a[56:57], v252 offset:24640
    ds_read_b64_tr_b16 a[58:59], v252 offset:25408
    v_mfma_f32_16x16x32_bf16 v[64:67], a[40:43], a[148:151], v[64:67]
    ds_read_b64_tr_b16 a[60:61], v253 offset:24672
    ds_read_b64_tr_b16 a[62:63], v253 offset:25440
    buffer_load_dwordx4 v9, s[16:19], s35 offen offset:2048 lds
    v_mfma_f32_16x16x32_bf16 v[68:71], a[44:47], a[148:151], v[68:71]
    ds_read_b64_tr_b16 a[64:65], v252 offset:24704
    ds_read_b64_tr_b16 a[66:67], v252 offset:25472
    v_mfma_f32_16x16x32_bf16 v[72:75], a[24:27], a[196:199], v[72:75]
    ds_read_b64_tr_b16 a[68:69], v253 offset:24736
    ds_read_b64_tr_b16 a[70:71], v253 offset:25504
    s_add_u32 m0, s32, 113664
    s_mov_b32 s35, 135168
    buffer_load_dwordx4 v7, s[16:19], s35 offen offset:0 lds
    v_mfma_f32_16x16x32_bf16 v[76:79], a[28:31], a[196:199], v[76:79]
    v_mfma_f32_16x16x32_bf16 v[80:83], a[32:35], a[196:199], v[80:83]
    buffer_load_dwordx4 v8, s[16:19], s35 offen offset:1024 lds
    v_mfma_f32_16x16x32_bf16 v[84:87], a[36:39], a[196:199], v[84:87]
    v_mfma_f32_16x16x32_bf16 v[88:91], a[40:43], a[196:199], v[88:91]
    buffer_load_dwordx4 v9, s[16:19], s35 offen offset:2048 lds
    v_mfma_f32_16x16x32_bf16 v[92:95], a[44:47], a[196:199], v[92:95]
    s_waitcnt lgkmcnt(0)
    s_waitcnt vmcnt(12)
    v_mfma_f32_16x16x32_bf16 v[48:51], a[48:51], a[152:155], v[48:51]
    ds_read_b128 a[156:159], v3 offset:0
    ds_read_b128 a[204:207], v3 offset:12288
    s_add_u32 m0, s32, 135168
    s_mov_b32 s35, 147456
    buffer_load_dwordx4 v7, s[16:19], s35 offen offset:0 lds
    v_mfma_f32_16x16x32_bf16 v[52:55], a[52:55], a[152:155], v[52:55]
    ds_read_b64_tr_b16 a[72:73], v10 offset:0
    ds_read_b64_tr_b16 a[74:75], v10 offset:768
    v_mfma_f32_16x16x32_bf16 v[56:59], a[56:59], a[152:155], v[56:59]
    ds_read_b64_tr_b16 a[76:77], v11 offset:32
    ds_read_b64_tr_b16 a[78:79], v11 offset:800
    buffer_load_dwordx4 v8, s[16:19], s35 offen offset:1024 lds
    v_mfma_f32_16x16x32_bf16 v[60:63], a[60:63], a[152:155], v[60:63]
    ds_read_b64_tr_b16 a[80:81], v10 offset:64
    ds_read_b64_tr_b16 a[82:83], v10 offset:832
    v_mfma_f32_16x16x32_bf16 v[64:67], a[64:67], a[152:155], v[64:67]
    ds_read_b64_tr_b16 a[84:85], v11 offset:96
    ds_read_b64_tr_b16 a[86:87], v11 offset:864
    buffer_load_dwordx4 v9, s[16:19], s35 offen offset:2048 lds
    v_mfma_f32_16x16x32_bf16 v[68:71], a[68:71], a[152:155], v[68:71]
    ds_read_b64_tr_b16 a[88:89], v10 offset:128
    ds_read_b64_tr_b16 a[90:91], v10 offset:896
    v_mfma_f32_16x16x32_bf16 v[72:75], a[48:51], a[200:203], v[72:75]
    ds_read_b64_tr_b16 a[92:93], v11 offset:160
    ds_read_b64_tr_b16 a[94:95], v11 offset:928
    s_add_u32 m0, s32, 138240
    s_mov_b32 s35, 159744
    buffer_load_dwordx4 v7, s[16:19], s35 offen offset:0 lds
    v_mfma_f32_16x16x32_bf16 v[76:79], a[52:55], a[200:203], v[76:79]
    v_mfma_f32_16x16x32_bf16 v[80:83], a[56:59], a[200:203], v[80:83]
    buffer_load_dwordx4 v8, s[16:19], s35 offen offset:1024 lds
    v_mfma_f32_16x16x32_bf16 v[84:87], a[60:63], a[200:203], v[84:87]
    v_mfma_f32_16x16x32_bf16 v[88:91], a[64:67], a[200:203], v[88:91]
    buffer_load_dwordx4 v9, s[16:19], s35 offen offset:2048 lds
    v_mfma_f32_16x16x32_bf16 v[92:95], a[68:71], a[200:203], v[92:95]
    s_waitcnt lgkmcnt(0)
    s_waitcnt vmcnt(12)
    v_mfma_f32_16x16x32_bf16 v[48:51], a[72:75], a[156:159], v[48:51]
    ds_read_b128 a[160:163], v0 offset:256
    ds_read_b128 a[208:211], v0 offset:12544
    s_add_u32 m0, s32, 61440
    s_mov_b32 s35, 172032
    buffer_load_dwordx4 v7, s[16:19], s35 offen offset:0 lds
    v_mfma_f32_16x16x32_bf16 v[52:55], a[76:79], a[156:159], v[52:55]
    ds_read_b64_tr_b16 a[96:97], v10 offset:24576
    ds_read_b64_tr_b16 a[98:99], v10 offset:25344
    v_mfma_f32_16x16x32_bf16 v[56:59], a[80:83], a[156:159], v[56:59]
    ds_read_b64_tr_b16 a[100:101], v11 offset:24608
    ds_read_b64_tr_b16 a[102:103], v11 offset:25376
    buffer_load_dwordx4 v8, s[16:19], s35 offen offset:1024 lds
    v_mfma_f32_16x16x32_bf16 v[60:63], a[84:87], a[156:159], v[60:63]
    ds_read_b64_tr_b16 a[104:105], v10 offset:24640
    ds_read_b64_tr_b16 a[106:107], v10 offset:25408
    v_mfma_f32_16x16x32_bf16 v[64:67], a[88:91], a[156:159], v[64:67]
    ds_read_b64_tr_b16 a[108:109], v11 offset:24672
    ds_read_b64_tr_b16 a[110:111], v11 offset:25440
    buffer_load_dwordx4 v9, s[16:19], s35 offen offset:2048 lds
    v_mfma_f32_16x16x32_bf16 v[68:71], a[92:95], a[156:159], v[68:71]
    ds_read_b64_tr_b16 a[112:113], v10 offset:24704
    ds_read_b64_tr_b16 a[114:115], v10 offset:25472
    v_mfma_f32_16x16x32_bf16 v[72:75], a[72:75], a[204:207], v[72:75]
    ds_read_b64_tr_b16 a[116:117], v11 offset:24736
    ds_read_b64_tr_b16 a[118:119], v11 offset:25504
    s_add_u32 m0, s32, 64512
    s_mov_b32 s35, 184320
    buffer_load_dwordx4 v7, s[16:19], s35 offen offset:0 lds
    v_mfma_f32_16x16x32_bf16 v[76:79], a[76:79], a[204:207], v[76:79]
    v_mfma_f32_16x16x32_bf16 v[80:83], a[80:83], a[204:207], v[80:83]
    buffer_load_dwordx4 v8, s[16:19], s35 offen offset:1024 lds
    v_mfma_f32_16x16x32_bf16 v[84:87], a[84:87], a[204:207], v[84:87]
    v_mfma_f32_16x16x32_bf16 v[88:91], a[88:91], a[204:207], v[88:91]
    buffer_load_dwordx4 v9, s[16:19], s35 offen offset:2048 lds
    v_mfma_f32_16x16x32_bf16 v[92:95], a[92:95], a[204:207], v[92:95]
    s_add_u32 m0, s42, s41
    s_add_u32 s42, s42, 12288
    buffer_load_dwordx4 v4, s[12:15], s30 offen offset:0 nt lds
    buffer_load_dwordx4 v5, s[12:15], s30 offen offset:1024 nt lds
    buffer_load_dwordx4 v6, s[12:15], s30 offen offset:2048 nt lds
    s_add_u32 s30, s30, 393216
    s_waitcnt lgkmcnt(0)
    s_waitcnt vmcnt(15)
    v_mfma_f32_16x16x32_bf16 v[48:51], a[96:99], a[160:163], v[48:51]
    ds_read_b128 a[164:167], v1 offset:256
    ds_read_b128 a[212:215], v1 offset:12544
    s_add_u32 m0, s32, 86016
    s_mov_b32 s35, 196608
    buffer_load_dwordx4 v7, s[16:19], s35 offen offset:0 lds
    v_mfma_f32_16x16x32_bf16 v[52:55], a[100:103], a[160:163], v[52:55]
    ds_read_b64_tr_b16 a[120:121], v252 offset:0
    ds_read_b64_tr_b16 a[122:123], v252 offset:768
    v_mfma_f32_16x16x32_bf16 v[56:59], a[104:107], a[160:163], v[56:59]
    ds_read_b64_tr_b16 a[124:125], v253 offset:32
    ds_read_b64_tr_b16 a[126:127], v253 offset:800
    buffer_load_dwordx4 v8, s[16:19], s35 offen offset:1024 lds
    v_mfma_f32_16x16x32_bf16 v[60:63], a[108:111], a[160:163], v[60:63]
    ds_read_b64_tr_b16 a[128:129], v252 offset:64
    ds_read_b64_tr_b16 a[130:131], v252 offset:832
    v_mfma_f32_16x16x32_bf16 v[64:67], a[112:115], a[160:163], v[64:67]
    ds_read_b64_tr_b16 a[132:133], v253 offset:96
    ds_read_b64_tr_b16 a[134:135], v253 offset:864
    buffer_load_dwordx4 v9, s[16:19], s35 offen offset:2048 lds
    v_mfma_f32_16x16x32_bf16 v[68:71], a[116:119], a[160:163], v[68:71]
    ds_read_b64_tr_b16 a[136:137], v252 offset:128
    ds_read_b64_tr_b16 a[138:139], v252 offset:896
    v_mfma_f32_16x16x32_bf16 v[72:75], a[96:99], a[208:211], v[72:75]
    ds_read_b64_tr_b16 a[140:141], v253 offset:160
    ds_read_b64_tr_b16 a[142:143], v253 offset:928
    s_add_u32 m0, s32, 89088
    s_mov_b32 s35, 208896
    buffer_load_dwordx4 v7, s[16:19], s35 offen offset:0 lds
    v_mfma_f32_16x16x32_bf16 v[76:79], a[100:103], a[208:211], v[76:79]
    v_mfma_f32_16x16x32_bf16 v[80:83], a[104:107], a[208:211], v[80:83]
    buffer_load_dwordx4 v8, s[16:19], s35 offen offset:1024 lds
    v_mfma_f32_16x16x32_bf16 v[84:87], a[108:111], a[208:211], v[84:87]
    v_mfma_f32_16x16x32_bf16 v[88:91], a[112:115], a[208:211], v[88:91]
    buffer_load_dwordx4 v9, s[16:19], s35 offen offset:2048 lds
    v_mfma_f32_16x16x32_bf16 v[92:95], a[116:119], a[208:211], v[92:95]
    s_waitcnt lgkmcnt(0)
    s_waitcnt vmcnt(15)
    v_mfma_f32_16x16x32_bf16 v[48:51], a[120:123], a[164:167], v[48:51]
    ds_read_b128 a[168:171], v2 offset:256
    ds_read_b128 a[216:219], v2 offset:12544
    s_add_u32 m0, s32, 110592
    s_mov_b32 s35, 221184
    buffer_load_dwordx4 v7, s[16:19], s35 offen offset:0 lds
    v_mfma_f32_16x16x32_bf16 v[52:55], a[124:127], a[164:167], v[52:55]
    ds_read_b64_tr_b16 v[96:97], v252 offset:24576
    ds_read_b64_tr_b16 v[98:99], v252 offset:25344
    v_mfma_f32_16x16x32_bf16 v[56:59], a[128:131], a[164:167], v[56:59]
    ds_read_b64_tr_b16 v[100:101], v253 offset:24608
    ds_read_b64_tr_b16 v[102:103], v253 offset:25376
    buffer_load_dwordx4 v8, s[16:19], s35 offen offset:1024 lds
    v_mfma_f32_16x16x32_bf16 v[60:63], a[132:135], a[164:167], v[60:63]
    ds_read_b64_tr_b16 v[104:105], v252 offset:24640
    ds_read_b64_tr_b16 v[106:107], v252 offset:25408
    v_mfma_f32_16x16x32_bf16 v[64:67], a[136:139], a[164:167], v[64:67]
    ds_read_b64_tr_b16 v[108:109], v253 offset:24672
    ds_read_b64_tr_b16 v[110:111], v253 offset:25440
    buffer_load_dwordx4 v9, s[16:19], s35 offen offset:2048 lds
    v_mfma_f32_16x16x32_bf16 v[68:71], a[140:143], a[164:167], v[68:71]
    ds_read_b64_tr_b16 v[112:113], v252 offset:24704
    ds_read_b64_tr_b16 v[114:115], v252 offset:25472
    v_mfma_f32_16x16x32_bf16 v[72:75], a[120:123], a[212:215], v[72:75]
    ds_read_b64_tr_b16 v[116:117], v253 offset:24736
    ds_read_b64_tr_b16 v[118:119], v253 offset:25504
    s_add_u32 m0, s32, 113664
    s_mov_b32 s35, 233472
    buffer_load_dwordx4 v7, s[16:19], s35 offen offset:0 lds
    v_mfma_f32_16x16x32_bf16 v[76:79], a[124:127], a[212:215], v[76:79]
    v_mfma_f32_16x16x32_bf16 v[80:83], a[128:131], a[212:215], v[80:83]
    buffer_load_dwordx4 v8, s[16:19], s35 offen offset:1024 lds
    v_mfma_f32_16x16x32_bf16 v[84:87], a[132:135], a[212:215], v[84:87]
    v_mfma_f32_16x16x32_bf16 v[88:91], a[136:139], a[212:215], v[88:91]
    buffer_load_dwordx4 v9, s[16:19], s35 offen offset:2048 lds
    v_mfma_f32_16x16x32_bf16 v[92:95], a[140:143], a[212:215], v[92:95]
    s_waitcnt lgkmcnt(0)
    s_waitcnt vmcnt(15)
    v_mfma_f32_16x16x32_bf16 v[48:51], v[96:99], a[168:171], v[48:51]
    ds_read_b128 a[172:175], v3 offset:256
    ds_read_b128 a[220:223], v3 offset:12544
    s_add_u32 m0, s32, 135168
    s_mov_b32 s35, 245760
    buffer_load_dwordx4 v7, s[16:19], s35 offen offset:0 lds
    v_mfma_f32_16x16x32_bf16 v[52:55], v[100:103], a[168:171], v[52:55]
    ds_read_b64_tr_b16 v[120:121], v10 offset:0
    ds_read_b64_tr_b16 v[122:123], v10 offset:768
    v_mfma_f32_16x16x32_bf16 v[56:59], v[104:107], a[168:171], v[56:59]
    ds_read_b64_tr_b16 v[124:125], v11 offset:32
    ds_read_b64_tr_b16 v[126:127], v11 offset:800
    buffer_load_dwordx4 v8, s[16:19], s35 offen offset:1024 lds
    v_mfma_f32_16x16x32_bf16 v[60:63], v[108:111], a[168:171], v[60:63]
    ds_read_b64_tr_b16 v[128:129], v10 offset:64
    ds_read_b64_tr_b16 v[130:131], v10 offset:832
    v_mfma_f32_16x16x32_bf16 v[64:67], v[112:115], a[168:171], v[64:67]
    ds_read_b64_tr_b16 v[132:133], v11 offset:96
    ds_read_b64_tr_b16 v[134:135], v11 offset:864
    buffer_load_dwordx4 v9, s[16:19], s35 offen offset:2048 lds
    v_mfma_f32_16x16x32_bf16 v[68:71], v[116:119], a[168:171], v[68:71]
    ds_read_b64_tr_b16 v[136:137], v10 offset:128
    ds_read_b64_tr_b16 v[138:139], v10 offset:896
    v_mfma_f32_16x16x32_bf16 v[72:75], v[96:99], a[216:219], v[72:75]
    ds_read_b64_tr_b16 v[140:141], v11 offset:160
    ds_read_b64_tr_b16 v[142:143], v11 offset:928
    s_add_u32 m0, s32, 138240
    s_mov_b32 s35, 258048
    buffer_load_dwordx4 v7, s[16:19], s35 offen offset:0 lds
    v_mfma_f32_16x16x32_bf16 v[76:79], v[100:103], a[216:219], v[76:79]
    v_mfma_f32_16x16x32_bf16 v[80:83], v[104:107], a[216:219], v[80:83]
    buffer_load_dwordx4 v8, s[16:19], s35 offen offset:1024 lds
    v_mfma_f32_16x16x32_bf16 v[84:87], v[108:111], a[216:219], v[84:87]
    v_mfma_f32_16x16x32_bf16 v[88:91], v[112:115], a[216:219], v[88:91]
    buffer_load_dwordx4 v9, s[16:19], s35 offen offset:2048 lds
    v_mfma_f32_16x16x32_bf16 v[92:95], v[116:119], a[216:219], v[92:95]
    s_waitcnt lgkmcnt(0)
    s_waitcnt vmcnt(12)
    v_mfma_f32_16x16x32_bf16 v[48:51], v[120:123], a[172:175], v[48:51]
    ds_read_b128 a[176:179], v0 offset:512
    ds_read_b128 a[224:227], v0 offset:12800
    s_add_u32 m0, s32, 61440
    s_mov_b32 s35, 270336
    buffer_load_dwordx4 v7, s[16:19], s35 offen offset:0 lds
    v_mfma_f32_16x16x32_bf16 v[52:55], v[124:127], a[172:175], v[52:55]
    ds_read_b64_tr_b16 v[144:145], v10 offset:24576
    ds_read_b64_tr_b16 v[146:147], v10 offset:25344
    v_mfma_f32_16x16x32_bf16 v[56:59], v[128:131], a[172:175], v[56:59]
    ds_read_b64_tr_b16 v[148:149], v11 offset:24608
    ds_read_b64_tr_b16 v[150:151], v11 offset:25376
    buffer_load_dwordx4 v8, s[16:19], s35 offen offset:1024 lds
    v_mfma_f32_16x16x32_bf16 v[60:63], v[132:135], a[172:175], v[60:63]
    ds_read_b64_tr_b16 v[152:153], v10 offset:24640
    ds_read_b64_tr_b16 v[154:155], v10 offset:25408
    v_mfma_f32_16x16x32_bf16 v[64:67], v[136:139], a[172:175], v[64:67]
    ds_read_b64_tr_b16 v[156:157], v11 offset:24672
    ds_read_b64_tr_b16 v[158:159], v11 offset:25440
    buffer_load_dwordx4 v9, s[16:19], s35 offen offset:2048 lds
    v_mfma_f32_16x16x32_bf16 v[68:71], v[140:143], a[172:175], v[68:71]
    ds_read_b64_tr_b16 v[160:161], v10 offset:24704
    ds_read_b64_tr_b16 v[162:163], v10 offset:25472
    v_mfma_f32_16x16x32_bf16 v[72:75], v[120:123], a[220:223], v[72:75]
    ds_read_b64_tr_b16 v[164:165], v11 offset:24736
    ds_read_b64_tr_b16 v[166:167], v11 offset:25504
    s_add_u32 m0, s32, 64512
    s_mov_b32 s35, 282624
    buffer_load_dwordx4 v7, s[16:19], s35 offen offset:0 lds
    v_mfma_f32_16x16x32_bf16 v[76:79], v[124:127], a[220:223], v[76:79]
    v_mfma_f32_16x16x32_bf16 v[80:83], v[128:131], a[220:223], v[80:83]
    buffer_load_dwordx4 v8, s[16:19], s35 offen offset:1024 lds
    v_mfma_f32_16x16x32_bf16 v[84:87], v[132:135], a[220:223], v[84:87]
    v_mfma_f32_16x16x32_bf16 v[88:91], v[136:139], a[220:223], v[88:91]
    buffer_load_dwordx4 v9, s[16:19], s35 offen offset:2048 lds
    v_mfma_f32_16x16x32_bf16 v[92:95], v[140:143], a[220:223], v[92:95]
    s_waitcnt lgkmcnt(0)
    s_waitcnt vmcnt(12)
    v_mfma_f32_16x16x32_bf16 v[48:51], v[144:147], a[176:179], v[48:51]
    ds_read_b128 a[180:183], v1 offset:512
    ds_read_b128 a[228:231], v1 offset:12800
    s_add_u32 m0, s42, s41
    s_add_u32 s42, s42, 12288
    buffer_load_dwordx4 v4, s[12:15], s30 offen offset:0 nt lds
    buffer_load_dwordx4 v5, s[12:15], s30 offen offset:1024 nt lds
    buffer_load_dwordx4 v6, s[12:15], s30 offen offset:2048 nt lds
    buffer_store_dwordx4 a[240:243], v16, s[24:27], 0 offen offset:0 sc0 sc1
    buffer_store_dwordx4 a[244:247], v16, s[24:27], 0 offen offset:1024 sc0 sc1
    buffer_store_dwordx4 a[248:251], v16, s[24:27], 0 offen offset:2048 sc0 sc1
    s_add_u32 s30, s30, 393216
    v_mfma_f32_16x16x32_bf16 v[52:55], v[148:151], a[176:179], v[52:55]
    ds_read_b64_tr_b16 v[168:169], v252 offset:0
    ds_read_b64_tr_b16 v[170:171], v252 offset:768
    v_mfma_f32_16x16x32_bf16 v[56:59], v[152:155], a[176:179], v[56:59]
    ds_read_b64_tr_b16 v[172:173], v253 offset:32
    ds_read_b64_tr_b16 v[174:175], v253 offset:800
    v_mfma_f32_16x16x32_bf16 v[60:63], v[156:159], a[176:179], v[60:63]
    ds_read_b64_tr_b16 v[176:177], v252 offset:64
    ds_read_b64_tr_b16 v[178:179], v252 offset:832
    v_mfma_f32_16x16x32_bf16 v[64:67], v[160:163], a[176:179], v[64:67]
    ds_read_b64_tr_b16 v[180:181], v253 offset:96
    ds_read_b64_tr_b16 v[182:183], v253 offset:864
    v_mfma_f32_16x16x32_bf16 v[68:71], v[164:167], a[176:179], v[68:71]
    ds_read_b64_tr_b16 v[184:185], v252 offset:128
    ds_read_b64_tr_b16 v[186:187], v252 offset:896
    v_mfma_f32_16x16x32_bf16 v[72:75], v[144:147], a[224:227], v[72:75]
    ds_read_b64_tr_b16 v[188:189], v253 offset:160
    ds_read_b64_tr_b16 v[190:191], v253 offset:928
    v_mfma_f32_16x16x32_bf16 v[76:79], v[148:151], a[224:227], v[76:79]
    v_mfma_f32_16x16x32_bf16 v[80:83], v[152:155], a[224:227], v[80:83]
    v_mfma_f32_16x16x32_bf16 v[84:87], v[156:159], a[224:227], v[84:87]
    v_mfma_f32_16x16x32_bf16 v[88:91], v[160:163], a[224:227], v[88:91]
    v_mfma_f32_16x16x32_bf16 v[92:95], v[164:167], a[224:227], v[92:95]
    s_waitcnt lgkmcnt(0)
    s_waitcnt vmcnt(12)
    v_mfma_f32_16x16x32_bf16 v[48:51], v[168:171], a[180:183], v[48:51]
    ds_read_b128 a[184:187], v2 offset:512
    ds_read_b128 a[232:235], v2 offset:12800
    s_add_u32 m0, s42, s41
    s_add_u32 s42, s42, 12288
    buffer_load_dwordx4 v4, s[12:15], s30 offen offset:0 nt lds
    buffer_load_dwordx4 v5, s[12:15], s30 offen offset:1024 nt lds
    buffer_load_dwordx4 v6, s[12:15], s30 offen offset:2048 nt lds
    buffer_store_dwordx4 a[240:243], v16, s[24:27], 0 offen offset:0 sc0 sc1
    buffer_store_dwordx4 a[244:247], v16, s[24:27], 0 offen offset:1024 sc0 sc1
    buffer_store_dwordx4 a[248:251], v16, s[24:27], 0 offen offset:2048 sc0 sc1
    s_add_u32 s30, s30, 393216
    v_mfma_f32_16x16x32_bf16 v[52:55], v[172:175], a[180:183], v[52:55]
    ds_read_b64_tr_b16 v[192:193], v252 offset:24576
    ds_read_b64_tr_b16 v[194:195], v252 offset:25344
    v_mfma_f32_16x16x32_bf16 v[56:59], v[176:179], a[180:183], v[56:59]
    ds_read_b64_tr_b16 v[196:197], v253 offset:24608
    ds_read_b64_tr_b16 v[198:199], v253 offset:25376
    v_mfma_f32_16x16x32_bf16 v[60:63], v[180:183], a[180:183], v[60:63]
    ds_read_b64_tr_b16 v[200:201], v252 offset:24640
    ds_read_b64_tr_b16 v[202:203], v252 offset:25408
    v_mfma_f32_16x16x32_bf16 v[64:67], v[184:187], a[180:183], v[64:67]
    ds_read_b64_tr_b16 v[204:205], v253 offset:24672
    ds_read_b64_tr_b16 v[206:207], v253 offset:25440
    v_mfma_f32_16x16x32_bf16 v[68:71], v[188:191], a[180:183], v[68:71]
    ds_read_b64_tr_b16 v[208:209], v252 offset:24704
    ds_read_b64_tr_b16 v[210:211], v252 offset:25472
    v_mfma_f32_16x16x32_bf16 v[72:75], v[168:171], a[228:231], v[72:75]
    ds_read_b64_tr_b16 v[212:213], v253 offset:24736
    ds_read_b64_tr_b16 v[214:215], v253 offset:25504
    v_mfma_f32_16x16x32_bf16 v[76:79], v[172:175], a[228:231], v[76:79]
    v_mfma_f32_16x16x32_bf16 v[80:83], v[176:179], a[228:231], v[80:83]
    v_mfma_f32_16x16x32_bf16 v[84:87], v[180:183], a[228:231], v[84:87]
    v_mfma_f32_16x16x32_bf16 v[88:91], v[184:187], a[228:231], v[88:91]
    v_mfma_f32_16x16x32_bf16 v[92:95], v[188:191], a[228:231], v[92:95]
    s_waitcnt lgkmcnt(0)
    s_waitcnt vmcnt(12)
    v_mfma_f32_16x16x32_bf16 v[48:51], v[192:195], a[184:187], v[48:51]
    ds_read_b128 a[188:191], v3 offset:512
    ds_read_b128 a[236:239], v3 offset:12800
    v_mfma_f32_16x16x32_bf16 v[52:55], v[196:199], a[184:187], v[52:55]
    ds_read_b64_tr_b16 v[216:217], v10 offset:0
    ds_read_b64_tr_b16 v[218:219], v10 offset:768
    v_mfma_f32_16x16x32_bf16 v[56:59], v[200:203], a[184:187], v[56:59]
    ds_read_b64_tr_b16 v[220:221], v11 offset:32
    ds_read_b64_tr_b16 v[222:223], v11 offset:800
    v_mfma_f32_16x16x32_bf16 v[60:63], v[204:207], a[184:187], v[60:63]
    ds_read_b64_tr_b16 v[224:225], v10 offset:64
    ds_read_b64_tr_b16 v[226:227], v10 offset:832
    v_mfma_f32_16x16x32_bf16 v[64:67], v[208:211], a[184:187], v[64:67]
    ds_read_b64_tr_b16 v[228:229], v11 offset:96
    ds_read_b64_tr_b16 v[230:231], v11 offset:864
    v_mfma_f32_16x16x32_bf16 v[68:71], v[212:215], a[184:187], v[68:71]
    ds_read_b64_tr_b16 v[232:233], v10 offset:128
    ds_read_b64_tr_b16 v[234:235], v10 offset:896
    v_mfma_f32_16x16x32_bf16 v[72:75], v[192:195], a[232:235], v[72:75]
    ds_read_b64_tr_b16 v[236:237], v11 offset:160
    ds_read_b64_tr_b16 v[238:239], v11 offset:928
    v_mfma_f32_16x16x32_bf16 v[76:79], v[196:199], a[232:235], v[76:79]
    v_mfma_f32_16x16x32_bf16 v[80:83], v[200:203], a[232:235], v[80:83]
    v_mfma_f32_16x16x32_bf16 v[84:87], v[204:207], a[232:235], v[84:87]
    v_mfma_f32_16x16x32_bf16 v[88:91], v[208:211], a[232:235], v[88:91]
    v_mfma_f32_16x16x32_bf16 v[92:95], v[212:215], a[232:235], v[92:95]
    s_waitcnt lgkmcnt(0)
    s_barrier
    v_mfma_f32_16x16x32_bf16 v[48:51], v[216:219], a[188:191], v[48:51]
    ds_read_b128 a[144:147], v0 offset:24576
    v_mfma_f32_16x16x32_bf16 v[52:55], v[220:223], a[188:191], v[52:55]
    ds_read_b128 a[148:151], v1 offset:24576
    v_mfma_f32_16x16x32_bf16 v[56:59], v[224:227], a[188:191], v[56:59]
    ds_read_b128 a[152:155], v2 offset:24576
    v_mfma_f32_16x16x32_bf16 v[60:63], v[228:231], a[188:191], v[60:63]
    ds_read_b128 a[156:159], v3 offset:24576
    v_mfma_f32_16x16x32_bf16 v[64:67], v[232:235], a[188:191], v[64:67]
    ds_read_b128 a[160:163], v0 offset:24832
    v_mfma_f32_16x16x32_bf16 v[68:71], v[236:239], a[188:191], v[68:71]
    ds_read_b128 a[164:167], v1 offset:24832
    v_mfma_f32_16x16x32_bf16 v[72:75], v[216:219], a[236:239], v[72:75]
    ds_read_b128 a[168:171], v2 offset:24832
    v_mfma_f32_16x16x32_bf16 v[76:79], v[220:223], a[236:239], v[76:79]
    ds_read_b128 a[172:175], v3 offset:24832
    v_mfma_f32_16x16x32_bf16 v[80:83], v[224:227], a[236:239], v[80:83]
    ds_read_b128 a[176:179], v0 offset:25088
    v_mfma_f32_16x16x32_bf16 v[84:87], v[228:231], a[236:239], v[84:87]
    ds_read_b128 a[180:183], v1 offset:25088
    v_mfma_f32_16x16x32_bf16 v[88:91], v[232:235], a[236:239], v[88:91]
    ds_read_b128 a[184:187], v2 offset:25088
    v_mfma_f32_16x16x32_bf16 v[92:95], v[236:239], a[236:239], v[92:95]
    ds_read_b128 a[188:191], v3 offset:25088
    s_waitcnt lgkmcnt(0)
    s_nop 1
    v_cvt_pk_bf16_f32 v48, v48, v49
    v_cvt_pk_bf16_f32 v49, v50, v51
    ds_write_b64 v12, v[48:49] offset:0
    v_cvt_pk_bf16_f32 v52, v52, v53
    v_cvt_pk_bf16_f32 v53, v54, v55
    ds_write_b64 v12, v[52:53] offset:32
    v_cvt_pk_bf16_f32 v56, v56, v57
    v_cvt_pk_bf16_f32 v57, v58, v59
    ds_write_b64 v12, v[56:57] offset:64
    v_cvt_pk_bf16_f32 v60, v60, v61
    v_cvt_pk_bf16_f32 v61, v62, v63
    ds_write_b64 v12, v[60:61] offset:96
    v_cvt_pk_bf16_f32 v64, v64, v65
    v_cvt_pk_bf16_f32 v65, v66, v67
    ds_write_b64 v12, v[64:65] offset:128
    v_cvt_pk_bf16_f32 v68, v68, v69
    v_cvt_pk_bf16_f32 v69, v70, v71
    ds_write_b64 v12, v[68:69] offset:160
    v_add_u32 v0, 36864, v0
    v_add_u32 v1, 36864, v1
    v_add_u32 v2, 36864, v2
    v_add_u32 v3, 36864, v3
    s_mov_b32 s34, 36864
    s_mov_b32 s29, 2
    s_add_u32 m0, s42, s41
    s_mov_b32 s26, 113246208
L_enter:
.p2align 6
L_loop0:
    s_waitcnt vmcnt(9) lgkmcnt(0)
    s_barrier
    v_mfma_f32_16x16x32_bf16 v[48:51], a[0:3], a[144:147], v[24:27]
    ds_read_b128 a[192:195], v0 offset:0
    v_mfma_f32_16x16x32_bf16 v[48:51], a[24:27], a[148:151], v[48:51]
    buffer_load_dwordx4 v4, s[12:15], s30 offen offset:0 nt lds
    v_mfma_f32_16x16x32_bf16 v[48:51], a[48:51], a[152:155], v[48:51]
    s_add_u32 s31, s31, 393216
    v_mfma_f32_16x16x32_bf16 v[48:51], a[72:75], a[156:159], v[48:51]
    v_mfma_f32_16x16x32_bf16 v[48:51], a[96:99], a[160:163], v[48:51]
    v_mfma_f32_16x16x32_bf16 v[48:51], a[120:123], a[164:167], v[48:51]
    ds_read_b128 a[196:199], v1 offset:0
    v_mfma_f32_16x16x32_bf16 v[48:51], v[96:99], a[168:171], v[48:51]
    v_mfma_f32_16x16x32_bf16 v[48:51], v[120:123], a[172:175], v[48:51]
    v_mfma_f32_16x16x32_bf16 v[48:51], v[144:147], a[176:179], v[48:51]
    v_cvt_pk_bf16_f32 v72, v72, v73
    v_mfma_f32_16x16x32_bf16 v[48:51], v[168:171], a[180:183], v[48:51]
    v_cvt_pk_bf16_f32 v73, v74, v75
    v_mfma_f32_16x16x32_bf16 v[48:51], v[192:195], a[184:187], v[48:51]
    ds_read_b128 a[200:203], v2 offset:0
    v_mfma_f32_16x16x32_bf16 v[48:51], v[216:219], a[188:191], v[48:51]
    ds_write_b64 v12, v[72:73] offset:12544
    v_mfma_f32_16x16x32_bf16 v[52:55], a[4:7], a[144:147], v[28:31]
    s_add_u32 s38, s34, 12288
    v_mfma_f32_16x16x32_bf16 v[52:55], a[28:31], a[148:151], v[52:55]
    buffer_load_dwordx4 v5, s[12:15], s30 offen offset:1024 nt lds
    v_mfma_f32_16x16x32_bf16 v[52:55], a[52:55], a[152:155], v[52:55]
    s_cmp_eq_u32 s38, 86016
    s_cselect_b32 s38, 0, s38
    v_mfma_f32_16x16x32_bf16 v[52:55], a[76:79], a[156:159], v[52:55]
    ds_read_b128 a[204:207], v3 offset:0
    v_mfma_f32_16x16x32_bf16 v[52:55], a[100:103], a[160:163], v[52:55]
    v_cvt_pk_bf16_f32 v76, v76, v77
    v_mfma_f32_16x16x32_bf16 v[52:55], a[124:127], a[164:167], v[52:55]
    v_cvt_pk_bf16_f32 v77, v78, v79
    v_mfma_f32_16x16x32_bf16 v[52:55], v[100:103], a[168:171], v[52:55]
    ds_write_b64 v12, v[76:77] offset:12576
    v_mfma_f32_16x16x32_bf16 v[52:55], v[124:127], a[172:175], v[52:55]
    ds_read_b128 a[240:243], v13 offset:0
    v_mfma_f32_16x16x32_bf16 v[52:55], v[148:151], a[176:179], v[52:55]
    ds_read_b128 a[208:211], v0 offset:256
    v_mfma_f32_16x16x32_bf16 v[52:55], v[172:175], a[180:183], v[52:55]
    s_sub_u32 s33, s38, s34
    v_mfma_f32_16x16x32_bf16 v[52:55], v[196:199], a[184:187], v[52:55]
    s_mov_b32 s34, s38
    v_mfma_f32_16x16x32_bf16 v[52:55], v[220:223], a[188:191], v[52:55]
    v_mfma_f32_16x16x32_bf16 v[56:59], a[8:11], a[144:147], v[32:35]
    v_cvt_pk_bf16_f32 v80, v80, v81
    v_mfma_f32_16x16x32_bf16 v[56:59], a[32:35], a[148:151], v[56:59]
    buffer_load_dwordx4 v6, s[12:15], s30 offen offset:2048 nt lds
    v_mfma_f32_16x16x32_bf16 v[56:59], a[56:59], a[152:155], v[56:59]
    ds_read_b128 a[212:215], v1 offset:256
    v_mfma_f32_16x16x32_bf16 v[56:59], a[80:83], a[156:159], v[56:59]
    s_add_u32 s30, s30, 393216
    v_mfma_f32_16x16x32_bf16 v[56:59], a[104:107], a[160:163], v[56:59]
    s_add_u32 s42, s42, 12288
    v_mfma_f32_16x16x32_bf16 v[56:59], a[128:131], a[164:167], v[56:59]
    s_cmp_eq_u32 s42, 86016
    s_cselect_b32 s42, 0, s42
    v_mfma_f32_16x16x32_bf16 v[56:59], v[104:107], a[168:171], v[56:59]
    ds_read_b128 a[216:219], v2 offset:256
    v_mfma_f32_16x16x32_bf16 v[56:59], v[128:131], a[172:175], v[56:59]
    s_add_u32 m0, s42, s41
    v_mfma_f32_16x16x32_bf16 v[56:59], v[152:155], a[176:179], v[56:59]
    ds_read_b128 a[244:247], v14 offset:0
    v_mfma_f32_16x16x32_bf16 v[56:59], v[176:179], a[180:183], v[56:59]
    v_cvt_pk_bf16_f32 v81, v82, v83
    v_mfma_f32_16x16x32_bf16 v[56:59], v[200:203], a[184:187], v[56:59]
    ds_write_b64 v12, v[80:81] offset:12608
    v_mfma_f32_16x16x32_bf16 v[56:59], v[224:227], a[188:191], v[56:59]
    ds_read_b128 a[220:223], v3 offset:256
    v_mfma_f32_16x16x32_bf16 v[60:63], a[12:15], a[144:147], v[36:39]
    v_cvt_pk_bf16_f32 v84, v84, v85
    v_mfma_f32_16x16x32_bf16 v[60:63], a[36:39], a[148:151], v[60:63]
    s_waitcnt lgkmcnt(6)
    buffer_store_dwordx4 a[240:243], v16, s[24:27], s31 offen offset:0 sc0 sc1
    v_mfma_f32_16x16x32_bf16 v[60:63], a[60:63], a[152:155], v[60:63]
    v_cvt_pk_bf16_f32 v85, v86, v87
    v_mfma_f32_16x16x32_bf16 v[60:63], a[84:87], a[156:159], v[60:63]
    ds_write_b64 v12, v[84:85] offset:12640
    v_mfma_f32_16x16x32_bf16 v[60:63], a[108:111], a[160:163], v[60:63]
    ds_read_b128 a[224:227], v0 offset:512
    v_mfma_f32_16x16x32_bf16 v[60:63], a[132:135], a[164:167], v[60:63]
    s_add_u32 s29, s29, 1
    v_mfma_f32_16x16x32_bf16 v[60:63], v[108:111], a[168:171], v[60:63]
    s_cmp_lt_u32 s29, 33
    s_cselect_b32 s14, s40, 0
    v_mfma_f32_16x16x32_bf16 v[60:63], v[132:135], a[172:175], v[60:63]
    ds_read_b128 a[248:251], v15 offset:0
    v_mfma_f32_16x16x32_bf16 v[60:63], v[156:159], a[176:179], v[60:63]
    v_cvt_pk_bf16_f32 v88, v88, v89
    v_mfma_f32_16x16x32_bf16 v[60:63], v[180:183], a[180:183], v[60:63]
    ds_read_b128 a[228:231], v1 offset:512
    v_mfma_f32_16x16x32_bf16 v[60:63], v[204:207], a[184:187], v[60:63]
    v_cvt_pk_bf16_f32 v89, v90, v91
    v_mfma_f32_16x16x32_bf16 v[60:63], v[228:231], a[188:191], v[60:63]
    ds_write_b64 v12, v[88:89] offset:12672
    v_mfma_f32_16x16x32_bf16 v[64:67], a[16:19], a[144:147], v[40:43]
    v_cvt_pk_bf16_f32 v92, v92, v93
    v_mfma_f32_16x16x32_bf16 v[64:67], a[40:43], a[148:151], v[64:67]
    s_waitcnt lgkmcnt(7)
    buffer_store_dwordx4 a[244:247], v16, s[24:27], s31 offen offset:1024 sc0 sc1
    v_mfma_f32_16x16x32_bf16 v[64:67], a[64:67], a[152:155], v[64:67]
    ds_read_b128 a[232:235], v2 offset:512
    v_mfma_f32_16x16x32_bf16 v[64:67], a[88:91], a[156:159], v[64:67]
    v_cvt_pk_bf16_f32 v93, v94, v95
    v_mfma_f32_16x16x32_bf16 v[64:67], a[112:115], a[160:163], v[64:67]
    ds_write_b64 v12, v[92:93] offset:12704
    v_mfma_f32_16x16x32_bf16 v[64:67], a[136:139], a[164:167], v[64:67]
    v_add_u32 v0, s33, v0
    v_mfma_f32_16x16x32_bf16 v[64:67], v[112:115], a[168:171], v[64:67]
    v_add_u32 v1, s33, v1
    v_mfma_f32_16x16x32_bf16 v[64:67], v[136:139], a[172:175], v[64:67]
    ds_read_b128 a[236:239], v3 offset:512
    v_mfma_f32_16x16x32_bf16 v[64:67], v[160:163], a[176:179], v[64:67]
    v_add_u32 v2, s33, v2
    v_mfma_f32_16x16x32_bf16 v[64:67], v[184:187], a[180:183], v[64:67]
    v_add_u32 v3, s33, v3
    v_mfma_f32_16x16x32_bf16 v[64:67], v[208:211], a[184:187], v[64:67]
    v_mfma_f32_16x16x32_bf16 v[64:67], v[232:235], a[188:191], v[64:67]
    v_mfma_f32_16x16x32_bf16 v[68:71], a[20:23], a[144:147], v[44:47]
    v_mfma_f32_16x16x32_bf16 v[68:71], a[44:47], a[148:151], v[68:71]
    s_waitcnt lgkmcnt(5)
    buffer_store_dwordx4 a[248:251], v16, s[24:27], s31 offen offset:2048 sc0 sc1
    v_mfma_f32_16x16x32_bf16 v[68:71], a[68:71], a[152:155], v[68:71]
    v_mfma_f32_16x16x32_bf16 v[68:71], a[92:95], a[156:159], v[68:71]
    v_mfma_f32_16x16x32_bf16 v[68:71], a[116:119], a[160:163], v[68:71]
    v_mfma_f32_16x16x32_bf16 v[68:71], a[140:143], a[164:167], v[68:71]
    v_mfma_f32_16x16x32_bf16 v[68:71], v[116:119], a[168:171], v[68:71]
    v_mfma_f32_16x16x32_bf16 v[68:71], v[140:143], a[172:175], v[68:71]
    v_mfma_f32_16x16x32_bf16 v[68:71], v[164:167], a[176:179], v[68:71]
    v_mfma_f32_16x16x32_bf16 v[68:71], v[188:191], a[180:183], v[68:71]
    v_mfma_f32_16x16x32_bf16 v[68:71], v[212:215], a[184:187], v[68:71]
    v_mfma_f32_16x16x32_bf16 v[68:71], v[236:239], a[188:191], v[68:71]
    s_waitcnt vmcnt(9) lgkmcnt(0)
    s_barrier
    v_mfma_f32_16x16x32_bf16 v[72:75], a[0:3], a[192:195], v[24:27]
    ds_read_b128 a[144:147], v0 offset:0
    v_mfma_f32_16x16x32_bf16 v[72:75], a[24:27], a[196:199], v[72:75]
    buffer_load_dwordx4 v4, s[12:15], s30 offen offset:0 nt lds
    v_mfma_f32_16x16x32_bf16 v[72:75], a[48:51], a[200:203], v[72:75]
    s_add_u32 s31, s31, 393216
    v_mfma_f32_16x16x32_bf16 v[72:75], a[72:75], a[204:207], v[72:75]
    v_mfma_f32_16x16x32_bf16 v[72:75], a[96:99], a[208:211], v[72:75]
    v_mfma_f32_16x16x32_bf16 v[72:75], a[120:123], a[212:215], v[72:75]
    ds_read_b128 a[148:151], v1 offset:0
    v_mfma_f32_16x16x32_bf16 v[72:75], v[96:99], a[216:219], v[72:75]
    v_mfma_f32_16x16x32_bf16 v[72:75], v[120:123], a[220:223], v[72:75]
    v_mfma_f32_16x16x32_bf16 v[72:75], v[144:147], a[224:227], v[72:75]
    v_cvt_pk_bf16_f32 v48, v48, v49
    v_mfma_f32_16x16x32_bf16 v[72:75], v[168:171], a[228:231], v[72:75]
    v_cvt_pk_bf16_f32 v49, v50, v51
    v_mfma_f32_16x16x32_bf16 v[72:75], v[192:195], a[232:235], v[72:75]
    ds_read_b128 a[152:155], v2 offset:0
    v_mfma_f32_16x16x32_bf16 v[72:75], v[216:219], a[236:239], v[72:75]
    ds_write_b64 v12, v[48:49] offset:0
    v_mfma_f32_16x16x32_bf16 v[76:79], a[4:7], a[192:195], v[28:31]
    s_add_u32 s38, s34, 12288
    v_mfma_f32_16x16x32_bf16 v[76:79], a[28:31], a[196:199], v[76:79]
    buffer_load_dwordx4 v5, s[12:15], s30 offen offset:1024 nt lds
    v_mfma_f32_16x16x32_bf16 v[76:79], a[52:55], a[200:203], v[76:79]
    s_cmp_eq_u32 s38, 86016
    s_cselect_b32 s38, 0, s38
    v_mfma_f32_16x16x32_bf16 v[76:79], a[76:79], a[204:207], v[76:79]
    ds_read_b128 a[156:159], v3 offset:0
    v_mfma_f32_16x16x32_bf16 v[76:79], a[100:103], a[208:211], v[76:79]
    v_cvt_pk_bf16_f32 v52, v52, v53
    v_mfma_f32_16x16x32_bf16 v[76:79], a[124:127], a[212:215], v[76:79]
    v_cvt_pk_bf16_f32 v53, v54, v55
    v_mfma_f32_16x16x32_bf16 v[76:79], v[100:103], a[216:219], v[76:79]
    ds_write_b64 v12, v[52:53] offset:32
    v_mfma_f32_16x16x32_bf16 v[76:79], v[124:127], a[220:223], v[76:79]
    ds_read_b128 a[240:243], v13 offset:12544
    v_mfma_f32_16x16x32_bf16 v[76:79], v[148:151], a[224:227], v[76:79]
    ds_read_b128 a[160:163], v0 offset:256
    v_mfma_f32_16x16x32_bf16 v[76:79], v[172:175], a[228:231], v[76:79]
    s_sub_u32 s33, s38, s34
    v_mfma_f32_16x16x32_bf16 v[76:79], v[196:199], a[232:235], v[76:79]
    s_mov_b32 s34, s38
    v_mfma_f32_16x16x32_bf16 v[76:79], v[220:223], a[236:239], v[76:79]
    v_mfma_f32_16x16x32_bf16 v[80:83], a[8:11], a[192:195], v[32:35]
    v_cvt_pk_bf16_f32 v56, v56, v57
    v_mfma_f32_16x16x32_bf16 v[80:83], a[32:35], a[196:199], v[80:83]
    buffer_load_dwordx4 v6, s[12:15], s30 offen offset:2048 nt lds
    v_mfma_f32_16x16x32_bf16 v[80:83], a[56:59], a[200:203], v[80:83]
    ds_read_b128 a[164:167], v1 offset:256
    v_mfma_f32_16x16x32_bf16 v[80:83], a[80:83], a[204:207], v[80:83]
    s_add_u32 s30, s30, 393216
    v_mfma_f32_16x16x32_bf16 v[80:83], a[104:107], a[208:211], v[80:83]
    s_add_u32 s42, s42, 12288
    v_mfma_f32_16x16x32_bf16 v[80:83], a[128:131], a[212:215], v[80:83]
    s_cmp_eq_u32 s42, 86016
    s_cselect_b32 s42, 0, s42
    v_mfma_f32_16x16x32_bf16 v[80:83], v[104:107], a[216:219], v[80:83]
    ds_read_b128 a[168:171], v2 offset:256
    v_mfma_f32_16x16x32_bf16 v[80:83], v[128:131], a[220:223], v[80:83]
    s_add_u32 m0, s42, s41
    v_mfma_f32_16x16x32_bf16 v[80:83], v[152:155], a[224:227], v[80:83]
    ds_read_b128 a[244:247], v14 offset:12544
    v_mfma_f32_16x16x32_bf16 v[80:83], v[176:179], a[228:231], v[80:83]
    v_cvt_pk_bf16_f32 v57, v58, v59
    v_mfma_f32_16x16x32_bf16 v[80:83], v[200:203], a[232:235], v[80:83]
    ds_write_b64 v12, v[56:57] offset:64
    v_mfma_f32_16x16x32_bf16 v[80:83], v[224:227], a[236:239], v[80:83]
    ds_read_b128 a[172:175], v3 offset:256
    v_mfma_f32_16x16x32_bf16 v[84:87], a[12:15], a[192:195], v[36:39]
    v_cvt_pk_bf16_f32 v60, v60, v61
    v_mfma_f32_16x16x32_bf16 v[84:87], a[36:39], a[196:199], v[84:87]
    s_waitcnt lgkmcnt(6)
    buffer_store_dwordx4 a[240:243], v16, s[24:27], s31 offen offset:0 sc0 sc1
    v_mfma_f32_16x16x32_bf16 v[84:87], a[60:63], a[200:203], v[84:87]
    v_cvt_pk_bf16_f32 v61, v62, v63
    v_mfma_f32_16x16x32_bf16 v[84:87], a[84:87], a[204:207], v[84:87]
    ds_write_b64 v12, v[60:61] offset:96
    v_mfma_f32_16x16x32_bf16 v[84:87], a[108:111], a[208:211], v[84:87]
    ds_read_b128 a[176:179], v0 offset:512
    v_mfma_f32_16x16x32_bf16 v[84:87], a[132:135], a[212:215], v[84:87]
    s_add_u32 s29, s29, 1
    v_mfma_f32_16x16x32_bf16 v[84:87], v[108:111], a[216:219], v[84:87]
    s_cmp_lt_u32 s29, 33
    s_cselect_b32 s14, s40, 0
    v_mfma_f32_16x16x32_bf16 v[84:87], v[132:135], a[220:223], v[84:87]
    ds_read_b128 a[248:251], v15 offset:12544
    v_mfma_f32_16x16x32_bf16 v[84:87], v[156:159], a[224:227], v[84:87]
    v_cvt_pk_bf16_f32 v64, v64, v65
    v_mfma_f32_16x16x32_bf16 v[84:87], v[180:183], a[228:231], v[84:87]
    ds_read_b128 a[180:183], v1 offset:512
    v_mfma_f32_16x16x32_bf16 v[84:87], v[204:207], a[232:235], v[84:87]
    v_cvt_pk_bf16_f32 v65, v66, v67
    v_mfma_f32_16x16x32_bf16 v[84:87], v[228:231], a[236:239], v[84:87]
    ds_write_b64 v12, v[64:65] offset:128
    v_mfma_f32_16x16x32_bf16 v[88:91], a[16:19], a[192:195], v[40:43]
    v_cvt_pk_bf16_f32 v68, v68, v69
    v_mfma_f32_16x16x32_bf16 v[88:91], a[40:43], a[196:199], v[88:91]
    s_waitcnt lgkmcnt(7)
    buffer_store_dwordx4 a[244:247], v16, s[24:27], s31 offen offset:1024 sc0 sc1
    v_mfma_f32_16x16x32_bf16 v[88:91], a[64:67], a[200:203], v[88:91]
    ds_read_b128 a[184:187], v2 offset:512
    v_mfma_f32_16x16x32_bf16 v[88:91], a[88:91], a[204:207], v[88:91]
    v_cvt_pk_bf16_f32 v69, v70, v71
    v_mfma_f32_16x16x32_bf16 v[88:91], a[112:115], a[208:211], v[88:91]
    ds_write_b64 v12, v[68:69] offset:160
    v_mfma_f32_16x16x32_bf16 v[88:91], a[136:139], a[212:215], v[88:91]
    v_add_u32 v0, s33, v0
    v_mfma_f32_16x16x32_bf16 v[88:91], v[112:115], a[216:219], v[88:91]
    v_add_u32 v1, s33, v1
    v_mfma_f32_16x16x32_bf16 v[88:91], v[136:139], a[220:223], v[88:91]
    ds_read_b128 a[188:191], v3 offset:512
    v_mfma_f32_16x16x32_bf16 v[88:91], v[160:163], a[224:227], v[88:91]
    v_add_u32 v2, s33, v2
    v_mfma_f32_16x16x32_bf16 v[88:91], v[184:187], a[228:231], v[88:91]
    v_add_u32 v3, s33, v3
    v_mfma_f32_16x16x32_bf16 v[88:91], v[208:211], a[232:235], v[88:91]
    v_mfma_f32_16x16x32_bf16 v[88:91], v[232:235], a[236:239], v[88:91]
    v_mfma_f32_16x16x32_bf16 v[92:95], a[20:23], a[192:195], v[44:47]
    v_mfma_f32_16x16x32_bf16 v[92:95], a[44:47], a[196:199], v[92:95]
    s_waitcnt lgkmcnt(5)
    buffer_store_dwordx4 a[248:251], v16, s[24:27], s31 offen offset:2048 sc0 sc1
    v_mfma_f32_16x16x32_bf16 v[92:95], a[68:71], a[200:203], v[92:95]
    v_mfma_f32_16x16x32_bf16 v[92:95], a[92:95], a[204:207], v[92:95]
    v_mfma_f32_16x16x32_bf16 v[92:95], a[116:119], a[208:211], v[92:95]
    v_mfma_f32_16x16x32_bf16 v[92:95], a[140:143], a[212:215], v[92:95]
    v_mfma_f32_16x16x32_bf16 v[92:95], v[116:119], a[216:219], v[92:95]
    v_mfma_f32_16x16x32_bf16 v[92:95], v[140:143], a[220:223], v[92:95]
    v_mfma_f32_16x16x32_bf16 v[92:95], v[164:167], a[224:227], v[92:95]
    v_mfma_f32_16x16x32_bf16 v[92:95], v[188:191], a[228:231], v[92:95]
    v_mfma_f32_16x16x32_bf16 v[92:95], v[212:215], a[232:235], v[92:95]
    v_mfma_f32_16x16x32_bf16 v[92:95], v[236:239], a[236:239], v[92:95]
    s_cmp_lt_u32 s29, 36
    s_cbranch_scc1 L_loop0
L_drain:
    s_waitcnt lgkmcnt(0)
    s_barrier
    s_add_u32 s31, s31, 393216
    s_nop 4
    ds_read_b128 a[240:243], v13 offset:0
    ds_read_b128 a[244:247], v14 offset:0
    ds_read_b128 a[248:251], v15 offset:0
    v_cvt_pk_bf16_f32 v72, v72, v73
    v_cvt_pk_bf16_f32 v73, v74, v75
    ds_write_b64 v12, v[72:73] offset:12544
    v_cvt_pk_bf16_f32 v76, v76, v77
    v_cvt_pk_bf16_f32 v77, v78, v79
    ds_write_b64 v12, v[76:77] offset:12576
    v_cvt_pk_bf16_f32 v80, v80, v81
    v_cvt_pk_bf16_f32 v81, v82, v83
    ds_write_b64 v12, v[80:81] offset:12608
    v_cvt_pk_bf16_f32 v84, v84, v85
    v_cvt_pk_bf16_f32 v85, v86, v87
    ds_write_b64 v12, v[84:85] offset:12640
    v_cvt_pk_bf16_f32 v88, v88, v89
    v_cvt_pk_bf16_f32 v89, v90, v91
    ds_write_b64 v12, v[88:89] offset:12672
    v_cvt_pk_bf16_f32 v92, v92, v93
    v_cvt_pk_bf16_f32 v93, v94, v95
    ds_write_b64 v12, v[92:93] offset:12704
    s_waitcnt lgkmcnt(8)
    buffer_store_dwordx4 a[240:243], v16, s[24:27], s31 offen offset:0 sc0 sc1
    s_waitcnt lgkmcnt(7)
    buffer_store_dwordx4 a[244:247], v16, s[24:27], s31 offen offset:1024 sc0 sc1
    s_waitcnt lgkmcnt(6)
    buffer_store_dwordx4 a[248:251], v16, s[24:27], s31 offen offset:2048 sc0 sc1
    s_add_u32 s31, s31, 393216
    s_waitcnt lgkmcnt(0)
    s_barrier
    ds_read_b128 a[144:147], v13 offset:12544
    ds_read_b128 a[148:151], v14 offset:12544
    ds_read_b128 a[152:155], v15 offset:12544
    s_waitcnt lgkmcnt(2)
    buffer_store_dwordx4 a[144:147], v16, s[24:27], s31 offen offset:0 sc0 sc1
    s_waitcnt lgkmcnt(1)
    buffer_store_dwordx4 a[148:151], v16, s[24:27], s31 offen offset:1024 sc0 sc1
    s_waitcnt lgkmcnt(0)
    buffer_store_dwordx4 a[152:155], v16, s[24:27], s31 offen offset:2048 sc0 sc1
L_done:
    s_endpgm
.section .rodata,"a"
.p2align 6
.amdhsa_kernel standalone__standard_2d_1d_3d_conv__vision_kernel
  .amdhsa_next_free_vgpr 512
  .amdhsa_next_free_sgpr 96
  .amdhsa_accum_offset 256
  .amdhsa_group_segment_fixed_size 0
  .amdhsa_kernarg_size 48
  .amdhsa_user_sgpr_count 2
  .amdhsa_user_sgpr_kernarg_segment_ptr 1
  .amdhsa_system_sgpr_workgroup_id_x 1
.end_amdhsa_kernel
```

```asm
; @launch grid=(256,1,1) block=(256,1,1) lds=159744
.amdgcn_target "amdgcn-amd-amdhsa--gfx950"
.text
.globl standalone__standard_2d_1d_3d_conv__vision_kernel
.p2align 8
.type standalone__standard_2d_1d_3d_conv__vision_kernel,@function
standalone__standard_2d_1d_3d_conv__vision_kernel:
    s_load_dwordx8 s[4:11], s[0:1], 0
    s_cmp_ge_u32 s2, 256
    s_cbranch_scc1 L_done
    v_lshrrev_b32 v18, 6, v0
    v_and_b32 v19, 63, v0
    v_readfirstlane_b32 s28, v18
    v_and_b32 v20, 15, v0
    v_bfe_u32 v21, v0, 4, 2
    v_mul_u32_u24 v22, 3072, v18
    v_add_u32 v23, 16, v19
    v_lshrrev_b32 v23, 6, v23
    v_lshl_add_u32 v23, v18, 2, v23
    v_xor_b32 v23, v23, v19
    v_lshl_add_u32 v4, v23, 4, v22
    v_lshrrev_b32 v23, 5, v19
    v_add_u32 v23, 1, v23
    v_lshl_add_u32 v23, v18, 2, v23
    v_xor_b32 v23, v23, v19
    v_lshl_add_u32 v5, v23, 4, v22
    v_add_u32 v23, 48, v19
    v_lshrrev_b32 v23, 6, v23
    v_add_u32 v23, 2, v23
    v_lshl_add_u32 v23, v18, 2, v23
    v_xor_b32 v23, v23, v19
    v_lshl_add_u32 v6, v23, 4, v22
    s_and_b32 s39, s2, 7
    s_mul_i32 s39, s39, 1152
    s_bitcmp1_b32 s2, 0
    s_cselect_b32 s38, 32, 0
    s_add_u32 s39, s39, s38
    s_lshr_b32 s30, s2, 3
    s_add_u32 s30, s30, s39
    s_mul_i32 s30, s30, 12288
    s_bitcmp1_b32 s2, 0
    s_mov_b32 s37, 37
    s_cselect_b32 s37, 35, s37
    s_sub_u32 s43, s37, 4
    s_sub_u32 s31, s30, 393216
    s_mul_i32 s41, s28, 3072
    s_mul_i32 s32, s28, 6144
    s_mov_b32 s42, 0
    s_mov_b32 s14, 113246208
    s_mov_b32 s15, 0x20000
    s_mov_b32 s18, 294912
    s_mov_b32 s19, 0x20000
    s_mov_b32 s26, 0
    s_mov_b32 s27, 0x20000
    v_mul_u32_u24 v22, 192, v18
    v_add_u32 v240, 0, v19
    v_mul_u32_u24 v241, 171, v240
    v_lshrrev_b32 v241, 11, v241
    v_mul_u32_u24 v242, 12, v241
    v_sub_u32 v240, v240, v242
    v_bfe_u32 v242, v241, 3, 1
    v_lshlrev_b32 v242, 1, v242
    v_xor_b32 v240, v240, v242
    v_lshl_add_u32 v240, v240, 4, v22
    v_mul_u32_u24 v241, 768, v241
    v_add_u32 v240, v240, v241
    v_subrev_u32 v7, 0, v240
    v_add_u32 v240, 64, v19
    v_mul_u32_u24 v241, 171, v240
    v_lshrrev_b32 v241, 11, v241
    v_mul_u32_u24 v242, 12, v241
    v_sub_u32 v240, v240, v242
    v_bfe_u32 v242, v241, 3, 1
    v_lshlrev_b32 v242, 1, v242
    v_xor_b32 v240, v240, v242
    v_lshl_add_u32 v240, v240, 4, v22
    v_mul_u32_u24 v241, 768, v241
    v_add_u32 v240, v240, v241
    v_subrev_u32 v8, 1024, v240
    v_add_u32 v240, 128, v19
    v_mul_u32_u24 v241, 171, v240
    v_lshrrev_b32 v241, 11, v241
    v_mul_u32_u24 v242, 12, v241
    v_sub_u32 v240, v240, v242
    v_bfe_u32 v242, v241, 3, 1
    v_lshlrev_b32 v242, 1, v242
    v_xor_b32 v240, v240, v242
    v_lshl_add_u32 v240, v240, 4, v22
    v_mul_u32_u24 v241, 768, v241
    v_add_u32 v240, v240, v241
    v_subrev_u32 v9, 2048, v240
    s_lshr_b32 s39, s2, 3
    s_and_b32 s39, s39, 31
    s_lshl_b32 s39, s39, 2
    s_add_u32 s39, s39, s28
    s_mul_i32 s39, s39, 2304
    v_lshlrev_b32 v255, 7, v19
    v_add_u32 v255, s39, v255
    v_mov_b32 v254, 0x7ffffff0
    v_cmp_gt_u32 vcc, 18, v19
    s_nop 1
    v_cndmask_b32 v255, v254, v255, vcc
    s_waitcnt lgkmcnt(0)
    s_mov_b32 s12, s4
    s_and_b32 s13, s5, 0xffff
    s_mov_b32 s16, s6
    s_and_b32 s17, s7, 0xffff
    s_mov_b32 s24, s10
    s_and_b32 s25, s11, 0xffff
L_g0:
    buffer_load_dword v254, v255, s[16:19], 0 offen
    s_add_u32 m0, s42, s41
    s_add_u32 s42, s42, 12288
    buffer_load_dwordx4 v4, s[12:15], s30 offen offset:0 nt lds
    buffer_load_dwordx4 v5, s[12:15], s30 offen offset:1024 nt lds
    buffer_load_dwordx4 v6, s[12:15], s30 offen offset:2048 nt lds
    s_add_u32 s30, s30, 393216
    s_add_u32 m0, s42, s41
    s_add_u32 s42, s42, 12288
    buffer_load_dwordx4 v4, s[12:15], s30 offen offset:0 nt lds
    buffer_load_dwordx4 v5, s[12:15], s30 offen offset:1024 nt lds
    buffer_load_dwordx4 v6, s[12:15], s30 offen offset:2048 nt lds
    s_add_u32 s30, s30, 393216
    s_add_u32 m0, s32, 86016
    s_mov_b32 s35, 0
    buffer_load_dwordx4 v7, s[16:19], s35 offen offset:0 lds
    buffer_load_dwordx4 v8, s[16:19], s35 offen offset:1024 lds
    buffer_load_dwordx4 v9, s[16:19], s35 offen offset:2048 lds
    s_add_u32 m0, s32, 89088
    s_mov_b32 s35, 12288
    buffer_load_dwordx4 v7, s[16:19], s35 offen offset:0 lds
    buffer_load_dwordx4 v8, s[16:19], s35 offen offset:1024 lds
    buffer_load_dwordx4 v9, s[16:19], s35 offen offset:2048 lds
    v_mul_u32_u24 v22, 192, v18
    v_lshl_add_u32 v17, v21, 3, v22
    s_mov_b32 s20, s8
    s_and_b32 s21, s9, 0xffff
    s_mov_b32 s22, 768
    s_mov_b32 s23, 0x20000
    buffer_load_dwordx2 a[240:241], v17, s[20:23], 0 offen offset:0
    buffer_load_dwordx2 a[242:243], v17, s[20:23], 0 offen offset:32
    buffer_load_dwordx2 a[244:245], v17, s[20:23], 0 offen offset:64
    buffer_load_dwordx2 a[246:247], v17, s[20:23], 0 offen offset:96
    buffer_load_dwordx2 a[248:249], v17, s[20:23], 0 offen offset:128
    buffer_load_dwordx2 a[250:251], v17, s[20:23], 0 offen offset:160
    v_mul_u32_u24 v22, 768, v20
    v_add_u32 v23, 0, v21
    v_xor_b32 v23, v23, v20
    v_lshl_add_u32 v0, v23, 4, v22
    v_add_u32 v23, 4, v21
    v_xor_b32 v23, v23, v20
    v_lshl_add_u32 v1, v23, 4, v22
    v_add_u32 v23, 8, v21
    v_xor_b32 v23, v23, v20
    v_lshl_add_u32 v2, v23, 4, v22
    v_add_u32 v23, 12, v21
    v_xor_b32 v23, v23, v20
    v_lshl_add_u32 v3, v23, 4, v22
    v_lshrrev_b32 v22, 2, v20
    v_lshl_add_u32 v22, v21, 3, v22
    v_mul_u32_u24 v22, 192, v22
    v_and_b32 v23, 3, v20
    v_lshl_add_u32 v22, v23, 3, v22
    v_mul_u32_u24 v23, 6144, v18
    v_add_u32 v22, v22, v23
    v_add_u32 v22, 61440, v22
    v_and_b32 v23, 1, v21
    v_lshlrev_b32 v23, 5, v23
    v_add_u32 v10, v22, v23
    v_sub_u32 v11, v22, v23
    v_add_u32 v252, 49152, v10
    v_add_u32 v253, 49152, v11
    v_mul_u32_u24 v12, 784, v20
    v_add_u32 v12, v12, v17
    v_add_u32 v12, 86016, v12
    v_mul_u32_u24 v16, 3072, v18
    v_lshl_add_u32 v16, v19, 4, v16
    v_mul_u32_u24 v22, 3136, v18
    v_add_u32 v22, 86016, v22
    v_add_u32 v23, 16, v19
    v_lshrrev_b32 v23, 6, v23
    v_add_u32 v23, v23, v19
    v_lshl_add_u32 v23, v23, 4, v22
    v_add_u32 v13, 0, v23
    v_lshrrev_b32 v23, 5, v19
    v_add_u32 v23, 1, v23
    v_add_u32 v23, v23, v19
    v_lshl_add_u32 v23, v23, 4, v22
    v_add_u32 v14, 1024, v23
    v_add_u32 v23, 48, v19
    v_lshrrev_b32 v23, 6, v23
    v_add_u32 v23, 2, v23
    v_add_u32 v23, v23, v19
    v_lshl_add_u32 v23, v23, 4, v22
    v_add_u32 v15, 2048, v23
    s_mov_b32 s40, 113246208
    s_add_u32 m0, s32, 110592
    s_mov_b32 s35, 24576
    buffer_load_dwordx4 v7, s[16:19], s35 offen offset:0 lds
    buffer_load_dwordx4 v8, s[16:19], s35 offen offset:1024 lds
    buffer_load_dwordx4 v9, s[16:19], s35 offen offset:2048 lds
    s_add_u32 m0, s32, 113664
    s_mov_b32 s35, 36864
    buffer_load_dwordx4 v7, s[16:19], s35 offen offset:0 lds
    buffer_load_dwordx4 v8, s[16:19], s35 offen offset:1024 lds
    buffer_load_dwordx4 v9, s[16:19], s35 offen offset:2048 lds
    s_add_u32 m0, s32, 135168
    s_mov_b32 s35, 49152
    buffer_load_dwordx4 v7, s[16:19], s35 offen offset:0 lds
    buffer_load_dwordx4 v8, s[16:19], s35 offen offset:1024 lds
    buffer_load_dwordx4 v9, s[16:19], s35 offen offset:2048 lds
    s_add_u32 m0, s32, 138240
    s_mov_b32 s35, 61440
    buffer_load_dwordx4 v7, s[16:19], s35 offen offset:0 lds
    buffer_load_dwordx4 v8, s[16:19], s35 offen offset:1024 lds
    buffer_load_dwordx4 v9, s[16:19], s35 offen offset:2048 lds
    s_add_u32 m0, s32, 61440
    s_mov_b32 s35, 73728
    buffer_load_dwordx4 v7, s[16:19], s35 offen offset:0 lds
    buffer_load_dwordx4 v8, s[16:19], s35 offen offset:1024 lds
    buffer_load_dwordx4 v9, s[16:19], s35 offen offset:2048 lds
    s_add_u32 m0, s32, 64512
    s_mov_b32 s35, 86016
    buffer_load_dwordx4 v7, s[16:19], s35 offen offset:0 lds
    buffer_load_dwordx4 v8, s[16:19], s35 offen offset:1024 lds
    buffer_load_dwordx4 v9, s[16:19], s35 offen offset:2048 lds
    s_waitcnt vmcnt(30)
    s_barrier
    ds_read_b128 a[144:147], v0 offset:0
    ds_read_b128 a[192:195], v0 offset:12288
    s_waitcnt vmcnt(24)
    ds_read_b64_tr_b16 a[0:1], v10 offset:24576
    ds_read_b64_tr_b16 a[2:3], v10 offset:25344
    ds_read_b64_tr_b16 a[4:5], v11 offset:24608
    ds_read_b64_tr_b16 a[6:7], v11 offset:25376
    ds_read_b64_tr_b16 a[8:9], v10 offset:24640
    ds_read_b64_tr_b16 a[10:11], v10 offset:25408
    ds_read_b64_tr_b16 a[12:13], v11 offset:24672
    ds_read_b64_tr_b16 a[14:15], v11 offset:25440
    ds_read_b64_tr_b16 a[16:17], v10 offset:24704
    ds_read_b64_tr_b16 a[18:19], v10 offset:25472
    ds_read_b64_tr_b16 a[20:21], v11 offset:24736
    ds_read_b64_tr_b16 a[22:23], v11 offset:25504
    s_waitcnt vmcnt(18)
    v_accvgpr_read_b32 v240, a240
    v_accvgpr_read_b32 v241, a241
    v_accvgpr_read_b32 v242, a242
    v_accvgpr_read_b32 v243, a243
    v_accvgpr_read_b32 v244, a244
    v_accvgpr_read_b32 v245, a245
    v_accvgpr_read_b32 v246, a246
    v_accvgpr_read_b32 v247, a247
    v_accvgpr_read_b32 v248, a248
    v_accvgpr_read_b32 v249, a249
    v_accvgpr_read_b32 v250, a250
    v_accvgpr_read_b32 v251, a251
    v_lshlrev_b32 v24, 16, v240
    v_and_b32 v25, 0xffff0000, v240
    v_lshlrev_b32 v26, 16, v241
    v_and_b32 v27, 0xffff0000, v241
    v_lshlrev_b32 v28, 16, v242
    v_and_b32 v29, 0xffff0000, v242
    v_lshlrev_b32 v30, 16, v243
    v_and_b32 v31, 0xffff0000, v243
    v_lshlrev_b32 v32, 16, v244
    v_and_b32 v33, 0xffff0000, v244
    v_lshlrev_b32 v34, 16, v245
    v_and_b32 v35, 0xffff0000, v245
    v_lshlrev_b32 v36, 16, v246
    v_and_b32 v37, 0xffff0000, v246
    v_lshlrev_b32 v38, 16, v247
    v_and_b32 v39, 0xffff0000, v247
    v_lshlrev_b32 v40, 16, v248
    v_and_b32 v41, 0xffff0000, v248
    v_lshlrev_b32 v42, 16, v249
    v_and_b32 v43, 0xffff0000, v249
    v_lshlrev_b32 v44, 16, v250
    v_and_b32 v45, 0xffff0000, v250
    v_lshlrev_b32 v46, 16, v251
    v_and_b32 v47, 0xffff0000, v251
    s_waitcnt lgkmcnt(0)
    s_waitcnt vmcnt(12)
    v_mfma_f32_16x16x32_bf16 v[48:51], a[0:3], a[144:147], v[24:27]
    ds_read_b128 a[148:151], v1 offset:0
    ds_read_b128 a[196:199], v1 offset:12288
    s_add_u32 m0, s32, 86016
    s_mov_b32 s35, 98304
    buffer_load_dwordx4 v7, s[16:19], s35 offen offset:0 lds
    v_mfma_f32_16x16x32_bf16 v[52:55], a[4:7], a[144:147], v[28:31]
    ds_read_b64_tr_b16 a[24:25], v252 offset:0
    ds_read_b64_tr_b16 a[26:27], v252 offset:768
    v_mfma_f32_16x16x32_bf16 v[56:59], a[8:11], a[144:147], v[32:35]
    ds_read_b64_tr_b16 a[28:29], v253 offset:32
    ds_read_b64_tr_b16 a[30:31], v253 offset:800
    buffer_load_dwordx4 v8, s[16:19], s35 offen offset:1024 lds
    v_mfma_f32_16x16x32_bf16 v[60:63], a[12:15], a[144:147], v[36:39]
    ds_read_b64_tr_b16 a[32:33], v252 offset:64
    ds_read_b64_tr_b16 a[34:35], v252 offset:832
    v_mfma_f32_16x16x32_bf16 v[64:67], a[16:19], a[144:147], v[40:43]
    ds_read_b64_tr_b16 a[36:37], v253 offset:96
    ds_read_b64_tr_b16 a[38:39], v253 offset:864
    buffer_load_dwordx4 v9, s[16:19], s35 offen offset:2048 lds
    v_mfma_f32_16x16x32_bf16 v[68:71], a[20:23], a[144:147], v[44:47]
    ds_read_b64_tr_b16 a[40:41], v252 offset:128
    ds_read_b64_tr_b16 a[42:43], v252 offset:896
    v_mfma_f32_16x16x32_bf16 v[72:75], a[0:3], a[192:195], v[24:27]
    ds_read_b64_tr_b16 a[44:45], v253 offset:160
    ds_read_b64_tr_b16 a[46:47], v253 offset:928
    s_add_u32 m0, s32, 89088
    s_mov_b32 s35, 110592
    buffer_load_dwordx4 v7, s[16:19], s35 offen offset:0 lds
    v_mfma_f32_16x16x32_bf16 v[76:79], a[4:7], a[192:195], v[28:31]
    v_mfma_f32_16x16x32_bf16 v[80:83], a[8:11], a[192:195], v[32:35]
    buffer_load_dwordx4 v8, s[16:19], s35 offen offset:1024 lds
    v_mfma_f32_16x16x32_bf16 v[84:87], a[12:15], a[192:195], v[36:39]
    v_mfma_f32_16x16x32_bf16 v[88:91], a[16:19], a[192:195], v[40:43]
    buffer_load_dwordx4 v9, s[16:19], s35 offen offset:2048 lds
    v_mfma_f32_16x16x32_bf16 v[92:95], a[20:23], a[192:195], v[44:47]
    s_waitcnt lgkmcnt(0)
    s_waitcnt vmcnt(12)
    v_mfma_f32_16x16x32_bf16 v[48:51], a[24:27], a[148:151], v[48:51]
    ds_read_b128 a[152:155], v2 offset:0
    ds_read_b128 a[200:203], v2 offset:12288
    s_add_u32 m0, s32, 110592
    s_mov_b32 s35, 122880
    buffer_load_dwordx4 v7, s[16:19], s35 offen offset:0 lds
    v_mfma_f32_16x16x32_bf16 v[52:55], a[28:31], a[148:151], v[52:55]
    ds_read_b64_tr_b16 a[48:49], v252 offset:24576
    ds_read_b64_tr_b16 a[50:51], v252 offset:25344
    v_mfma_f32_16x16x32_bf16 v[56:59], a[32:35], a[148:151], v[56:59]
    ds_read_b64_tr_b16 a[52:53], v253 offset:24608
    ds_read_b64_tr_b16 a[54:55], v253 offset:25376
    buffer_load_dwordx4 v8, s[16:19], s35 offen offset:1024 lds
    v_mfma_f32_16x16x32_bf16 v[60:63], a[36:39], a[148:151], v[60:63]
    ds_read_b64_tr_b16 a[56:57], v252 offset:24640
    ds_read_b64_tr_b16 a[58:59], v252 offset:25408
    v_mfma_f32_16x16x32_bf16 v[64:67], a[40:43], a[148:151], v[64:67]
    ds_read_b64_tr_b16 a[60:61], v253 offset:24672
    ds_read_b64_tr_b16 a[62:63], v253 offset:25440
    buffer_load_dwordx4 v9, s[16:19], s35 offen offset:2048 lds
    v_mfma_f32_16x16x32_bf16 v[68:71], a[44:47], a[148:151], v[68:71]
    ds_read_b64_tr_b16 a[64:65], v252 offset:24704
    ds_read_b64_tr_b16 a[66:67], v252 offset:25472
    v_mfma_f32_16x16x32_bf16 v[72:75], a[24:27], a[196:199], v[72:75]
    ds_read_b64_tr_b16 a[68:69], v253 offset:24736
    ds_read_b64_tr_b16 a[70:71], v253 offset:25504
    s_add_u32 m0, s32, 113664
    s_mov_b32 s35, 135168
    buffer_load_dwordx4 v7, s[16:19], s35 offen offset:0 lds
    v_mfma_f32_16x16x32_bf16 v[76:79], a[28:31], a[196:199], v[76:79]
    v_mfma_f32_16x16x32_bf16 v[80:83], a[32:35], a[196:199], v[80:83]
    buffer_load_dwordx4 v8, s[16:19], s35 offen offset:1024 lds
    v_mfma_f32_16x16x32_bf16 v[84:87], a[36:39], a[196:199], v[84:87]
    v_mfma_f32_16x16x32_bf16 v[88:91], a[40:43], a[196:199], v[88:91]
    buffer_load_dwordx4 v9, s[16:19], s35 offen offset:2048 lds
    v_mfma_f32_16x16x32_bf16 v[92:95], a[44:47], a[196:199], v[92:95]
    s_waitcnt lgkmcnt(0)
    s_waitcnt vmcnt(12)
    v_mfma_f32_16x16x32_bf16 v[48:51], a[48:51], a[152:155], v[48:51]
    ds_read_b128 a[156:159], v3 offset:0
    ds_read_b128 a[204:207], v3 offset:12288
    s_add_u32 m0, s32, 135168
    s_mov_b32 s35, 147456
    buffer_load_dwordx4 v7, s[16:19], s35 offen offset:0 lds
    v_mfma_f32_16x16x32_bf16 v[52:55], a[52:55], a[152:155], v[52:55]
    ds_read_b64_tr_b16 a[72:73], v10 offset:0
    ds_read_b64_tr_b16 a[74:75], v10 offset:768
    v_mfma_f32_16x16x32_bf16 v[56:59], a[56:59], a[152:155], v[56:59]
    ds_read_b64_tr_b16 a[76:77], v11 offset:32
    ds_read_b64_tr_b16 a[78:79], v11 offset:800
    buffer_load_dwordx4 v8, s[16:19], s35 offen offset:1024 lds
    v_mfma_f32_16x16x32_bf16 v[60:63], a[60:63], a[152:155], v[60:63]
    ds_read_b64_tr_b16 a[80:81], v10 offset:64
    ds_read_b64_tr_b16 a[82:83], v10 offset:832
    v_mfma_f32_16x16x32_bf16 v[64:67], a[64:67], a[152:155], v[64:67]
    ds_read_b64_tr_b16 a[84:85], v11 offset:96
    ds_read_b64_tr_b16 a[86:87], v11 offset:864
    buffer_load_dwordx4 v9, s[16:19], s35 offen offset:2048 lds
    v_mfma_f32_16x16x32_bf16 v[68:71], a[68:71], a[152:155], v[68:71]
    ds_read_b64_tr_b16 a[88:89], v10 offset:128
    ds_read_b64_tr_b16 a[90:91], v10 offset:896
    v_mfma_f32_16x16x32_bf16 v[72:75], a[48:51], a[200:203], v[72:75]
    ds_read_b64_tr_b16 a[92:93], v11 offset:160
    ds_read_b64_tr_b16 a[94:95], v11 offset:928
    s_add_u32 m0, s32, 138240
    s_mov_b32 s35, 159744
    buffer_load_dwordx4 v7, s[16:19], s35 offen offset:0 lds
    v_mfma_f32_16x16x32_bf16 v[76:79], a[52:55], a[200:203], v[76:79]
    v_mfma_f32_16x16x32_bf16 v[80:83], a[56:59], a[200:203], v[80:83]
    buffer_load_dwordx4 v8, s[16:19], s35 offen offset:1024 lds
    v_mfma_f32_16x16x32_bf16 v[84:87], a[60:63], a[200:203], v[84:87]
    v_mfma_f32_16x16x32_bf16 v[88:91], a[64:67], a[200:203], v[88:91]
    buffer_load_dwordx4 v9, s[16:19], s35 offen offset:2048 lds
    v_mfma_f32_16x16x32_bf16 v[92:95], a[68:71], a[200:203], v[92:95]
    s_waitcnt lgkmcnt(0)
    s_waitcnt vmcnt(12)
    v_mfma_f32_16x16x32_bf16 v[48:51], a[72:75], a[156:159], v[48:51]
    ds_read_b128 a[160:163], v0 offset:256
    ds_read_b128 a[208:211], v0 offset:12544
    s_add_u32 m0, s32, 61440
    s_mov_b32 s35, 172032
    buffer_load_dwordx4 v7, s[16:19], s35 offen offset:0 lds
    v_mfma_f32_16x16x32_bf16 v[52:55], a[76:79], a[156:159], v[52:55]
    ds_read_b64_tr_b16 a[96:97], v10 offset:24576
    ds_read_b64_tr_b16 a[98:99], v10 offset:25344
    v_mfma_f32_16x16x32_bf16 v[56:59], a[80:83], a[156:159], v[56:59]
    ds_read_b64_tr_b16 a[100:101], v11 offset:24608
    ds_read_b64_tr_b16 a[102:103], v11 offset:25376
    buffer_load_dwordx4 v8, s[16:19], s35 offen offset:1024 lds
    v_mfma_f32_16x16x32_bf16 v[60:63], a[84:87], a[156:159], v[60:63]
    ds_read_b64_tr_b16 a[104:105], v10 offset:24640
    ds_read_b64_tr_b16 a[106:107], v10 offset:25408
    v_mfma_f32_16x16x32_bf16 v[64:67], a[88:91], a[156:159], v[64:67]
    ds_read_b64_tr_b16 a[108:109], v11 offset:24672
    ds_read_b64_tr_b16 a[110:111], v11 offset:25440
    buffer_load_dwordx4 v9, s[16:19], s35 offen offset:2048 lds
    v_mfma_f32_16x16x32_bf16 v[68:71], a[92:95], a[156:159], v[68:71]
    ds_read_b64_tr_b16 a[112:113], v10 offset:24704
    ds_read_b64_tr_b16 a[114:115], v10 offset:25472
    v_mfma_f32_16x16x32_bf16 v[72:75], a[72:75], a[204:207], v[72:75]
    ds_read_b64_tr_b16 a[116:117], v11 offset:24736
    ds_read_b64_tr_b16 a[118:119], v11 offset:25504
    s_add_u32 m0, s32, 64512
    s_mov_b32 s35, 184320
    buffer_load_dwordx4 v7, s[16:19], s35 offen offset:0 lds
    v_mfma_f32_16x16x32_bf16 v[76:79], a[76:79], a[204:207], v[76:79]
    v_mfma_f32_16x16x32_bf16 v[80:83], a[80:83], a[204:207], v[80:83]
    buffer_load_dwordx4 v8, s[16:19], s35 offen offset:1024 lds
    v_mfma_f32_16x16x32_bf16 v[84:87], a[84:87], a[204:207], v[84:87]
    v_mfma_f32_16x16x32_bf16 v[88:91], a[88:91], a[204:207], v[88:91]
    buffer_load_dwordx4 v9, s[16:19], s35 offen offset:2048 lds
    v_mfma_f32_16x16x32_bf16 v[92:95], a[92:95], a[204:207], v[92:95]
    s_add_u32 m0, s42, s41
    s_add_u32 s42, s42, 12288
    buffer_load_dwordx4 v4, s[12:15], s30 offen offset:0 nt lds
    buffer_load_dwordx4 v5, s[12:15], s30 offen offset:1024 nt lds
    buffer_load_dwordx4 v6, s[12:15], s30 offen offset:2048 nt lds
    s_add_u32 s30, s30, 393216
    s_waitcnt lgkmcnt(0)
    s_waitcnt vmcnt(15)
    v_mfma_f32_16x16x32_bf16 v[48:51], a[96:99], a[160:163], v[48:51]
    ds_read_b128 a[164:167], v1 offset:256
    ds_read_b128 a[212:215], v1 offset:12544
    s_add_u32 m0, s32, 86016
    s_mov_b32 s35, 196608
    buffer_load_dwordx4 v7, s[16:19], s35 offen offset:0 lds
    v_mfma_f32_16x16x32_bf16 v[52:55], a[100:103], a[160:163], v[52:55]
    ds_read_b64_tr_b16 a[120:121], v252 offset:0
    ds_read_b64_tr_b16 a[122:123], v252 offset:768
    v_mfma_f32_16x16x32_bf16 v[56:59], a[104:107], a[160:163], v[56:59]
    ds_read_b64_tr_b16 a[124:125], v253 offset:32
    ds_read_b64_tr_b16 a[126:127], v253 offset:800
    buffer_load_dwordx4 v8, s[16:19], s35 offen offset:1024 lds
    v_mfma_f32_16x16x32_bf16 v[60:63], a[108:111], a[160:163], v[60:63]
    ds_read_b64_tr_b16 a[128:129], v252 offset:64
    ds_read_b64_tr_b16 a[130:131], v252 offset:832
    v_mfma_f32_16x16x32_bf16 v[64:67], a[112:115], a[160:163], v[64:67]
    ds_read_b64_tr_b16 a[132:133], v253 offset:96
    ds_read_b64_tr_b16 a[134:135], v253 offset:864
    buffer_load_dwordx4 v9, s[16:19], s35 offen offset:2048 lds
    v_mfma_f32_16x16x32_bf16 v[68:71], a[116:119], a[160:163], v[68:71]
    ds_read_b64_tr_b16 a[136:137], v252 offset:128
    ds_read_b64_tr_b16 a[138:139], v252 offset:896
    v_mfma_f32_16x16x32_bf16 v[72:75], a[96:99], a[208:211], v[72:75]
    ds_read_b64_tr_b16 a[140:141], v253 offset:160
    ds_read_b64_tr_b16 a[142:143], v253 offset:928
    s_add_u32 m0, s32, 89088
    s_mov_b32 s35, 208896
    buffer_load_dwordx4 v7, s[16:19], s35 offen offset:0 lds
    v_mfma_f32_16x16x32_bf16 v[76:79], a[100:103], a[208:211], v[76:79]
    v_mfma_f32_16x16x32_bf16 v[80:83], a[104:107], a[208:211], v[80:83]
    buffer_load_dwordx4 v8, s[16:19], s35 offen offset:1024 lds
    v_mfma_f32_16x16x32_bf16 v[84:87], a[108:111], a[208:211], v[84:87]
    v_mfma_f32_16x16x32_bf16 v[88:91], a[112:115], a[208:211], v[88:91]
    buffer_load_dwordx4 v9, s[16:19], s35 offen offset:2048 lds
    v_mfma_f32_16x16x32_bf16 v[92:95], a[116:119], a[208:211], v[92:95]
    s_waitcnt lgkmcnt(0)
    s_waitcnt vmcnt(15)
    v_mfma_f32_16x16x32_bf16 v[48:51], a[120:123], a[164:167], v[48:51]
    ds_read_b128 a[168:171], v2 offset:256
    ds_read_b128 a[216:219], v2 offset:12544
    s_add_u32 m0, s32, 110592
    s_mov_b32 s35, 221184
    buffer_load_dwordx4 v7, s[16:19], s35 offen offset:0 lds
    v_mfma_f32_16x16x32_bf16 v[52:55], a[124:127], a[164:167], v[52:55]
    ds_read_b64_tr_b16 v[96:97], v252 offset:24576
    ds_read_b64_tr_b16 v[98:99], v252 offset:25344
    v_mfma_f32_16x16x32_bf16 v[56:59], a[128:131], a[164:167], v[56:59]
    ds_read_b64_tr_b16 v[100:101], v253 offset:24608
    ds_read_b64_tr_b16 v[102:103], v253 offset:25376
    buffer_load_dwordx4 v8, s[16:19], s35 offen offset:1024 lds
    v_mfma_f32_16x16x32_bf16 v[60:63], a[132:135], a[164:167], v[60:63]
    ds_read_b64_tr_b16 v[104:105], v252 offset:24640
    ds_read_b64_tr_b16 v[106:107], v252 offset:25408
    v_mfma_f32_16x16x32_bf16 v[64:67], a[136:139], a[164:167], v[64:67]
    ds_read_b64_tr_b16 v[108:109], v253 offset:24672
    ds_read_b64_tr_b16 v[110:111], v253 offset:25440
    buffer_load_dwordx4 v9, s[16:19], s35 offen offset:2048 lds
    v_mfma_f32_16x16x32_bf16 v[68:71], a[140:143], a[164:167], v[68:71]
    ds_read_b64_tr_b16 v[112:113], v252 offset:24704
    ds_read_b64_tr_b16 v[114:115], v252 offset:25472
    v_mfma_f32_16x16x32_bf16 v[72:75], a[120:123], a[212:215], v[72:75]
    ds_read_b64_tr_b16 v[116:117], v253 offset:24736
    ds_read_b64_tr_b16 v[118:119], v253 offset:25504
    s_add_u32 m0, s32, 113664
    s_mov_b32 s35, 233472
    buffer_load_dwordx4 v7, s[16:19], s35 offen offset:0 lds
    v_mfma_f32_16x16x32_bf16 v[76:79], a[124:127], a[212:215], v[76:79]
    v_mfma_f32_16x16x32_bf16 v[80:83], a[128:131], a[212:215], v[80:83]
    buffer_load_dwordx4 v8, s[16:19], s35 offen offset:1024 lds
    v_mfma_f32_16x16x32_bf16 v[84:87], a[132:135], a[212:215], v[84:87]
    v_mfma_f32_16x16x32_bf16 v[88:91], a[136:139], a[212:215], v[88:91]
    buffer_load_dwordx4 v9, s[16:19], s35 offen offset:2048 lds
    v_mfma_f32_16x16x32_bf16 v[92:95], a[140:143], a[212:215], v[92:95]
    s_waitcnt lgkmcnt(0)
    s_waitcnt vmcnt(15)
    v_mfma_f32_16x16x32_bf16 v[48:51], v[96:99], a[168:171], v[48:51]
    ds_read_b128 a[172:175], v3 offset:256
    ds_read_b128 a[220:223], v3 offset:12544
    s_add_u32 m0, s32, 135168
    s_mov_b32 s35, 245760
    buffer_load_dwordx4 v7, s[16:19], s35 offen offset:0 lds
    v_mfma_f32_16x16x32_bf16 v[52:55], v[100:103], a[168:171], v[52:55]
    ds_read_b64_tr_b16 v[120:121], v10 offset:0
    ds_read_b64_tr_b16 v[122:123], v10 offset:768
    v_mfma_f32_16x16x32_bf16 v[56:59], v[104:107], a[168:171], v[56:59]
    ds_read_b64_tr_b16 v[124:125], v11 offset:32
    ds_read_b64_tr_b16 v[126:127], v11 offset:800
    buffer_load_dwordx4 v8, s[16:19], s35 offen offset:1024 lds
    v_mfma_f32_16x16x32_bf16 v[60:63], v[108:111], a[168:171], v[60:63]
    ds_read_b64_tr_b16 v[128:129], v10 offset:64
    ds_read_b64_tr_b16 v[130:131], v10 offset:832
    v_mfma_f32_16x16x32_bf16 v[64:67], v[112:115], a[168:171], v[64:67]
    ds_read_b64_tr_b16 v[132:133], v11 offset:96
    ds_read_b64_tr_b16 v[134:135], v11 offset:864
    buffer_load_dwordx4 v9, s[16:19], s35 offen offset:2048 lds
    v_mfma_f32_16x16x32_bf16 v[68:71], v[116:119], a[168:171], v[68:71]
    ds_read_b64_tr_b16 v[136:137], v10 offset:128
    ds_read_b64_tr_b16 v[138:139], v10 offset:896
    v_mfma_f32_16x16x32_bf16 v[72:75], v[96:99], a[216:219], v[72:75]
    ds_read_b64_tr_b16 v[140:141], v11 offset:160
    ds_read_b64_tr_b16 v[142:143], v11 offset:928
    s_add_u32 m0, s32, 138240
    s_mov_b32 s35, 258048
    buffer_load_dwordx4 v7, s[16:19], s35 offen offset:0 lds
    v_mfma_f32_16x16x32_bf16 v[76:79], v[100:103], a[216:219], v[76:79]
    v_mfma_f32_16x16x32_bf16 v[80:83], v[104:107], a[216:219], v[80:83]
    buffer_load_dwordx4 v8, s[16:19], s35 offen offset:1024 lds
    v_mfma_f32_16x16x32_bf16 v[84:87], v[108:111], a[216:219], v[84:87]
    v_mfma_f32_16x16x32_bf16 v[88:91], v[112:115], a[216:219], v[88:91]
    buffer_load_dwordx4 v9, s[16:19], s35 offen offset:2048 lds
    v_mfma_f32_16x16x32_bf16 v[92:95], v[116:119], a[216:219], v[92:95]
    s_waitcnt lgkmcnt(0)
    s_waitcnt vmcnt(12)
    v_mfma_f32_16x16x32_bf16 v[48:51], v[120:123], a[172:175], v[48:51]
    ds_read_b128 a[176:179], v0 offset:512
    ds_read_b128 a[224:227], v0 offset:12800
    s_add_u32 m0, s32, 61440
    s_mov_b32 s35, 270336
    buffer_load_dwordx4 v7, s[16:19], s35 offen offset:0 lds
    v_mfma_f32_16x16x32_bf16 v[52:55], v[124:127], a[172:175], v[52:55]
    ds_read_b64_tr_b16 v[144:145], v10 offset:24576
    ds_read_b64_tr_b16 v[146:147], v10 offset:25344
    v_mfma_f32_16x16x32_bf16 v[56:59], v[128:131], a[172:175], v[56:59]
    ds_read_b64_tr_b16 v[148:149], v11 offset:24608
    ds_read_b64_tr_b16 v[150:151], v11 offset:25376
    buffer_load_dwordx4 v8, s[16:19], s35 offen offset:1024 lds
    v_mfma_f32_16x16x32_bf16 v[60:63], v[132:135], a[172:175], v[60:63]
    ds_read_b64_tr_b16 v[152:153], v10 offset:24640
    ds_read_b64_tr_b16 v[154:155], v10 offset:25408
    v_mfma_f32_16x16x32_bf16 v[64:67], v[136:139], a[172:175], v[64:67]
    ds_read_b64_tr_b16 v[156:157], v11 offset:24672
    ds_read_b64_tr_b16 v[158:159], v11 offset:25440
    buffer_load_dwordx4 v9, s[16:19], s35 offen offset:2048 lds
    v_mfma_f32_16x16x32_bf16 v[68:71], v[140:143], a[172:175], v[68:71]
    ds_read_b64_tr_b16 v[160:161], v10 offset:24704
    ds_read_b64_tr_b16 v[162:163], v10 offset:25472
    v_mfma_f32_16x16x32_bf16 v[72:75], v[120:123], a[220:223], v[72:75]
    ds_read_b64_tr_b16 v[164:165], v11 offset:24736
    ds_read_b64_tr_b16 v[166:167], v11 offset:25504
    s_add_u32 m0, s32, 64512
    s_mov_b32 s35, 282624
    buffer_load_dwordx4 v7, s[16:19], s35 offen offset:0 lds
    v_mfma_f32_16x16x32_bf16 v[76:79], v[124:127], a[220:223], v[76:79]
    v_mfma_f32_16x16x32_bf16 v[80:83], v[128:131], a[220:223], v[80:83]
    buffer_load_dwordx4 v8, s[16:19], s35 offen offset:1024 lds
    v_mfma_f32_16x16x32_bf16 v[84:87], v[132:135], a[220:223], v[84:87]
    v_mfma_f32_16x16x32_bf16 v[88:91], v[136:139], a[220:223], v[88:91]
    buffer_load_dwordx4 v9, s[16:19], s35 offen offset:2048 lds
    v_mfma_f32_16x16x32_bf16 v[92:95], v[140:143], a[220:223], v[92:95]
    s_waitcnt lgkmcnt(0)
    s_waitcnt vmcnt(12)
    v_mfma_f32_16x16x32_bf16 v[48:51], v[144:147], a[176:179], v[48:51]
    ds_read_b128 a[180:183], v1 offset:512
    ds_read_b128 a[228:231], v1 offset:12800
    s_add_u32 m0, s42, s41
    s_add_u32 s42, s42, 12288
    buffer_load_dwordx4 v4, s[12:15], s30 offen offset:0 nt lds
    buffer_load_dwordx4 v5, s[12:15], s30 offen offset:1024 nt lds
    buffer_load_dwordx4 v6, s[12:15], s30 offen offset:2048 nt lds
    buffer_store_dwordx4 a[240:243], v16, s[24:27], 0 offen offset:0 sc0 sc1
    buffer_store_dwordx4 a[244:247], v16, s[24:27], 0 offen offset:1024 sc0 sc1
    buffer_store_dwordx4 a[248:251], v16, s[24:27], 0 offen offset:2048 sc0 sc1
    s_add_u32 s30, s30, 393216
    v_mfma_f32_16x16x32_bf16 v[52:55], v[148:151], a[176:179], v[52:55]
    ds_read_b64_tr_b16 v[168:169], v252 offset:0
    ds_read_b64_tr_b16 v[170:171], v252 offset:768
    v_mfma_f32_16x16x32_bf16 v[56:59], v[152:155], a[176:179], v[56:59]
    ds_read_b64_tr_b16 v[172:173], v253 offset:32
    ds_read_b64_tr_b16 v[174:175], v253 offset:800
    v_mfma_f32_16x16x32_bf16 v[60:63], v[156:159], a[176:179], v[60:63]
    ds_read_b64_tr_b16 v[176:177], v252 offset:64
    ds_read_b64_tr_b16 v[178:179], v252 offset:832
    v_mfma_f32_16x16x32_bf16 v[64:67], v[160:163], a[176:179], v[64:67]
    ds_read_b64_tr_b16 v[180:181], v253 offset:96
    ds_read_b64_tr_b16 v[182:183], v253 offset:864
    v_mfma_f32_16x16x32_bf16 v[68:71], v[164:167], a[176:179], v[68:71]
    ds_read_b64_tr_b16 v[184:185], v252 offset:128
    ds_read_b64_tr_b16 v[186:187], v252 offset:896
    v_mfma_f32_16x16x32_bf16 v[72:75], v[144:147], a[224:227], v[72:75]
    ds_read_b64_tr_b16 v[188:189], v253 offset:160
    ds_read_b64_tr_b16 v[190:191], v253 offset:928
    v_mfma_f32_16x16x32_bf16 v[76:79], v[148:151], a[224:227], v[76:79]
    v_mfma_f32_16x16x32_bf16 v[80:83], v[152:155], a[224:227], v[80:83]
    v_mfma_f32_16x16x32_bf16 v[84:87], v[156:159], a[224:227], v[84:87]
    v_mfma_f32_16x16x32_bf16 v[88:91], v[160:163], a[224:227], v[88:91]
    v_mfma_f32_16x16x32_bf16 v[92:95], v[164:167], a[224:227], v[92:95]
    s_waitcnt lgkmcnt(0)
    s_waitcnt vmcnt(12)
    v_mfma_f32_16x16x32_bf16 v[48:51], v[168:171], a[180:183], v[48:51]
    ds_read_b128 a[184:187], v2 offset:512
    ds_read_b128 a[232:235], v2 offset:12800
    s_add_u32 m0, s42, s41
    s_add_u32 s42, s42, 12288
    buffer_load_dwordx4 v4, s[12:15], s30 offen offset:0 nt lds
    buffer_load_dwordx4 v5, s[12:15], s30 offen offset:1024 nt lds
    buffer_load_dwordx4 v6, s[12:15], s30 offen offset:2048 nt lds
    buffer_store_dwordx4 a[240:243], v16, s[24:27], 0 offen offset:0 sc0 sc1
    buffer_store_dwordx4 a[244:247], v16, s[24:27], 0 offen offset:1024 sc0 sc1
    buffer_store_dwordx4 a[248:251], v16, s[24:27], 0 offen offset:2048 sc0 sc1
    s_add_u32 s30, s30, 393216
    v_mfma_f32_16x16x32_bf16 v[52:55], v[172:175], a[180:183], v[52:55]
    ds_read_b64_tr_b16 v[192:193], v252 offset:24576
    ds_read_b64_tr_b16 v[194:195], v252 offset:25344
    v_mfma_f32_16x16x32_bf16 v[56:59], v[176:179], a[180:183], v[56:59]
    ds_read_b64_tr_b16 v[196:197], v253 offset:24608
    ds_read_b64_tr_b16 v[198:199], v253 offset:25376
    v_mfma_f32_16x16x32_bf16 v[60:63], v[180:183], a[180:183], v[60:63]
    ds_read_b64_tr_b16 v[200:201], v252 offset:24640
    ds_read_b64_tr_b16 v[202:203], v252 offset:25408
    v_mfma_f32_16x16x32_bf16 v[64:67], v[184:187], a[180:183], v[64:67]
    ds_read_b64_tr_b16 v[204:205], v253 offset:24672
    ds_read_b64_tr_b16 v[206:207], v253 offset:25440
    v_mfma_f32_16x16x32_bf16 v[68:71], v[188:191], a[180:183], v[68:71]
    ds_read_b64_tr_b16 v[208:209], v252 offset:24704
    ds_read_b64_tr_b16 v[210:211], v252 offset:25472
    v_mfma_f32_16x16x32_bf16 v[72:75], v[168:171], a[228:231], v[72:75]
    ds_read_b64_tr_b16 v[212:213], v253 offset:24736
    ds_read_b64_tr_b16 v[214:215], v253 offset:25504
    v_mfma_f32_16x16x32_bf16 v[76:79], v[172:175], a[228:231], v[76:79]
    v_mfma_f32_16x16x32_bf16 v[80:83], v[176:179], a[228:231], v[80:83]
    v_mfma_f32_16x16x32_bf16 v[84:87], v[180:183], a[228:231], v[84:87]
    v_mfma_f32_16x16x32_bf16 v[88:91], v[184:187], a[228:231], v[88:91]
    v_mfma_f32_16x16x32_bf16 v[92:95], v[188:191], a[228:231], v[92:95]
    s_waitcnt lgkmcnt(0)
    s_waitcnt vmcnt(12)
    v_mfma_f32_16x16x32_bf16 v[48:51], v[192:195], a[184:187], v[48:51]
    ds_read_b128 a[188:191], v3 offset:512
    ds_read_b128 a[236:239], v3 offset:12800
    v_mfma_f32_16x16x32_bf16 v[52:55], v[196:199], a[184:187], v[52:55]
    ds_read_b64_tr_b16 v[216:217], v10 offset:0
    ds_read_b64_tr_b16 v[218:219], v10 offset:768
    v_mfma_f32_16x16x32_bf16 v[56:59], v[200:203], a[184:187], v[56:59]
    ds_read_b64_tr_b16 v[220:221], v11 offset:32
    ds_read_b64_tr_b16 v[222:223], v11 offset:800
    v_mfma_f32_16x16x32_bf16 v[60:63], v[204:207], a[184:187], v[60:63]
    ds_read_b64_tr_b16 v[224:225], v10 offset:64
    ds_read_b64_tr_b16 v[226:227], v10 offset:832
    v_mfma_f32_16x16x32_bf16 v[64:67], v[208:211], a[184:187], v[64:67]
    ds_read_b64_tr_b16 v[228:229], v11 offset:96
    ds_read_b64_tr_b16 v[230:231], v11 offset:864
    v_mfma_f32_16x16x32_bf16 v[68:71], v[212:215], a[184:187], v[68:71]
    ds_read_b64_tr_b16 v[232:233], v10 offset:128
    ds_read_b64_tr_b16 v[234:235], v10 offset:896
    v_mfma_f32_16x16x32_bf16 v[72:75], v[192:195], a[232:235], v[72:75]
    ds_read_b64_tr_b16 v[236:237], v11 offset:160
    ds_read_b64_tr_b16 v[238:239], v11 offset:928
    v_mfma_f32_16x16x32_bf16 v[76:79], v[196:199], a[232:235], v[76:79]
    v_mfma_f32_16x16x32_bf16 v[80:83], v[200:203], a[232:235], v[80:83]
    v_mfma_f32_16x16x32_bf16 v[84:87], v[204:207], a[232:235], v[84:87]
    v_mfma_f32_16x16x32_bf16 v[88:91], v[208:211], a[232:235], v[88:91]
    v_mfma_f32_16x16x32_bf16 v[92:95], v[212:215], a[232:235], v[92:95]
    s_waitcnt lgkmcnt(0)
    s_barrier
    v_mfma_f32_16x16x32_bf16 v[48:51], v[216:219], a[188:191], v[48:51]
    ds_read_b128 a[144:147], v0 offset:24576
    v_mfma_f32_16x16x32_bf16 v[52:55], v[220:223], a[188:191], v[52:55]
    ds_read_b128 a[148:151], v1 offset:24576
    v_mfma_f32_16x16x32_bf16 v[56:59], v[224:227], a[188:191], v[56:59]
    ds_read_b128 a[152:155], v2 offset:24576
    v_mfma_f32_16x16x32_bf16 v[60:63], v[228:231], a[188:191], v[60:63]
    ds_read_b128 a[156:159], v3 offset:24576
    v_mfma_f32_16x16x32_bf16 v[64:67], v[232:235], a[188:191], v[64:67]
    ds_read_b128 a[160:163], v0 offset:24832
    v_mfma_f32_16x16x32_bf16 v[68:71], v[236:239], a[188:191], v[68:71]
    ds_read_b128 a[164:167], v1 offset:24832
    v_mfma_f32_16x16x32_bf16 v[72:75], v[216:219], a[236:239], v[72:75]
    ds_read_b128 a[168:171], v2 offset:24832
    v_mfma_f32_16x16x32_bf16 v[76:79], v[220:223], a[236:239], v[76:79]
    ds_read_b128 a[172:175], v3 offset:24832
    v_mfma_f32_16x16x32_bf16 v[80:83], v[224:227], a[236:239], v[80:83]
    ds_read_b128 a[176:179], v0 offset:25088
    v_mfma_f32_16x16x32_bf16 v[84:87], v[228:231], a[236:239], v[84:87]
    ds_read_b128 a[180:183], v1 offset:25088
    v_mfma_f32_16x16x32_bf16 v[88:91], v[232:235], a[236:239], v[88:91]
    ds_read_b128 a[184:187], v2 offset:25088
    v_mfma_f32_16x16x32_bf16 v[92:95], v[236:239], a[236:239], v[92:95]
    ds_read_b128 a[188:191], v3 offset:25088
    s_add_u32 m0, s42, s41
    s_add_u32 s42, s42, 12288
    buffer_load_dwordx4 v4, s[12:15], s30 offen offset:0 nt lds
    buffer_load_dwordx4 v5, s[12:15], s30 offen offset:1024 nt lds
    buffer_load_dwordx4 v6, s[12:15], s30 offen offset:2048 nt lds
    buffer_store_dwordx4 a[240:243], v16, s[24:27], 0 offen offset:0 sc0 sc1
    buffer_store_dwordx4 a[244:247], v16, s[24:27], 0 offen offset:1024 sc0 sc1
    buffer_store_dwordx4 a[248:251], v16, s[24:27], 0 offen offset:2048 sc0 sc1
    s_add_u32 s30, s30, 393216
    s_waitcnt lgkmcnt(0)
    s_nop 1
    v_cvt_pk_bf16_f32 v48, v48, v49
    v_cvt_pk_bf16_f32 v49, v50, v51
    ds_write_b64 v12, v[48:49] offset:0
    v_cvt_pk_bf16_f32 v52, v52, v53
    v_cvt_pk_bf16_f32 v53, v54, v55
    ds_write_b64 v12, v[52:53] offset:32
    v_cvt_pk_bf16_f32 v56, v56, v57
    v_cvt_pk_bf16_f32 v57, v58, v59
    ds_write_b64 v12, v[56:57] offset:64
    v_cvt_pk_bf16_f32 v60, v60, v61
    v_cvt_pk_bf16_f32 v61, v62, v63
    ds_write_b64 v12, v[60:61] offset:96
    v_cvt_pk_bf16_f32 v64, v64, v65
    v_cvt_pk_bf16_f32 v65, v66, v67
    ds_write_b64 v12, v[64:65] offset:128
    v_cvt_pk_bf16_f32 v68, v68, v69
    v_cvt_pk_bf16_f32 v69, v70, v71
    ds_write_b64 v12, v[68:69] offset:160
    v_add_u32 v0, 36864, v0
    v_add_u32 v1, 36864, v1
    v_add_u32 v2, 36864, v2
    v_add_u32 v3, 36864, v3
    s_mov_b32 s34, 36864
    s_mov_b32 s29, 2
    s_add_u32 m0, s42, s41
    s_mov_b32 s26, 113246208
L_enter:
.p2align 6
L_loop0:
    s_waitcnt vmcnt(15) lgkmcnt(0)
    s_barrier
    v_mfma_f32_16x16x32_bf16 v[48:51], a[0:3], a[144:147], v[24:27]
    ds_read_b128 a[192:195], v0 offset:0
    v_mfma_f32_16x16x32_bf16 v[48:51], a[24:27], a[148:151], v[48:51]
    buffer_load_dwordx4 v4, s[12:15], s30 offen offset:0 nt lds
    v_mfma_f32_16x16x32_bf16 v[48:51], a[48:51], a[152:155], v[48:51]
    s_add_u32 s31, s31, 393216
    v_mfma_f32_16x16x32_bf16 v[48:51], a[72:75], a[156:159], v[48:51]
    v_mfma_f32_16x16x32_bf16 v[48:51], a[96:99], a[160:163], v[48:51]
    v_mfma_f32_16x16x32_bf16 v[48:51], a[120:123], a[164:167], v[48:51]
    ds_read_b128 a[196:199], v1 offset:0
    v_mfma_f32_16x16x32_bf16 v[48:51], v[96:99], a[168:171], v[48:51]
    v_mfma_f32_16x16x32_bf16 v[48:51], v[120:123], a[172:175], v[48:51]
    v_mfma_f32_16x16x32_bf16 v[48:51], v[144:147], a[176:179], v[48:51]
    v_cvt_pk_bf16_f32 v72, v72, v73
    v_mfma_f32_16x16x32_bf16 v[48:51], v[168:171], a[180:183], v[48:51]
    v_cvt_pk_bf16_f32 v73, v74, v75
    v_mfma_f32_16x16x32_bf16 v[48:51], v[192:195], a[184:187], v[48:51]
    ds_read_b128 a[200:203], v2 offset:0
    v_mfma_f32_16x16x32_bf16 v[48:51], v[216:219], a[188:191], v[48:51]
    ds_write_b64 v12, v[72:73] offset:12544
    v_mfma_f32_16x16x32_bf16 v[52:55], a[4:7], a[144:147], v[28:31]
    s_add_u32 s38, s34, 12288
    v_mfma_f32_16x16x32_bf16 v[52:55], a[28:31], a[148:151], v[52:55]
    buffer_load_dwordx4 v5, s[12:15], s30 offen offset:1024 nt lds
    v_mfma_f32_16x16x32_bf16 v[52:55], a[52:55], a[152:155], v[52:55]
    s_cmp_eq_u32 s38, 86016
    s_cselect_b32 s38, 0, s38
    v_mfma_f32_16x16x32_bf16 v[52:55], a[76:79], a[156:159], v[52:55]
    ds_read_b128 a[204:207], v3 offset:0
    v_mfma_f32_16x16x32_bf16 v[52:55], a[100:103], a[160:163], v[52:55]
    v_cvt_pk_bf16_f32 v76, v76, v77
    v_mfma_f32_16x16x32_bf16 v[52:55], a[124:127], a[164:167], v[52:55]
    v_cvt_pk_bf16_f32 v77, v78, v79
    v_mfma_f32_16x16x32_bf16 v[52:55], v[100:103], a[168:171], v[52:55]
    ds_write_b64 v12, v[76:77] offset:12576
    v_mfma_f32_16x16x32_bf16 v[52:55], v[124:127], a[172:175], v[52:55]
    ds_read_b128 a[240:243], v13 offset:0
    v_mfma_f32_16x16x32_bf16 v[52:55], v[148:151], a[176:179], v[52:55]
    ds_read_b128 a[208:211], v0 offset:256
    v_mfma_f32_16x16x32_bf16 v[52:55], v[172:175], a[180:183], v[52:55]
    s_sub_u32 s33, s38, s34
    v_mfma_f32_16x16x32_bf16 v[52:55], v[196:199], a[184:187], v[52:55]
    s_mov_b32 s34, s38
    v_mfma_f32_16x16x32_bf16 v[52:55], v[220:223], a[188:191], v[52:55]
    v_mfma_f32_16x16x32_bf16 v[56:59], a[8:11], a[144:147], v[32:35]
    v_cvt_pk_bf16_f32 v80, v80, v81
    v_mfma_f32_16x16x32_bf16 v[56:59], a[32:35], a[148:151], v[56:59]
    buffer_load_dwordx4 v6, s[12:15], s30 offen offset:2048 nt lds
    v_mfma_f32_16x16x32_bf16 v[56:59], a[56:59], a[152:155], v[56:59]
    ds_read_b128 a[212:215], v1 offset:256
    v_mfma_f32_16x16x32_bf16 v[56:59], a[80:83], a[156:159], v[56:59]
    s_add_u32 s30, s30, 393216
    v_mfma_f32_16x16x32_bf16 v[56:59], a[104:107], a[160:163], v[56:59]
    s_add_u32 s42, s42, 12288
    v_mfma_f32_16x16x32_bf16 v[56:59], a[128:131], a[164:167], v[56:59]
    s_cmp_eq_u32 s42, 86016
    s_cselect_b32 s42, 0, s42
    v_mfma_f32_16x16x32_bf16 v[56:59], v[104:107], a[168:171], v[56:59]
    ds_read_b128 a[216:219], v2 offset:256
    v_mfma_f32_16x16x32_bf16 v[56:59], v[128:131], a[172:175], v[56:59]
    s_add_u32 m0, s42, s41
    v_mfma_f32_16x16x32_bf16 v[56:59], v[152:155], a[176:179], v[56:59]
    ds_read_b128 a[244:247], v14 offset:0
    v_mfma_f32_16x16x32_bf16 v[56:59], v[176:179], a[180:183], v[56:59]
    v_cvt_pk_bf16_f32 v81, v82, v83
    v_mfma_f32_16x16x32_bf16 v[56:59], v[200:203], a[184:187], v[56:59]
    ds_write_b64 v12, v[80:81] offset:12608
    v_mfma_f32_16x16x32_bf16 v[56:59], v[224:227], a[188:191], v[56:59]
    ds_read_b128 a[220:223], v3 offset:256
    v_mfma_f32_16x16x32_bf16 v[60:63], a[12:15], a[144:147], v[36:39]
    v_cvt_pk_bf16_f32 v84, v84, v85
    v_mfma_f32_16x16x32_bf16 v[60:63], a[36:39], a[148:151], v[60:63]
    s_waitcnt lgkmcnt(6)
    buffer_store_dwordx4 a[240:243], v16, s[24:27], s31 offen offset:0 sc0 sc1
    v_mfma_f32_16x16x32_bf16 v[60:63], a[60:63], a[152:155], v[60:63]
    v_cvt_pk_bf16_f32 v85, v86, v87
    v_mfma_f32_16x16x32_bf16 v[60:63], a[84:87], a[156:159], v[60:63]
    ds_write_b64 v12, v[84:85] offset:12640
    v_mfma_f32_16x16x32_bf16 v[60:63], a[108:111], a[160:163], v[60:63]
    ds_read_b128 a[224:227], v0 offset:512
    v_mfma_f32_16x16x32_bf16 v[60:63], a[132:135], a[164:167], v[60:63]
    s_add_u32 s29, s29, 1
    v_mfma_f32_16x16x32_bf16 v[60:63], v[108:111], a[168:171], v[60:63]
    s_cmp_lt_u32 s29, s43
    s_cselect_b32 s14, s40, 0
    v_mfma_f32_16x16x32_bf16 v[60:63], v[132:135], a[172:175], v[60:63]
    ds_read_b128 a[248:251], v15 offset:0
    v_mfma_f32_16x16x32_bf16 v[60:63], v[156:159], a[176:179], v[60:63]
    v_cvt_pk_bf16_f32 v88, v88, v89
    v_mfma_f32_16x16x32_bf16 v[60:63], v[180:183], a[180:183], v[60:63]
    ds_read_b128 a[228:231], v1 offset:512
    v_mfma_f32_16x16x32_bf16 v[60:63], v[204:207], a[184:187], v[60:63]
    v_cvt_pk_bf16_f32 v89, v90, v91
    v_mfma_f32_16x16x32_bf16 v[60:63], v[228:231], a[188:191], v[60:63]
    ds_write_b64 v12, v[88:89] offset:12672
    v_mfma_f32_16x16x32_bf16 v[64:67], a[16:19], a[144:147], v[40:43]
    v_cvt_pk_bf16_f32 v92, v92, v93
    v_mfma_f32_16x16x32_bf16 v[64:67], a[40:43], a[148:151], v[64:67]
    s_waitcnt lgkmcnt(7)
    buffer_store_dwordx4 a[244:247], v16, s[24:27], s31 offen offset:1024 sc0 sc1
    v_mfma_f32_16x16x32_bf16 v[64:67], a[64:67], a[152:155], v[64:67]
    ds_read_b128 a[232:235], v2 offset:512
    v_mfma_f32_16x16x32_bf16 v[64:67], a[88:91], a[156:159], v[64:67]
    v_cvt_pk_bf16_f32 v93, v94, v95
    v_mfma_f32_16x16x32_bf16 v[64:67], a[112:115], a[160:163], v[64:67]
    ds_write_b64 v12, v[92:93] offset:12704
    v_mfma_f32_16x16x32_bf16 v[64:67], a[136:139], a[164:167], v[64:67]
    v_add_u32 v0, s33, v0
    v_mfma_f32_16x16x32_bf16 v[64:67], v[112:115], a[168:171], v[64:67]
    v_add_u32 v1, s33, v1
    v_mfma_f32_16x16x32_bf16 v[64:67], v[136:139], a[172:175], v[64:67]
    ds_read_b128 a[236:239], v3 offset:512
    v_mfma_f32_16x16x32_bf16 v[64:67], v[160:163], a[176:179], v[64:67]
    v_add_u32 v2, s33, v2
    v_mfma_f32_16x16x32_bf16 v[64:67], v[184:187], a[180:183], v[64:67]
    v_add_u32 v3, s33, v3
    v_mfma_f32_16x16x32_bf16 v[64:67], v[208:211], a[184:187], v[64:67]
    v_mfma_f32_16x16x32_bf16 v[64:67], v[232:235], a[188:191], v[64:67]
    v_mfma_f32_16x16x32_bf16 v[68:71], a[20:23], a[144:147], v[44:47]
    v_mfma_f32_16x16x32_bf16 v[68:71], a[44:47], a[148:151], v[68:71]
    s_waitcnt lgkmcnt(5)
    buffer_store_dwordx4 a[248:251], v16, s[24:27], s31 offen offset:2048 sc0 sc1
    v_mfma_f32_16x16x32_bf16 v[68:71], a[68:71], a[152:155], v[68:71]
    v_mfma_f32_16x16x32_bf16 v[68:71], a[92:95], a[156:159], v[68:71]
    v_mfma_f32_16x16x32_bf16 v[68:71], a[116:119], a[160:163], v[68:71]
    v_mfma_f32_16x16x32_bf16 v[68:71], a[140:143], a[164:167], v[68:71]
    v_mfma_f32_16x16x32_bf16 v[68:71], v[116:119], a[168:171], v[68:71]
    v_mfma_f32_16x16x32_bf16 v[68:71], v[140:143], a[172:175], v[68:71]
    v_mfma_f32_16x16x32_bf16 v[68:71], v[164:167], a[176:179], v[68:71]
    v_mfma_f32_16x16x32_bf16 v[68:71], v[188:191], a[180:183], v[68:71]
    v_mfma_f32_16x16x32_bf16 v[68:71], v[212:215], a[184:187], v[68:71]
    v_mfma_f32_16x16x32_bf16 v[68:71], v[236:239], a[188:191], v[68:71]
    s_cmp_ge_u32 s29, s37
    s_cbranch_scc1 L_drain0
    s_waitcnt vmcnt(15) lgkmcnt(0)
    s_barrier
    v_mfma_f32_16x16x32_bf16 v[72:75], a[0:3], a[192:195], v[24:27]
    ds_read_b128 a[144:147], v0 offset:0
    v_mfma_f32_16x16x32_bf16 v[72:75], a[24:27], a[196:199], v[72:75]
    buffer_load_dwordx4 v4, s[12:15], s30 offen offset:0 nt lds
    v_mfma_f32_16x16x32_bf16 v[72:75], a[48:51], a[200:203], v[72:75]
    s_add_u32 s31, s31, 393216
    v_mfma_f32_16x16x32_bf16 v[72:75], a[72:75], a[204:207], v[72:75]
    v_mfma_f32_16x16x32_bf16 v[72:75], a[96:99], a[208:211], v[72:75]
    v_mfma_f32_16x16x32_bf16 v[72:75], a[120:123], a[212:215], v[72:75]
    ds_read_b128 a[148:151], v1 offset:0
    v_mfma_f32_16x16x32_bf16 v[72:75], v[96:99], a[216:219], v[72:75]
    v_mfma_f32_16x16x32_bf16 v[72:75], v[120:123], a[220:223], v[72:75]
    v_mfma_f32_16x16x32_bf16 v[72:75], v[144:147], a[224:227], v[72:75]
    v_cvt_pk_bf16_f32 v48, v48, v49
    v_mfma_f32_16x16x32_bf16 v[72:75], v[168:171], a[228:231], v[72:75]
    v_cvt_pk_bf16_f32 v49, v50, v51
    v_mfma_f32_16x16x32_bf16 v[72:75], v[192:195], a[232:235], v[72:75]
    ds_read_b128 a[152:155], v2 offset:0
    v_mfma_f32_16x16x32_bf16 v[72:75], v[216:219], a[236:239], v[72:75]
    ds_write_b64 v12, v[48:49] offset:0
    v_mfma_f32_16x16x32_bf16 v[76:79], a[4:7], a[192:195], v[28:31]
    s_add_u32 s38, s34, 12288
    v_mfma_f32_16x16x32_bf16 v[76:79], a[28:31], a[196:199], v[76:79]
    buffer_load_dwordx4 v5, s[12:15], s30 offen offset:1024 nt lds
    v_mfma_f32_16x16x32_bf16 v[76:79], a[52:55], a[200:203], v[76:79]
    s_cmp_eq_u32 s38, 86016
    s_cselect_b32 s38, 0, s38
    v_mfma_f32_16x16x32_bf16 v[76:79], a[76:79], a[204:207], v[76:79]
    ds_read_b128 a[156:159], v3 offset:0
    v_mfma_f32_16x16x32_bf16 v[76:79], a[100:103], a[208:211], v[76:79]
    v_cvt_pk_bf16_f32 v52, v52, v53
    v_mfma_f32_16x16x32_bf16 v[76:79], a[124:127], a[212:215], v[76:79]
    v_cvt_pk_bf16_f32 v53, v54, v55
    v_mfma_f32_16x16x32_bf16 v[76:79], v[100:103], a[216:219], v[76:79]
    ds_write_b64 v12, v[52:53] offset:32
    v_mfma_f32_16x16x32_bf16 v[76:79], v[124:127], a[220:223], v[76:79]
    ds_read_b128 a[240:243], v13 offset:12544
    v_mfma_f32_16x16x32_bf16 v[76:79], v[148:151], a[224:227], v[76:79]
    ds_read_b128 a[160:163], v0 offset:256
    v_mfma_f32_16x16x32_bf16 v[76:79], v[172:175], a[228:231], v[76:79]
    s_sub_u32 s33, s38, s34
    v_mfma_f32_16x16x32_bf16 v[76:79], v[196:199], a[232:235], v[76:79]
    s_mov_b32 s34, s38
    v_mfma_f32_16x16x32_bf16 v[76:79], v[220:223], a[236:239], v[76:79]
    v_mfma_f32_16x16x32_bf16 v[80:83], a[8:11], a[192:195], v[32:35]
    v_cvt_pk_bf16_f32 v56, v56, v57
    v_mfma_f32_16x16x32_bf16 v[80:83], a[32:35], a[196:199], v[80:83]
    buffer_load_dwordx4 v6, s[12:15], s30 offen offset:2048 nt lds
    v_mfma_f32_16x16x32_bf16 v[80:83], a[56:59], a[200:203], v[80:83]
    ds_read_b128 a[164:167], v1 offset:256
    v_mfma_f32_16x16x32_bf16 v[80:83], a[80:83], a[204:207], v[80:83]
    s_add_u32 s30, s30, 393216
    v_mfma_f32_16x16x32_bf16 v[80:83], a[104:107], a[208:211], v[80:83]
    s_add_u32 s42, s42, 12288
    v_mfma_f32_16x16x32_bf16 v[80:83], a[128:131], a[212:215], v[80:83]
    s_cmp_eq_u32 s42, 86016
    s_cselect_b32 s42, 0, s42
    v_mfma_f32_16x16x32_bf16 v[80:83], v[104:107], a[216:219], v[80:83]
    ds_read_b128 a[168:171], v2 offset:256
    v_mfma_f32_16x16x32_bf16 v[80:83], v[128:131], a[220:223], v[80:83]
    s_add_u32 m0, s42, s41
    v_mfma_f32_16x16x32_bf16 v[80:83], v[152:155], a[224:227], v[80:83]
    ds_read_b128 a[244:247], v14 offset:12544
    v_mfma_f32_16x16x32_bf16 v[80:83], v[176:179], a[228:231], v[80:83]
    v_cvt_pk_bf16_f32 v57, v58, v59
    v_mfma_f32_16x16x32_bf16 v[80:83], v[200:203], a[232:235], v[80:83]
    ds_write_b64 v12, v[56:57] offset:64
    v_mfma_f32_16x16x32_bf16 v[80:83], v[224:227], a[236:239], v[80:83]
    ds_read_b128 a[172:175], v3 offset:256
    v_mfma_f32_16x16x32_bf16 v[84:87], a[12:15], a[192:195], v[36:39]
    v_cvt_pk_bf16_f32 v60, v60, v61
    v_mfma_f32_16x16x32_bf16 v[84:87], a[36:39], a[196:199], v[84:87]
    s_waitcnt lgkmcnt(6)
    buffer_store_dwordx4 a[240:243], v16, s[24:27], s31 offen offset:0 sc0 sc1
    v_mfma_f32_16x16x32_bf16 v[84:87], a[60:63], a[200:203], v[84:87]
    v_cvt_pk_bf16_f32 v61, v62, v63
    v_mfma_f32_16x16x32_bf16 v[84:87], a[84:87], a[204:207], v[84:87]
    ds_write_b64 v12, v[60:61] offset:96
    v_mfma_f32_16x16x32_bf16 v[84:87], a[108:111], a[208:211], v[84:87]
    ds_read_b128 a[176:179], v0 offset:512
    v_mfma_f32_16x16x32_bf16 v[84:87], a[132:135], a[212:215], v[84:87]
    s_add_u32 s29, s29, 1
    v_mfma_f32_16x16x32_bf16 v[84:87], v[108:111], a[216:219], v[84:87]
    s_cmp_lt_u32 s29, s43
    s_cselect_b32 s14, s40, 0
    v_mfma_f32_16x16x32_bf16 v[84:87], v[132:135], a[220:223], v[84:87]
    ds_read_b128 a[248:251], v15 offset:12544
    v_mfma_f32_16x16x32_bf16 v[84:87], v[156:159], a[224:227], v[84:87]
    v_cvt_pk_bf16_f32 v64, v64, v65
    v_mfma_f32_16x16x32_bf16 v[84:87], v[180:183], a[228:231], v[84:87]
    ds_read_b128 a[180:183], v1 offset:512
    v_mfma_f32_16x16x32_bf16 v[84:87], v[204:207], a[232:235], v[84:87]
    v_cvt_pk_bf16_f32 v65, v66, v67
    v_mfma_f32_16x16x32_bf16 v[84:87], v[228:231], a[236:239], v[84:87]
    ds_write_b64 v12, v[64:65] offset:128
    v_mfma_f32_16x16x32_bf16 v[88:91], a[16:19], a[192:195], v[40:43]
    v_cvt_pk_bf16_f32 v68, v68, v69
    v_mfma_f32_16x16x32_bf16 v[88:91], a[40:43], a[196:199], v[88:91]
    s_waitcnt lgkmcnt(7)
    buffer_store_dwordx4 a[244:247], v16, s[24:27], s31 offen offset:1024 sc0 sc1
    v_mfma_f32_16x16x32_bf16 v[88:91], a[64:67], a[200:203], v[88:91]
    ds_read_b128 a[184:187], v2 offset:512
    v_mfma_f32_16x16x32_bf16 v[88:91], a[88:91], a[204:207], v[88:91]
    v_cvt_pk_bf16_f32 v69, v70, v71
    v_mfma_f32_16x16x32_bf16 v[88:91], a[112:115], a[208:211], v[88:91]
    ds_write_b64 v12, v[68:69] offset:160
    v_mfma_f32_16x16x32_bf16 v[88:91], a[136:139], a[212:215], v[88:91]
    v_add_u32 v0, s33, v0
    v_mfma_f32_16x16x32_bf16 v[88:91], v[112:115], a[216:219], v[88:91]
    v_add_u32 v1, s33, v1
    v_mfma_f32_16x16x32_bf16 v[88:91], v[136:139], a[220:223], v[88:91]
    ds_read_b128 a[188:191], v3 offset:512
    v_mfma_f32_16x16x32_bf16 v[88:91], v[160:163], a[224:227], v[88:91]
    v_add_u32 v2, s33, v2
    v_mfma_f32_16x16x32_bf16 v[88:91], v[184:187], a[228:231], v[88:91]
    v_add_u32 v3, s33, v3
    v_mfma_f32_16x16x32_bf16 v[88:91], v[208:211], a[232:235], v[88:91]
    v_mfma_f32_16x16x32_bf16 v[88:91], v[232:235], a[236:239], v[88:91]
    v_mfma_f32_16x16x32_bf16 v[92:95], a[20:23], a[192:195], v[44:47]
    v_mfma_f32_16x16x32_bf16 v[92:95], a[44:47], a[196:199], v[92:95]
    s_waitcnt lgkmcnt(5)
    buffer_store_dwordx4 a[248:251], v16, s[24:27], s31 offen offset:2048 sc0 sc1
    v_mfma_f32_16x16x32_bf16 v[92:95], a[68:71], a[200:203], v[92:95]
    v_mfma_f32_16x16x32_bf16 v[92:95], a[92:95], a[204:207], v[92:95]
    v_mfma_f32_16x16x32_bf16 v[92:95], a[116:119], a[208:211], v[92:95]
    v_mfma_f32_16x16x32_bf16 v[92:95], a[140:143], a[212:215], v[92:95]
    v_mfma_f32_16x16x32_bf16 v[92:95], v[116:119], a[216:219], v[92:95]
    v_mfma_f32_16x16x32_bf16 v[92:95], v[140:143], a[220:223], v[92:95]
    v_mfma_f32_16x16x32_bf16 v[92:95], v[164:167], a[224:227], v[92:95]
    v_mfma_f32_16x16x32_bf16 v[92:95], v[188:191], a[228:231], v[92:95]
    v_mfma_f32_16x16x32_bf16 v[92:95], v[212:215], a[232:235], v[92:95]
    v_mfma_f32_16x16x32_bf16 v[92:95], v[236:239], a[236:239], v[92:95]
    s_cmp_lt_u32 s29, s37
    s_cbranch_scc1 L_loop0
L_drain1:
    s_waitcnt lgkmcnt(0)
    s_barrier
    s_add_u32 s31, s31, 393216
    s_nop 4
    ds_read_b128 a[240:243], v13 offset:0
    ds_read_b128 a[244:247], v14 offset:0
    ds_read_b128 a[248:251], v15 offset:0
    v_cvt_pk_bf16_f32 v72, v72, v73
    v_cvt_pk_bf16_f32 v73, v74, v75
    ds_write_b64 v12, v[72:73] offset:12544
    v_cvt_pk_bf16_f32 v76, v76, v77
    v_cvt_pk_bf16_f32 v77, v78, v79
    ds_write_b64 v12, v[76:77] offset:12576
    v_cvt_pk_bf16_f32 v80, v80, v81
    v_cvt_pk_bf16_f32 v81, v82, v83
    ds_write_b64 v12, v[80:81] offset:12608
    v_cvt_pk_bf16_f32 v84, v84, v85
    v_cvt_pk_bf16_f32 v85, v86, v87
    ds_write_b64 v12, v[84:85] offset:12640
    v_cvt_pk_bf16_f32 v88, v88, v89
    v_cvt_pk_bf16_f32 v89, v90, v91
    ds_write_b64 v12, v[88:89] offset:12672
    v_cvt_pk_bf16_f32 v92, v92, v93
    v_cvt_pk_bf16_f32 v93, v94, v95
    ds_write_b64 v12, v[92:93] offset:12704
    s_waitcnt lgkmcnt(8)
    buffer_store_dwordx4 a[240:243], v16, s[24:27], s31 offen offset:0 sc0 sc1
    s_waitcnt lgkmcnt(7)
    buffer_store_dwordx4 a[244:247], v16, s[24:27], s31 offen offset:1024 sc0 sc1
    s_waitcnt lgkmcnt(6)
    buffer_store_dwordx4 a[248:251], v16, s[24:27], s31 offen offset:2048 sc0 sc1
    s_add_u32 s31, s31, 393216
    s_waitcnt lgkmcnt(0)
    s_barrier
    ds_read_b128 a[144:147], v13 offset:12544
    ds_read_b128 a[148:151], v14 offset:12544
    ds_read_b128 a[152:155], v15 offset:12544
    s_waitcnt lgkmcnt(2)
    buffer_store_dwordx4 a[144:147], v16, s[24:27], s31 offen offset:0 sc0 sc1
    s_waitcnt lgkmcnt(1)
    buffer_store_dwordx4 a[148:151], v16, s[24:27], s31 offen offset:1024 sc0 sc1
    s_waitcnt lgkmcnt(0)
    buffer_store_dwordx4 a[152:155], v16, s[24:27], s31 offen offset:2048 sc0 sc1
    s_branch L_end
L_drain0:
    s_waitcnt lgkmcnt(0)
    s_barrier
    s_add_u32 s31, s31, 393216
    s_nop 4
    ds_read_b128 a[240:243], v13 offset:12544
    ds_read_b128 a[244:247], v14 offset:12544
    ds_read_b128 a[248:251], v15 offset:12544
    v_cvt_pk_bf16_f32 v48, v48, v49
    v_cvt_pk_bf16_f32 v49, v50, v51
    ds_write_b64 v12, v[48:49] offset:0
    v_cvt_pk_bf16_f32 v52, v52, v53
    v_cvt_pk_bf16_f32 v53, v54, v55
    ds_write_b64 v12, v[52:53] offset:32
    v_cvt_pk_bf16_f32 v56, v56, v57
    v_cvt_pk_bf16_f32 v57, v58, v59
    ds_write_b64 v12, v[56:57] offset:64
    v_cvt_pk_bf16_f32 v60, v60, v61
    v_cvt_pk_bf16_f32 v61, v62, v63
    ds_write_b64 v12, v[60:61] offset:96
    v_cvt_pk_bf16_f32 v64, v64, v65
    v_cvt_pk_bf16_f32 v65, v66, v67
    ds_write_b64 v12, v[64:65] offset:128
    v_cvt_pk_bf16_f32 v68, v68, v69
    v_cvt_pk_bf16_f32 v69, v70, v71
    ds_write_b64 v12, v[68:69] offset:160
    s_waitcnt lgkmcnt(8)
    buffer_store_dwordx4 a[240:243], v16, s[24:27], s31 offen offset:0 sc0 sc1
    s_waitcnt lgkmcnt(7)
    buffer_store_dwordx4 a[244:247], v16, s[24:27], s31 offen offset:1024 sc0 sc1
    s_waitcnt lgkmcnt(6)
    buffer_store_dwordx4 a[248:251], v16, s[24:27], s31 offen offset:2048 sc0 sc1
    s_add_u32 s31, s31, 393216
    s_waitcnt lgkmcnt(0)
    s_barrier
    ds_read_b128 a[144:147], v13 offset:0
    ds_read_b128 a[148:151], v14 offset:0
    ds_read_b128 a[152:155], v15 offset:0
    s_waitcnt lgkmcnt(2)
    buffer_store_dwordx4 a[144:147], v16, s[24:27], s31 offen offset:0 sc0 sc1
    s_waitcnt lgkmcnt(1)
    buffer_store_dwordx4 a[148:151], v16, s[24:27], s31 offen offset:1024 sc0 sc1
    s_waitcnt lgkmcnt(0)
    buffer_store_dwordx4 a[152:155], v16, s[24:27], s31 offen offset:2048 sc0 sc1
L_end:
L_done:
    s_endpgm
.section .rodata,"a"
.p2align 6
.amdhsa_kernel standalone__standard_2d_1d_3d_conv__vision_kernel
  .amdhsa_next_free_vgpr 512
  .amdhsa_next_free_sgpr 96
  .amdhsa_accum_offset 256
  .amdhsa_group_segment_fixed_size 0
  .amdhsa_kernarg_size 48
  .amdhsa_user_sgpr_count 2
  .amdhsa_user_sgpr_kernarg_segment_ptr 1
  .amdhsa_system_sgpr_workgroup_id_x 1
.end_amdhsa_kernel
```

```asm
; @launch grid=(256,1,1) block=(256,1,1) lds=159744
.amdgcn_target "amdgcn-amd-amdhsa--gfx950"
.text
.globl standalone__standard_2d_1d_3d_conv__vision_kernel
.p2align 8
.type standalone__standard_2d_1d_3d_conv__vision_kernel,@function
standalone__standard_2d_1d_3d_conv__vision_kernel:
    s_load_dwordx8 s[4:11], s[0:1], 0
    s_cmp_ge_u32 s2, 256
    s_cbranch_scc1 L_done
    v_lshrrev_b32 v18, 6, v0
    v_and_b32 v19, 63, v0
    v_readfirstlane_b32 s28, v18
    s_lshr_b32 s39, s2, 3
    s_and_b32 s39, s39, 31
    s_lshl_b32 s39, s39, 8
    v_add_u32 v255, s39, v0
    v_mul_u32_u24 v255, 36, v255
    v_and_b32 v20, 15, v0
    v_bfe_u32 v21, v0, 4, 2
    v_mul_u32_u24 v22, 3072, v18
    v_add_u32 v23, 16, v19
    v_lshrrev_b32 v23, 6, v23
    v_lshl_add_u32 v23, v18, 2, v23
    v_xor_b32 v23, v23, v19
    v_lshl_add_u32 v4, v23, 4, v22
    v_lshrrev_b32 v23, 5, v19
    v_add_u32 v23, 1, v23
    v_lshl_add_u32 v23, v18, 2, v23
    v_xor_b32 v23, v23, v19
    v_lshl_add_u32 v5, v23, 4, v22
    v_add_u32 v23, 48, v19
    v_lshrrev_b32 v23, 6, v23
    v_add_u32 v23, 2, v23
    v_lshl_add_u32 v23, v18, 2, v23
    v_xor_b32 v23, v23, v19
    v_lshl_add_u32 v6, v23, 4, v22
    s_and_b32 s39, s2, 7
    s_mul_i32 s39, s39, 1152
    s_bitcmp1_b32 s2, 0
    s_cselect_b32 s38, 32, 0
    s_add_u32 s39, s39, s38
    s_lshr_b32 s30, s2, 3
    s_add_u32 s30, s30, s39
    s_mul_i32 s30, s30, 12288
    s_sub_u32 s31, s30, 393216
    s_mul_i32 s41, s28, 3072
    s_mov_b32 s42, 0
    s_mov_b32 s14, 113246208
    s_mov_b32 s15, 0x20000
    s_mov_b32 s18, 294912
    s_mov_b32 s19, 0x20000
    s_waitcnt lgkmcnt(0)
    s_mov_b32 s12, s4
    s_and_b32 s13, s5, 0xffff
    s_mov_b32 s16, s6
    s_and_b32 s17, s7, 0xffff
L_g0:
    buffer_load_dword v254, v255, s[16:19], 0 offen
    s_add_u32 m0, s42, s41
    s_add_u32 s42, s42, 12288
    buffer_load_dwordx4 v4, s[12:15], s30 offen offset:0 nt lds
    buffer_load_dwordx4 v5, s[12:15], s30 offen offset:1024 nt lds
    buffer_load_dwordx4 v6, s[12:15], s30 offen offset:2048 nt lds
    s_add_u32 s30, s30, 393216
    s_add_u32 m0, s42, s41
    s_add_u32 s42, s42, 12288
    buffer_load_dwordx4 v4, s[12:15], s30 offen offset:0 nt lds
    buffer_load_dwordx4 v5, s[12:15], s30 offen offset:1024 nt lds
    buffer_load_dwordx4 v6, s[12:15], s30 offen offset:2048 nt lds
    s_add_u32 s30, s30, 393216
    s_mul_i32 s32, s28, 6144
    s_bitcmp1_b32 s2, 0
    s_mov_b32 s37, 37
    s_cselect_b32 s37, 35, s37
    s_sub_u32 s43, s37, 3
    v_mul_u32_u24 v22, 192, v18
    v_add_u32 v240, 0, v19
    v_mul_u32_u24 v241, 171, v240
    v_lshrrev_b32 v241, 11, v241
    v_mul_u32_u24 v242, 12, v241
    v_sub_u32 v240, v240, v242
    v_bfe_u32 v242, v241, 3, 1
    v_lshlrev_b32 v242, 1, v242
    v_xor_b32 v240, v240, v242
    v_lshl_add_u32 v240, v240, 4, v22
    v_mul_u32_u24 v241, 768, v241
    v_add_u32 v240, v240, v241
    v_subrev_u32 v7, 0, v240
    v_add_u32 v240, 64, v19
    v_mul_u32_u24 v241, 171, v240
    v_lshrrev_b32 v241, 11, v241
    v_mul_u32_u24 v242, 12, v241
    v_sub_u32 v240, v240, v242
    v_bfe_u32 v242, v241, 3, 1
    v_lshlrev_b32 v242, 1, v242
    v_xor_b32 v240, v240, v242
    v_lshl_add_u32 v240, v240, 4, v22
    v_mul_u32_u24 v241, 768, v241
    v_add_u32 v240, v240, v241
    v_subrev_u32 v8, 1024, v240
    v_add_u32 v240, 128, v19
    v_mul_u32_u24 v241, 171, v240
    v_lshrrev_b32 v241, 11, v241
    v_mul_u32_u24 v242, 12, v241
    v_sub_u32 v240, v240, v242
    v_bfe_u32 v242, v241, 3, 1
    v_lshlrev_b32 v242, 1, v242
    v_xor_b32 v240, v240, v242
    v_lshl_add_u32 v240, v240, 4, v22
    v_mul_u32_u24 v241, 768, v241
    v_add_u32 v240, v240, v241
    v_subrev_u32 v9, 2048, v240
    s_mov_b32 s24, s10
    s_and_b32 s25, s11, 0xffff
    s_mov_b32 s26, 0
    s_mov_b32 s27, 0x20000
    s_add_u32 m0, s32, 86016
    s_mov_b32 s35, 0
    buffer_load_dwordx4 v7, s[16:19], s35 offen offset:0 lds
    buffer_load_dwordx4 v8, s[16:19], s35 offen offset:1024 lds
    buffer_load_dwordx4 v9, s[16:19], s35 offen offset:2048 lds
    s_add_u32 m0, s32, 89088
    s_mov_b32 s35, 12288
    buffer_load_dwordx4 v7, s[16:19], s35 offen offset:0 lds
    buffer_load_dwordx4 v8, s[16:19], s35 offen offset:1024 lds
    buffer_load_dwordx4 v9, s[16:19], s35 offen offset:2048 lds
    v_mul_u32_u24 v22, 192, v18
    v_lshl_add_u32 v17, v21, 3, v22
    s_mov_b32 s20, s8
    s_and_b32 s21, s9, 0xffff
    s_mov_b32 s22, 768
    s_mov_b32 s23, 0x20000
    buffer_load_dwordx2 a[240:241], v17, s[20:23], 0 offen offset:0
    buffer_load_dwordx2 a[242:243], v17, s[20:23], 0 offen offset:32
    buffer_load_dwordx2 a[244:245], v17, s[20:23], 0 offen offset:64
    buffer_load_dwordx2 a[246:247], v17, s[20:23], 0 offen offset:96
    buffer_load_dwordx2 a[248:249], v17, s[20:23], 0 offen offset:128
    buffer_load_dwordx2 a[250:251], v17, s[20:23], 0 offen offset:160
    v_mul_u32_u24 v22, 768, v20
    v_add_u32 v23, 0, v21
    v_xor_b32 v23, v23, v20
    v_lshl_add_u32 v0, v23, 4, v22
    v_add_u32 v23, 4, v21
    v_xor_b32 v23, v23, v20
    v_lshl_add_u32 v1, v23, 4, v22
    v_add_u32 v23, 8, v21
    v_xor_b32 v23, v23, v20
    v_lshl_add_u32 v2, v23, 4, v22
    v_add_u32 v23, 12, v21
    v_xor_b32 v23, v23, v20
    v_lshl_add_u32 v3, v23, 4, v22
    v_lshrrev_b32 v22, 2, v20
    v_lshl_add_u32 v22, v21, 3, v22
    v_mul_u32_u24 v22, 192, v22
    v_and_b32 v23, 3, v20
    v_lshl_add_u32 v22, v23, 3, v22
    v_mul_u32_u24 v23, 6144, v18
    v_add_u32 v22, v22, v23
    v_add_u32 v22, 61440, v22
    v_and_b32 v23, 1, v21
    v_lshlrev_b32 v23, 5, v23
    v_add_u32 v10, v22, v23
    v_sub_u32 v11, v22, v23
    v_add_u32 v252, 49152, v10
    v_add_u32 v253, 49152, v11
    v_mul_u32_u24 v12, 784, v20
    v_add_u32 v12, v12, v17
    v_add_u32 v12, 86016, v12
    v_mul_u32_u24 v16, 3072, v18
    v_lshl_add_u32 v16, v19, 4, v16
    v_mul_u32_u24 v22, 3136, v18
    v_add_u32 v22, 86016, v22
    v_add_u32 v23, 16, v19
    v_lshrrev_b32 v23, 6, v23
    v_add_u32 v23, v23, v19
    v_lshl_add_u32 v23, v23, 4, v22
    v_add_u32 v13, 0, v23
    v_lshrrev_b32 v23, 5, v19
    v_add_u32 v23, 1, v23
    v_add_u32 v23, v23, v19
    v_lshl_add_u32 v23, v23, 4, v22
    v_add_u32 v14, 1024, v23
    v_add_u32 v23, 48, v19
    v_lshrrev_b32 v23, 6, v23
    v_add_u32 v23, 2, v23
    v_add_u32 v23, v23, v19
    v_lshl_add_u32 v23, v23, 4, v22
    v_add_u32 v15, 2048, v23
    s_mov_b32 s40, 113246208
    s_add_u32 m0, s32, 110592
    s_mov_b32 s35, 24576
    buffer_load_dwordx4 v7, s[16:19], s35 offen offset:0 lds
    buffer_load_dwordx4 v8, s[16:19], s35 offen offset:1024 lds
    buffer_load_dwordx4 v9, s[16:19], s35 offen offset:2048 lds
    s_add_u32 m0, s32, 113664
    s_mov_b32 s35, 36864
    buffer_load_dwordx4 v7, s[16:19], s35 offen offset:0 lds
    buffer_load_dwordx4 v8, s[16:19], s35 offen offset:1024 lds
    buffer_load_dwordx4 v9, s[16:19], s35 offen offset:2048 lds
    s_add_u32 m0, s32, 135168
    s_mov_b32 s35, 49152
    buffer_load_dwordx4 v7, s[16:19], s35 offen offset:0 lds
    buffer_load_dwordx4 v8, s[16:19], s35 offen offset:1024 lds
    buffer_load_dwordx4 v9, s[16:19], s35 offen offset:2048 lds
    s_add_u32 m0, s32, 138240
    s_mov_b32 s35, 61440
    buffer_load_dwordx4 v7, s[16:19], s35 offen offset:0 lds
    buffer_load_dwordx4 v8, s[16:19], s35 offen offset:1024 lds
    buffer_load_dwordx4 v9, s[16:19], s35 offen offset:2048 lds
    s_add_u32 m0, s32, 61440
    s_mov_b32 s35, 73728
    buffer_load_dwordx4 v7, s[16:19], s35 offen offset:0 lds
    buffer_load_dwordx4 v8, s[16:19], s35 offen offset:1024 lds
    buffer_load_dwordx4 v9, s[16:19], s35 offen offset:2048 lds
    s_add_u32 m0, s32, 64512
    s_mov_b32 s35, 86016
    buffer_load_dwordx4 v7, s[16:19], s35 offen offset:0 lds
    buffer_load_dwordx4 v8, s[16:19], s35 offen offset:1024 lds
    buffer_load_dwordx4 v9, s[16:19], s35 offen offset:2048 lds
    s_waitcnt vmcnt(30)
    s_barrier
    ds_read_b128 a[144:147], v0 offset:0
    ds_read_b128 a[192:195], v0 offset:12288
    s_waitcnt vmcnt(24)
    ds_read_b64_tr_b16 a[0:1], v10 offset:24576
    ds_read_b64_tr_b16 a[2:3], v10 offset:25344
    ds_read_b64_tr_b16 a[4:5], v11 offset:24608
    ds_read_b64_tr_b16 a[6:7], v11 offset:25376
    ds_read_b64_tr_b16 a[8:9], v10 offset:24640
    ds_read_b64_tr_b16 a[10:11], v10 offset:25408
    ds_read_b64_tr_b16 a[12:13], v11 offset:24672
    ds_read_b64_tr_b16 a[14:15], v11 offset:25440
    ds_read_b64_tr_b16 a[16:17], v10 offset:24704
    ds_read_b64_tr_b16 a[18:19], v10 offset:25472
    ds_read_b64_tr_b16 a[20:21], v11 offset:24736
    ds_read_b64_tr_b16 a[22:23], v11 offset:25504
    s_waitcnt vmcnt(18)
    v_accvgpr_read_b32 v240, a240
    v_accvgpr_read_b32 v241, a241
    v_accvgpr_read_b32 v242, a242
    v_accvgpr_read_b32 v243, a243
    v_accvgpr_read_b32 v244, a244
    v_accvgpr_read_b32 v245, a245
    v_accvgpr_read_b32 v246, a246
    v_accvgpr_read_b32 v247, a247
    v_accvgpr_read_b32 v248, a248
    v_accvgpr_read_b32 v249, a249
    v_accvgpr_read_b32 v250, a250
    v_accvgpr_read_b32 v251, a251
    v_lshlrev_b32 v24, 16, v240
    v_and_b32 v25, 0xffff0000, v240
    v_lshlrev_b32 v26, 16, v241
    v_and_b32 v27, 0xffff0000, v241
    v_lshlrev_b32 v28, 16, v242
    v_and_b32 v29, 0xffff0000, v242
    v_lshlrev_b32 v30, 16, v243
    v_and_b32 v31, 0xffff0000, v243
    v_lshlrev_b32 v32, 16, v244
    v_and_b32 v33, 0xffff0000, v244
    v_lshlrev_b32 v34, 16, v245
    v_and_b32 v35, 0xffff0000, v245
    v_lshlrev_b32 v36, 16, v246
    v_and_b32 v37, 0xffff0000, v246
    v_lshlrev_b32 v38, 16, v247
    v_and_b32 v39, 0xffff0000, v247
    v_lshlrev_b32 v40, 16, v248
    v_and_b32 v41, 0xffff0000, v248
    v_lshlrev_b32 v42, 16, v249
    v_and_b32 v43, 0xffff0000, v249
    v_lshlrev_b32 v44, 16, v250
    v_and_b32 v45, 0xffff0000, v250
    v_lshlrev_b32 v46, 16, v251
    v_and_b32 v47, 0xffff0000, v251
    s_waitcnt lgkmcnt(0)
    s_waitcnt vmcnt(12)
    v_mfma_f32_16x16x32_bf16 v[48:51], a[0:3], a[144:147], v[24:27]
    ds_read_b128 a[148:151], v1 offset:0
    ds_read_b128 a[196:199], v1 offset:12288
    s_add_u32 m0, s32, 86016
    s_mov_b32 s35, 98304
    buffer_load_dwordx4 v7, s[16:19], s35 offen offset:0 lds
    v_mfma_f32_16x16x32_bf16 v[52:55], a[4:7], a[144:147], v[28:31]
    ds_read_b64_tr_b16 a[24:25], v252 offset:0
    ds_read_b64_tr_b16 a[26:27], v252 offset:768
    v_mfma_f32_16x16x32_bf16 v[56:59], a[8:11], a[144:147], v[32:35]
    ds_read_b64_tr_b16 a[28:29], v253 offset:32
    ds_read_b64_tr_b16 a[30:31], v253 offset:800
    buffer_load_dwordx4 v8, s[16:19], s35 offen offset:1024 lds
    v_mfma_f32_16x16x32_bf16 v[60:63], a[12:15], a[144:147], v[36:39]
    ds_read_b64_tr_b16 a[32:33], v252 offset:64
    ds_read_b64_tr_b16 a[34:35], v252 offset:832
    v_mfma_f32_16x16x32_bf16 v[64:67], a[16:19], a[144:147], v[40:43]
    ds_read_b64_tr_b16 a[36:37], v253 offset:96
    ds_read_b64_tr_b16 a[38:39], v253 offset:864
    buffer_load_dwordx4 v9, s[16:19], s35 offen offset:2048 lds
    v_mfma_f32_16x16x32_bf16 v[68:71], a[20:23], a[144:147], v[44:47]
    ds_read_b64_tr_b16 a[40:41], v252 offset:128
    ds_read_b64_tr_b16 a[42:43], v252 offset:896
    v_mfma_f32_16x16x32_bf16 v[72:75], a[0:3], a[192:195], v[24:27]
    ds_read_b64_tr_b16 a[44:45], v253 offset:160
    ds_read_b64_tr_b16 a[46:47], v253 offset:928
    s_add_u32 m0, s32, 89088
    s_mov_b32 s35, 110592
    buffer_load_dwordx4 v7, s[16:19], s35 offen offset:0 lds
    v_mfma_f32_16x16x32_bf16 v[76:79], a[4:7], a[192:195], v[28:31]
    v_mfma_f32_16x16x32_bf16 v[80:83], a[8:11], a[192:195], v[32:35]
    buffer_load_dwordx4 v8, s[16:19], s35 offen offset:1024 lds
    v_mfma_f32_16x16x32_bf16 v[84:87], a[12:15], a[192:195], v[36:39]
    v_mfma_f32_16x16x32_bf16 v[88:91], a[16:19], a[192:195], v[40:43]
    buffer_load_dwordx4 v9, s[16:19], s35 offen offset:2048 lds
    v_mfma_f32_16x16x32_bf16 v[92:95], a[20:23], a[192:195], v[44:47]
    s_waitcnt lgkmcnt(0)
    s_waitcnt vmcnt(12)
    v_mfma_f32_16x16x32_bf16 v[48:51], a[24:27], a[148:151], v[48:51]
    ds_read_b128 a[152:155], v2 offset:0
    ds_read_b128 a[200:203], v2 offset:12288
    s_add_u32 m0, s32, 110592
    s_mov_b32 s35, 122880
    buffer_load_dwordx4 v7, s[16:19], s35 offen offset:0 lds
    v_mfma_f32_16x16x32_bf16 v[52:55], a[28:31], a[148:151], v[52:55]
    ds_read_b64_tr_b16 a[48:49], v252 offset:24576
    ds_read_b64_tr_b16 a[50:51], v252 offset:25344
    v_mfma_f32_16x16x32_bf16 v[56:59], a[32:35], a[148:151], v[56:59]
    ds_read_b64_tr_b16 a[52:53], v253 offset:24608
    ds_read_b64_tr_b16 a[54:55], v253 offset:25376
    buffer_load_dwordx4 v8, s[16:19], s35 offen offset:1024 lds
    v_mfma_f32_16x16x32_bf16 v[60:63], a[36:39], a[148:151], v[60:63]
    ds_read_b64_tr_b16 a[56:57], v252 offset:24640
    ds_read_b64_tr_b16 a[58:59], v252 offset:25408
    v_mfma_f32_16x16x32_bf16 v[64:67], a[40:43], a[148:151], v[64:67]
    ds_read_b64_tr_b16 a[60:61], v253 offset:24672
    ds_read_b64_tr_b16 a[62:63], v253 offset:25440
    buffer_load_dwordx4 v9, s[16:19], s35 offen offset:2048 lds
    v_mfma_f32_16x16x32_bf16 v[68:71], a[44:47], a[148:151], v[68:71]
    ds_read_b64_tr_b16 a[64:65], v252 offset:24704
    ds_read_b64_tr_b16 a[66:67], v252 offset:25472
    v_mfma_f32_16x16x32_bf16 v[72:75], a[24:27], a[196:199], v[72:75]
    ds_read_b64_tr_b16 a[68:69], v253 offset:24736
    ds_read_b64_tr_b16 a[70:71], v253 offset:25504
    s_add_u32 m0, s32, 113664
    s_mov_b32 s35, 135168
    buffer_load_dwordx4 v7, s[16:19], s35 offen offset:0 lds
    v_mfma_f32_16x16x32_bf16 v[76:79], a[28:31], a[196:199], v[76:79]
    v_mfma_f32_16x16x32_bf16 v[80:83], a[32:35], a[196:199], v[80:83]
    buffer_load_dwordx4 v8, s[16:19], s35 offen offset:1024 lds
    v_mfma_f32_16x16x32_bf16 v[84:87], a[36:39], a[196:199], v[84:87]
    v_mfma_f32_16x16x32_bf16 v[88:91], a[40:43], a[196:199], v[88:91]
    buffer_load_dwordx4 v9, s[16:19], s35 offen offset:2048 lds
    v_mfma_f32_16x16x32_bf16 v[92:95], a[44:47], a[196:199], v[92:95]
    s_waitcnt lgkmcnt(0)
    s_waitcnt vmcnt(12)
    v_mfma_f32_16x16x32_bf16 v[48:51], a[48:51], a[152:155], v[48:51]
    ds_read_b128 a[156:159], v3 offset:0
    ds_read_b128 a[204:207], v3 offset:12288
    s_add_u32 m0, s32, 135168
    s_mov_b32 s35, 147456
    buffer_load_dwordx4 v7, s[16:19], s35 offen offset:0 lds
    v_mfma_f32_16x16x32_bf16 v[52:55], a[52:55], a[152:155], v[52:55]
    ds_read_b64_tr_b16 a[72:73], v10 offset:0
    ds_read_b64_tr_b16 a[74:75], v10 offset:768
    v_mfma_f32_16x16x32_bf16 v[56:59], a[56:59], a[152:155], v[56:59]
    ds_read_b64_tr_b16 a[76:77], v11 offset:32
    ds_read_b64_tr_b16 a[78:79], v11 offset:800
    buffer_load_dwordx4 v8, s[16:19], s35 offen offset:1024 lds
    v_mfma_f32_16x16x32_bf16 v[60:63], a[60:63], a[152:155], v[60:63]
    ds_read_b64_tr_b16 a[80:81], v10 offset:64
    ds_read_b64_tr_b16 a[82:83], v10 offset:832
    v_mfma_f32_16x16x32_bf16 v[64:67], a[64:67], a[152:155], v[64:67]
    ds_read_b64_tr_b16 a[84:85], v11 offset:96
    ds_read_b64_tr_b16 a[86:87], v11 offset:864
    buffer_load_dwordx4 v9, s[16:19], s35 offen offset:2048 lds
    v_mfma_f32_16x16x32_bf16 v[68:71], a[68:71], a[152:155], v[68:71]
    ds_read_b64_tr_b16 a[88:89], v10 offset:128
    ds_read_b64_tr_b16 a[90:91], v10 offset:896
    v_mfma_f32_16x16x32_bf16 v[72:75], a[48:51], a[200:203], v[72:75]
    ds_read_b64_tr_b16 a[92:93], v11 offset:160
    ds_read_b64_tr_b16 a[94:95], v11 offset:928
    s_add_u32 m0, s32, 138240
    s_mov_b32 s35, 159744
    buffer_load_dwordx4 v7, s[16:19], s35 offen offset:0 lds
    v_mfma_f32_16x16x32_bf16 v[76:79], a[52:55], a[200:203], v[76:79]
    v_mfma_f32_16x16x32_bf16 v[80:83], a[56:59], a[200:203], v[80:83]
    buffer_load_dwordx4 v8, s[16:19], s35 offen offset:1024 lds
    v_mfma_f32_16x16x32_bf16 v[84:87], a[60:63], a[200:203], v[84:87]
    v_mfma_f32_16x16x32_bf16 v[88:91], a[64:67], a[200:203], v[88:91]
    buffer_load_dwordx4 v9, s[16:19], s35 offen offset:2048 lds
    v_mfma_f32_16x16x32_bf16 v[92:95], a[68:71], a[200:203], v[92:95]
    s_waitcnt lgkmcnt(0)
    s_waitcnt vmcnt(12)
    v_mfma_f32_16x16x32_bf16 v[48:51], a[72:75], a[156:159], v[48:51]
    ds_read_b128 a[160:163], v0 offset:256
    ds_read_b128 a[208:211], v0 offset:12544
    s_add_u32 m0, s32, 61440
    s_mov_b32 s35, 172032
    buffer_load_dwordx4 v7, s[16:19], s35 offen offset:0 lds
    v_mfma_f32_16x16x32_bf16 v[52:55], a[76:79], a[156:159], v[52:55]
    ds_read_b64_tr_b16 a[96:97], v10 offset:24576
    ds_read_b64_tr_b16 a[98:99], v10 offset:25344
    v_mfma_f32_16x16x32_bf16 v[56:59], a[80:83], a[156:159], v[56:59]
    ds_read_b64_tr_b16 a[100:101], v11 offset:24608
    ds_read_b64_tr_b16 a[102:103], v11 offset:25376
    buffer_load_dwordx4 v8, s[16:19], s35 offen offset:1024 lds
    v_mfma_f32_16x16x32_bf16 v[60:63], a[84:87], a[156:159], v[60:63]
    ds_read_b64_tr_b16 a[104:105], v10 offset:24640
    ds_read_b64_tr_b16 a[106:107], v10 offset:25408
    v_mfma_f32_16x16x32_bf16 v[64:67], a[88:91], a[156:159], v[64:67]
    ds_read_b64_tr_b16 a[108:109], v11 offset:24672
    ds_read_b64_tr_b16 a[110:111], v11 offset:25440
    buffer_load_dwordx4 v9, s[16:19], s35 offen offset:2048 lds
    v_mfma_f32_16x16x32_bf16 v[68:71], a[92:95], a[156:159], v[68:71]
    ds_read_b64_tr_b16 a[112:113], v10 offset:24704
    ds_read_b64_tr_b16 a[114:115], v10 offset:25472
    v_mfma_f32_16x16x32_bf16 v[72:75], a[72:75], a[204:207], v[72:75]
    ds_read_b64_tr_b16 a[116:117], v11 offset:24736
    ds_read_b64_tr_b16 a[118:119], v11 offset:25504
    s_add_u32 m0, s32, 64512
    s_mov_b32 s35, 184320
    buffer_load_dwordx4 v7, s[16:19], s35 offen offset:0 lds
    v_mfma_f32_16x16x32_bf16 v[76:79], a[76:79], a[204:207], v[76:79]
    v_mfma_f32_16x16x32_bf16 v[80:83], a[80:83], a[204:207], v[80:83]
    buffer_load_dwordx4 v8, s[16:19], s35 offen offset:1024 lds
    v_mfma_f32_16x16x32_bf16 v[84:87], a[84:87], a[204:207], v[84:87]
    v_mfma_f32_16x16x32_bf16 v[88:91], a[88:91], a[204:207], v[88:91]
    buffer_load_dwordx4 v9, s[16:19], s35 offen offset:2048 lds
    v_mfma_f32_16x16x32_bf16 v[92:95], a[92:95], a[204:207], v[92:95]
    s_add_u32 m0, s42, s41
    s_add_u32 s42, s42, 12288
    buffer_load_dwordx4 v4, s[12:15], s30 offen offset:0 nt lds
    buffer_load_dwordx4 v5, s[12:15], s30 offen offset:1024 nt lds
    buffer_load_dwordx4 v6, s[12:15], s30 offen offset:2048 nt lds
    s_add_u32 s30, s30, 393216
    s_waitcnt lgkmcnt(0)
    s_waitcnt vmcnt(15)
    v_mfma_f32_16x16x32_bf16 v[48:51], a[96:99], a[160:163], v[48:51]
    ds_read_b128 a[164:167], v1 offset:256
    ds_read_b128 a[212:215], v1 offset:12544
    s_add_u32 m0, s32, 86016
    s_mov_b32 s35, 196608
    buffer_load_dwordx4 v7, s[16:19], s35 offen offset:0 lds
    v_mfma_f32_16x16x32_bf16 v[52:55], a[100:103], a[160:163], v[52:55]
    ds_read_b64_tr_b16 a[120:121], v252 offset:0
    ds_read_b64_tr_b16 a[122:123], v252 offset:768
    v_mfma_f32_16x16x32_bf16 v[56:59], a[104:107], a[160:163], v[56:59]
    ds_read_b64_tr_b16 a[124:125], v253 offset:32
    ds_read_b64_tr_b16 a[126:127], v253 offset:800
    buffer_load_dwordx4 v8, s[16:19], s35 offen offset:1024 lds
    v_mfma_f32_16x16x32_bf16 v[60:63], a[108:111], a[160:163], v[60:63]
    ds_read_b64_tr_b16 a[128:129], v252 offset:64
    ds_read_b64_tr_b16 a[130:131], v252 offset:832
    v_mfma_f32_16x16x32_bf16 v[64:67], a[112:115], a[160:163], v[64:67]
    ds_read_b64_tr_b16 a[132:133], v253 offset:96
    ds_read_b64_tr_b16 a[134:135], v253 offset:864
    buffer_load_dwordx4 v9, s[16:19], s35 offen offset:2048 lds
    v_mfma_f32_16x16x32_bf16 v[68:71], a[116:119], a[160:163], v[68:71]
    ds_read_b64_tr_b16 a[136:137], v252 offset:128
    ds_read_b64_tr_b16 a[138:139], v252 offset:896
    v_mfma_f32_16x16x32_bf16 v[72:75], a[96:99], a[208:211], v[72:75]
    ds_read_b64_tr_b16 a[140:141], v253 offset:160
    ds_read_b64_tr_b16 a[142:143], v253 offset:928
    s_add_u32 m0, s32, 89088
    s_mov_b32 s35, 208896
    buffer_load_dwordx4 v7, s[16:19], s35 offen offset:0 lds
    v_mfma_f32_16x16x32_bf16 v[76:79], a[100:103], a[208:211], v[76:79]
    v_mfma_f32_16x16x32_bf16 v[80:83], a[104:107], a[208:211], v[80:83]
    buffer_load_dwordx4 v8, s[16:19], s35 offen offset:1024 lds
    v_mfma_f32_16x16x32_bf16 v[84:87], a[108:111], a[208:211], v[84:87]
    v_mfma_f32_16x16x32_bf16 v[88:91], a[112:115], a[208:211], v[88:91]
    buffer_load_dwordx4 v9, s[16:19], s35 offen offset:2048 lds
    v_mfma_f32_16x16x32_bf16 v[92:95], a[116:119], a[208:211], v[92:95]
    s_waitcnt lgkmcnt(0)
    s_waitcnt vmcnt(15)
    v_mfma_f32_16x16x32_bf16 v[48:51], a[120:123], a[164:167], v[48:51]
    ds_read_b128 a[168:171], v2 offset:256
    ds_read_b128 a[216:219], v2 offset:12544
    s_add_u32 m0, s32, 110592
    s_mov_b32 s35, 221184
    buffer_load_dwordx4 v7, s[16:19], s35 offen offset:0 lds
    v_mfma_f32_16x16x32_bf16 v[52:55], a[124:127], a[164:167], v[52:55]
    ds_read_b64_tr_b16 v[96:97], v252 offset:24576
    ds_read_b64_tr_b16 v[98:99], v252 offset:25344
    v_mfma_f32_16x16x32_bf16 v[56:59], a[128:131], a[164:167], v[56:59]
    ds_read_b64_tr_b16 v[100:101], v253 offset:24608
    ds_read_b64_tr_b16 v[102:103], v253 offset:25376
    buffer_load_dwordx4 v8, s[16:19], s35 offen offset:1024 lds
    v_mfma_f32_16x16x32_bf16 v[60:63], a[132:135], a[164:167], v[60:63]
    ds_read_b64_tr_b16 v[104:105], v252 offset:24640
    ds_read_b64_tr_b16 v[106:107], v252 offset:25408
    v_mfma_f32_16x16x32_bf16 v[64:67], a[136:139], a[164:167], v[64:67]
    ds_read_b64_tr_b16 v[108:109], v253 offset:24672
    ds_read_b64_tr_b16 v[110:111], v253 offset:25440
    buffer_load_dwordx4 v9, s[16:19], s35 offen offset:2048 lds
    v_mfma_f32_16x16x32_bf16 v[68:71], a[140:143], a[164:167], v[68:71]
    ds_read_b64_tr_b16 v[112:113], v252 offset:24704
    ds_read_b64_tr_b16 v[114:115], v252 offset:25472
    v_mfma_f32_16x16x32_bf16 v[72:75], a[120:123], a[212:215], v[72:75]
    ds_read_b64_tr_b16 v[116:117], v253 offset:24736
    ds_read_b64_tr_b16 v[118:119], v253 offset:25504
    s_add_u32 m0, s32, 113664
    s_mov_b32 s35, 233472
    buffer_load_dwordx4 v7, s[16:19], s35 offen offset:0 lds
    v_mfma_f32_16x16x32_bf16 v[76:79], a[124:127], a[212:215], v[76:79]
    v_mfma_f32_16x16x32_bf16 v[80:83], a[128:131], a[212:215], v[80:83]
    buffer_load_dwordx4 v8, s[16:19], s35 offen offset:1024 lds
    v_mfma_f32_16x16x32_bf16 v[84:87], a[132:135], a[212:215], v[84:87]
    v_mfma_f32_16x16x32_bf16 v[88:91], a[136:139], a[212:215], v[88:91]
    buffer_load_dwordx4 v9, s[16:19], s35 offen offset:2048 lds
    v_mfma_f32_16x16x32_bf16 v[92:95], a[140:143], a[212:215], v[92:95]
    s_waitcnt lgkmcnt(0)
    s_waitcnt vmcnt(15)
    v_mfma_f32_16x16x32_bf16 v[48:51], v[96:99], a[168:171], v[48:51]
    ds_read_b128 a[172:175], v3 offset:256
    ds_read_b128 a[220:223], v3 offset:12544
    s_add_u32 m0, s32, 135168
    s_mov_b32 s35, 245760
    buffer_load_dwordx4 v7, s[16:19], s35 offen offset:0 lds
    v_mfma_f32_16x16x32_bf16 v[52:55], v[100:103], a[168:171], v[52:55]
    ds_read_b64_tr_b16 v[120:121], v10 offset:0
    ds_read_b64_tr_b16 v[122:123], v10 offset:768
    v_mfma_f32_16x16x32_bf16 v[56:59], v[104:107], a[168:171], v[56:59]
    ds_read_b64_tr_b16 v[124:125], v11 offset:32
    ds_read_b64_tr_b16 v[126:127], v11 offset:800
    buffer_load_dwordx4 v8, s[16:19], s35 offen offset:1024 lds
    v_mfma_f32_16x16x32_bf16 v[60:63], v[108:111], a[168:171], v[60:63]
    ds_read_b64_tr_b16 v[128:129], v10 offset:64
    ds_read_b64_tr_b16 v[130:131], v10 offset:832
    v_mfma_f32_16x16x32_bf16 v[64:67], v[112:115], a[168:171], v[64:67]
    ds_read_b64_tr_b16 v[132:133], v11 offset:96
    ds_read_b64_tr_b16 v[134:135], v11 offset:864
    buffer_load_dwordx4 v9, s[16:19], s35 offen offset:2048 lds
    v_mfma_f32_16x16x32_bf16 v[68:71], v[116:119], a[168:171], v[68:71]
    ds_read_b64_tr_b16 v[136:137], v10 offset:128
    ds_read_b64_tr_b16 v[138:139], v10 offset:896
    v_mfma_f32_16x16x32_bf16 v[72:75], v[96:99], a[216:219], v[72:75]
    ds_read_b64_tr_b16 v[140:141], v11 offset:160
    ds_read_b64_tr_b16 v[142:143], v11 offset:928
    s_add_u32 m0, s32, 138240
    s_mov_b32 s35, 258048
    buffer_load_dwordx4 v7, s[16:19], s35 offen offset:0 lds
    v_mfma_f32_16x16x32_bf16 v[76:79], v[100:103], a[216:219], v[76:79]
    v_mfma_f32_16x16x32_bf16 v[80:83], v[104:107], a[216:219], v[80:83]
    buffer_load_dwordx4 v8, s[16:19], s35 offen offset:1024 lds
    v_mfma_f32_16x16x32_bf16 v[84:87], v[108:111], a[216:219], v[84:87]
    v_mfma_f32_16x16x32_bf16 v[88:91], v[112:115], a[216:219], v[88:91]
    buffer_load_dwordx4 v9, s[16:19], s35 offen offset:2048 lds
    v_mfma_f32_16x16x32_bf16 v[92:95], v[116:119], a[216:219], v[92:95]
    s_waitcnt lgkmcnt(0)
    s_waitcnt vmcnt(12)
    v_mfma_f32_16x16x32_bf16 v[48:51], v[120:123], a[172:175], v[48:51]
    ds_read_b128 a[176:179], v0 offset:512
    ds_read_b128 a[224:227], v0 offset:12800
    s_add_u32 m0, s32, 61440
    s_mov_b32 s35, 270336
    buffer_load_dwordx4 v7, s[16:19], s35 offen offset:0 lds
    v_mfma_f32_16x16x32_bf16 v[52:55], v[124:127], a[172:175], v[52:55]
    ds_read_b64_tr_b16 v[144:145], v10 offset:24576
    ds_read_b64_tr_b16 v[146:147], v10 offset:25344
    v_mfma_f32_16x16x32_bf16 v[56:59], v[128:131], a[172:175], v[56:59]
    ds_read_b64_tr_b16 v[148:149], v11 offset:24608
    ds_read_b64_tr_b16 v[150:151], v11 offset:25376
    buffer_load_dwordx4 v8, s[16:19], s35 offen offset:1024 lds
    v_mfma_f32_16x16x32_bf16 v[60:63], v[132:135], a[172:175], v[60:63]
    ds_read_b64_tr_b16 v[152:153], v10 offset:24640
    ds_read_b64_tr_b16 v[154:155], v10 offset:25408
    v_mfma_f32_16x16x32_bf16 v[64:67], v[136:139], a[172:175], v[64:67]
    ds_read_b64_tr_b16 v[156:157], v11 offset:24672
    ds_read_b64_tr_b16 v[158:159], v11 offset:25440
    buffer_load_dwordx4 v9, s[16:19], s35 offen offset:2048 lds
    v_mfma_f32_16x16x32_bf16 v[68:71], v[140:143], a[172:175], v[68:71]
    ds_read_b64_tr_b16 v[160:161], v10 offset:24704
    ds_read_b64_tr_b16 v[162:163], v10 offset:25472
    v_mfma_f32_16x16x32_bf16 v[72:75], v[120:123], a[220:223], v[72:75]
    ds_read_b64_tr_b16 v[164:165], v11 offset:24736
    ds_read_b64_tr_b16 v[166:167], v11 offset:25504
    s_add_u32 m0, s32, 64512
    s_mov_b32 s35, 282624
    buffer_load_dwordx4 v7, s[16:19], s35 offen offset:0 lds
    v_mfma_f32_16x16x32_bf16 v[76:79], v[124:127], a[220:223], v[76:79]
    v_mfma_f32_16x16x32_bf16 v[80:83], v[128:131], a[220:223], v[80:83]
    buffer_load_dwordx4 v8, s[16:19], s35 offen offset:1024 lds
    v_mfma_f32_16x16x32_bf16 v[84:87], v[132:135], a[220:223], v[84:87]
    v_mfma_f32_16x16x32_bf16 v[88:91], v[136:139], a[220:223], v[88:91]
    buffer_load_dwordx4 v9, s[16:19], s35 offen offset:2048 lds
    v_mfma_f32_16x16x32_bf16 v[92:95], v[140:143], a[220:223], v[92:95]
    s_waitcnt lgkmcnt(0)
    s_waitcnt vmcnt(12)
    v_mfma_f32_16x16x32_bf16 v[48:51], v[144:147], a[176:179], v[48:51]
    ds_read_b128 a[180:183], v1 offset:512
    ds_read_b128 a[228:231], v1 offset:12800
    s_add_u32 m0, s42, s41
    s_add_u32 s42, s42, 12288
    buffer_load_dwordx4 v4, s[12:15], s30 offen offset:0 nt lds
    buffer_load_dwordx4 v5, s[12:15], s30 offen offset:1024 nt lds
    buffer_load_dwordx4 v6, s[12:15], s30 offen offset:2048 nt lds
    buffer_store_dwordx4 a[240:243], v16, s[24:27], 0 offen offset:0 sc0 sc1
    buffer_store_dwordx4 a[244:247], v16, s[24:27], 0 offen offset:1024 sc0 sc1
    buffer_store_dwordx4 a[248:251], v16, s[24:27], 0 offen offset:2048 sc0 sc1
    s_add_u32 s30, s30, 393216
    v_mfma_f32_16x16x32_bf16 v[52:55], v[148:151], a[176:179], v[52:55]
    ds_read_b64_tr_b16 v[168:169], v252 offset:0
    ds_read_b64_tr_b16 v[170:171], v252 offset:768
    v_mfma_f32_16x16x32_bf16 v[56:59], v[152:155], a[176:179], v[56:59]
    ds_read_b64_tr_b16 v[172:173], v253 offset:32
    ds_read_b64_tr_b16 v[174:175], v253 offset:800
    v_mfma_f32_16x16x32_bf16 v[60:63], v[156:159], a[176:179], v[60:63]
    ds_read_b64_tr_b16 v[176:177], v252 offset:64
    ds_read_b64_tr_b16 v[178:179], v252 offset:832
    v_mfma_f32_16x16x32_bf16 v[64:67], v[160:163], a[176:179], v[64:67]
    ds_read_b64_tr_b16 v[180:181], v253 offset:96
    ds_read_b64_tr_b16 v[182:183], v253 offset:864
    v_mfma_f32_16x16x32_bf16 v[68:71], v[164:167], a[176:179], v[68:71]
    ds_read_b64_tr_b16 v[184:185], v252 offset:128
    ds_read_b64_tr_b16 v[186:187], v252 offset:896
    v_mfma_f32_16x16x32_bf16 v[72:75], v[144:147], a[224:227], v[72:75]
    ds_read_b64_tr_b16 v[188:189], v253 offset:160
    ds_read_b64_tr_b16 v[190:191], v253 offset:928
    v_mfma_f32_16x16x32_bf16 v[76:79], v[148:151], a[224:227], v[76:79]
    v_mfma_f32_16x16x32_bf16 v[80:83], v[152:155], a[224:227], v[80:83]
    v_mfma_f32_16x16x32_bf16 v[84:87], v[156:159], a[224:227], v[84:87]
    v_mfma_f32_16x16x32_bf16 v[88:91], v[160:163], a[224:227], v[88:91]
    v_mfma_f32_16x16x32_bf16 v[92:95], v[164:167], a[224:227], v[92:95]
    s_waitcnt lgkmcnt(0)
    s_waitcnt vmcnt(12)
    v_mfma_f32_16x16x32_bf16 v[48:51], v[168:171], a[180:183], v[48:51]
    ds_read_b128 a[184:187], v2 offset:512
    ds_read_b128 a[232:235], v2 offset:12800
    s_add_u32 m0, s42, s41
    s_add_u32 s42, s42, 12288
    buffer_load_dwordx4 v4, s[12:15], s30 offen offset:0 nt lds
    buffer_load_dwordx4 v5, s[12:15], s30 offen offset:1024 nt lds
    buffer_load_dwordx4 v6, s[12:15], s30 offen offset:2048 nt lds
    buffer_store_dwordx4 a[240:243], v16, s[24:27], 0 offen offset:0 sc0 sc1
    buffer_store_dwordx4 a[244:247], v16, s[24:27], 0 offen offset:1024 sc0 sc1
    buffer_store_dwordx4 a[248:251], v16, s[24:27], 0 offen offset:2048 sc0 sc1
    s_add_u32 s30, s30, 393216
    v_mfma_f32_16x16x32_bf16 v[52:55], v[172:175], a[180:183], v[52:55]
    ds_read_b64_tr_b16 v[192:193], v252 offset:24576
    ds_read_b64_tr_b16 v[194:195], v252 offset:25344
    v_mfma_f32_16x16x32_bf16 v[56:59], v[176:179], a[180:183], v[56:59]
    ds_read_b64_tr_b16 v[196:197], v253 offset:24608
    ds_read_b64_tr_b16 v[198:199], v253 offset:25376
    v_mfma_f32_16x16x32_bf16 v[60:63], v[180:183], a[180:183], v[60:63]
    ds_read_b64_tr_b16 v[200:201], v252 offset:24640
    ds_read_b64_tr_b16 v[202:203], v252 offset:25408
    v_mfma_f32_16x16x32_bf16 v[64:67], v[184:187], a[180:183], v[64:67]
    ds_read_b64_tr_b16 v[204:205], v253 offset:24672
    ds_read_b64_tr_b16 v[206:207], v253 offset:25440
    v_mfma_f32_16x16x32_bf16 v[68:71], v[188:191], a[180:183], v[68:71]
    ds_read_b64_tr_b16 v[208:209], v252 offset:24704
    ds_read_b64_tr_b16 v[210:211], v252 offset:25472
    v_mfma_f32_16x16x32_bf16 v[72:75], v[168:171], a[228:231], v[72:75]
    ds_read_b64_tr_b16 v[212:213], v253 offset:24736
    ds_read_b64_tr_b16 v[214:215], v253 offset:25504
    v_mfma_f32_16x16x32_bf16 v[76:79], v[172:175], a[228:231], v[76:79]
    v_mfma_f32_16x16x32_bf16 v[80:83], v[176:179], a[228:231], v[80:83]
    v_mfma_f32_16x16x32_bf16 v[84:87], v[180:183], a[228:231], v[84:87]
    v_mfma_f32_16x16x32_bf16 v[88:91], v[184:187], a[228:231], v[88:91]
    v_mfma_f32_16x16x32_bf16 v[92:95], v[188:191], a[228:231], v[92:95]
    s_waitcnt lgkmcnt(0)
    s_waitcnt vmcnt(12)
    v_mfma_f32_16x16x32_bf16 v[48:51], v[192:195], a[184:187], v[48:51]
    ds_read_b128 a[188:191], v3 offset:512
    ds_read_b128 a[236:239], v3 offset:12800
    v_mfma_f32_16x16x32_bf16 v[52:55], v[196:199], a[184:187], v[52:55]
    ds_read_b64_tr_b16 v[216:217], v10 offset:0
    ds_read_b64_tr_b16 v[218:219], v10 offset:768
    v_mfma_f32_16x16x32_bf16 v[56:59], v[200:203], a[184:187], v[56:59]
    ds_read_b64_tr_b16 v[220:221], v11 offset:32
    ds_read_b64_tr_b16 v[222:223], v11 offset:800
    v_mfma_f32_16x16x32_bf16 v[60:63], v[204:207], a[184:187], v[60:63]
    ds_read_b64_tr_b16 v[224:225], v10 offset:64
    ds_read_b64_tr_b16 v[226:227], v10 offset:832
    v_mfma_f32_16x16x32_bf16 v[64:67], v[208:211], a[184:187], v[64:67]
    ds_read_b64_tr_b16 v[228:229], v11 offset:96
    ds_read_b64_tr_b16 v[230:231], v11 offset:864
    v_mfma_f32_16x16x32_bf16 v[68:71], v[212:215], a[184:187], v[68:71]
    ds_read_b64_tr_b16 v[232:233], v10 offset:128
    ds_read_b64_tr_b16 v[234:235], v10 offset:896
    v_mfma_f32_16x16x32_bf16 v[72:75], v[192:195], a[232:235], v[72:75]
    ds_read_b64_tr_b16 v[236:237], v11 offset:160
    ds_read_b64_tr_b16 v[238:239], v11 offset:928
    v_mfma_f32_16x16x32_bf16 v[76:79], v[196:199], a[232:235], v[76:79]
    v_mfma_f32_16x16x32_bf16 v[80:83], v[200:203], a[232:235], v[80:83]
    v_mfma_f32_16x16x32_bf16 v[84:87], v[204:207], a[232:235], v[84:87]
    v_mfma_f32_16x16x32_bf16 v[88:91], v[208:211], a[232:235], v[88:91]
    v_mfma_f32_16x16x32_bf16 v[92:95], v[212:215], a[232:235], v[92:95]
    s_waitcnt lgkmcnt(0)
    s_barrier
    v_mfma_f32_16x16x32_bf16 v[48:51], v[216:219], a[188:191], v[48:51]
    ds_read_b128 a[144:147], v0 offset:24576
    v_mfma_f32_16x16x32_bf16 v[52:55], v[220:223], a[188:191], v[52:55]
    ds_read_b128 a[148:151], v1 offset:24576
    v_mfma_f32_16x16x32_bf16 v[56:59], v[224:227], a[188:191], v[56:59]
    ds_read_b128 a[152:155], v2 offset:24576
    v_mfma_f32_16x16x32_bf16 v[60:63], v[228:231], a[188:191], v[60:63]
    ds_read_b128 a[156:159], v3 offset:24576
    v_mfma_f32_16x16x32_bf16 v[64:67], v[232:235], a[188:191], v[64:67]
    ds_read_b128 a[160:163], v0 offset:24832
    v_mfma_f32_16x16x32_bf16 v[68:71], v[236:239], a[188:191], v[68:71]
    ds_read_b128 a[164:167], v1 offset:24832
    v_mfma_f32_16x16x32_bf16 v[72:75], v[216:219], a[236:239], v[72:75]
    ds_read_b128 a[168:171], v2 offset:24832
    v_mfma_f32_16x16x32_bf16 v[76:79], v[220:223], a[236:239], v[76:79]
    ds_read_b128 a[172:175], v3 offset:24832
    v_mfma_f32_16x16x32_bf16 v[80:83], v[224:227], a[236:239], v[80:83]
    ds_read_b128 a[176:179], v0 offset:25088
    v_mfma_f32_16x16x32_bf16 v[84:87], v[228:231], a[236:239], v[84:87]
    ds_read_b128 a[180:183], v1 offset:25088
    v_mfma_f32_16x16x32_bf16 v[88:91], v[232:235], a[236:239], v[88:91]
    ds_read_b128 a[184:187], v2 offset:25088
    v_mfma_f32_16x16x32_bf16 v[92:95], v[236:239], a[236:239], v[92:95]
    ds_read_b128 a[188:191], v3 offset:25088
    s_waitcnt lgkmcnt(0)
    s_nop 1
    v_cvt_pk_bf16_f32 v48, v48, v49
    v_cvt_pk_bf16_f32 v49, v50, v51
    ds_write_b64 v12, v[48:49] offset:0
    v_cvt_pk_bf16_f32 v52, v52, v53
    v_cvt_pk_bf16_f32 v53, v54, v55
    ds_write_b64 v12, v[52:53] offset:32
    v_cvt_pk_bf16_f32 v56, v56, v57
    v_cvt_pk_bf16_f32 v57, v58, v59
    ds_write_b64 v12, v[56:57] offset:64
    v_cvt_pk_bf16_f32 v60, v60, v61
    v_cvt_pk_bf16_f32 v61, v62, v63
    ds_write_b64 v12, v[60:61] offset:96
    v_cvt_pk_bf16_f32 v64, v64, v65
    v_cvt_pk_bf16_f32 v65, v66, v67
    ds_write_b64 v12, v[64:65] offset:128
    v_cvt_pk_bf16_f32 v68, v68, v69
    v_cvt_pk_bf16_f32 v69, v70, v71
    ds_write_b64 v12, v[68:69] offset:160
    v_add_u32 v0, 36864, v0
    v_add_u32 v1, 36864, v1
    v_add_u32 v2, 36864, v2
    v_add_u32 v3, 36864, v3
    s_mov_b32 s34, 36864
    s_mov_b32 s29, 2
    s_add_u32 m0, s42, s41
    s_mov_b32 s26, 113246208
L_enter:
.p2align 6
L_loop0:
    s_waitcnt vmcnt(9) lgkmcnt(0)
    s_barrier
    v_mfma_f32_16x16x32_bf16 v[48:51], a[0:3], a[144:147], v[24:27]
    ds_read_b128 a[192:195], v0 offset:0
    v_mfma_f32_16x16x32_bf16 v[48:51], a[24:27], a[148:151], v[48:51]
    buffer_load_dwordx4 v4, s[12:15], s30 offen offset:0 nt lds
    v_mfma_f32_16x16x32_bf16 v[48:51], a[48:51], a[152:155], v[48:51]
    s_add_u32 s31, s31, 393216
    v_mfma_f32_16x16x32_bf16 v[48:51], a[72:75], a[156:159], v[48:51]
    v_mfma_f32_16x16x32_bf16 v[48:51], a[96:99], a[160:163], v[48:51]
    v_mfma_f32_16x16x32_bf16 v[48:51], a[120:123], a[164:167], v[48:51]
    ds_read_b128 a[196:199], v1 offset:0
    v_mfma_f32_16x16x32_bf16 v[48:51], v[96:99], a[168:171], v[48:51]
    v_mfma_f32_16x16x32_bf16 v[48:51], v[120:123], a[172:175], v[48:51]
    v_mfma_f32_16x16x32_bf16 v[48:51], v[144:147], a[176:179], v[48:51]
    v_cvt_pk_bf16_f32 v72, v72, v73
    v_mfma_f32_16x16x32_bf16 v[48:51], v[168:171], a[180:183], v[48:51]
    v_cvt_pk_bf16_f32 v73, v74, v75
    v_mfma_f32_16x16x32_bf16 v[48:51], v[192:195], a[184:187], v[48:51]
    ds_read_b128 a[200:203], v2 offset:0
    v_mfma_f32_16x16x32_bf16 v[48:51], v[216:219], a[188:191], v[48:51]
    ds_write_b64 v12, v[72:73] offset:12544
    v_mfma_f32_16x16x32_bf16 v[52:55], a[4:7], a[144:147], v[28:31]
    s_add_u32 s38, s34, 12288
    v_mfma_f32_16x16x32_bf16 v[52:55], a[28:31], a[148:151], v[52:55]
    buffer_load_dwordx4 v5, s[12:15], s30 offen offset:1024 nt lds
    v_mfma_f32_16x16x32_bf16 v[52:55], a[52:55], a[152:155], v[52:55]
    s_cmp_eq_u32 s38, 86016
    s_cselect_b32 s38, 0, s38
    v_mfma_f32_16x16x32_bf16 v[52:55], a[76:79], a[156:159], v[52:55]
    ds_read_b128 a[204:207], v3 offset:0
    v_mfma_f32_16x16x32_bf16 v[52:55], a[100:103], a[160:163], v[52:55]
    v_cvt_pk_bf16_f32 v76, v76, v77
    v_mfma_f32_16x16x32_bf16 v[52:55], a[124:127], a[164:167], v[52:55]
    v_cvt_pk_bf16_f32 v77, v78, v79
    v_mfma_f32_16x16x32_bf16 v[52:55], v[100:103], a[168:171], v[52:55]
    ds_write_b64 v12, v[76:77] offset:12576
    v_mfma_f32_16x16x32_bf16 v[52:55], v[124:127], a[172:175], v[52:55]
    ds_read_b128 a[240:243], v13 offset:0
    v_mfma_f32_16x16x32_bf16 v[52:55], v[148:151], a[176:179], v[52:55]
    ds_read_b128 a[208:211], v0 offset:256
    v_mfma_f32_16x16x32_bf16 v[52:55], v[172:175], a[180:183], v[52:55]
    s_sub_u32 s33, s38, s34
    v_mfma_f32_16x16x32_bf16 v[52:55], v[196:199], a[184:187], v[52:55]
    s_mov_b32 s34, s38
    v_mfma_f32_16x16x32_bf16 v[52:55], v[220:223], a[188:191], v[52:55]
    v_mfma_f32_16x16x32_bf16 v[56:59], a[8:11], a[144:147], v[32:35]
    v_cvt_pk_bf16_f32 v80, v80, v81
    v_mfma_f32_16x16x32_bf16 v[56:59], a[32:35], a[148:151], v[56:59]
    buffer_load_dwordx4 v6, s[12:15], s30 offen offset:2048 nt lds
    v_mfma_f32_16x16x32_bf16 v[56:59], a[56:59], a[152:155], v[56:59]
    ds_read_b128 a[212:215], v1 offset:256
    v_mfma_f32_16x16x32_bf16 v[56:59], a[80:83], a[156:159], v[56:59]
    s_add_u32 s30, s30, 393216
    v_mfma_f32_16x16x32_bf16 v[56:59], a[104:107], a[160:163], v[56:59]
    s_add_u32 s42, s42, 12288
    v_mfma_f32_16x16x32_bf16 v[56:59], a[128:131], a[164:167], v[56:59]
    s_cmp_eq_u32 s42, 86016
    s_cselect_b32 s42, 0, s42
    v_mfma_f32_16x16x32_bf16 v[56:59], v[104:107], a[168:171], v[56:59]
    ds_read_b128 a[216:219], v2 offset:256
    v_mfma_f32_16x16x32_bf16 v[56:59], v[128:131], a[172:175], v[56:59]
    s_add_u32 m0, s42, s41
    v_mfma_f32_16x16x32_bf16 v[56:59], v[152:155], a[176:179], v[56:59]
    ds_read_b128 a[244:247], v14 offset:0
    v_mfma_f32_16x16x32_bf16 v[56:59], v[176:179], a[180:183], v[56:59]
    v_cvt_pk_bf16_f32 v81, v82, v83
    v_mfma_f32_16x16x32_bf16 v[56:59], v[200:203], a[184:187], v[56:59]
    ds_write_b64 v12, v[80:81] offset:12608
    v_mfma_f32_16x16x32_bf16 v[56:59], v[224:227], a[188:191], v[56:59]
    ds_read_b128 a[220:223], v3 offset:256
    v_mfma_f32_16x16x32_bf16 v[60:63], a[12:15], a[144:147], v[36:39]
    v_cvt_pk_bf16_f32 v84, v84, v85
    v_mfma_f32_16x16x32_bf16 v[60:63], a[36:39], a[148:151], v[60:63]
    s_waitcnt lgkmcnt(6)
    buffer_store_dwordx4 a[240:243], v16, s[24:27], s31 offen offset:0 sc0 sc1
    v_mfma_f32_16x16x32_bf16 v[60:63], a[60:63], a[152:155], v[60:63]
    v_cvt_pk_bf16_f32 v85, v86, v87
    v_mfma_f32_16x16x32_bf16 v[60:63], a[84:87], a[156:159], v[60:63]
    ds_write_b64 v12, v[84:85] offset:12640
    v_mfma_f32_16x16x32_bf16 v[60:63], a[108:111], a[160:163], v[60:63]
    ds_read_b128 a[224:227], v0 offset:512
    v_mfma_f32_16x16x32_bf16 v[60:63], a[132:135], a[164:167], v[60:63]
    s_add_u32 s29, s29, 1
    v_mfma_f32_16x16x32_bf16 v[60:63], v[108:111], a[168:171], v[60:63]
    s_cmp_lt_u32 s29, s43
    s_cselect_b32 s14, s40, 0
    v_mfma_f32_16x16x32_bf16 v[60:63], v[132:135], a[172:175], v[60:63]
    ds_read_b128 a[248:251], v15 offset:0
    v_mfma_f32_16x16x32_bf16 v[60:63], v[156:159], a[176:179], v[60:63]
    v_cvt_pk_bf16_f32 v88, v88, v89
    v_mfma_f32_16x16x32_bf16 v[60:63], v[180:183], a[180:183], v[60:63]
    ds_read_b128 a[228:231], v1 offset:512
    v_mfma_f32_16x16x32_bf16 v[60:63], v[204:207], a[184:187], v[60:63]
    v_cvt_pk_bf16_f32 v89, v90, v91
    v_mfma_f32_16x16x32_bf16 v[60:63], v[228:231], a[188:191], v[60:63]
    ds_write_b64 v12, v[88:89] offset:12672
    v_mfma_f32_16x16x32_bf16 v[64:67], a[16:19], a[144:147], v[40:43]
    v_cvt_pk_bf16_f32 v92, v92, v93
    v_mfma_f32_16x16x32_bf16 v[64:67], a[40:43], a[148:151], v[64:67]
    s_waitcnt lgkmcnt(7)
    buffer_store_dwordx4 a[244:247], v16, s[24:27], s31 offen offset:1024 sc0 sc1
    v_mfma_f32_16x16x32_bf16 v[64:67], a[64:67], a[152:155], v[64:67]
    ds_read_b128 a[232:235], v2 offset:512
    v_mfma_f32_16x16x32_bf16 v[64:67], a[88:91], a[156:159], v[64:67]
    v_cvt_pk_bf16_f32 v93, v94, v95
    v_mfma_f32_16x16x32_bf16 v[64:67], a[112:115], a[160:163], v[64:67]
    ds_write_b64 v12, v[92:93] offset:12704
    v_mfma_f32_16x16x32_bf16 v[64:67], a[136:139], a[164:167], v[64:67]
    v_add_u32 v0, s33, v0
    v_mfma_f32_16x16x32_bf16 v[64:67], v[112:115], a[168:171], v[64:67]
    v_add_u32 v1, s33, v1
    v_mfma_f32_16x16x32_bf16 v[64:67], v[136:139], a[172:175], v[64:67]
    ds_read_b128 a[236:239], v3 offset:512
    v_mfma_f32_16x16x32_bf16 v[64:67], v[160:163], a[176:179], v[64:67]
    v_add_u32 v2, s33, v2
    v_mfma_f32_16x16x32_bf16 v[64:67], v[184:187], a[180:183], v[64:67]
    v_add_u32 v3, s33, v3
    v_mfma_f32_16x16x32_bf16 v[64:67], v[208:211], a[184:187], v[64:67]
    v_mfma_f32_16x16x32_bf16 v[64:67], v[232:235], a[188:191], v[64:67]
    v_mfma_f32_16x16x32_bf16 v[68:71], a[20:23], a[144:147], v[44:47]
    v_mfma_f32_16x16x32_bf16 v[68:71], a[44:47], a[148:151], v[68:71]
    s_waitcnt lgkmcnt(5)
    buffer_store_dwordx4 a[248:251], v16, s[24:27], s31 offen offset:2048 sc0 sc1
    v_mfma_f32_16x16x32_bf16 v[68:71], a[68:71], a[152:155], v[68:71]
    v_mfma_f32_16x16x32_bf16 v[68:71], a[92:95], a[156:159], v[68:71]
    v_mfma_f32_16x16x32_bf16 v[68:71], a[116:119], a[160:163], v[68:71]
    v_mfma_f32_16x16x32_bf16 v[68:71], a[140:143], a[164:167], v[68:71]
    v_mfma_f32_16x16x32_bf16 v[68:71], v[116:119], a[168:171], v[68:71]
    v_mfma_f32_16x16x32_bf16 v[68:71], v[140:143], a[172:175], v[68:71]
    v_mfma_f32_16x16x32_bf16 v[68:71], v[164:167], a[176:179], v[68:71]
    v_mfma_f32_16x16x32_bf16 v[68:71], v[188:191], a[180:183], v[68:71]
    v_mfma_f32_16x16x32_bf16 v[68:71], v[212:215], a[184:187], v[68:71]
    v_mfma_f32_16x16x32_bf16 v[68:71], v[236:239], a[188:191], v[68:71]
    s_cmp_ge_u32 s29, s37
    s_cbranch_scc1 L_drain0
    s_waitcnt vmcnt(9) lgkmcnt(0)
    s_barrier
    v_mfma_f32_16x16x32_bf16 v[72:75], a[0:3], a[192:195], v[24:27]
    ds_read_b128 a[144:147], v0 offset:0
    v_mfma_f32_16x16x32_bf16 v[72:75], a[24:27], a[196:199], v[72:75]
    buffer_load_dwordx4 v4, s[12:15], s30 offen offset:0 nt lds
    v_mfma_f32_16x16x32_bf16 v[72:75], a[48:51], a[200:203], v[72:75]
    s_add_u32 s31, s31, 393216
    v_mfma_f32_16x16x32_bf16 v[72:75], a[72:75], a[204:207], v[72:75]
    v_mfma_f32_16x16x32_bf16 v[72:75], a[96:99], a[208:211], v[72:75]
    v_mfma_f32_16x16x32_bf16 v[72:75], a[120:123], a[212:215], v[72:75]
    ds_read_b128 a[148:151], v1 offset:0
    v_mfma_f32_16x16x32_bf16 v[72:75], v[96:99], a[216:219], v[72:75]
    v_mfma_f32_16x16x32_bf16 v[72:75], v[120:123], a[220:223], v[72:75]
    v_mfma_f32_16x16x32_bf16 v[72:75], v[144:147], a[224:227], v[72:75]
    v_cvt_pk_bf16_f32 v48, v48, v49
    v_mfma_f32_16x16x32_bf16 v[72:75], v[168:171], a[228:231], v[72:75]
    v_cvt_pk_bf16_f32 v49, v50, v51
    v_mfma_f32_16x16x32_bf16 v[72:75], v[192:195], a[232:235], v[72:75]
    ds_read_b128 a[152:155], v2 offset:0
    v_mfma_f32_16x16x32_bf16 v[72:75], v[216:219], a[236:239], v[72:75]
    ds_write_b64 v12, v[48:49] offset:0
    v_mfma_f32_16x16x32_bf16 v[76:79], a[4:7], a[192:195], v[28:31]
    s_add_u32 s38, s34, 12288
    v_mfma_f32_16x16x32_bf16 v[76:79], a[28:31], a[196:199], v[76:79]
    buffer_load_dwordx4 v5, s[12:15], s30 offen offset:1024 nt lds
    v_mfma_f32_16x16x32_bf16 v[76:79], a[52:55], a[200:203], v[76:79]
    s_cmp_eq_u32 s38, 86016
    s_cselect_b32 s38, 0, s38
    v_mfma_f32_16x16x32_bf16 v[76:79], a[76:79], a[204:207], v[76:79]
    ds_read_b128 a[156:159], v3 offset:0
    v_mfma_f32_16x16x32_bf16 v[76:79], a[100:103], a[208:211], v[76:79]
    v_cvt_pk_bf16_f32 v52, v52, v53
    v_mfma_f32_16x16x32_bf16 v[76:79], a[124:127], a[212:215], v[76:79]
    v_cvt_pk_bf16_f32 v53, v54, v55
    v_mfma_f32_16x16x32_bf16 v[76:79], v[100:103], a[216:219], v[76:79]
    ds_write_b64 v12, v[52:53] offset:32
    v_mfma_f32_16x16x32_bf16 v[76:79], v[124:127], a[220:223], v[76:79]
    ds_read_b128 a[240:243], v13 offset:12544
    v_mfma_f32_16x16x32_bf16 v[76:79], v[148:151], a[224:227], v[76:79]
    ds_read_b128 a[160:163], v0 offset:256
    v_mfma_f32_16x16x32_bf16 v[76:79], v[172:175], a[228:231], v[76:79]
    s_sub_u32 s33, s38, s34
    v_mfma_f32_16x16x32_bf16 v[76:79], v[196:199], a[232:235], v[76:79]
    s_mov_b32 s34, s38
    v_mfma_f32_16x16x32_bf16 v[76:79], v[220:223], a[236:239], v[76:79]
    v_mfma_f32_16x16x32_bf16 v[80:83], a[8:11], a[192:195], v[32:35]
    v_cvt_pk_bf16_f32 v56, v56, v57
    v_mfma_f32_16x16x32_bf16 v[80:83], a[32:35], a[196:199], v[80:83]
    buffer_load_dwordx4 v6, s[12:15], s30 offen offset:2048 nt lds
    v_mfma_f32_16x16x32_bf16 v[80:83], a[56:59], a[200:203], v[80:83]
    ds_read_b128 a[164:167], v1 offset:256
    v_mfma_f32_16x16x32_bf16 v[80:83], a[80:83], a[204:207], v[80:83]
    s_add_u32 s30, s30, 393216
    v_mfma_f32_16x16x32_bf16 v[80:83], a[104:107], a[208:211], v[80:83]
    s_add_u32 s42, s42, 12288
    v_mfma_f32_16x16x32_bf16 v[80:83], a[128:131], a[212:215], v[80:83]
    s_cmp_eq_u32 s42, 86016
    s_cselect_b32 s42, 0, s42
    v_mfma_f32_16x16x32_bf16 v[80:83], v[104:107], a[216:219], v[80:83]
    ds_read_b128 a[168:171], v2 offset:256
    v_mfma_f32_16x16x32_bf16 v[80:83], v[128:131], a[220:223], v[80:83]
    s_add_u32 m0, s42, s41
    v_mfma_f32_16x16x32_bf16 v[80:83], v[152:155], a[224:227], v[80:83]
    ds_read_b128 a[244:247], v14 offset:12544
    v_mfma_f32_16x16x32_bf16 v[80:83], v[176:179], a[228:231], v[80:83]
    v_cvt_pk_bf16_f32 v57, v58, v59
    v_mfma_f32_16x16x32_bf16 v[80:83], v[200:203], a[232:235], v[80:83]
    ds_write_b64 v12, v[56:57] offset:64
    v_mfma_f32_16x16x32_bf16 v[80:83], v[224:227], a[236:239], v[80:83]
    ds_read_b128 a[172:175], v3 offset:256
    v_mfma_f32_16x16x32_bf16 v[84:87], a[12:15], a[192:195], v[36:39]
    v_cvt_pk_bf16_f32 v60, v60, v61
    v_mfma_f32_16x16x32_bf16 v[84:87], a[36:39], a[196:199], v[84:87]
    s_waitcnt lgkmcnt(6)
    buffer_store_dwordx4 a[240:243], v16, s[24:27], s31 offen offset:0 sc0 sc1
    v_mfma_f32_16x16x32_bf16 v[84:87], a[60:63], a[200:203], v[84:87]
    v_cvt_pk_bf16_f32 v61, v62, v63
    v_mfma_f32_16x16x32_bf16 v[84:87], a[84:87], a[204:207], v[84:87]
    ds_write_b64 v12, v[60:61] offset:96
    v_mfma_f32_16x16x32_bf16 v[84:87], a[108:111], a[208:211], v[84:87]
    ds_read_b128 a[176:179], v0 offset:512
    v_mfma_f32_16x16x32_bf16 v[84:87], a[132:135], a[212:215], v[84:87]
    s_add_u32 s29, s29, 1
    v_mfma_f32_16x16x32_bf16 v[84:87], v[108:111], a[216:219], v[84:87]
    s_cmp_lt_u32 s29, s43
    s_cselect_b32 s14, s40, 0
    v_mfma_f32_16x16x32_bf16 v[84:87], v[132:135], a[220:223], v[84:87]
    ds_read_b128 a[248:251], v15 offset:12544
    v_mfma_f32_16x16x32_bf16 v[84:87], v[156:159], a[224:227], v[84:87]
    v_cvt_pk_bf16_f32 v64, v64, v65
    v_mfma_f32_16x16x32_bf16 v[84:87], v[180:183], a[228:231], v[84:87]
    ds_read_b128 a[180:183], v1 offset:512
    v_mfma_f32_16x16x32_bf16 v[84:87], v[204:207], a[232:235], v[84:87]
    v_cvt_pk_bf16_f32 v65, v66, v67
    v_mfma_f32_16x16x32_bf16 v[84:87], v[228:231], a[236:239], v[84:87]
    ds_write_b64 v12, v[64:65] offset:128
    v_mfma_f32_16x16x32_bf16 v[88:91], a[16:19], a[192:195], v[40:43]
    v_cvt_pk_bf16_f32 v68, v68, v69
    v_mfma_f32_16x16x32_bf16 v[88:91], a[40:43], a[196:199], v[88:91]
    s_waitcnt lgkmcnt(7)
    buffer_store_dwordx4 a[244:247], v16, s[24:27], s31 offen offset:1024 sc0 sc1
    v_mfma_f32_16x16x32_bf16 v[88:91], a[64:67], a[200:203], v[88:91]
    ds_read_b128 a[184:187], v2 offset:512
    v_mfma_f32_16x16x32_bf16 v[88:91], a[88:91], a[204:207], v[88:91]
    v_cvt_pk_bf16_f32 v69, v70, v71
    v_mfma_f32_16x16x32_bf16 v[88:91], a[112:115], a[208:211], v[88:91]
    ds_write_b64 v12, v[68:69] offset:160
    v_mfma_f32_16x16x32_bf16 v[88:91], a[136:139], a[212:215], v[88:91]
    v_add_u32 v0, s33, v0
    v_mfma_f32_16x16x32_bf16 v[88:91], v[112:115], a[216:219], v[88:91]
    v_add_u32 v1, s33, v1
    v_mfma_f32_16x16x32_bf16 v[88:91], v[136:139], a[220:223], v[88:91]
    ds_read_b128 a[188:191], v3 offset:512
    v_mfma_f32_16x16x32_bf16 v[88:91], v[160:163], a[224:227], v[88:91]
    v_add_u32 v2, s33, v2
    v_mfma_f32_16x16x32_bf16 v[88:91], v[184:187], a[228:231], v[88:91]
    v_add_u32 v3, s33, v3
    v_mfma_f32_16x16x32_bf16 v[88:91], v[208:211], a[232:235], v[88:91]
    v_mfma_f32_16x16x32_bf16 v[88:91], v[232:235], a[236:239], v[88:91]
    v_mfma_f32_16x16x32_bf16 v[92:95], a[20:23], a[192:195], v[44:47]
    v_mfma_f32_16x16x32_bf16 v[92:95], a[44:47], a[196:199], v[92:95]
    s_waitcnt lgkmcnt(5)
    buffer_store_dwordx4 a[248:251], v16, s[24:27], s31 offen offset:2048 sc0 sc1
    v_mfma_f32_16x16x32_bf16 v[92:95], a[68:71], a[200:203], v[92:95]
    v_mfma_f32_16x16x32_bf16 v[92:95], a[92:95], a[204:207], v[92:95]
    v_mfma_f32_16x16x32_bf16 v[92:95], a[116:119], a[208:211], v[92:95]
    v_mfma_f32_16x16x32_bf16 v[92:95], a[140:143], a[212:215], v[92:95]
    v_mfma_f32_16x16x32_bf16 v[92:95], v[116:119], a[216:219], v[92:95]
    v_mfma_f32_16x16x32_bf16 v[92:95], v[140:143], a[220:223], v[92:95]
    v_mfma_f32_16x16x32_bf16 v[92:95], v[164:167], a[224:227], v[92:95]
    v_mfma_f32_16x16x32_bf16 v[92:95], v[188:191], a[228:231], v[92:95]
    v_mfma_f32_16x16x32_bf16 v[92:95], v[212:215], a[232:235], v[92:95]
    v_mfma_f32_16x16x32_bf16 v[92:95], v[236:239], a[236:239], v[92:95]
    s_cmp_lt_u32 s29, s37
    s_cbranch_scc1 L_loop0
L_drain1:
    s_waitcnt lgkmcnt(0)
    s_barrier
    s_add_u32 s31, s31, 393216
    s_nop 4
    ds_read_b128 a[240:243], v13 offset:0
    ds_read_b128 a[244:247], v14 offset:0
    ds_read_b128 a[248:251], v15 offset:0
    v_cvt_pk_bf16_f32 v72, v72, v73
    v_cvt_pk_bf16_f32 v73, v74, v75
    ds_write_b64 v12, v[72:73] offset:12544
    v_cvt_pk_bf16_f32 v76, v76, v77
    v_cvt_pk_bf16_f32 v77, v78, v79
    ds_write_b64 v12, v[76:77] offset:12576
    v_cvt_pk_bf16_f32 v80, v80, v81
    v_cvt_pk_bf16_f32 v81, v82, v83
    ds_write_b64 v12, v[80:81] offset:12608
    v_cvt_pk_bf16_f32 v84, v84, v85
    v_cvt_pk_bf16_f32 v85, v86, v87
    ds_write_b64 v12, v[84:85] offset:12640
    v_cvt_pk_bf16_f32 v88, v88, v89
    v_cvt_pk_bf16_f32 v89, v90, v91
    ds_write_b64 v12, v[88:89] offset:12672
    v_cvt_pk_bf16_f32 v92, v92, v93
    v_cvt_pk_bf16_f32 v93, v94, v95
    ds_write_b64 v12, v[92:93] offset:12704
    s_waitcnt lgkmcnt(8)
    buffer_store_dwordx4 a[240:243], v16, s[24:27], s31 offen offset:0 sc0 sc1
    s_waitcnt lgkmcnt(7)
    buffer_store_dwordx4 a[244:247], v16, s[24:27], s31 offen offset:1024 sc0 sc1
    s_waitcnt lgkmcnt(6)
    buffer_store_dwordx4 a[248:251], v16, s[24:27], s31 offen offset:2048 sc0 sc1
    s_add_u32 s31, s31, 393216
    s_waitcnt lgkmcnt(0)
    s_barrier
    ds_read_b128 a[144:147], v13 offset:12544
    ds_read_b128 a[148:151], v14 offset:12544
    ds_read_b128 a[152:155], v15 offset:12544
    s_waitcnt lgkmcnt(2)
    buffer_store_dwordx4 a[144:147], v16, s[24:27], s31 offen offset:0 sc0 sc1
    s_waitcnt lgkmcnt(1)
    buffer_store_dwordx4 a[148:151], v16, s[24:27], s31 offen offset:1024 sc0 sc1
    s_waitcnt lgkmcnt(0)
    buffer_store_dwordx4 a[152:155], v16, s[24:27], s31 offen offset:2048 sc0 sc1
    s_branch L_end
L_drain0:
    s_waitcnt lgkmcnt(0)
    s_barrier
    s_add_u32 s31, s31, 393216
    s_nop 4
    ds_read_b128 a[240:243], v13 offset:12544
    ds_read_b128 a[244:247], v14 offset:12544
    ds_read_b128 a[248:251], v15 offset:12544
    v_cvt_pk_bf16_f32 v48, v48, v49
    v_cvt_pk_bf16_f32 v49, v50, v51
    ds_write_b64 v12, v[48:49] offset:0
    v_cvt_pk_bf16_f32 v52, v52, v53
    v_cvt_pk_bf16_f32 v53, v54, v55
    ds_write_b64 v12, v[52:53] offset:32
    v_cvt_pk_bf16_f32 v56, v56, v57
    v_cvt_pk_bf16_f32 v57, v58, v59
    ds_write_b64 v12, v[56:57] offset:64
    v_cvt_pk_bf16_f32 v60, v60, v61
    v_cvt_pk_bf16_f32 v61, v62, v63
    ds_write_b64 v12, v[60:61] offset:96
    v_cvt_pk_bf16_f32 v64, v64, v65
    v_cvt_pk_bf16_f32 v65, v66, v67
    ds_write_b64 v12, v[64:65] offset:128
    v_cvt_pk_bf16_f32 v68, v68, v69
    v_cvt_pk_bf16_f32 v69, v70, v71
    ds_write_b64 v12, v[68:69] offset:160
    s_waitcnt lgkmcnt(8)
    buffer_store_dwordx4 a[240:243], v16, s[24:27], s31 offen offset:0 sc0 sc1
    s_waitcnt lgkmcnt(7)
    buffer_store_dwordx4 a[244:247], v16, s[24:27], s31 offen offset:1024 sc0 sc1
    s_waitcnt lgkmcnt(6)
    buffer_store_dwordx4 a[248:251], v16, s[24:27], s31 offen offset:2048 sc0 sc1
    s_add_u32 s31, s31, 393216
    s_waitcnt lgkmcnt(0)
    s_barrier
    ds_read_b128 a[144:147], v13 offset:0
    ds_read_b128 a[148:151], v14 offset:0
    ds_read_b128 a[152:155], v15 offset:0
    s_waitcnt lgkmcnt(2)
    buffer_store_dwordx4 a[144:147], v16, s[24:27], s31 offen offset:0 sc0 sc1
    s_waitcnt lgkmcnt(1)
    buffer_store_dwordx4 a[148:151], v16, s[24:27], s31 offen offset:1024 sc0 sc1
    s_waitcnt lgkmcnt(0)
    buffer_store_dwordx4 a[152:155], v16, s[24:27], s31 offen offset:2048 sc0 sc1
L_end:
L_done:
    s_endpgm
.section .rodata,"a"
.p2align 6
.amdhsa_kernel standalone__standard_2d_1d_3d_conv__vision_kernel
  .amdhsa_next_free_vgpr 512
  .amdhsa_next_free_sgpr 96
  .amdhsa_accum_offset 256
  .amdhsa_group_segment_fixed_size 0
  .amdhsa_kernarg_size 48
  .amdhsa_user_sgpr_count 2
  .amdhsa_user_sgpr_kernarg_segment_ptr 1
  .amdhsa_system_sgpr_workgroup_id_x 1
.end_amdhsa_kernel
```

```asm
; @launch grid=(256,1,1) block=(256,1,1) lds=159744
.amdgcn_target "amdgcn-amd-amdhsa--gfx950"
.text
.globl standalone__standard_2d_1d_3d_conv__vision_kernel
.p2align 8
.type standalone__standard_2d_1d_3d_conv__vision_kernel,@function
standalone__standard_2d_1d_3d_conv__vision_kernel:
    s_load_dwordx8 s[4:11], s[0:1], 0
    s_cmp_ge_u32 s2, 256
    s_cbranch_scc1 L_done
    v_lshrrev_b32 v18, 6, v0
    v_and_b32 v19, 63, v0
    v_readfirstlane_b32 s28, v18
    s_lshr_b32 s39, s2, 3
    s_and_b32 s39, s39, 31
    s_lshl_b32 s39, s39, 8
    v_add_u32 v255, s39, v0
    v_mul_u32_u24 v255, 36, v255
    v_and_b32 v20, 15, v0
    v_bfe_u32 v21, v0, 4, 2
    v_mul_u32_u24 v22, 3072, v18
    v_add_u32 v23, 16, v19
    v_lshrrev_b32 v23, 6, v23
    v_lshl_add_u32 v23, v18, 2, v23
    v_xor_b32 v23, v23, v19
    v_lshl_add_u32 v4, v23, 4, v22
    v_lshrrev_b32 v23, 5, v19
    v_add_u32 v23, 1, v23
    v_lshl_add_u32 v23, v18, 2, v23
    v_xor_b32 v23, v23, v19
    v_lshl_add_u32 v5, v23, 4, v22
    v_add_u32 v23, 48, v19
    v_lshrrev_b32 v23, 6, v23
    v_add_u32 v23, 2, v23
    v_lshl_add_u32 v23, v18, 2, v23
    v_xor_b32 v23, v23, v19
    v_lshl_add_u32 v6, v23, 4, v22
    s_and_b32 s39, s2, 7
    s_mul_i32 s39, s39, 1152
    s_bitcmp1_b32 s2, 0
    s_cselect_b32 s38, 32, 0
    s_add_u32 s39, s39, s38
    s_lshr_b32 s30, s2, 3
    s_add_u32 s30, s30, s39
    s_mul_i32 s30, s30, 12288
    s_sub_u32 s31, s30, 393216
    s_mul_i32 s41, s28, 3072
    s_mov_b32 s42, 0
    s_mov_b32 s14, 113246208
    s_mov_b32 s15, 0x20000
    s_mov_b32 s18, 294912
    s_mov_b32 s19, 0x20000
    s_waitcnt lgkmcnt(0)
    s_mov_b32 s12, s4
    s_and_b32 s13, s5, 0xffff
    s_mov_b32 s16, s6
    s_and_b32 s17, s7, 0xffff
L_g0:
    buffer_load_dword v254, v255, s[16:19], 0 offen
    s_add_u32 m0, s42, s41
    s_add_u32 s42, s42, 12288
    buffer_load_dwordx4 v4, s[12:15], s30 offen offset:0 nt lds
    buffer_load_dwordx4 v5, s[12:15], s30 offen offset:1024 nt lds
    buffer_load_dwordx4 v6, s[12:15], s30 offen offset:2048 nt lds
    s_add_u32 s30, s30, 393216
    s_add_u32 m0, s42, s41
    s_add_u32 s42, s42, 12288
    buffer_load_dwordx4 v4, s[12:15], s30 offen offset:0 nt lds
    buffer_load_dwordx4 v5, s[12:15], s30 offen offset:1024 nt lds
    buffer_load_dwordx4 v6, s[12:15], s30 offen offset:2048 nt lds
    s_add_u32 s30, s30, 393216
    s_mul_i32 s32, s28, 6144
    s_bitcmp1_b32 s2, 0
    s_mov_b32 s37, 37
    s_cselect_b32 s37, 35, s37
    s_sub_u32 s43, s37, 3
    v_mul_u32_u24 v22, 192, v18
    v_add_u32 v240, 0, v19
    v_mul_u32_u24 v241, 171, v240
    v_lshrrev_b32 v241, 11, v241
    v_mul_u32_u24 v242, 12, v241
    v_sub_u32 v240, v240, v242
    v_bfe_u32 v242, v241, 3, 1
    v_lshlrev_b32 v242, 1, v242
    v_xor_b32 v240, v240, v242
    v_lshl_add_u32 v240, v240, 4, v22
    v_mul_u32_u24 v241, 768, v241
    v_add_u32 v240, v240, v241
    v_subrev_u32 v7, 0, v240
    v_add_u32 v240, 64, v19
    v_mul_u32_u24 v241, 171, v240
    v_lshrrev_b32 v241, 11, v241
    v_mul_u32_u24 v242, 12, v241
    v_sub_u32 v240, v240, v242
    v_bfe_u32 v242, v241, 3, 1
    v_lshlrev_b32 v242, 1, v242
    v_xor_b32 v240, v240, v242
    v_lshl_add_u32 v240, v240, 4, v22
    v_mul_u32_u24 v241, 768, v241
    v_add_u32 v240, v240, v241
    v_subrev_u32 v8, 1024, v240
    v_add_u32 v240, 128, v19
    v_mul_u32_u24 v241, 171, v240
    v_lshrrev_b32 v241, 11, v241
    v_mul_u32_u24 v242, 12, v241
    v_sub_u32 v240, v240, v242
    v_bfe_u32 v242, v241, 3, 1
    v_lshlrev_b32 v242, 1, v242
    v_xor_b32 v240, v240, v242
    v_lshl_add_u32 v240, v240, 4, v22
    v_mul_u32_u24 v241, 768, v241
    v_add_u32 v240, v240, v241
    v_subrev_u32 v9, 2048, v240
    s_mov_b32 s24, s10
    s_and_b32 s25, s11, 0xffff
    s_mov_b32 s26, 0
    s_mov_b32 s27, 0x20000
    s_add_u32 m0, s32, 86016
    s_mov_b32 s35, 0
    buffer_load_dwordx4 v7, s[16:19], s35 offen offset:0 lds
    buffer_load_dwordx4 v8, s[16:19], s35 offen offset:1024 lds
    buffer_load_dwordx4 v9, s[16:19], s35 offen offset:2048 lds
    s_add_u32 m0, s32, 89088
    s_mov_b32 s35, 12288
    buffer_load_dwordx4 v7, s[16:19], s35 offen offset:0 lds
    buffer_load_dwordx4 v8, s[16:19], s35 offen offset:1024 lds
    buffer_load_dwordx4 v9, s[16:19], s35 offen offset:2048 lds
    v_mul_u32_u24 v22, 192, v18
    v_lshl_add_u32 v17, v21, 3, v22
    s_mov_b32 s20, s8
    s_and_b32 s21, s9, 0xffff
    s_mov_b32 s22, 768
    s_mov_b32 s23, 0x20000
    buffer_load_dwordx2 a[240:241], v17, s[20:23], 0 offen offset:0
    buffer_load_dwordx2 a[242:243], v17, s[20:23], 0 offen offset:32
    buffer_load_dwordx2 a[244:245], v17, s[20:23], 0 offen offset:64
    buffer_load_dwordx2 a[246:247], v17, s[20:23], 0 offen offset:96
    buffer_load_dwordx2 a[248:249], v17, s[20:23], 0 offen offset:128
    buffer_load_dwordx2 a[250:251], v17, s[20:23], 0 offen offset:160
    v_mul_u32_u24 v22, 768, v20
    v_add_u32 v23, 0, v21
    v_xor_b32 v23, v23, v20
    v_lshl_add_u32 v0, v23, 4, v22
    v_add_u32 v23, 4, v21
    v_xor_b32 v23, v23, v20
    v_lshl_add_u32 v1, v23, 4, v22
    v_add_u32 v23, 8, v21
    v_xor_b32 v23, v23, v20
    v_lshl_add_u32 v2, v23, 4, v22
    v_add_u32 v23, 12, v21
    v_xor_b32 v23, v23, v20
    v_lshl_add_u32 v3, v23, 4, v22
    v_lshrrev_b32 v22, 2, v20
    v_lshl_add_u32 v22, v21, 3, v22
    v_mul_u32_u24 v22, 192, v22
    v_and_b32 v23, 3, v20
    v_lshl_add_u32 v22, v23, 3, v22
    v_mul_u32_u24 v23, 6144, v18
    v_add_u32 v22, v22, v23
    v_add_u32 v22, 61440, v22
    v_and_b32 v23, 1, v21
    v_lshlrev_b32 v23, 5, v23
    v_add_u32 v10, v22, v23
    v_sub_u32 v11, v22, v23
    v_add_u32 v252, 49152, v10
    v_add_u32 v253, 49152, v11
    v_mul_u32_u24 v12, 784, v20
    v_add_u32 v12, v12, v17
    v_add_u32 v12, 86016, v12
    v_mul_u32_u24 v16, 3072, v18
    v_lshl_add_u32 v16, v19, 4, v16
    v_mul_u32_u24 v22, 3136, v18
    v_add_u32 v22, 86016, v22
    v_add_u32 v23, 16, v19
    v_lshrrev_b32 v23, 6, v23
    v_add_u32 v23, v23, v19
    v_lshl_add_u32 v23, v23, 4, v22
    v_add_u32 v13, 0, v23
    v_lshrrev_b32 v23, 5, v19
    v_add_u32 v23, 1, v23
    v_add_u32 v23, v23, v19
    v_lshl_add_u32 v23, v23, 4, v22
    v_add_u32 v14, 1024, v23
    v_add_u32 v23, 48, v19
    v_lshrrev_b32 v23, 6, v23
    v_add_u32 v23, 2, v23
    v_add_u32 v23, v23, v19
    v_lshl_add_u32 v23, v23, 4, v22
    v_add_u32 v15, 2048, v23
    s_mov_b32 s40, 113246208
    s_add_u32 m0, s32, 110592
    s_mov_b32 s35, 24576
    buffer_load_dwordx4 v7, s[16:19], s35 offen offset:0 lds
    buffer_load_dwordx4 v8, s[16:19], s35 offen offset:1024 lds
    buffer_load_dwordx4 v9, s[16:19], s35 offen offset:2048 lds
    s_add_u32 m0, s32, 113664
    s_mov_b32 s35, 36864
    buffer_load_dwordx4 v7, s[16:19], s35 offen offset:0 lds
    buffer_load_dwordx4 v8, s[16:19], s35 offen offset:1024 lds
    buffer_load_dwordx4 v9, s[16:19], s35 offen offset:2048 lds
    s_add_u32 m0, s32, 135168
    s_mov_b32 s35, 49152
    buffer_load_dwordx4 v7, s[16:19], s35 offen offset:0 lds
    buffer_load_dwordx4 v8, s[16:19], s35 offen offset:1024 lds
    buffer_load_dwordx4 v9, s[16:19], s35 offen offset:2048 lds
    s_add_u32 m0, s32, 138240
    s_mov_b32 s35, 61440
    buffer_load_dwordx4 v7, s[16:19], s35 offen offset:0 lds
    buffer_load_dwordx4 v8, s[16:19], s35 offen offset:1024 lds
    buffer_load_dwordx4 v9, s[16:19], s35 offen offset:2048 lds
    s_add_u32 m0, s32, 61440
    s_mov_b32 s35, 73728
    buffer_load_dwordx4 v7, s[16:19], s35 offen offset:0 lds
    buffer_load_dwordx4 v8, s[16:19], s35 offen offset:1024 lds
    buffer_load_dwordx4 v9, s[16:19], s35 offen offset:2048 lds
    s_add_u32 m0, s32, 64512
    s_mov_b32 s35, 86016
    buffer_load_dwordx4 v7, s[16:19], s35 offen offset:0 lds
    buffer_load_dwordx4 v8, s[16:19], s35 offen offset:1024 lds
    buffer_load_dwordx4 v9, s[16:19], s35 offen offset:2048 lds
    s_waitcnt vmcnt(30)
    s_barrier
    ds_read_b128 a[144:147], v0 offset:0
    ds_read_b128 a[192:195], v0 offset:12288
    s_waitcnt vmcnt(24)
    ds_read_b64_tr_b16 a[0:1], v10 offset:24576
    ds_read_b64_tr_b16 a[2:3], v10 offset:25344
    ds_read_b64_tr_b16 a[4:5], v11 offset:24608
    ds_read_b64_tr_b16 a[6:7], v11 offset:25376
    ds_read_b64_tr_b16 a[8:9], v10 offset:24640
    ds_read_b64_tr_b16 a[10:11], v10 offset:25408
    ds_read_b64_tr_b16 a[12:13], v11 offset:24672
    ds_read_b64_tr_b16 a[14:15], v11 offset:25440
    ds_read_b64_tr_b16 a[16:17], v10 offset:24704
    ds_read_b64_tr_b16 a[18:19], v10 offset:25472
    ds_read_b64_tr_b16 a[20:21], v11 offset:24736
    ds_read_b64_tr_b16 a[22:23], v11 offset:25504
    s_waitcnt vmcnt(18)
    v_accvgpr_read_b32 v240, a240
    v_accvgpr_read_b32 v241, a241
    v_accvgpr_read_b32 v242, a242
    v_accvgpr_read_b32 v243, a243
    v_accvgpr_read_b32 v244, a244
    v_accvgpr_read_b32 v245, a245
    v_accvgpr_read_b32 v246, a246
    v_accvgpr_read_b32 v247, a247
    v_accvgpr_read_b32 v248, a248
    v_accvgpr_read_b32 v249, a249
    v_accvgpr_read_b32 v250, a250
    v_accvgpr_read_b32 v251, a251
    v_lshlrev_b32 v24, 16, v240
    v_and_b32 v25, 0xffff0000, v240
    v_lshlrev_b32 v26, 16, v241
    v_and_b32 v27, 0xffff0000, v241
    v_lshlrev_b32 v28, 16, v242
    v_and_b32 v29, 0xffff0000, v242
    v_lshlrev_b32 v30, 16, v243
    v_and_b32 v31, 0xffff0000, v243
    v_lshlrev_b32 v32, 16, v244
    v_and_b32 v33, 0xffff0000, v244
    v_lshlrev_b32 v34, 16, v245
    v_and_b32 v35, 0xffff0000, v245
    v_lshlrev_b32 v36, 16, v246
    v_and_b32 v37, 0xffff0000, v246
    v_lshlrev_b32 v38, 16, v247
    v_and_b32 v39, 0xffff0000, v247
    v_lshlrev_b32 v40, 16, v248
    v_and_b32 v41, 0xffff0000, v248
    v_lshlrev_b32 v42, 16, v249
    v_and_b32 v43, 0xffff0000, v249
    v_lshlrev_b32 v44, 16, v250
    v_and_b32 v45, 0xffff0000, v250
    v_lshlrev_b32 v46, 16, v251
    v_and_b32 v47, 0xffff0000, v251
    s_waitcnt lgkmcnt(0)
    s_waitcnt vmcnt(12)
    v_mfma_f32_16x16x32_bf16 v[48:51], a[0:3], a[144:147], v[24:27]
    ds_read_b128 a[148:151], v1 offset:0
    ds_read_b128 a[196:199], v1 offset:12288
    s_add_u32 m0, s32, 86016
    s_mov_b32 s35, 98304
    buffer_load_dwordx4 v7, s[16:19], s35 offen offset:0 lds
    v_mfma_f32_16x16x32_bf16 v[52:55], a[4:7], a[144:147], v[28:31]
    ds_read_b64_tr_b16 a[24:25], v252 offset:0
    ds_read_b64_tr_b16 a[26:27], v252 offset:768
    v_mfma_f32_16x16x32_bf16 v[56:59], a[8:11], a[144:147], v[32:35]
    ds_read_b64_tr_b16 a[28:29], v253 offset:32
    ds_read_b64_tr_b16 a[30:31], v253 offset:800
    buffer_load_dwordx4 v8, s[16:19], s35 offen offset:1024 lds
    v_mfma_f32_16x16x32_bf16 v[60:63], a[12:15], a[144:147], v[36:39]
    ds_read_b64_tr_b16 a[32:33], v252 offset:64
    ds_read_b64_tr_b16 a[34:35], v252 offset:832
    v_mfma_f32_16x16x32_bf16 v[64:67], a[16:19], a[144:147], v[40:43]
    ds_read_b64_tr_b16 a[36:37], v253 offset:96
    ds_read_b64_tr_b16 a[38:39], v253 offset:864
    buffer_load_dwordx4 v9, s[16:19], s35 offen offset:2048 lds
    v_mfma_f32_16x16x32_bf16 v[68:71], a[20:23], a[144:147], v[44:47]
    ds_read_b64_tr_b16 a[40:41], v252 offset:128
    ds_read_b64_tr_b16 a[42:43], v252 offset:896
    v_mfma_f32_16x16x32_bf16 v[72:75], a[0:3], a[192:195], v[24:27]
    ds_read_b64_tr_b16 a[44:45], v253 offset:160
    ds_read_b64_tr_b16 a[46:47], v253 offset:928
    s_add_u32 m0, s32, 89088
    s_mov_b32 s35, 110592
    buffer_load_dwordx4 v7, s[16:19], s35 offen offset:0 lds
    v_mfma_f32_16x16x32_bf16 v[76:79], a[4:7], a[192:195], v[28:31]
    v_mfma_f32_16x16x32_bf16 v[80:83], a[8:11], a[192:195], v[32:35]
    buffer_load_dwordx4 v8, s[16:19], s35 offen offset:1024 lds
    v_mfma_f32_16x16x32_bf16 v[84:87], a[12:15], a[192:195], v[36:39]
    v_mfma_f32_16x16x32_bf16 v[88:91], a[16:19], a[192:195], v[40:43]
    buffer_load_dwordx4 v9, s[16:19], s35 offen offset:2048 lds
    v_mfma_f32_16x16x32_bf16 v[92:95], a[20:23], a[192:195], v[44:47]
    s_waitcnt lgkmcnt(0)
    s_waitcnt vmcnt(12)
    v_mfma_f32_16x16x32_bf16 v[48:51], a[24:27], a[148:151], v[48:51]
    ds_read_b128 a[152:155], v2 offset:0
    ds_read_b128 a[200:203], v2 offset:12288
    s_add_u32 m0, s32, 110592
    s_mov_b32 s35, 122880
    buffer_load_dwordx4 v7, s[16:19], s35 offen offset:0 lds
    v_mfma_f32_16x16x32_bf16 v[52:55], a[28:31], a[148:151], v[52:55]
    ds_read_b64_tr_b16 a[48:49], v252 offset:24576
    ds_read_b64_tr_b16 a[50:51], v252 offset:25344
    v_mfma_f32_16x16x32_bf16 v[56:59], a[32:35], a[148:151], v[56:59]
    ds_read_b64_tr_b16 a[52:53], v253 offset:24608
    ds_read_b64_tr_b16 a[54:55], v253 offset:25376
    buffer_load_dwordx4 v8, s[16:19], s35 offen offset:1024 lds
    v_mfma_f32_16x16x32_bf16 v[60:63], a[36:39], a[148:151], v[60:63]
    ds_read_b64_tr_b16 a[56:57], v252 offset:24640
    ds_read_b64_tr_b16 a[58:59], v252 offset:25408
    v_mfma_f32_16x16x32_bf16 v[64:67], a[40:43], a[148:151], v[64:67]
    ds_read_b64_tr_b16 a[60:61], v253 offset:24672
    ds_read_b64_tr_b16 a[62:63], v253 offset:25440
    buffer_load_dwordx4 v9, s[16:19], s35 offen offset:2048 lds
    v_mfma_f32_16x16x32_bf16 v[68:71], a[44:47], a[148:151], v[68:71]
    ds_read_b64_tr_b16 a[64:65], v252 offset:24704
    ds_read_b64_tr_b16 a[66:67], v252 offset:25472
    v_mfma_f32_16x16x32_bf16 v[72:75], a[24:27], a[196:199], v[72:75]
    ds_read_b64_tr_b16 a[68:69], v253 offset:24736
    ds_read_b64_tr_b16 a[70:71], v253 offset:25504
    s_add_u32 m0, s32, 113664
    s_mov_b32 s35, 135168
    buffer_load_dwordx4 v7, s[16:19], s35 offen offset:0 lds
    v_mfma_f32_16x16x32_bf16 v[76:79], a[28:31], a[196:199], v[76:79]
    v_mfma_f32_16x16x32_bf16 v[80:83], a[32:35], a[196:199], v[80:83]
    buffer_load_dwordx4 v8, s[16:19], s35 offen offset:1024 lds
    v_mfma_f32_16x16x32_bf16 v[84:87], a[36:39], a[196:199], v[84:87]
    v_mfma_f32_16x16x32_bf16 v[88:91], a[40:43], a[196:199], v[88:91]
    buffer_load_dwordx4 v9, s[16:19], s35 offen offset:2048 lds
    v_mfma_f32_16x16x32_bf16 v[92:95], a[44:47], a[196:199], v[92:95]
    s_waitcnt lgkmcnt(0)
    s_waitcnt vmcnt(12)
    v_mfma_f32_16x16x32_bf16 v[48:51], a[48:51], a[152:155], v[48:51]
    ds_read_b128 a[156:159], v3 offset:0
    ds_read_b128 a[204:207], v3 offset:12288
    s_add_u32 m0, s32, 135168
    s_mov_b32 s35, 147456
    buffer_load_dwordx4 v7, s[16:19], s35 offen offset:0 lds
    v_mfma_f32_16x16x32_bf16 v[52:55], a[52:55], a[152:155], v[52:55]
    ds_read_b64_tr_b16 a[72:73], v10 offset:0
    ds_read_b64_tr_b16 a[74:75], v10 offset:768
    v_mfma_f32_16x16x32_bf16 v[56:59], a[56:59], a[152:155], v[56:59]
    ds_read_b64_tr_b16 a[76:77], v11 offset:32
    ds_read_b64_tr_b16 a[78:79], v11 offset:800
    buffer_load_dwordx4 v8, s[16:19], s35 offen offset:1024 lds
    v_mfma_f32_16x16x32_bf16 v[60:63], a[60:63], a[152:155], v[60:63]
    ds_read_b64_tr_b16 a[80:81], v10 offset:64
    ds_read_b64_tr_b16 a[82:83], v10 offset:832
    v_mfma_f32_16x16x32_bf16 v[64:67], a[64:67], a[152:155], v[64:67]
    ds_read_b64_tr_b16 a[84:85], v11 offset:96
    ds_read_b64_tr_b16 a[86:87], v11 offset:864
    buffer_load_dwordx4 v9, s[16:19], s35 offen offset:2048 lds
    v_mfma_f32_16x16x32_bf16 v[68:71], a[68:71], a[152:155], v[68:71]
    ds_read_b64_tr_b16 a[88:89], v10 offset:128
    ds_read_b64_tr_b16 a[90:91], v10 offset:896
    v_mfma_f32_16x16x32_bf16 v[72:75], a[48:51], a[200:203], v[72:75]
    ds_read_b64_tr_b16 a[92:93], v11 offset:160
    ds_read_b64_tr_b16 a[94:95], v11 offset:928
    s_add_u32 m0, s32, 138240
    s_mov_b32 s35, 159744
    buffer_load_dwordx4 v7, s[16:19], s35 offen offset:0 lds
    v_mfma_f32_16x16x32_bf16 v[76:79], a[52:55], a[200:203], v[76:79]
    v_mfma_f32_16x16x32_bf16 v[80:83], a[56:59], a[200:203], v[80:83]
    buffer_load_dwordx4 v8, s[16:19], s35 offen offset:1024 lds
    v_mfma_f32_16x16x32_bf16 v[84:87], a[60:63], a[200:203], v[84:87]
    v_mfma_f32_16x16x32_bf16 v[88:91], a[64:67], a[200:203], v[88:91]
    buffer_load_dwordx4 v9, s[16:19], s35 offen offset:2048 lds
    v_mfma_f32_16x16x32_bf16 v[92:95], a[68:71], a[200:203], v[92:95]
    s_waitcnt lgkmcnt(0)
    s_waitcnt vmcnt(12)
    v_mfma_f32_16x16x32_bf16 v[48:51], a[72:75], a[156:159], v[48:51]
    ds_read_b128 a[160:163], v0 offset:256
    ds_read_b128 a[208:211], v0 offset:12544
    s_add_u32 m0, s32, 61440
    s_mov_b32 s35, 172032
    buffer_load_dwordx4 v7, s[16:19], s35 offen offset:0 lds
    v_mfma_f32_16x16x32_bf16 v[52:55], a[76:79], a[156:159], v[52:55]
    ds_read_b64_tr_b16 a[96:97], v10 offset:24576
    ds_read_b64_tr_b16 a[98:99], v10 offset:25344
    v_mfma_f32_16x16x32_bf16 v[56:59], a[80:83], a[156:159], v[56:59]
    ds_read_b64_tr_b16 a[100:101], v11 offset:24608
    ds_read_b64_tr_b16 a[102:103], v11 offset:25376
    buffer_load_dwordx4 v8, s[16:19], s35 offen offset:1024 lds
    v_mfma_f32_16x16x32_bf16 v[60:63], a[84:87], a[156:159], v[60:63]
    ds_read_b64_tr_b16 a[104:105], v10 offset:24640
    ds_read_b64_tr_b16 a[106:107], v10 offset:25408
    v_mfma_f32_16x16x32_bf16 v[64:67], a[88:91], a[156:159], v[64:67]
    ds_read_b64_tr_b16 a[108:109], v11 offset:24672
    ds_read_b64_tr_b16 a[110:111], v11 offset:25440
    buffer_load_dwordx4 v9, s[16:19], s35 offen offset:2048 lds
    v_mfma_f32_16x16x32_bf16 v[68:71], a[92:95], a[156:159], v[68:71]
    ds_read_b64_tr_b16 a[112:113], v10 offset:24704
    ds_read_b64_tr_b16 a[114:115], v10 offset:25472
    v_mfma_f32_16x16x32_bf16 v[72:75], a[72:75], a[204:207], v[72:75]
    ds_read_b64_tr_b16 a[116:117], v11 offset:24736
    ds_read_b64_tr_b16 a[118:119], v11 offset:25504
    s_add_u32 m0, s32, 64512
    s_mov_b32 s35, 184320
    buffer_load_dwordx4 v7, s[16:19], s35 offen offset:0 lds
    v_mfma_f32_16x16x32_bf16 v[76:79], a[76:79], a[204:207], v[76:79]
    v_mfma_f32_16x16x32_bf16 v[80:83], a[80:83], a[204:207], v[80:83]
    buffer_load_dwordx4 v8, s[16:19], s35 offen offset:1024 lds
    v_mfma_f32_16x16x32_bf16 v[84:87], a[84:87], a[204:207], v[84:87]
    v_mfma_f32_16x16x32_bf16 v[88:91], a[88:91], a[204:207], v[88:91]
    buffer_load_dwordx4 v9, s[16:19], s35 offen offset:2048 lds
    v_mfma_f32_16x16x32_bf16 v[92:95], a[92:95], a[204:207], v[92:95]
    s_add_u32 m0, s42, s41
    s_add_u32 s42, s42, 12288
    buffer_load_dwordx4 v4, s[12:15], s30 offen offset:0 nt lds
    buffer_load_dwordx4 v5, s[12:15], s30 offen offset:1024 nt lds
    buffer_load_dwordx4 v6, s[12:15], s30 offen offset:2048 nt lds
    s_add_u32 s30, s30, 393216
    s_waitcnt lgkmcnt(0)
    s_waitcnt vmcnt(15)
    v_mfma_f32_16x16x32_bf16 v[48:51], a[96:99], a[160:163], v[48:51]
    ds_read_b128 a[164:167], v1 offset:256
    ds_read_b128 a[212:215], v1 offset:12544
    s_add_u32 m0, s32, 86016
    s_mov_b32 s35, 196608
    buffer_load_dwordx4 v7, s[16:19], s35 offen offset:0 lds
    v_mfma_f32_16x16x32_bf16 v[52:55], a[100:103], a[160:163], v[52:55]
    ds_read_b64_tr_b16 a[120:121], v252 offset:0
    ds_read_b64_tr_b16 a[122:123], v252 offset:768
    v_mfma_f32_16x16x32_bf16 v[56:59], a[104:107], a[160:163], v[56:59]
    ds_read_b64_tr_b16 a[124:125], v253 offset:32
    ds_read_b64_tr_b16 a[126:127], v253 offset:800
    buffer_load_dwordx4 v8, s[16:19], s35 offen offset:1024 lds
    v_mfma_f32_16x16x32_bf16 v[60:63], a[108:111], a[160:163], v[60:63]
    ds_read_b64_tr_b16 a[128:129], v252 offset:64
    ds_read_b64_tr_b16 a[130:131], v252 offset:832
    v_mfma_f32_16x16x32_bf16 v[64:67], a[112:115], a[160:163], v[64:67]
    ds_read_b64_tr_b16 a[132:133], v253 offset:96
    ds_read_b64_tr_b16 a[134:135], v253 offset:864
    buffer_load_dwordx4 v9, s[16:19], s35 offen offset:2048 lds
    v_mfma_f32_16x16x32_bf16 v[68:71], a[116:119], a[160:163], v[68:71]
    ds_read_b64_tr_b16 a[136:137], v252 offset:128
    ds_read_b64_tr_b16 a[138:139], v252 offset:896
    v_mfma_f32_16x16x32_bf16 v[72:75], a[96:99], a[208:211], v[72:75]
    ds_read_b64_tr_b16 a[140:141], v253 offset:160
    ds_read_b64_tr_b16 a[142:143], v253 offset:928
    s_add_u32 m0, s32, 89088
    s_mov_b32 s35, 208896
    buffer_load_dwordx4 v7, s[16:19], s35 offen offset:0 lds
    v_mfma_f32_16x16x32_bf16 v[76:79], a[100:103], a[208:211], v[76:79]
    v_mfma_f32_16x16x32_bf16 v[80:83], a[104:107], a[208:211], v[80:83]
    buffer_load_dwordx4 v8, s[16:19], s35 offen offset:1024 lds
    v_mfma_f32_16x16x32_bf16 v[84:87], a[108:111], a[208:211], v[84:87]
    v_mfma_f32_16x16x32_bf16 v[88:91], a[112:115], a[208:211], v[88:91]
    buffer_load_dwordx4 v9, s[16:19], s35 offen offset:2048 lds
    v_mfma_f32_16x16x32_bf16 v[92:95], a[116:119], a[208:211], v[92:95]
    s_waitcnt lgkmcnt(0)
    s_waitcnt vmcnt(15)
    v_mfma_f32_16x16x32_bf16 v[48:51], a[120:123], a[164:167], v[48:51]
    ds_read_b128 a[168:171], v2 offset:256
    ds_read_b128 a[216:219], v2 offset:12544
    s_add_u32 m0, s32, 110592
    s_mov_b32 s35, 221184
    buffer_load_dwordx4 v7, s[16:19], s35 offen offset:0 lds
    v_mfma_f32_16x16x32_bf16 v[52:55], a[124:127], a[164:167], v[52:55]
    ds_read_b64_tr_b16 v[96:97], v252 offset:24576
    ds_read_b64_tr_b16 v[98:99], v252 offset:25344
    v_mfma_f32_16x16x32_bf16 v[56:59], a[128:131], a[164:167], v[56:59]
    ds_read_b64_tr_b16 v[100:101], v253 offset:24608
    ds_read_b64_tr_b16 v[102:103], v253 offset:25376
    buffer_load_dwordx4 v8, s[16:19], s35 offen offset:1024 lds
    v_mfma_f32_16x16x32_bf16 v[60:63], a[132:135], a[164:167], v[60:63]
    ds_read_b64_tr_b16 v[104:105], v252 offset:24640
    ds_read_b64_tr_b16 v[106:107], v252 offset:25408
    v_mfma_f32_16x16x32_bf16 v[64:67], a[136:139], a[164:167], v[64:67]
    ds_read_b64_tr_b16 v[108:109], v253 offset:24672
    ds_read_b64_tr_b16 v[110:111], v253 offset:25440
    buffer_load_dwordx4 v9, s[16:19], s35 offen offset:2048 lds
    v_mfma_f32_16x16x32_bf16 v[68:71], a[140:143], a[164:167], v[68:71]
    ds_read_b64_tr_b16 v[112:113], v252 offset:24704
    ds_read_b64_tr_b16 v[114:115], v252 offset:25472
    v_mfma_f32_16x16x32_bf16 v[72:75], a[120:123], a[212:215], v[72:75]
    ds_read_b64_tr_b16 v[116:117], v253 offset:24736
    ds_read_b64_tr_b16 v[118:119], v253 offset:25504
    s_add_u32 m0, s32, 113664
    s_mov_b32 s35, 233472
    buffer_load_dwordx4 v7, s[16:19], s35 offen offset:0 lds
    v_mfma_f32_16x16x32_bf16 v[76:79], a[124:127], a[212:215], v[76:79]
    v_mfma_f32_16x16x32_bf16 v[80:83], a[128:131], a[212:215], v[80:83]
    buffer_load_dwordx4 v8, s[16:19], s35 offen offset:1024 lds
    v_mfma_f32_16x16x32_bf16 v[84:87], a[132:135], a[212:215], v[84:87]
    v_mfma_f32_16x16x32_bf16 v[88:91], a[136:139], a[212:215], v[88:91]
    buffer_load_dwordx4 v9, s[16:19], s35 offen offset:2048 lds
    v_mfma_f32_16x16x32_bf16 v[92:95], a[140:143], a[212:215], v[92:95]
    s_waitcnt lgkmcnt(0)
    s_waitcnt vmcnt(15)
    v_mfma_f32_16x16x32_bf16 v[48:51], v[96:99], a[168:171], v[48:51]
    ds_read_b128 a[172:175], v3 offset:256
    ds_read_b128 a[220:223], v3 offset:12544
    s_add_u32 m0, s32, 135168
    s_mov_b32 s35, 245760
    buffer_load_dwordx4 v7, s[16:19], s35 offen offset:0 lds
    v_mfma_f32_16x16x32_bf16 v[52:55], v[100:103], a[168:171], v[52:55]
    ds_read_b64_tr_b16 v[120:121], v10 offset:0
    ds_read_b64_tr_b16 v[122:123], v10 offset:768
    v_mfma_f32_16x16x32_bf16 v[56:59], v[104:107], a[168:171], v[56:59]
    ds_read_b64_tr_b16 v[124:125], v11 offset:32
    ds_read_b64_tr_b16 v[126:127], v11 offset:800
    buffer_load_dwordx4 v8, s[16:19], s35 offen offset:1024 lds
    v_mfma_f32_16x16x32_bf16 v[60:63], v[108:111], a[168:171], v[60:63]
    ds_read_b64_tr_b16 v[128:129], v10 offset:64
    ds_read_b64_tr_b16 v[130:131], v10 offset:832
    v_mfma_f32_16x16x32_bf16 v[64:67], v[112:115], a[168:171], v[64:67]
    ds_read_b64_tr_b16 v[132:133], v11 offset:96
    ds_read_b64_tr_b16 v[134:135], v11 offset:864
    buffer_load_dwordx4 v9, s[16:19], s35 offen offset:2048 lds
    v_mfma_f32_16x16x32_bf16 v[68:71], v[116:119], a[168:171], v[68:71]
    ds_read_b64_tr_b16 v[136:137], v10 offset:128
    ds_read_b64_tr_b16 v[138:139], v10 offset:896
    v_mfma_f32_16x16x32_bf16 v[72:75], v[96:99], a[216:219], v[72:75]
    ds_read_b64_tr_b16 v[140:141], v11 offset:160
    ds_read_b64_tr_b16 v[142:143], v11 offset:928
    s_add_u32 m0, s32, 138240
    s_mov_b32 s35, 258048
    buffer_load_dwordx4 v7, s[16:19], s35 offen offset:0 lds
    v_mfma_f32_16x16x32_bf16 v[76:79], v[100:103], a[216:219], v[76:79]
    v_mfma_f32_16x16x32_bf16 v[80:83], v[104:107], a[216:219], v[80:83]
    buffer_load_dwordx4 v8, s[16:19], s35 offen offset:1024 lds
    v_mfma_f32_16x16x32_bf16 v[84:87], v[108:111], a[216:219], v[84:87]
    v_mfma_f32_16x16x32_bf16 v[88:91], v[112:115], a[216:219], v[88:91]
    buffer_load_dwordx4 v9, s[16:19], s35 offen offset:2048 lds
    v_mfma_f32_16x16x32_bf16 v[92:95], v[116:119], a[216:219], v[92:95]
    s_waitcnt lgkmcnt(0)
    s_waitcnt vmcnt(12)
    v_mfma_f32_16x16x32_bf16 v[48:51], v[120:123], a[172:175], v[48:51]
    ds_read_b128 a[176:179], v0 offset:512
    ds_read_b128 a[224:227], v0 offset:12800
    s_add_u32 m0, s32, 61440
    s_mov_b32 s35, 270336
    buffer_load_dwordx4 v7, s[16:19], s35 offen offset:0 lds
    v_mfma_f32_16x16x32_bf16 v[52:55], v[124:127], a[172:175], v[52:55]
    ds_read_b64_tr_b16 v[144:145], v10 offset:24576
    ds_read_b64_tr_b16 v[146:147], v10 offset:25344
    v_mfma_f32_16x16x32_bf16 v[56:59], v[128:131], a[172:175], v[56:59]
    ds_read_b64_tr_b16 v[148:149], v11 offset:24608
    ds_read_b64_tr_b16 v[150:151], v11 offset:25376
    buffer_load_dwordx4 v8, s[16:19], s35 offen offset:1024 lds
    v_mfma_f32_16x16x32_bf16 v[60:63], v[132:135], a[172:175], v[60:63]
    ds_read_b64_tr_b16 v[152:153], v10 offset:24640
    ds_read_b64_tr_b16 v[154:155], v10 offset:25408
    v_mfma_f32_16x16x32_bf16 v[64:67], v[136:139], a[172:175], v[64:67]
    ds_read_b64_tr_b16 v[156:157], v11 offset:24672
    ds_read_b64_tr_b16 v[158:159], v11 offset:25440
    buffer_load_dwordx4 v9, s[16:19], s35 offen offset:2048 lds
    v_mfma_f32_16x16x32_bf16 v[68:71], v[140:143], a[172:175], v[68:71]
    ds_read_b64_tr_b16 v[160:161], v10 offset:24704
    ds_read_b64_tr_b16 v[162:163], v10 offset:25472
    v_mfma_f32_16x16x32_bf16 v[72:75], v[120:123], a[220:223], v[72:75]
    ds_read_b64_tr_b16 v[164:165], v11 offset:24736
    ds_read_b64_tr_b16 v[166:167], v11 offset:25504
    s_add_u32 m0, s32, 64512
    s_mov_b32 s35, 282624
    buffer_load_dwordx4 v7, s[16:19], s35 offen offset:0 lds
    v_mfma_f32_16x16x32_bf16 v[76:79], v[124:127], a[220:223], v[76:79]
    v_mfma_f32_16x16x32_bf16 v[80:83], v[128:131], a[220:223], v[80:83]
    buffer_load_dwordx4 v8, s[16:19], s35 offen offset:1024 lds
    v_mfma_f32_16x16x32_bf16 v[84:87], v[132:135], a[220:223], v[84:87]
    v_mfma_f32_16x16x32_bf16 v[88:91], v[136:139], a[220:223], v[88:91]
    buffer_load_dwordx4 v9, s[16:19], s35 offen offset:2048 lds
    v_mfma_f32_16x16x32_bf16 v[92:95], v[140:143], a[220:223], v[92:95]
    s_waitcnt lgkmcnt(0)
    s_waitcnt vmcnt(12)
    v_mfma_f32_16x16x32_bf16 v[48:51], v[144:147], a[176:179], v[48:51]
    ds_read_b128 a[180:183], v1 offset:512
    ds_read_b128 a[228:231], v1 offset:12800
    s_add_u32 m0, s42, s41
    s_add_u32 s42, s42, 12288
    buffer_load_dwordx4 v4, s[12:15], s30 offen offset:0 nt lds
    buffer_load_dwordx4 v5, s[12:15], s30 offen offset:1024 nt lds
    buffer_load_dwordx4 v6, s[12:15], s30 offen offset:2048 nt lds
    buffer_store_dwordx4 a[240:243], v16, s[24:27], 0 offen offset:0 sc0 sc1
    buffer_store_dwordx4 a[244:247], v16, s[24:27], 0 offen offset:1024 sc0 sc1
    buffer_store_dwordx4 a[248:251], v16, s[24:27], 0 offen offset:2048 sc0 sc1
    s_add_u32 s30, s30, 393216
    v_mfma_f32_16x16x32_bf16 v[52:55], v[148:151], a[176:179], v[52:55]
    ds_read_b64_tr_b16 v[168:169], v252 offset:0
    ds_read_b64_tr_b16 v[170:171], v252 offset:768
    v_mfma_f32_16x16x32_bf16 v[56:59], v[152:155], a[176:179], v[56:59]
    ds_read_b64_tr_b16 v[172:173], v253 offset:32
    ds_read_b64_tr_b16 v[174:175], v253 offset:800
    v_mfma_f32_16x16x32_bf16 v[60:63], v[156:159], a[176:179], v[60:63]
    ds_read_b64_tr_b16 v[176:177], v252 offset:64
    ds_read_b64_tr_b16 v[178:179], v252 offset:832
    v_mfma_f32_16x16x32_bf16 v[64:67], v[160:163], a[176:179], v[64:67]
    ds_read_b64_tr_b16 v[180:181], v253 offset:96
    ds_read_b64_tr_b16 v[182:183], v253 offset:864
    v_mfma_f32_16x16x32_bf16 v[68:71], v[164:167], a[176:179], v[68:71]
    ds_read_b64_tr_b16 v[184:185], v252 offset:128
    ds_read_b64_tr_b16 v[186:187], v252 offset:896
    v_mfma_f32_16x16x32_bf16 v[72:75], v[144:147], a[224:227], v[72:75]
    ds_read_b64_tr_b16 v[188:189], v253 offset:160
    ds_read_b64_tr_b16 v[190:191], v253 offset:928
    v_mfma_f32_16x16x32_bf16 v[76:79], v[148:151], a[224:227], v[76:79]
    v_mfma_f32_16x16x32_bf16 v[80:83], v[152:155], a[224:227], v[80:83]
    v_mfma_f32_16x16x32_bf16 v[84:87], v[156:159], a[224:227], v[84:87]
    v_mfma_f32_16x16x32_bf16 v[88:91], v[160:163], a[224:227], v[88:91]
    v_mfma_f32_16x16x32_bf16 v[92:95], v[164:167], a[224:227], v[92:95]
    s_waitcnt lgkmcnt(0)
    s_waitcnt vmcnt(12)
    v_mfma_f32_16x16x32_bf16 v[48:51], v[168:171], a[180:183], v[48:51]
    ds_read_b128 a[184:187], v2 offset:512
    ds_read_b128 a[232:235], v2 offset:12800
    s_add_u32 m0, s42, s41
    s_add_u32 s42, s42, 12288
    buffer_load_dwordx4 v4, s[12:15], s30 offen offset:0 nt lds
    buffer_load_dwordx4 v5, s[12:15], s30 offen offset:1024 nt lds
    buffer_load_dwordx4 v6, s[12:15], s30 offen offset:2048 nt lds
    buffer_store_dwordx4 a[240:243], v16, s[24:27], 0 offen offset:0 sc0 sc1
    buffer_store_dwordx4 a[244:247], v16, s[24:27], 0 offen offset:1024 sc0 sc1
    buffer_store_dwordx4 a[248:251], v16, s[24:27], 0 offen offset:2048 sc0 sc1
    s_add_u32 s30, s30, 393216
    v_mfma_f32_16x16x32_bf16 v[52:55], v[172:175], a[180:183], v[52:55]
    ds_read_b64_tr_b16 v[192:193], v252 offset:24576
    ds_read_b64_tr_b16 v[194:195], v252 offset:25344
    v_mfma_f32_16x16x32_bf16 v[56:59], v[176:179], a[180:183], v[56:59]
    ds_read_b64_tr_b16 v[196:197], v253 offset:24608
    ds_read_b64_tr_b16 v[198:199], v253 offset:25376
    v_mfma_f32_16x16x32_bf16 v[60:63], v[180:183], a[180:183], v[60:63]
    ds_read_b64_tr_b16 v[200:201], v252 offset:24640
    ds_read_b64_tr_b16 v[202:203], v252 offset:25408
    v_mfma_f32_16x16x32_bf16 v[64:67], v[184:187], a[180:183], v[64:67]
    ds_read_b64_tr_b16 v[204:205], v253 offset:24672
    ds_read_b64_tr_b16 v[206:207], v253 offset:25440
    v_mfma_f32_16x16x32_bf16 v[68:71], v[188:191], a[180:183], v[68:71]
    ds_read_b64_tr_b16 v[208:209], v252 offset:24704
    ds_read_b64_tr_b16 v[210:211], v252 offset:25472
    v_mfma_f32_16x16x32_bf16 v[72:75], v[168:171], a[228:231], v[72:75]
    ds_read_b64_tr_b16 v[212:213], v253 offset:24736
    ds_read_b64_tr_b16 v[214:215], v253 offset:25504
    v_mfma_f32_16x16x32_bf16 v[76:79], v[172:175], a[228:231], v[76:79]
    v_mfma_f32_16x16x32_bf16 v[80:83], v[176:179], a[228:231], v[80:83]
    v_mfma_f32_16x16x32_bf16 v[84:87], v[180:183], a[228:231], v[84:87]
    v_mfma_f32_16x16x32_bf16 v[88:91], v[184:187], a[228:231], v[88:91]
    v_mfma_f32_16x16x32_bf16 v[92:95], v[188:191], a[228:231], v[92:95]
    s_waitcnt lgkmcnt(0)
    s_waitcnt vmcnt(12)
    v_mfma_f32_16x16x32_bf16 v[48:51], v[192:195], a[184:187], v[48:51]
    ds_read_b128 a[188:191], v3 offset:512
    ds_read_b128 a[236:239], v3 offset:12800
    v_mfma_f32_16x16x32_bf16 v[52:55], v[196:199], a[184:187], v[52:55]
    ds_read_b64_tr_b16 v[216:217], v10 offset:0
    ds_read_b64_tr_b16 v[218:219], v10 offset:768
    v_mfma_f32_16x16x32_bf16 v[56:59], v[200:203], a[184:187], v[56:59]
    ds_read_b64_tr_b16 v[220:221], v11 offset:32
    ds_read_b64_tr_b16 v[222:223], v11 offset:800
    v_mfma_f32_16x16x32_bf16 v[60:63], v[204:207], a[184:187], v[60:63]
    ds_read_b64_tr_b16 v[224:225], v10 offset:64
    ds_read_b64_tr_b16 v[226:227], v10 offset:832
    v_mfma_f32_16x16x32_bf16 v[64:67], v[208:211], a[184:187], v[64:67]
    ds_read_b64_tr_b16 v[228:229], v11 offset:96
    ds_read_b64_tr_b16 v[230:231], v11 offset:864
    v_mfma_f32_16x16x32_bf16 v[68:71], v[212:215], a[184:187], v[68:71]
    ds_read_b64_tr_b16 v[232:233], v10 offset:128
    ds_read_b64_tr_b16 v[234:235], v10 offset:896
    v_mfma_f32_16x16x32_bf16 v[72:75], v[192:195], a[232:235], v[72:75]
    ds_read_b64_tr_b16 v[236:237], v11 offset:160
    ds_read_b64_tr_b16 v[238:239], v11 offset:928
    v_mfma_f32_16x16x32_bf16 v[76:79], v[196:199], a[232:235], v[76:79]
    v_mfma_f32_16x16x32_bf16 v[80:83], v[200:203], a[232:235], v[80:83]
    v_mfma_f32_16x16x32_bf16 v[84:87], v[204:207], a[232:235], v[84:87]
    v_mfma_f32_16x16x32_bf16 v[88:91], v[208:211], a[232:235], v[88:91]
    v_mfma_f32_16x16x32_bf16 v[92:95], v[212:215], a[232:235], v[92:95]
    s_waitcnt lgkmcnt(0)
    s_barrier
    v_mfma_f32_16x16x32_bf16 v[48:51], v[216:219], a[188:191], v[48:51]
    ds_read_b128 a[144:147], v0 offset:24576
    v_mfma_f32_16x16x32_bf16 v[52:55], v[220:223], a[188:191], v[52:55]
    ds_read_b128 a[148:151], v1 offset:24576
    v_mfma_f32_16x16x32_bf16 v[56:59], v[224:227], a[188:191], v[56:59]
    ds_read_b128 a[152:155], v2 offset:24576
    v_mfma_f32_16x16x32_bf16 v[60:63], v[228:231], a[188:191], v[60:63]
    ds_read_b128 a[156:159], v3 offset:24576
    v_mfma_f32_16x16x32_bf16 v[64:67], v[232:235], a[188:191], v[64:67]
    ds_read_b128 a[160:163], v0 offset:24832
    v_mfma_f32_16x16x32_bf16 v[68:71], v[236:239], a[188:191], v[68:71]
    ds_read_b128 a[164:167], v1 offset:24832
    v_mfma_f32_16x16x32_bf16 v[72:75], v[216:219], a[236:239], v[72:75]
    ds_read_b128 a[168:171], v2 offset:24832
    v_mfma_f32_16x16x32_bf16 v[76:79], v[220:223], a[236:239], v[76:79]
    ds_read_b128 a[172:175], v3 offset:24832
    v_mfma_f32_16x16x32_bf16 v[80:83], v[224:227], a[236:239], v[80:83]
    ds_read_b128 a[176:179], v0 offset:25088
    v_mfma_f32_16x16x32_bf16 v[84:87], v[228:231], a[236:239], v[84:87]
    ds_read_b128 a[180:183], v1 offset:25088
    v_mfma_f32_16x16x32_bf16 v[88:91], v[232:235], a[236:239], v[88:91]
    ds_read_b128 a[184:187], v2 offset:25088
    v_mfma_f32_16x16x32_bf16 v[92:95], v[236:239], a[236:239], v[92:95]
    ds_read_b128 a[188:191], v3 offset:25088
    s_waitcnt lgkmcnt(0)
    s_nop 1
    v_cvt_pk_bf16_f32 v48, v48, v49
    v_cvt_pk_bf16_f32 v49, v50, v51
    ds_write_b64 v12, v[48:49] offset:0
    v_cvt_pk_bf16_f32 v52, v52, v53
    v_cvt_pk_bf16_f32 v53, v54, v55
    ds_write_b64 v12, v[52:53] offset:32
    v_cvt_pk_bf16_f32 v56, v56, v57
    v_cvt_pk_bf16_f32 v57, v58, v59
    ds_write_b64 v12, v[56:57] offset:64
    v_cvt_pk_bf16_f32 v60, v60, v61
    v_cvt_pk_bf16_f32 v61, v62, v63
    ds_write_b64 v12, v[60:61] offset:96
    v_cvt_pk_bf16_f32 v64, v64, v65
    v_cvt_pk_bf16_f32 v65, v66, v67
    ds_write_b64 v12, v[64:65] offset:128
    v_cvt_pk_bf16_f32 v68, v68, v69
    v_cvt_pk_bf16_f32 v69, v70, v71
    ds_write_b64 v12, v[68:69] offset:160
    v_add_u32 v0, 36864, v0
    v_add_u32 v1, 36864, v1
    v_add_u32 v2, 36864, v2
    v_add_u32 v3, 36864, v3
    s_mov_b32 s34, 36864
    s_mov_b32 s29, 2
    s_add_u32 m0, s42, s41
    s_mov_b32 s26, 113246208
L_enter:
.p2align 6
L_loop0:
    s_waitcnt vmcnt(9) lgkmcnt(0)
    s_barrier
    v_mfma_f32_16x16x32_bf16 v[48:51], a[0:3], a[144:147], v[24:27]
    ds_read_b128 a[192:195], v0 offset:0
    v_mfma_f32_16x16x32_bf16 v[48:51], a[24:27], a[148:151], v[48:51]
    s_add_u32 s31, s31, 393216
    v_mfma_f32_16x16x32_bf16 v[48:51], a[48:51], a[152:155], v[48:51]
    v_mfma_f32_16x16x32_bf16 v[48:51], a[72:75], a[156:159], v[48:51]
    v_mfma_f32_16x16x32_bf16 v[48:51], a[96:99], a[160:163], v[48:51]
    v_mfma_f32_16x16x32_bf16 v[48:51], a[120:123], a[164:167], v[48:51]
    ds_read_b128 a[196:199], v1 offset:0
    v_mfma_f32_16x16x32_bf16 v[48:51], v[96:99], a[168:171], v[48:51]
    v_mfma_f32_16x16x32_bf16 v[48:51], v[120:123], a[172:175], v[48:51]
    v_mfma_f32_16x16x32_bf16 v[48:51], v[144:147], a[176:179], v[48:51]
    v_cvt_pk_bf16_f32 v72, v72, v73
    v_mfma_f32_16x16x32_bf16 v[48:51], v[168:171], a[180:183], v[48:51]
    v_cvt_pk_bf16_f32 v73, v74, v75
    v_mfma_f32_16x16x32_bf16 v[48:51], v[192:195], a[184:187], v[48:51]
    ds_read_b128 a[200:203], v2 offset:0
    v_mfma_f32_16x16x32_bf16 v[48:51], v[216:219], a[188:191], v[48:51]
    ds_write_b64 v12, v[72:73] offset:12544
    v_mfma_f32_16x16x32_bf16 v[52:55], a[4:7], a[144:147], v[28:31]
    s_add_u32 s38, s34, 12288
    v_mfma_f32_16x16x32_bf16 v[52:55], a[28:31], a[148:151], v[52:55]
    s_cmp_eq_u32 s38, 86016
    s_cselect_b32 s38, 0, s38
    v_mfma_f32_16x16x32_bf16 v[52:55], a[52:55], a[152:155], v[52:55]
    s_sub_u32 s33, s38, s34
    v_mfma_f32_16x16x32_bf16 v[52:55], a[76:79], a[156:159], v[52:55]
    ds_read_b128 a[204:207], v3 offset:0
    v_mfma_f32_16x16x32_bf16 v[52:55], a[100:103], a[160:163], v[52:55]
    v_cvt_pk_bf16_f32 v76, v76, v77
    v_mfma_f32_16x16x32_bf16 v[52:55], a[124:127], a[164:167], v[52:55]
    ds_read_b128 a[240:243], v13 offset:0
    v_mfma_f32_16x16x32_bf16 v[52:55], v[100:103], a[168:171], v[52:55]
    v_cvt_pk_bf16_f32 v77, v78, v79
    v_mfma_f32_16x16x32_bf16 v[52:55], v[124:127], a[172:175], v[52:55]
    ds_write_b64 v12, v[76:77] offset:12576
    v_mfma_f32_16x16x32_bf16 v[52:55], v[148:151], a[176:179], v[52:55]
    ds_read_b128 a[208:211], v0 offset:256
    v_mfma_f32_16x16x32_bf16 v[52:55], v[172:175], a[180:183], v[52:55]
    ds_read_b128 a[244:247], v14 offset:0
    v_mfma_f32_16x16x32_bf16 v[52:55], v[196:199], a[184:187], v[52:55]
    s_mov_b32 s34, s38
    v_mfma_f32_16x16x32_bf16 v[52:55], v[220:223], a[188:191], v[52:55]
    ds_read_b128 a[248:251], v15 offset:0
    v_mfma_f32_16x16x32_bf16 v[56:59], a[8:11], a[144:147], v[32:35]
    buffer_load_dwordx4 v4, s[12:15], s30 offen offset:0 nt lds
    v_mfma_f32_16x16x32_bf16 v[56:59], a[32:35], a[148:151], v[56:59]
    ds_read_b128 a[212:215], v1 offset:256
    v_mfma_f32_16x16x32_bf16 v[56:59], a[56:59], a[152:155], v[56:59]
    v_cvt_pk_bf16_f32 v80, v80, v81
    v_mfma_f32_16x16x32_bf16 v[56:59], a[80:83], a[156:159], v[56:59]
    buffer_load_dwordx4 v5, s[12:15], s30 offen offset:1024 nt lds
    v_mfma_f32_16x16x32_bf16 v[56:59], a[104:107], a[160:163], v[56:59]
    v_cvt_pk_bf16_f32 v81, v82, v83
    v_mfma_f32_16x16x32_bf16 v[56:59], a[128:131], a[164:167], v[56:59]
    ds_write_b64 v12, v[80:81] offset:12608
    v_mfma_f32_16x16x32_bf16 v[56:59], v[104:107], a[168:171], v[56:59]
    buffer_load_dwordx4 v6, s[12:15], s30 offen offset:2048 nt lds
    v_mfma_f32_16x16x32_bf16 v[56:59], v[128:131], a[172:175], v[56:59]
    ds_read_b128 a[216:219], v2 offset:256
    v_mfma_f32_16x16x32_bf16 v[56:59], v[152:155], a[176:179], v[56:59]
    s_add_u32 s30, s30, 393216
    v_mfma_f32_16x16x32_bf16 v[56:59], v[176:179], a[180:183], v[56:59]
    s_waitcnt lgkmcnt(7)
    buffer_store_dwordx4 a[240:243], v16, s[24:27], s31 offen offset:0 sc0 sc1
    v_mfma_f32_16x16x32_bf16 v[56:59], v[200:203], a[184:187], v[56:59]
    s_add_u32 s42, s42, 12288
    v_mfma_f32_16x16x32_bf16 v[56:59], v[224:227], a[188:191], v[56:59]
    ds_read_b128 a[220:223], v3 offset:256
    v_mfma_f32_16x16x32_bf16 v[60:63], a[12:15], a[144:147], v[36:39]
    s_waitcnt lgkmcnt(5)
    buffer_store_dwordx4 a[244:247], v16, s[24:27], s31 offen offset:1024 sc0 sc1
    v_mfma_f32_16x16x32_bf16 v[60:63], a[36:39], a[148:151], v[60:63]
    s_cmp_eq_u32 s42, 86016
    s_cselect_b32 s42, 0, s42
    v_mfma_f32_16x16x32_bf16 v[60:63], a[60:63], a[152:155], v[60:63]
    s_add_u32 m0, s42, s41
    v_mfma_f32_16x16x32_bf16 v[60:63], a[84:87], a[156:159], v[60:63]
    s_waitcnt lgkmcnt(4)
    buffer_store_dwordx4 a[248:251], v16, s[24:27], s31 offen offset:2048 sc0 sc1
    v_mfma_f32_16x16x32_bf16 v[60:63], a[108:111], a[160:163], v[60:63]
    ds_read_b128 a[224:227], v0 offset:512
    v_mfma_f32_16x16x32_bf16 v[60:63], a[132:135], a[164:167], v[60:63]
    s_add_u32 s29, s29, 1
    v_mfma_f32_16x16x32_bf16 v[60:63], v[108:111], a[168:171], v[60:63]
    s_cmp_lt_u32 s29, s43
    s_cselect_b32 s14, s40, 0
    v_mfma_f32_16x16x32_bf16 v[60:63], v[132:135], a[172:175], v[60:63]
    v_cvt_pk_bf16_f32 v84, v84, v85
    v_mfma_f32_16x16x32_bf16 v[60:63], v[156:159], a[176:179], v[60:63]
    v_cvt_pk_bf16_f32 v85, v86, v87
    v_mfma_f32_16x16x32_bf16 v[60:63], v[180:183], a[180:183], v[60:63]
    ds_read_b128 a[228:231], v1 offset:512
    v_mfma_f32_16x16x32_bf16 v[60:63], v[204:207], a[184:187], v[60:63]
    ds_write_b64 v12, v[84:85] offset:12640
    v_mfma_f32_16x16x32_bf16 v[60:63], v[228:231], a[188:191], v[60:63]
    v_cvt_pk_bf16_f32 v88, v88, v89
    v_mfma_f32_16x16x32_bf16 v[64:67], a[16:19], a[144:147], v[40:43]
    v_cvt_pk_bf16_f32 v89, v90, v91
    v_mfma_f32_16x16x32_bf16 v[64:67], a[40:43], a[148:151], v[64:67]
    ds_write_b64 v12, v[88:89] offset:12672
    v_mfma_f32_16x16x32_bf16 v[64:67], a[64:67], a[152:155], v[64:67]
    ds_read_b128 a[232:235], v2 offset:512
    v_mfma_f32_16x16x32_bf16 v[64:67], a[88:91], a[156:159], v[64:67]
    v_cvt_pk_bf16_f32 v92, v92, v93
    v_mfma_f32_16x16x32_bf16 v[64:67], a[112:115], a[160:163], v[64:67]
    v_cvt_pk_bf16_f32 v93, v94, v95
    v_mfma_f32_16x16x32_bf16 v[64:67], a[136:139], a[164:167], v[64:67]
    ds_write_b64 v12, v[92:93] offset:12704
    v_mfma_f32_16x16x32_bf16 v[64:67], v[112:115], a[168:171], v[64:67]
    v_add_u32 v0, s33, v0
    v_mfma_f32_16x16x32_bf16 v[64:67], v[136:139], a[172:175], v[64:67]
    ds_read_b128 a[236:239], v3 offset:512
    v_mfma_f32_16x16x32_bf16 v[64:67], v[160:163], a[176:179], v[64:67]
    v_add_u32 v1, s33, v1
    v_mfma_f32_16x16x32_bf16 v[64:67], v[184:187], a[180:183], v[64:67]
    v_add_u32 v2, s33, v2
    v_mfma_f32_16x16x32_bf16 v[64:67], v[208:211], a[184:187], v[64:67]
    v_add_u32 v3, s33, v3
    v_mfma_f32_16x16x32_bf16 v[64:67], v[232:235], a[188:191], v[64:67]
    v_mfma_f32_16x16x32_bf16 v[68:71], a[20:23], a[144:147], v[44:47]
    v_mfma_f32_16x16x32_bf16 v[68:71], a[44:47], a[148:151], v[68:71]
    v_mfma_f32_16x16x32_bf16 v[68:71], a[68:71], a[152:155], v[68:71]
    v_mfma_f32_16x16x32_bf16 v[68:71], a[92:95], a[156:159], v[68:71]
    v_mfma_f32_16x16x32_bf16 v[68:71], a[116:119], a[160:163], v[68:71]
    v_mfma_f32_16x16x32_bf16 v[68:71], a[140:143], a[164:167], v[68:71]
    v_mfma_f32_16x16x32_bf16 v[68:71], v[116:119], a[168:171], v[68:71]
    v_mfma_f32_16x16x32_bf16 v[68:71], v[140:143], a[172:175], v[68:71]
    v_mfma_f32_16x16x32_bf16 v[68:71], v[164:167], a[176:179], v[68:71]
    v_mfma_f32_16x16x32_bf16 v[68:71], v[188:191], a[180:183], v[68:71]
    v_mfma_f32_16x16x32_bf16 v[68:71], v[212:215], a[184:187], v[68:71]
    v_mfma_f32_16x16x32_bf16 v[68:71], v[236:239], a[188:191], v[68:71]
    s_cmp_ge_u32 s29, s37
    s_cbranch_scc1 L_drain0
    s_waitcnt vmcnt(9) lgkmcnt(0)
    s_barrier
    v_mfma_f32_16x16x32_bf16 v[72:75], a[0:3], a[192:195], v[24:27]
    ds_read_b128 a[144:147], v0 offset:0
    v_mfma_f32_16x16x32_bf16 v[72:75], a[24:27], a[196:199], v[72:75]
    s_add_u32 s31, s31, 393216
    v_mfma_f32_16x16x32_bf16 v[72:75], a[48:51], a[200:203], v[72:75]
    v_mfma_f32_16x16x32_bf16 v[72:75], a[72:75], a[204:207], v[72:75]
    v_mfma_f32_16x16x32_bf16 v[72:75], a[96:99], a[208:211], v[72:75]
    v_mfma_f32_16x16x32_bf16 v[72:75], a[120:123], a[212:215], v[72:75]
    ds_read_b128 a[148:151], v1 offset:0
    v_mfma_f32_16x16x32_bf16 v[72:75], v[96:99], a[216:219], v[72:75]
    v_mfma_f32_16x16x32_bf16 v[72:75], v[120:123], a[220:223], v[72:75]
    v_mfma_f32_16x16x32_bf16 v[72:75], v[144:147], a[224:227], v[72:75]
    v_cvt_pk_bf16_f32 v48, v48, v49
    v_mfma_f32_16x16x32_bf16 v[72:75], v[168:171], a[228:231], v[72:75]
    v_cvt_pk_bf16_f32 v49, v50, v51
    v_mfma_f32_16x16x32_bf16 v[72:75], v[192:195], a[232:235], v[72:75]
    ds_read_b128 a[152:155], v2 offset:0
    v_mfma_f32_16x16x32_bf16 v[72:75], v[216:219], a[236:239], v[72:75]
    ds_write_b64 v12, v[48:49] offset:0
    v_mfma_f32_16x16x32_bf16 v[76:79], a[4:7], a[192:195], v[28:31]
    s_add_u32 s38, s34, 12288
    v_mfma_f32_16x16x32_bf16 v[76:79], a[28:31], a[196:199], v[76:79]
    s_cmp_eq_u32 s38, 86016
    s_cselect_b32 s38, 0, s38
    v_mfma_f32_16x16x32_bf16 v[76:79], a[52:55], a[200:203], v[76:79]
    s_sub_u32 s33, s38, s34
    v_mfma_f32_16x16x32_bf16 v[76:79], a[76:79], a[204:207], v[76:79]
    ds_read_b128 a[156:159], v3 offset:0
    v_mfma_f32_16x16x32_bf16 v[76:79], a[100:103], a[208:211], v[76:79]
    v_cvt_pk_bf16_f32 v52, v52, v53
    v_mfma_f32_16x16x32_bf16 v[76:79], a[124:127], a[212:215], v[76:79]
    ds_read_b128 a[240:243], v13 offset:12544
    v_mfma_f32_16x16x32_bf16 v[76:79], v[100:103], a[216:219], v[76:79]
    v_cvt_pk_bf16_f32 v53, v54, v55
    v_mfma_f32_16x16x32_bf16 v[76:79], v[124:127], a[220:223], v[76:79]
    ds_write_b64 v12, v[52:53] offset:32
    v_mfma_f32_16x16x32_bf16 v[76:79], v[148:151], a[224:227], v[76:79]
    ds_read_b128 a[160:163], v0 offset:256
    v_mfma_f32_16x16x32_bf16 v[76:79], v[172:175], a[228:231], v[76:79]
    ds_read_b128 a[244:247], v14 offset:12544
    v_mfma_f32_16x16x32_bf16 v[76:79], v[196:199], a[232:235], v[76:79]
    s_mov_b32 s34, s38
    v_mfma_f32_16x16x32_bf16 v[76:79], v[220:223], a[236:239], v[76:79]
    ds_read_b128 a[248:251], v15 offset:12544
    v_mfma_f32_16x16x32_bf16 v[80:83], a[8:11], a[192:195], v[32:35]
    buffer_load_dwordx4 v4, s[12:15], s30 offen offset:0 nt lds
    v_mfma_f32_16x16x32_bf16 v[80:83], a[32:35], a[196:199], v[80:83]
    ds_read_b128 a[164:167], v1 offset:256
    v_mfma_f32_16x16x32_bf16 v[80:83], a[56:59], a[200:203], v[80:83]
    v_cvt_pk_bf16_f32 v56, v56, v57
    v_mfma_f32_16x16x32_bf16 v[80:83], a[80:83], a[204:207], v[80:83]
    buffer_load_dwordx4 v5, s[12:15], s30 offen offset:1024 nt lds
    v_mfma_f32_16x16x32_bf16 v[80:83], a[104:107], a[208:211], v[80:83]
    v_cvt_pk_bf16_f32 v57, v58, v59
    v_mfma_f32_16x16x32_bf16 v[80:83], a[128:131], a[212:215], v[80:83]
    ds_write_b64 v12, v[56:57] offset:64
    v_mfma_f32_16x16x32_bf16 v[80:83], v[104:107], a[216:219], v[80:83]
    buffer_load_dwordx4 v6, s[12:15], s30 offen offset:2048 nt lds
    v_mfma_f32_16x16x32_bf16 v[80:83], v[128:131], a[220:223], v[80:83]
    ds_read_b128 a[168:171], v2 offset:256
    v_mfma_f32_16x16x32_bf16 v[80:83], v[152:155], a[224:227], v[80:83]
    s_add_u32 s30, s30, 393216
    v_mfma_f32_16x16x32_bf16 v[80:83], v[176:179], a[228:231], v[80:83]
    s_waitcnt lgkmcnt(7)
    buffer_store_dwordx4 a[240:243], v16, s[24:27], s31 offen offset:0 sc0 sc1
    v_mfma_f32_16x16x32_bf16 v[80:83], v[200:203], a[232:235], v[80:83]
    s_add_u32 s42, s42, 12288
    v_mfma_f32_16x16x32_bf16 v[80:83], v[224:227], a[236:239], v[80:83]
    ds_read_b128 a[172:175], v3 offset:256
    v_mfma_f32_16x16x32_bf16 v[84:87], a[12:15], a[192:195], v[36:39]
    s_waitcnt lgkmcnt(5)
    buffer_store_dwordx4 a[244:247], v16, s[24:27], s31 offen offset:1024 sc0 sc1
    v_mfma_f32_16x16x32_bf16 v[84:87], a[36:39], a[196:199], v[84:87]
    s_cmp_eq_u32 s42, 86016
    s_cselect_b32 s42, 0, s42
    v_mfma_f32_16x16x32_bf16 v[84:87], a[60:63], a[200:203], v[84:87]
    s_add_u32 m0, s42, s41
    v_mfma_f32_16x16x32_bf16 v[84:87], a[84:87], a[204:207], v[84:87]
    s_waitcnt lgkmcnt(4)
    buffer_store_dwordx4 a[248:251], v16, s[24:27], s31 offen offset:2048 sc0 sc1
    v_mfma_f32_16x16x32_bf16 v[84:87], a[108:111], a[208:211], v[84:87]
    ds_read_b128 a[176:179], v0 offset:512
    v_mfma_f32_16x16x32_bf16 v[84:87], a[132:135], a[212:215], v[84:87]
    s_add_u32 s29, s29, 1
    v_mfma_f32_16x16x32_bf16 v[84:87], v[108:111], a[216:219], v[84:87]
    s_cmp_lt_u32 s29, s43
    s_cselect_b32 s14, s40, 0
    v_mfma_f32_16x16x32_bf16 v[84:87], v[132:135], a[220:223], v[84:87]
    v_cvt_pk_bf16_f32 v60, v60, v61
    v_mfma_f32_16x16x32_bf16 v[84:87], v[156:159], a[224:227], v[84:87]
    v_cvt_pk_bf16_f32 v61, v62, v63
    v_mfma_f32_16x16x32_bf16 v[84:87], v[180:183], a[228:231], v[84:87]
    ds_read_b128 a[180:183], v1 offset:512
    v_mfma_f32_16x16x32_bf16 v[84:87], v[204:207], a[232:235], v[84:87]
    ds_write_b64 v12, v[60:61] offset:96
    v_mfma_f32_16x16x32_bf16 v[84:87], v[228:231], a[236:239], v[84:87]
    v_cvt_pk_bf16_f32 v64, v64, v65
    v_mfma_f32_16x16x32_bf16 v[88:91], a[16:19], a[192:195], v[40:43]
    v_cvt_pk_bf16_f32 v65, v66, v67
    v_mfma_f32_16x16x32_bf16 v[88:91], a[40:43], a[196:199], v[88:91]
    ds_write_b64 v12, v[64:65] offset:128
    v_mfma_f32_16x16x32_bf16 v[88:91], a[64:67], a[200:203], v[88:91]
    ds_read_b128 a[184:187], v2 offset:512
    v_mfma_f32_16x16x32_bf16 v[88:91], a[88:91], a[204:207], v[88:91]
    v_cvt_pk_bf16_f32 v68, v68, v69
    v_mfma_f32_16x16x32_bf16 v[88:91], a[112:115], a[208:211], v[88:91]
    v_cvt_pk_bf16_f32 v69, v70, v71
    v_mfma_f32_16x16x32_bf16 v[88:91], a[136:139], a[212:215], v[88:91]
    ds_write_b64 v12, v[68:69] offset:160
    v_mfma_f32_16x16x32_bf16 v[88:91], v[112:115], a[216:219], v[88:91]
    v_add_u32 v0, s33, v0
    v_mfma_f32_16x16x32_bf16 v[88:91], v[136:139], a[220:223], v[88:91]
    ds_read_b128 a[188:191], v3 offset:512
    v_mfma_f32_16x16x32_bf16 v[88:91], v[160:163], a[224:227], v[88:91]
    v_add_u32 v1, s33, v1
    v_mfma_f32_16x16x32_bf16 v[88:91], v[184:187], a[228:231], v[88:91]
    v_add_u32 v2, s33, v2
    v_mfma_f32_16x16x32_bf16 v[88:91], v[208:211], a[232:235], v[88:91]
    v_add_u32 v3, s33, v3
    v_mfma_f32_16x16x32_bf16 v[88:91], v[232:235], a[236:239], v[88:91]
    v_mfma_f32_16x16x32_bf16 v[92:95], a[20:23], a[192:195], v[44:47]
    v_mfma_f32_16x16x32_bf16 v[92:95], a[44:47], a[196:199], v[92:95]
    v_mfma_f32_16x16x32_bf16 v[92:95], a[68:71], a[200:203], v[92:95]
    v_mfma_f32_16x16x32_bf16 v[92:95], a[92:95], a[204:207], v[92:95]
    v_mfma_f32_16x16x32_bf16 v[92:95], a[116:119], a[208:211], v[92:95]
    v_mfma_f32_16x16x32_bf16 v[92:95], a[140:143], a[212:215], v[92:95]
    v_mfma_f32_16x16x32_bf16 v[92:95], v[116:119], a[216:219], v[92:95]
    v_mfma_f32_16x16x32_bf16 v[92:95], v[140:143], a[220:223], v[92:95]
    v_mfma_f32_16x16x32_bf16 v[92:95], v[164:167], a[224:227], v[92:95]
    v_mfma_f32_16x16x32_bf16 v[92:95], v[188:191], a[228:231], v[92:95]
    v_mfma_f32_16x16x32_bf16 v[92:95], v[212:215], a[232:235], v[92:95]
    v_mfma_f32_16x16x32_bf16 v[92:95], v[236:239], a[236:239], v[92:95]
    s_cmp_lt_u32 s29, s37
    s_cbranch_scc1 L_loop0
L_drain1:
    s_waitcnt lgkmcnt(0)
    s_barrier
    s_add_u32 s31, s31, 393216
    s_nop 4
    ds_read_b128 a[240:243], v13 offset:0
    ds_read_b128 a[244:247], v14 offset:0
    ds_read_b128 a[248:251], v15 offset:0
    v_cvt_pk_bf16_f32 v72, v72, v73
    v_cvt_pk_bf16_f32 v73, v74, v75
    ds_write_b64 v12, v[72:73] offset:12544
    v_cvt_pk_bf16_f32 v76, v76, v77
    v_cvt_pk_bf16_f32 v77, v78, v79
    ds_write_b64 v12, v[76:77] offset:12576
    v_cvt_pk_bf16_f32 v80, v80, v81
    v_cvt_pk_bf16_f32 v81, v82, v83
    ds_write_b64 v12, v[80:81] offset:12608
    v_cvt_pk_bf16_f32 v84, v84, v85
    v_cvt_pk_bf16_f32 v85, v86, v87
    ds_write_b64 v12, v[84:85] offset:12640
    v_cvt_pk_bf16_f32 v88, v88, v89
    v_cvt_pk_bf16_f32 v89, v90, v91
    ds_write_b64 v12, v[88:89] offset:12672
    v_cvt_pk_bf16_f32 v92, v92, v93
    v_cvt_pk_bf16_f32 v93, v94, v95
    ds_write_b64 v12, v[92:93] offset:12704
    s_waitcnt lgkmcnt(8)
    buffer_store_dwordx4 a[240:243], v16, s[24:27], s31 offen offset:0 sc0 sc1
    s_waitcnt lgkmcnt(7)
    buffer_store_dwordx4 a[244:247], v16, s[24:27], s31 offen offset:1024 sc0 sc1
    s_waitcnt lgkmcnt(6)
    buffer_store_dwordx4 a[248:251], v16, s[24:27], s31 offen offset:2048 sc0 sc1
    s_add_u32 s31, s31, 393216
    s_waitcnt lgkmcnt(0)
    s_barrier
    ds_read_b128 a[144:147], v13 offset:12544
    ds_read_b128 a[148:151], v14 offset:12544
    ds_read_b128 a[152:155], v15 offset:12544
    s_waitcnt lgkmcnt(2)
    buffer_store_dwordx4 a[144:147], v16, s[24:27], s31 offen offset:0 sc0 sc1
    s_waitcnt lgkmcnt(1)
    buffer_store_dwordx4 a[148:151], v16, s[24:27], s31 offen offset:1024 sc0 sc1
    s_waitcnt lgkmcnt(0)
    buffer_store_dwordx4 a[152:155], v16, s[24:27], s31 offen offset:2048 sc0 sc1
    s_branch L_end
L_drain0:
    s_waitcnt lgkmcnt(0)
    s_barrier
    s_add_u32 s31, s31, 393216
    s_nop 4
    ds_read_b128 a[240:243], v13 offset:12544
    ds_read_b128 a[244:247], v14 offset:12544
    ds_read_b128 a[248:251], v15 offset:12544
    v_cvt_pk_bf16_f32 v48, v48, v49
    v_cvt_pk_bf16_f32 v49, v50, v51
    ds_write_b64 v12, v[48:49] offset:0
    v_cvt_pk_bf16_f32 v52, v52, v53
    v_cvt_pk_bf16_f32 v53, v54, v55
    ds_write_b64 v12, v[52:53] offset:32
    v_cvt_pk_bf16_f32 v56, v56, v57
    v_cvt_pk_bf16_f32 v57, v58, v59
    ds_write_b64 v12, v[56:57] offset:64
    v_cvt_pk_bf16_f32 v60, v60, v61
    v_cvt_pk_bf16_f32 v61, v62, v63
    ds_write_b64 v12, v[60:61] offset:96
    v_cvt_pk_bf16_f32 v64, v64, v65
    v_cvt_pk_bf16_f32 v65, v66, v67
    ds_write_b64 v12, v[64:65] offset:128
    v_cvt_pk_bf16_f32 v68, v68, v69
    v_cvt_pk_bf16_f32 v69, v70, v71
    ds_write_b64 v12, v[68:69] offset:160
    s_waitcnt lgkmcnt(8)
    buffer_store_dwordx4 a[240:243], v16, s[24:27], s31 offen offset:0 sc0 sc1
    s_waitcnt lgkmcnt(7)
    buffer_store_dwordx4 a[244:247], v16, s[24:27], s31 offen offset:1024 sc0 sc1
    s_waitcnt lgkmcnt(6)
    buffer_store_dwordx4 a[248:251], v16, s[24:27], s31 offen offset:2048 sc0 sc1
    s_add_u32 s31, s31, 393216
    s_waitcnt lgkmcnt(0)
    s_barrier
    ds_read_b128 a[144:147], v13 offset:0
    ds_read_b128 a[148:151], v14 offset:0
    ds_read_b128 a[152:155], v15 offset:0
    s_waitcnt lgkmcnt(2)
    buffer_store_dwordx4 a[144:147], v16, s[24:27], s31 offen offset:0 sc0 sc1
    s_waitcnt lgkmcnt(1)
    buffer_store_dwordx4 a[148:151], v16, s[24:27], s31 offen offset:1024 sc0 sc1
    s_waitcnt lgkmcnt(0)
    buffer_store_dwordx4 a[152:155], v16, s[24:27], s31 offen offset:2048 sc0 sc1
L_end:
L_done:
    s_endpgm
.section .rodata,"a"
.p2align 6
.amdhsa_kernel standalone__standard_2d_1d_3d_conv__vision_kernel
  .amdhsa_next_free_vgpr 512
  .amdhsa_next_free_sgpr 96
  .amdhsa_accum_offset 256
  .amdhsa_group_segment_fixed_size 0
  .amdhsa_kernarg_size 48
  .amdhsa_user_sgpr_count 2
  .amdhsa_user_sgpr_kernarg_segment_ptr 1
  .amdhsa_system_sgpr_workgroup_id_x 1
.end_amdhsa_kernel
```

```asm
; @launch grid=(256,1,1) block=(256,1,1) lds=159744
.amdgcn_target "amdgcn-amd-amdhsa--gfx950"
.text
.globl standalone__standard_2d_1d_3d_conv__vision_kernel
.p2align 8
.type standalone__standard_2d_1d_3d_conv__vision_kernel,@function
standalone__standard_2d_1d_3d_conv__vision_kernel:
    s_load_dwordx8 s[4:11], s[0:1], 0
    s_cmp_ge_u32 s2, 256
    s_cbranch_scc1 L_done
    v_lshrrev_b32 v18, 6, v0
    v_and_b32 v19, 63, v0
    v_readfirstlane_b32 s28, v18
    s_lshr_b32 s39, s2, 3
    s_and_b32 s39, s39, 31
    s_lshl_b32 s39, s39, 8
    v_add_u32 v255, s39, v0
    v_mul_u32_u24 v255, 36, v255
    v_and_b32 v20, 15, v0
    v_bfe_u32 v21, v0, 4, 2
    v_mul_u32_u24 v22, 3072, v18
    v_add_u32 v23, 16, v19
    v_lshrrev_b32 v23, 6, v23
    v_lshl_add_u32 v23, v18, 2, v23
    v_xor_b32 v23, v23, v19
    v_lshl_add_u32 v4, v23, 4, v22
    v_lshrrev_b32 v23, 5, v19
    v_add_u32 v23, 1, v23
    v_lshl_add_u32 v23, v18, 2, v23
    v_xor_b32 v23, v23, v19
    v_lshl_add_u32 v5, v23, 4, v22
    v_add_u32 v23, 48, v19
    v_lshrrev_b32 v23, 6, v23
    v_add_u32 v23, 2, v23
    v_lshl_add_u32 v23, v18, 2, v23
    v_xor_b32 v23, v23, v19
    v_lshl_add_u32 v6, v23, 4, v22
    s_and_b32 s39, s2, 7
    s_mul_i32 s39, s39, 1152
    s_bitcmp1_b32 s2, 0
    s_cselect_b32 s38, 32, 0
    s_add_u32 s39, s39, s38
    s_lshr_b32 s30, s2, 3
    s_add_u32 s30, s30, s39
    s_mul_i32 s30, s30, 12288
    s_sub_u32 s31, s30, 393216
    s_mul_i32 s41, s28, 3072
    s_mov_b32 s42, 0
    s_mov_b32 s14, 113246208
    s_mov_b32 s15, 0x20000
    s_mov_b32 s18, 294912
    s_mov_b32 s19, 0x20000
    s_waitcnt lgkmcnt(0)
    s_mov_b32 s12, s4
    s_and_b32 s13, s5, 0xffff
    s_mov_b32 s16, s6
    s_and_b32 s17, s7, 0xffff
L_g0:
    buffer_load_dword v254, v255, s[16:19], 0 offen
    s_add_u32 m0, s42, s41
    s_add_u32 s42, s42, 12288
    buffer_load_dwordx4 v4, s[12:15], s30 offen offset:0 nt lds
    buffer_load_dwordx4 v5, s[12:15], s30 offen offset:1024 nt lds
    buffer_load_dwordx4 v6, s[12:15], s30 offen offset:2048 nt lds
    s_add_u32 s30, s30, 393216
    s_add_u32 m0, s42, s41
    s_add_u32 s42, s42, 12288
    buffer_load_dwordx4 v4, s[12:15], s30 offen offset:0 nt lds
    buffer_load_dwordx4 v5, s[12:15], s30 offen offset:1024 nt lds
    buffer_load_dwordx4 v6, s[12:15], s30 offen offset:2048 nt lds
    s_add_u32 s30, s30, 393216
    s_mul_i32 s32, s28, 6144
    s_bitcmp1_b32 s2, 0
    s_mov_b32 s37, 37
    s_cselect_b32 s37, 35, s37
    s_sub_u32 s43, s37, 3
    v_mul_u32_u24 v22, 192, v18
    v_add_u32 v240, 0, v19
    v_mul_u32_u24 v241, 171, v240
    v_lshrrev_b32 v241, 11, v241
    v_mul_u32_u24 v242, 12, v241
    v_sub_u32 v240, v240, v242
    v_bfe_u32 v242, v241, 3, 1
    v_lshlrev_b32 v242, 1, v242
    v_xor_b32 v240, v240, v242
    v_lshl_add_u32 v240, v240, 4, v22
    v_mul_u32_u24 v241, 768, v241
    v_add_u32 v240, v240, v241
    v_subrev_u32 v7, 0, v240
    v_add_u32 v240, 64, v19
    v_mul_u32_u24 v241, 171, v240
    v_lshrrev_b32 v241, 11, v241
    v_mul_u32_u24 v242, 12, v241
    v_sub_u32 v240, v240, v242
    v_bfe_u32 v242, v241, 3, 1
    v_lshlrev_b32 v242, 1, v242
    v_xor_b32 v240, v240, v242
    v_lshl_add_u32 v240, v240, 4, v22
    v_mul_u32_u24 v241, 768, v241
    v_add_u32 v240, v240, v241
    v_subrev_u32 v8, 1024, v240
    v_add_u32 v240, 128, v19
    v_mul_u32_u24 v241, 171, v240
    v_lshrrev_b32 v241, 11, v241
    v_mul_u32_u24 v242, 12, v241
    v_sub_u32 v240, v240, v242
    v_bfe_u32 v242, v241, 3, 1
    v_lshlrev_b32 v242, 1, v242
    v_xor_b32 v240, v240, v242
    v_lshl_add_u32 v240, v240, 4, v22
    v_mul_u32_u24 v241, 768, v241
    v_add_u32 v240, v240, v241
    v_subrev_u32 v9, 2048, v240
    s_mov_b32 s24, s10
    s_and_b32 s25, s11, 0xffff
    s_mov_b32 s26, 0
    s_mov_b32 s27, 0x20000
    s_add_u32 m0, s32, 86016
    s_mov_b32 s35, 0
    buffer_load_dwordx4 v7, s[16:19], s35 offen offset:0 lds
    buffer_load_dwordx4 v8, s[16:19], s35 offen offset:1024 lds
    buffer_load_dwordx4 v9, s[16:19], s35 offen offset:2048 lds
    s_add_u32 m0, s32, 89088
    s_mov_b32 s35, 12288
    buffer_load_dwordx4 v7, s[16:19], s35 offen offset:0 lds
    buffer_load_dwordx4 v8, s[16:19], s35 offen offset:1024 lds
    buffer_load_dwordx4 v9, s[16:19], s35 offen offset:2048 lds
    v_mul_u32_u24 v22, 192, v18
    v_lshl_add_u32 v17, v21, 3, v22
    s_mov_b32 s20, s8
    s_and_b32 s21, s9, 0xffff
    s_mov_b32 s22, 768
    s_mov_b32 s23, 0x20000
    buffer_load_dwordx2 a[240:241], v17, s[20:23], 0 offen offset:0
    buffer_load_dwordx2 a[242:243], v17, s[20:23], 0 offen offset:32
    buffer_load_dwordx2 a[244:245], v17, s[20:23], 0 offen offset:64
    buffer_load_dwordx2 a[246:247], v17, s[20:23], 0 offen offset:96
    buffer_load_dwordx2 a[248:249], v17, s[20:23], 0 offen offset:128
    buffer_load_dwordx2 a[250:251], v17, s[20:23], 0 offen offset:160
    v_mul_u32_u24 v22, 768, v20
    v_add_u32 v23, 0, v21
    v_xor_b32 v23, v23, v20
    v_lshl_add_u32 v0, v23, 4, v22
    v_add_u32 v23, 4, v21
    v_xor_b32 v23, v23, v20
    v_lshl_add_u32 v1, v23, 4, v22
    v_add_u32 v23, 8, v21
    v_xor_b32 v23, v23, v20
    v_lshl_add_u32 v2, v23, 4, v22
    v_add_u32 v23, 12, v21
    v_xor_b32 v23, v23, v20
    v_lshl_add_u32 v3, v23, 4, v22
    v_lshrrev_b32 v22, 2, v20
    v_lshl_add_u32 v22, v21, 3, v22
    v_mul_u32_u24 v22, 192, v22
    v_and_b32 v23, 3, v20
    v_lshl_add_u32 v22, v23, 3, v22
    v_mul_u32_u24 v23, 6144, v18
    v_add_u32 v22, v22, v23
    v_add_u32 v22, 61440, v22
    v_and_b32 v23, 1, v21
    v_lshlrev_b32 v23, 5, v23
    v_add_u32 v10, v22, v23
    v_sub_u32 v11, v22, v23
    v_add_u32 v252, 49152, v10
    v_add_u32 v253, 49152, v11
    v_mul_u32_u24 v12, 784, v20
    v_add_u32 v12, v12, v17
    v_add_u32 v12, 86016, v12
    v_mul_u32_u24 v16, 3072, v18
    v_lshl_add_u32 v16, v19, 4, v16
    v_mul_u32_u24 v22, 3136, v18
    v_add_u32 v22, 86016, v22
    v_add_u32 v23, 16, v19
    v_lshrrev_b32 v23, 6, v23
    v_add_u32 v23, v23, v19
    v_lshl_add_u32 v23, v23, 4, v22
    v_add_u32 v13, 0, v23
    v_lshrrev_b32 v23, 5, v19
    v_add_u32 v23, 1, v23
    v_add_u32 v23, v23, v19
    v_lshl_add_u32 v23, v23, 4, v22
    v_add_u32 v14, 1024, v23
    v_add_u32 v23, 48, v19
    v_lshrrev_b32 v23, 6, v23
    v_add_u32 v23, 2, v23
    v_add_u32 v23, v23, v19
    v_lshl_add_u32 v23, v23, 4, v22
    v_add_u32 v15, 2048, v23
    s_mov_b32 s40, 113246208
    s_add_u32 m0, s32, 110592
    s_mov_b32 s35, 24576
    buffer_load_dwordx4 v7, s[16:19], s35 offen offset:0 lds
    buffer_load_dwordx4 v8, s[16:19], s35 offen offset:1024 lds
    buffer_load_dwordx4 v9, s[16:19], s35 offen offset:2048 lds
    s_add_u32 m0, s32, 113664
    s_mov_b32 s35, 36864
    buffer_load_dwordx4 v7, s[16:19], s35 offen offset:0 lds
    buffer_load_dwordx4 v8, s[16:19], s35 offen offset:1024 lds
    buffer_load_dwordx4 v9, s[16:19], s35 offen offset:2048 lds
    s_add_u32 m0, s32, 135168
    s_mov_b32 s35, 49152
    buffer_load_dwordx4 v7, s[16:19], s35 offen offset:0 lds
    buffer_load_dwordx4 v8, s[16:19], s35 offen offset:1024 lds
    buffer_load_dwordx4 v9, s[16:19], s35 offen offset:2048 lds
    s_add_u32 m0, s32, 138240
    s_mov_b32 s35, 61440
    buffer_load_dwordx4 v7, s[16:19], s35 offen offset:0 lds
    buffer_load_dwordx4 v8, s[16:19], s35 offen offset:1024 lds
    buffer_load_dwordx4 v9, s[16:19], s35 offen offset:2048 lds
    s_add_u32 m0, s32, 61440
    s_mov_b32 s35, 73728
    buffer_load_dwordx4 v7, s[16:19], s35 offen offset:0 lds
    buffer_load_dwordx4 v8, s[16:19], s35 offen offset:1024 lds
    buffer_load_dwordx4 v9, s[16:19], s35 offen offset:2048 lds
    s_add_u32 m0, s32, 64512
    s_mov_b32 s35, 86016
    buffer_load_dwordx4 v7, s[16:19], s35 offen offset:0 lds
    buffer_load_dwordx4 v8, s[16:19], s35 offen offset:1024 lds
    buffer_load_dwordx4 v9, s[16:19], s35 offen offset:2048 lds
    s_waitcnt vmcnt(30)
    s_barrier
    ds_read_b128 a[144:147], v0 offset:0
    ds_read_b128 a[192:195], v0 offset:12288
    s_waitcnt vmcnt(24)
    ds_read_b64_tr_b16 a[0:1], v10 offset:24576
    ds_read_b64_tr_b16 a[2:3], v10 offset:25344
    ds_read_b64_tr_b16 a[4:5], v11 offset:24608
    ds_read_b64_tr_b16 a[6:7], v11 offset:25376
    ds_read_b64_tr_b16 a[8:9], v10 offset:24640
    ds_read_b64_tr_b16 a[10:11], v10 offset:25408
    ds_read_b64_tr_b16 a[12:13], v11 offset:24672
    ds_read_b64_tr_b16 a[14:15], v11 offset:25440
    ds_read_b64_tr_b16 a[16:17], v10 offset:24704
    ds_read_b64_tr_b16 a[18:19], v10 offset:25472
    ds_read_b64_tr_b16 a[20:21], v11 offset:24736
    ds_read_b64_tr_b16 a[22:23], v11 offset:25504
    s_waitcnt vmcnt(18)
    v_accvgpr_read_b32 v240, a240
    v_accvgpr_read_b32 v241, a241
    v_accvgpr_read_b32 v242, a242
    v_accvgpr_read_b32 v243, a243
    v_accvgpr_read_b32 v244, a244
    v_accvgpr_read_b32 v245, a245
    v_accvgpr_read_b32 v246, a246
    v_accvgpr_read_b32 v247, a247
    v_accvgpr_read_b32 v248, a248
    v_accvgpr_read_b32 v249, a249
    v_accvgpr_read_b32 v250, a250
    v_accvgpr_read_b32 v251, a251
    v_lshlrev_b32 v24, 16, v240
    v_and_b32 v25, 0xffff0000, v240
    v_lshlrev_b32 v26, 16, v241
    v_and_b32 v27, 0xffff0000, v241
    v_lshlrev_b32 v28, 16, v242
    v_and_b32 v29, 0xffff0000, v242
    v_lshlrev_b32 v30, 16, v243
    v_and_b32 v31, 0xffff0000, v243
    v_lshlrev_b32 v32, 16, v244
    v_and_b32 v33, 0xffff0000, v244
    v_lshlrev_b32 v34, 16, v245
    v_and_b32 v35, 0xffff0000, v245
    v_lshlrev_b32 v36, 16, v246
    v_and_b32 v37, 0xffff0000, v246
    v_lshlrev_b32 v38, 16, v247
    v_and_b32 v39, 0xffff0000, v247
    v_lshlrev_b32 v40, 16, v248
    v_and_b32 v41, 0xffff0000, v248
    v_lshlrev_b32 v42, 16, v249
    v_and_b32 v43, 0xffff0000, v249
    v_lshlrev_b32 v44, 16, v250
    v_and_b32 v45, 0xffff0000, v250
    v_lshlrev_b32 v46, 16, v251
    v_and_b32 v47, 0xffff0000, v251
    s_waitcnt lgkmcnt(0)
    s_waitcnt vmcnt(12)
    v_mfma_f32_16x16x32_bf16 v[48:51], a[0:3], a[144:147], v[24:27]
    ds_read_b128 a[148:151], v1 offset:0
    ds_read_b128 a[196:199], v1 offset:12288
    s_add_u32 m0, s32, 86016
    s_mov_b32 s35, 98304
    buffer_load_dwordx4 v7, s[16:19], s35 offen offset:0 lds
    v_mfma_f32_16x16x32_bf16 v[52:55], a[4:7], a[144:147], v[28:31]
    ds_read_b64_tr_b16 a[24:25], v252 offset:0
    ds_read_b64_tr_b16 a[26:27], v252 offset:768
    v_mfma_f32_16x16x32_bf16 v[56:59], a[8:11], a[144:147], v[32:35]
    ds_read_b64_tr_b16 a[28:29], v253 offset:32
    ds_read_b64_tr_b16 a[30:31], v253 offset:800
    buffer_load_dwordx4 v8, s[16:19], s35 offen offset:1024 lds
    v_mfma_f32_16x16x32_bf16 v[60:63], a[12:15], a[144:147], v[36:39]
    ds_read_b64_tr_b16 a[32:33], v252 offset:64
    ds_read_b64_tr_b16 a[34:35], v252 offset:832
    v_mfma_f32_16x16x32_bf16 v[64:67], a[16:19], a[144:147], v[40:43]
    ds_read_b64_tr_b16 a[36:37], v253 offset:96
    ds_read_b64_tr_b16 a[38:39], v253 offset:864
    buffer_load_dwordx4 v9, s[16:19], s35 offen offset:2048 lds
    v_mfma_f32_16x16x32_bf16 v[68:71], a[20:23], a[144:147], v[44:47]
    ds_read_b64_tr_b16 a[40:41], v252 offset:128
    ds_read_b64_tr_b16 a[42:43], v252 offset:896
    v_mfma_f32_16x16x32_bf16 v[72:75], a[0:3], a[192:195], v[24:27]
    ds_read_b64_tr_b16 a[44:45], v253 offset:160
    ds_read_b64_tr_b16 a[46:47], v253 offset:928
    s_add_u32 m0, s32, 89088
    s_mov_b32 s35, 110592
    buffer_load_dwordx4 v7, s[16:19], s35 offen offset:0 lds
    v_mfma_f32_16x16x32_bf16 v[76:79], a[4:7], a[192:195], v[28:31]
    v_mfma_f32_16x16x32_bf16 v[80:83], a[8:11], a[192:195], v[32:35]
    buffer_load_dwordx4 v8, s[16:19], s35 offen offset:1024 lds
    v_mfma_f32_16x16x32_bf16 v[84:87], a[12:15], a[192:195], v[36:39]
    v_mfma_f32_16x16x32_bf16 v[88:91], a[16:19], a[192:195], v[40:43]
    buffer_load_dwordx4 v9, s[16:19], s35 offen offset:2048 lds
    v_mfma_f32_16x16x32_bf16 v[92:95], a[20:23], a[192:195], v[44:47]
    s_waitcnt lgkmcnt(0)
    s_waitcnt vmcnt(12)
    v_mfma_f32_16x16x32_bf16 v[48:51], a[24:27], a[148:151], v[48:51]
    ds_read_b128 a[152:155], v2 offset:0
    ds_read_b128 a[200:203], v2 offset:12288
    s_add_u32 m0, s32, 110592
    s_mov_b32 s35, 122880
    buffer_load_dwordx4 v7, s[16:19], s35 offen offset:0 lds
    v_mfma_f32_16x16x32_bf16 v[52:55], a[28:31], a[148:151], v[52:55]
    ds_read_b64_tr_b16 a[48:49], v252 offset:24576
    ds_read_b64_tr_b16 a[50:51], v252 offset:25344
    v_mfma_f32_16x16x32_bf16 v[56:59], a[32:35], a[148:151], v[56:59]
    ds_read_b64_tr_b16 a[52:53], v253 offset:24608
    ds_read_b64_tr_b16 a[54:55], v253 offset:25376
    buffer_load_dwordx4 v8, s[16:19], s35 offen offset:1024 lds
    v_mfma_f32_16x16x32_bf16 v[60:63], a[36:39], a[148:151], v[60:63]
    ds_read_b64_tr_b16 a[56:57], v252 offset:24640
    ds_read_b64_tr_b16 a[58:59], v252 offset:25408
    v_mfma_f32_16x16x32_bf16 v[64:67], a[40:43], a[148:151], v[64:67]
    ds_read_b64_tr_b16 a[60:61], v253 offset:24672
    ds_read_b64_tr_b16 a[62:63], v253 offset:25440
    buffer_load_dwordx4 v9, s[16:19], s35 offen offset:2048 lds
    v_mfma_f32_16x16x32_bf16 v[68:71], a[44:47], a[148:151], v[68:71]
    ds_read_b64_tr_b16 a[64:65], v252 offset:24704
    ds_read_b64_tr_b16 a[66:67], v252 offset:25472
    v_mfma_f32_16x16x32_bf16 v[72:75], a[24:27], a[196:199], v[72:75]
    ds_read_b64_tr_b16 a[68:69], v253 offset:24736
    ds_read_b64_tr_b16 a[70:71], v253 offset:25504
    s_add_u32 m0, s32, 113664
    s_mov_b32 s35, 135168
    buffer_load_dwordx4 v7, s[16:19], s35 offen offset:0 lds
    v_mfma_f32_16x16x32_bf16 v[76:79], a[28:31], a[196:199], v[76:79]
    v_mfma_f32_16x16x32_bf16 v[80:83], a[32:35], a[196:199], v[80:83]
    buffer_load_dwordx4 v8, s[16:19], s35 offen offset:1024 lds
    v_mfma_f32_16x16x32_bf16 v[84:87], a[36:39], a[196:199], v[84:87]
    v_mfma_f32_16x16x32_bf16 v[88:91], a[40:43], a[196:199], v[88:91]
    buffer_load_dwordx4 v9, s[16:19], s35 offen offset:2048 lds
    v_mfma_f32_16x16x32_bf16 v[92:95], a[44:47], a[196:199], v[92:95]
    s_waitcnt lgkmcnt(0)
    s_waitcnt vmcnt(12)
    v_mfma_f32_16x16x32_bf16 v[48:51], a[48:51], a[152:155], v[48:51]
    ds_read_b128 a[156:159], v3 offset:0
    ds_read_b128 a[204:207], v3 offset:12288
    s_add_u32 m0, s32, 135168
    s_mov_b32 s35, 147456
    buffer_load_dwordx4 v7, s[16:19], s35 offen offset:0 lds
    v_mfma_f32_16x16x32_bf16 v[52:55], a[52:55], a[152:155], v[52:55]
    ds_read_b64_tr_b16 a[72:73], v10 offset:0
    ds_read_b64_tr_b16 a[74:75], v10 offset:768
    v_mfma_f32_16x16x32_bf16 v[56:59], a[56:59], a[152:155], v[56:59]
    ds_read_b64_tr_b16 a[76:77], v11 offset:32
    ds_read_b64_tr_b16 a[78:79], v11 offset:800
    buffer_load_dwordx4 v8, s[16:19], s35 offen offset:1024 lds
    v_mfma_f32_16x16x32_bf16 v[60:63], a[60:63], a[152:155], v[60:63]
    ds_read_b64_tr_b16 a[80:81], v10 offset:64
    ds_read_b64_tr_b16 a[82:83], v10 offset:832
    v_mfma_f32_16x16x32_bf16 v[64:67], a[64:67], a[152:155], v[64:67]
    ds_read_b64_tr_b16 a[84:85], v11 offset:96
    ds_read_b64_tr_b16 a[86:87], v11 offset:864
    buffer_load_dwordx4 v9, s[16:19], s35 offen offset:2048 lds
    v_mfma_f32_16x16x32_bf16 v[68:71], a[68:71], a[152:155], v[68:71]
    ds_read_b64_tr_b16 a[88:89], v10 offset:128
    ds_read_b64_tr_b16 a[90:91], v10 offset:896
    v_mfma_f32_16x16x32_bf16 v[72:75], a[48:51], a[200:203], v[72:75]
    ds_read_b64_tr_b16 a[92:93], v11 offset:160
    ds_read_b64_tr_b16 a[94:95], v11 offset:928
    s_add_u32 m0, s32, 138240
    s_mov_b32 s35, 159744
    buffer_load_dwordx4 v7, s[16:19], s35 offen offset:0 lds
    v_mfma_f32_16x16x32_bf16 v[76:79], a[52:55], a[200:203], v[76:79]
    v_mfma_f32_16x16x32_bf16 v[80:83], a[56:59], a[200:203], v[80:83]
    buffer_load_dwordx4 v8, s[16:19], s35 offen offset:1024 lds
    v_mfma_f32_16x16x32_bf16 v[84:87], a[60:63], a[200:203], v[84:87]
    v_mfma_f32_16x16x32_bf16 v[88:91], a[64:67], a[200:203], v[88:91]
    buffer_load_dwordx4 v9, s[16:19], s35 offen offset:2048 lds
    v_mfma_f32_16x16x32_bf16 v[92:95], a[68:71], a[200:203], v[92:95]
    s_waitcnt lgkmcnt(0)
    s_waitcnt vmcnt(12)
    v_mfma_f32_16x16x32_bf16 v[48:51], a[72:75], a[156:159], v[48:51]
    ds_read_b128 a[160:163], v0 offset:256
    ds_read_b128 a[208:211], v0 offset:12544
    s_add_u32 m0, s32, 61440
    s_mov_b32 s35, 172032
    buffer_load_dwordx4 v7, s[16:19], s35 offen offset:0 lds
    v_mfma_f32_16x16x32_bf16 v[52:55], a[76:79], a[156:159], v[52:55]
    ds_read_b64_tr_b16 a[96:97], v10 offset:24576
    ds_read_b64_tr_b16 a[98:99], v10 offset:25344
    v_mfma_f32_16x16x32_bf16 v[56:59], a[80:83], a[156:159], v[56:59]
    ds_read_b64_tr_b16 a[100:101], v11 offset:24608
    ds_read_b64_tr_b16 a[102:103], v11 offset:25376
    buffer_load_dwordx4 v8, s[16:19], s35 offen offset:1024 lds
    v_mfma_f32_16x16x32_bf16 v[60:63], a[84:87], a[156:159], v[60:63]
    ds_read_b64_tr_b16 a[104:105], v10 offset:24640
    ds_read_b64_tr_b16 a[106:107], v10 offset:25408
    v_mfma_f32_16x16x32_bf16 v[64:67], a[88:91], a[156:159], v[64:67]
    ds_read_b64_tr_b16 a[108:109], v11 offset:24672
    ds_read_b64_tr_b16 a[110:111], v11 offset:25440
    buffer_load_dwordx4 v9, s[16:19], s35 offen offset:2048 lds
    v_mfma_f32_16x16x32_bf16 v[68:71], a[92:95], a[156:159], v[68:71]
    ds_read_b64_tr_b16 a[112:113], v10 offset:24704
    ds_read_b64_tr_b16 a[114:115], v10 offset:25472
    v_mfma_f32_16x16x32_bf16 v[72:75], a[72:75], a[204:207], v[72:75]
    ds_read_b64_tr_b16 a[116:117], v11 offset:24736
    ds_read_b64_tr_b16 a[118:119], v11 offset:25504
    s_add_u32 m0, s32, 64512
    s_mov_b32 s35, 184320
    buffer_load_dwordx4 v7, s[16:19], s35 offen offset:0 lds
    v_mfma_f32_16x16x32_bf16 v[76:79], a[76:79], a[204:207], v[76:79]
    v_mfma_f32_16x16x32_bf16 v[80:83], a[80:83], a[204:207], v[80:83]
    buffer_load_dwordx4 v8, s[16:19], s35 offen offset:1024 lds
    v_mfma_f32_16x16x32_bf16 v[84:87], a[84:87], a[204:207], v[84:87]
    v_mfma_f32_16x16x32_bf16 v[88:91], a[88:91], a[204:207], v[88:91]
    buffer_load_dwordx4 v9, s[16:19], s35 offen offset:2048 lds
    v_mfma_f32_16x16x32_bf16 v[92:95], a[92:95], a[204:207], v[92:95]
    s_add_u32 m0, s42, s41
    s_add_u32 s42, s42, 12288
    buffer_load_dwordx4 v4, s[12:15], s30 offen offset:0 nt lds
    buffer_load_dwordx4 v5, s[12:15], s30 offen offset:1024 nt lds
    buffer_load_dwordx4 v6, s[12:15], s30 offen offset:2048 nt lds
    s_add_u32 s30, s30, 393216
    s_waitcnt lgkmcnt(0)
    s_waitcnt vmcnt(15)
    v_mfma_f32_16x16x32_bf16 v[48:51], a[96:99], a[160:163], v[48:51]
    ds_read_b128 a[164:167], v1 offset:256
    ds_read_b128 a[212:215], v1 offset:12544
    s_add_u32 m0, s32, 86016
    s_mov_b32 s35, 196608
    buffer_load_dwordx4 v7, s[16:19], s35 offen offset:0 lds
    v_mfma_f32_16x16x32_bf16 v[52:55], a[100:103], a[160:163], v[52:55]
    ds_read_b64_tr_b16 a[120:121], v252 offset:0
    ds_read_b64_tr_b16 a[122:123], v252 offset:768
    v_mfma_f32_16x16x32_bf16 v[56:59], a[104:107], a[160:163], v[56:59]
    ds_read_b64_tr_b16 a[124:125], v253 offset:32
    ds_read_b64_tr_b16 a[126:127], v253 offset:800
    buffer_load_dwordx4 v8, s[16:19], s35 offen offset:1024 lds
    v_mfma_f32_16x16x32_bf16 v[60:63], a[108:111], a[160:163], v[60:63]
    ds_read_b64_tr_b16 a[128:129], v252 offset:64
    ds_read_b64_tr_b16 a[130:131], v252 offset:832
    v_mfma_f32_16x16x32_bf16 v[64:67], a[112:115], a[160:163], v[64:67]
    ds_read_b64_tr_b16 a[132:133], v253 offset:96
    ds_read_b64_tr_b16 a[134:135], v253 offset:864
    buffer_load_dwordx4 v9, s[16:19], s35 offen offset:2048 lds
    v_mfma_f32_16x16x32_bf16 v[68:71], a[116:119], a[160:163], v[68:71]
    ds_read_b64_tr_b16 a[136:137], v252 offset:128
    ds_read_b64_tr_b16 a[138:139], v252 offset:896
    v_mfma_f32_16x16x32_bf16 v[72:75], a[96:99], a[208:211], v[72:75]
    ds_read_b64_tr_b16 a[140:141], v253 offset:160
    ds_read_b64_tr_b16 a[142:143], v253 offset:928
    s_add_u32 m0, s32, 89088
    s_mov_b32 s35, 208896
    buffer_load_dwordx4 v7, s[16:19], s35 offen offset:0 lds
    v_mfma_f32_16x16x32_bf16 v[76:79], a[100:103], a[208:211], v[76:79]
    v_mfma_f32_16x16x32_bf16 v[80:83], a[104:107], a[208:211], v[80:83]
    buffer_load_dwordx4 v8, s[16:19], s35 offen offset:1024 lds
    v_mfma_f32_16x16x32_bf16 v[84:87], a[108:111], a[208:211], v[84:87]
    v_mfma_f32_16x16x32_bf16 v[88:91], a[112:115], a[208:211], v[88:91]
    buffer_load_dwordx4 v9, s[16:19], s35 offen offset:2048 lds
    v_mfma_f32_16x16x32_bf16 v[92:95], a[116:119], a[208:211], v[92:95]
    s_waitcnt lgkmcnt(0)
    s_waitcnt vmcnt(15)
    v_mfma_f32_16x16x32_bf16 v[48:51], a[120:123], a[164:167], v[48:51]
    ds_read_b128 a[168:171], v2 offset:256
    ds_read_b128 a[216:219], v2 offset:12544
    s_add_u32 m0, s32, 110592
    s_mov_b32 s35, 221184
    buffer_load_dwordx4 v7, s[16:19], s35 offen offset:0 lds
    v_mfma_f32_16x16x32_bf16 v[52:55], a[124:127], a[164:167], v[52:55]
    ds_read_b64_tr_b16 v[96:97], v252 offset:24576
    ds_read_b64_tr_b16 v[98:99], v252 offset:25344
    v_mfma_f32_16x16x32_bf16 v[56:59], a[128:131], a[164:167], v[56:59]
    ds_read_b64_tr_b16 v[100:101], v253 offset:24608
    ds_read_b64_tr_b16 v[102:103], v253 offset:25376
    buffer_load_dwordx4 v8, s[16:19], s35 offen offset:1024 lds
    v_mfma_f32_16x16x32_bf16 v[60:63], a[132:135], a[164:167], v[60:63]
    ds_read_b64_tr_b16 v[104:105], v252 offset:24640
    ds_read_b64_tr_b16 v[106:107], v252 offset:25408
    v_mfma_f32_16x16x32_bf16 v[64:67], a[136:139], a[164:167], v[64:67]
    ds_read_b64_tr_b16 v[108:109], v253 offset:24672
    ds_read_b64_tr_b16 v[110:111], v253 offset:25440
    buffer_load_dwordx4 v9, s[16:19], s35 offen offset:2048 lds
    v_mfma_f32_16x16x32_bf16 v[68:71], a[140:143], a[164:167], v[68:71]
    ds_read_b64_tr_b16 v[112:113], v252 offset:24704
    ds_read_b64_tr_b16 v[114:115], v252 offset:25472
    v_mfma_f32_16x16x32_bf16 v[72:75], a[120:123], a[212:215], v[72:75]
    ds_read_b64_tr_b16 v[116:117], v253 offset:24736
    ds_read_b64_tr_b16 v[118:119], v253 offset:25504
    s_add_u32 m0, s32, 113664
    s_mov_b32 s35, 233472
    buffer_load_dwordx4 v7, s[16:19], s35 offen offset:0 lds
    v_mfma_f32_16x16x32_bf16 v[76:79], a[124:127], a[212:215], v[76:79]
    v_mfma_f32_16x16x32_bf16 v[80:83], a[128:131], a[212:215], v[80:83]
    buffer_load_dwordx4 v8, s[16:19], s35 offen offset:1024 lds
    v_mfma_f32_16x16x32_bf16 v[84:87], a[132:135], a[212:215], v[84:87]
    v_mfma_f32_16x16x32_bf16 v[88:91], a[136:139], a[212:215], v[88:91]
    buffer_load_dwordx4 v9, s[16:19], s35 offen offset:2048 lds
    v_mfma_f32_16x16x32_bf16 v[92:95], a[140:143], a[212:215], v[92:95]
    s_waitcnt lgkmcnt(0)
    s_waitcnt vmcnt(15)
    v_mfma_f32_16x16x32_bf16 v[48:51], v[96:99], a[168:171], v[48:51]
    ds_read_b128 a[172:175], v3 offset:256
    ds_read_b128 a[220:223], v3 offset:12544
    s_add_u32 m0, s32, 135168
    s_mov_b32 s35, 245760
    buffer_load_dwordx4 v7, s[16:19], s35 offen offset:0 lds
    v_mfma_f32_16x16x32_bf16 v[52:55], v[100:103], a[168:171], v[52:55]
    ds_read_b64_tr_b16 v[120:121], v10 offset:0
    ds_read_b64_tr_b16 v[122:123], v10 offset:768
    v_mfma_f32_16x16x32_bf16 v[56:59], v[104:107], a[168:171], v[56:59]
    ds_read_b64_tr_b16 v[124:125], v11 offset:32
    ds_read_b64_tr_b16 v[126:127], v11 offset:800
    buffer_load_dwordx4 v8, s[16:19], s35 offen offset:1024 lds
    v_mfma_f32_16x16x32_bf16 v[60:63], v[108:111], a[168:171], v[60:63]
    ds_read_b64_tr_b16 v[128:129], v10 offset:64
    ds_read_b64_tr_b16 v[130:131], v10 offset:832
    v_mfma_f32_16x16x32_bf16 v[64:67], v[112:115], a[168:171], v[64:67]
    ds_read_b64_tr_b16 v[132:133], v11 offset:96
    ds_read_b64_tr_b16 v[134:135], v11 offset:864
    buffer_load_dwordx4 v9, s[16:19], s35 offen offset:2048 lds
    v_mfma_f32_16x16x32_bf16 v[68:71], v[116:119], a[168:171], v[68:71]
    ds_read_b64_tr_b16 v[136:137], v10 offset:128
    ds_read_b64_tr_b16 v[138:139], v10 offset:896
    v_mfma_f32_16x16x32_bf16 v[72:75], v[96:99], a[216:219], v[72:75]
    ds_read_b64_tr_b16 v[140:141], v11 offset:160
    ds_read_b64_tr_b16 v[142:143], v11 offset:928
    s_add_u32 m0, s32, 138240
    s_mov_b32 s35, 258048
    buffer_load_dwordx4 v7, s[16:19], s35 offen offset:0 lds
    v_mfma_f32_16x16x32_bf16 v[76:79], v[100:103], a[216:219], v[76:79]
    v_mfma_f32_16x16x32_bf16 v[80:83], v[104:107], a[216:219], v[80:83]
    buffer_load_dwordx4 v8, s[16:19], s35 offen offset:1024 lds
    v_mfma_f32_16x16x32_bf16 v[84:87], v[108:111], a[216:219], v[84:87]
    v_mfma_f32_16x16x32_bf16 v[88:91], v[112:115], a[216:219], v[88:91]
    buffer_load_dwordx4 v9, s[16:19], s35 offen offset:2048 lds
    v_mfma_f32_16x16x32_bf16 v[92:95], v[116:119], a[216:219], v[92:95]
    s_waitcnt lgkmcnt(0)
    s_waitcnt vmcnt(12)
    v_mfma_f32_16x16x32_bf16 v[48:51], v[120:123], a[172:175], v[48:51]
    ds_read_b128 a[176:179], v0 offset:512
    ds_read_b128 a[224:227], v0 offset:12800
    s_add_u32 m0, s32, 61440
    s_mov_b32 s35, 270336
    buffer_load_dwordx4 v7, s[16:19], s35 offen offset:0 lds
    v_mfma_f32_16x16x32_bf16 v[52:55], v[124:127], a[172:175], v[52:55]
    ds_read_b64_tr_b16 v[144:145], v10 offset:24576
    ds_read_b64_tr_b16 v[146:147], v10 offset:25344
    v_mfma_f32_16x16x32_bf16 v[56:59], v[128:131], a[172:175], v[56:59]
    ds_read_b64_tr_b16 v[148:149], v11 offset:24608
    ds_read_b64_tr_b16 v[150:151], v11 offset:25376
    buffer_load_dwordx4 v8, s[16:19], s35 offen offset:1024 lds
    v_mfma_f32_16x16x32_bf16 v[60:63], v[132:135], a[172:175], v[60:63]
    ds_read_b64_tr_b16 v[152:153], v10 offset:24640
    ds_read_b64_tr_b16 v[154:155], v10 offset:25408
    v_mfma_f32_16x16x32_bf16 v[64:67], v[136:139], a[172:175], v[64:67]
    ds_read_b64_tr_b16 v[156:157], v11 offset:24672
    ds_read_b64_tr_b16 v[158:159], v11 offset:25440
    buffer_load_dwordx4 v9, s[16:19], s35 offen offset:2048 lds
    v_mfma_f32_16x16x32_bf16 v[68:71], v[140:143], a[172:175], v[68:71]
    ds_read_b64_tr_b16 v[160:161], v10 offset:24704
    ds_read_b64_tr_b16 v[162:163], v10 offset:25472
    v_mfma_f32_16x16x32_bf16 v[72:75], v[120:123], a[220:223], v[72:75]
    ds_read_b64_tr_b16 v[164:165], v11 offset:24736
    ds_read_b64_tr_b16 v[166:167], v11 offset:25504
    s_add_u32 m0, s32, 64512
    s_mov_b32 s35, 282624
    buffer_load_dwordx4 v7, s[16:19], s35 offen offset:0 lds
    v_mfma_f32_16x16x32_bf16 v[76:79], v[124:127], a[220:223], v[76:79]
    v_mfma_f32_16x16x32_bf16 v[80:83], v[128:131], a[220:223], v[80:83]
    buffer_load_dwordx4 v8, s[16:19], s35 offen offset:1024 lds
    v_mfma_f32_16x16x32_bf16 v[84:87], v[132:135], a[220:223], v[84:87]
    v_mfma_f32_16x16x32_bf16 v[88:91], v[136:139], a[220:223], v[88:91]
    buffer_load_dwordx4 v9, s[16:19], s35 offen offset:2048 lds
    v_mfma_f32_16x16x32_bf16 v[92:95], v[140:143], a[220:223], v[92:95]
    s_waitcnt lgkmcnt(0)
    s_waitcnt vmcnt(12)
    v_mfma_f32_16x16x32_bf16 v[48:51], v[144:147], a[176:179], v[48:51]
    ds_read_b128 a[180:183], v1 offset:512
    ds_read_b128 a[228:231], v1 offset:12800
    s_add_u32 m0, s42, s41
    s_add_u32 s42, s42, 12288
    buffer_store_dwordx4 a[240:243], v16, s[24:27], 0 offen offset:0 sc0 sc1
    buffer_store_dwordx4 a[244:247], v16, s[24:27], 0 offen offset:1024 sc0 sc1
    buffer_store_dwordx4 a[248:251], v16, s[24:27], 0 offen offset:2048 sc0 sc1
    buffer_load_dwordx4 v4, s[12:15], s30 offen offset:0 nt lds
    buffer_load_dwordx4 v5, s[12:15], s30 offen offset:1024 nt lds
    buffer_load_dwordx4 v6, s[12:15], s30 offen offset:2048 nt lds
    s_add_u32 s30, s30, 393216
    v_mfma_f32_16x16x32_bf16 v[52:55], v[148:151], a[176:179], v[52:55]
    ds_read_b64_tr_b16 v[168:169], v252 offset:0
    ds_read_b64_tr_b16 v[170:171], v252 offset:768
    v_mfma_f32_16x16x32_bf16 v[56:59], v[152:155], a[176:179], v[56:59]
    ds_read_b64_tr_b16 v[172:173], v253 offset:32
    ds_read_b64_tr_b16 v[174:175], v253 offset:800
    v_mfma_f32_16x16x32_bf16 v[60:63], v[156:159], a[176:179], v[60:63]
    ds_read_b64_tr_b16 v[176:177], v252 offset:64
    ds_read_b64_tr_b16 v[178:179], v252 offset:832
    v_mfma_f32_16x16x32_bf16 v[64:67], v[160:163], a[176:179], v[64:67]
    ds_read_b64_tr_b16 v[180:181], v253 offset:96
    ds_read_b64_tr_b16 v[182:183], v253 offset:864
    v_mfma_f32_16x16x32_bf16 v[68:71], v[164:167], a[176:179], v[68:71]
    ds_read_b64_tr_b16 v[184:185], v252 offset:128
    ds_read_b64_tr_b16 v[186:187], v252 offset:896
    v_mfma_f32_16x16x32_bf16 v[72:75], v[144:147], a[224:227], v[72:75]
    ds_read_b64_tr_b16 v[188:189], v253 offset:160
    ds_read_b64_tr_b16 v[190:191], v253 offset:928
    v_mfma_f32_16x16x32_bf16 v[76:79], v[148:151], a[224:227], v[76:79]
    v_mfma_f32_16x16x32_bf16 v[80:83], v[152:155], a[224:227], v[80:83]
    v_mfma_f32_16x16x32_bf16 v[84:87], v[156:159], a[224:227], v[84:87]
    v_mfma_f32_16x16x32_bf16 v[88:91], v[160:163], a[224:227], v[88:91]
    v_mfma_f32_16x16x32_bf16 v[92:95], v[164:167], a[224:227], v[92:95]
    s_waitcnt lgkmcnt(0)
    s_waitcnt vmcnt(12)
    v_mfma_f32_16x16x32_bf16 v[48:51], v[168:171], a[180:183], v[48:51]
    ds_read_b128 a[184:187], v2 offset:512
    ds_read_b128 a[232:235], v2 offset:12800
    s_add_u32 m0, s42, s41
    s_add_u32 s42, s42, 12288
    buffer_store_dwordx4 a[240:243], v16, s[24:27], 0 offen offset:0 sc0 sc1
    buffer_store_dwordx4 a[244:247], v16, s[24:27], 0 offen offset:1024 sc0 sc1
    buffer_store_dwordx4 a[248:251], v16, s[24:27], 0 offen offset:2048 sc0 sc1
    buffer_load_dwordx4 v4, s[12:15], s30 offen offset:0 nt lds
    buffer_load_dwordx4 v5, s[12:15], s30 offen offset:1024 nt lds
    buffer_load_dwordx4 v6, s[12:15], s30 offen offset:2048 nt lds
    s_add_u32 s30, s30, 393216
    v_mfma_f32_16x16x32_bf16 v[52:55], v[172:175], a[180:183], v[52:55]
    ds_read_b64_tr_b16 v[192:193], v252 offset:24576
    ds_read_b64_tr_b16 v[194:195], v252 offset:25344
    v_mfma_f32_16x16x32_bf16 v[56:59], v[176:179], a[180:183], v[56:59]
    ds_read_b64_tr_b16 v[196:197], v253 offset:24608
    ds_read_b64_tr_b16 v[198:199], v253 offset:25376
    v_mfma_f32_16x16x32_bf16 v[60:63], v[180:183], a[180:183], v[60:63]
    ds_read_b64_tr_b16 v[200:201], v252 offset:24640
    ds_read_b64_tr_b16 v[202:203], v252 offset:25408
    v_mfma_f32_16x16x32_bf16 v[64:67], v[184:187], a[180:183], v[64:67]
    ds_read_b64_tr_b16 v[204:205], v253 offset:24672
    ds_read_b64_tr_b16 v[206:207], v253 offset:25440
    v_mfma_f32_16x16x32_bf16 v[68:71], v[188:191], a[180:183], v[68:71]
    ds_read_b64_tr_b16 v[208:209], v252 offset:24704
    ds_read_b64_tr_b16 v[210:211], v252 offset:25472
    v_mfma_f32_16x16x32_bf16 v[72:75], v[168:171], a[228:231], v[72:75]
    ds_read_b64_tr_b16 v[212:213], v253 offset:24736
    ds_read_b64_tr_b16 v[214:215], v253 offset:25504
    v_mfma_f32_16x16x32_bf16 v[76:79], v[172:175], a[228:231], v[76:79]
    v_mfma_f32_16x16x32_bf16 v[80:83], v[176:179], a[228:231], v[80:83]
    v_mfma_f32_16x16x32_bf16 v[84:87], v[180:183], a[228:231], v[84:87]
    v_mfma_f32_16x16x32_bf16 v[88:91], v[184:187], a[228:231], v[88:91]
    v_mfma_f32_16x16x32_bf16 v[92:95], v[188:191], a[228:231], v[92:95]
    s_waitcnt lgkmcnt(0)
    s_waitcnt vmcnt(12)
    v_mfma_f32_16x16x32_bf16 v[48:51], v[192:195], a[184:187], v[48:51]
    ds_read_b128 a[188:191], v3 offset:512
    ds_read_b128 a[236:239], v3 offset:12800
    v_mfma_f32_16x16x32_bf16 v[52:55], v[196:199], a[184:187], v[52:55]
    ds_read_b64_tr_b16 v[216:217], v10 offset:0
    ds_read_b64_tr_b16 v[218:219], v10 offset:768
    v_mfma_f32_16x16x32_bf16 v[56:59], v[200:203], a[184:187], v[56:59]
    ds_read_b64_tr_b16 v[220:221], v11 offset:32
    ds_read_b64_tr_b16 v[222:223], v11 offset:800
    v_mfma_f32_16x16x32_bf16 v[60:63], v[204:207], a[184:187], v[60:63]
    ds_read_b64_tr_b16 v[224:225], v10 offset:64
    ds_read_b64_tr_b16 v[226:227], v10 offset:832
    v_mfma_f32_16x16x32_bf16 v[64:67], v[208:211], a[184:187], v[64:67]
    ds_read_b64_tr_b16 v[228:229], v11 offset:96
    ds_read_b64_tr_b16 v[230:231], v11 offset:864
    v_mfma_f32_16x16x32_bf16 v[68:71], v[212:215], a[184:187], v[68:71]
    ds_read_b64_tr_b16 v[232:233], v10 offset:128
    ds_read_b64_tr_b16 v[234:235], v10 offset:896
    v_mfma_f32_16x16x32_bf16 v[72:75], v[192:195], a[232:235], v[72:75]
    ds_read_b64_tr_b16 v[236:237], v11 offset:160
    ds_read_b64_tr_b16 v[238:239], v11 offset:928
    v_mfma_f32_16x16x32_bf16 v[76:79], v[196:199], a[232:235], v[76:79]
    v_mfma_f32_16x16x32_bf16 v[80:83], v[200:203], a[232:235], v[80:83]
    v_mfma_f32_16x16x32_bf16 v[84:87], v[204:207], a[232:235], v[84:87]
    v_mfma_f32_16x16x32_bf16 v[88:91], v[208:211], a[232:235], v[88:91]
    v_mfma_f32_16x16x32_bf16 v[92:95], v[212:215], a[232:235], v[92:95]
    s_waitcnt lgkmcnt(0)
    s_barrier
    v_mfma_f32_16x16x32_bf16 v[48:51], v[216:219], a[188:191], v[48:51]
    ds_read_b128 a[144:147], v0 offset:24576
    v_mfma_f32_16x16x32_bf16 v[52:55], v[220:223], a[188:191], v[52:55]
    ds_read_b128 a[148:151], v1 offset:24576
    v_mfma_f32_16x16x32_bf16 v[56:59], v[224:227], a[188:191], v[56:59]
    ds_read_b128 a[152:155], v2 offset:24576
    v_mfma_f32_16x16x32_bf16 v[60:63], v[228:231], a[188:191], v[60:63]
    ds_read_b128 a[156:159], v3 offset:24576
    v_mfma_f32_16x16x32_bf16 v[64:67], v[232:235], a[188:191], v[64:67]
    ds_read_b128 a[160:163], v0 offset:24832
    v_mfma_f32_16x16x32_bf16 v[68:71], v[236:239], a[188:191], v[68:71]
    ds_read_b128 a[164:167], v1 offset:24832
    v_mfma_f32_16x16x32_bf16 v[72:75], v[216:219], a[236:239], v[72:75]
    ds_read_b128 a[168:171], v2 offset:24832
    v_mfma_f32_16x16x32_bf16 v[76:79], v[220:223], a[236:239], v[76:79]
    ds_read_b128 a[172:175], v3 offset:24832
    v_mfma_f32_16x16x32_bf16 v[80:83], v[224:227], a[236:239], v[80:83]
    ds_read_b128 a[176:179], v0 offset:25088
    v_mfma_f32_16x16x32_bf16 v[84:87], v[228:231], a[236:239], v[84:87]
    ds_read_b128 a[180:183], v1 offset:25088
    v_mfma_f32_16x16x32_bf16 v[88:91], v[232:235], a[236:239], v[88:91]
    ds_read_b128 a[184:187], v2 offset:25088
    v_mfma_f32_16x16x32_bf16 v[92:95], v[236:239], a[236:239], v[92:95]
    ds_read_b128 a[188:191], v3 offset:25088
    s_waitcnt lgkmcnt(0)
    s_nop 1
    v_cvt_pk_bf16_f32 v48, v48, v49
    v_cvt_pk_bf16_f32 v49, v50, v51
    ds_write_b64 v12, v[48:49] offset:0
    v_cvt_pk_bf16_f32 v52, v52, v53
    v_cvt_pk_bf16_f32 v53, v54, v55
    ds_write_b64 v12, v[52:53] offset:32
    v_cvt_pk_bf16_f32 v56, v56, v57
    v_cvt_pk_bf16_f32 v57, v58, v59
    ds_write_b64 v12, v[56:57] offset:64
    v_cvt_pk_bf16_f32 v60, v60, v61
    v_cvt_pk_bf16_f32 v61, v62, v63
    ds_write_b64 v12, v[60:61] offset:96
    v_cvt_pk_bf16_f32 v64, v64, v65
    v_cvt_pk_bf16_f32 v65, v66, v67
    ds_write_b64 v12, v[64:65] offset:128
    v_cvt_pk_bf16_f32 v68, v68, v69
    v_cvt_pk_bf16_f32 v69, v70, v71
    ds_write_b64 v12, v[68:69] offset:160
    v_add_u32 v0, 36864, v0
    v_add_u32 v1, 36864, v1
    v_add_u32 v2, 36864, v2
    v_add_u32 v3, 36864, v3
    s_mov_b32 s34, 36864
    s_mov_b32 s29, 2
    s_add_u32 m0, s42, s41
    s_mov_b32 s26, 113246208
L_enter:
.p2align 6
L_loop0:
    s_waitcnt vmcnt(6) lgkmcnt(0)
    s_barrier
    v_mfma_f32_16x16x32_bf16 v[48:51], a[0:3], a[144:147], v[24:27]
    ds_read_b128 a[192:195], v0 offset:0
    v_mfma_f32_16x16x32_bf16 v[48:51], a[24:27], a[148:151], v[48:51]
    s_add_u32 s31, s31, 393216
    v_mfma_f32_16x16x32_bf16 v[48:51], a[48:51], a[152:155], v[48:51]
    v_mfma_f32_16x16x32_bf16 v[48:51], a[72:75], a[156:159], v[48:51]
    v_mfma_f32_16x16x32_bf16 v[48:51], a[96:99], a[160:163], v[48:51]
    v_mfma_f32_16x16x32_bf16 v[48:51], a[120:123], a[164:167], v[48:51]
    ds_read_b128 a[196:199], v1 offset:0
    v_mfma_f32_16x16x32_bf16 v[48:51], v[96:99], a[168:171], v[48:51]
    v_mfma_f32_16x16x32_bf16 v[48:51], v[120:123], a[172:175], v[48:51]
    v_mfma_f32_16x16x32_bf16 v[48:51], v[144:147], a[176:179], v[48:51]
    ds_read_b128 a[240:243], v13 offset:0
    v_mfma_f32_16x16x32_bf16 v[48:51], v[168:171], a[180:183], v[48:51]
    v_cvt_pk_bf16_f32 v72, v72, v73
    v_mfma_f32_16x16x32_bf16 v[48:51], v[192:195], a[184:187], v[48:51]
    ds_read_b128 a[200:203], v2 offset:0
    v_mfma_f32_16x16x32_bf16 v[48:51], v[216:219], a[188:191], v[48:51]
    ds_read_b128 a[244:247], v14 offset:0
    v_mfma_f32_16x16x32_bf16 v[52:55], a[4:7], a[144:147], v[28:31]
    v_cvt_pk_bf16_f32 v73, v74, v75
    v_mfma_f32_16x16x32_bf16 v[52:55], a[28:31], a[148:151], v[52:55]
    ds_write_b64 v12, v[72:73] offset:12544
    v_mfma_f32_16x16x32_bf16 v[52:55], a[52:55], a[152:155], v[52:55]
    ds_read_b128 a[248:251], v15 offset:0
    v_mfma_f32_16x16x32_bf16 v[52:55], a[76:79], a[156:159], v[52:55]
    ds_read_b128 a[204:207], v3 offset:0
    v_mfma_f32_16x16x32_bf16 v[52:55], a[100:103], a[160:163], v[52:55]
    v_cvt_pk_bf16_f32 v76, v76, v77
    v_mfma_f32_16x16x32_bf16 v[52:55], a[124:127], a[164:167], v[52:55]
    v_cvt_pk_bf16_f32 v77, v78, v79
    v_mfma_f32_16x16x32_bf16 v[52:55], v[100:103], a[168:171], v[52:55]
    ds_write_b64 v12, v[76:77] offset:12576
    v_mfma_f32_16x16x32_bf16 v[52:55], v[124:127], a[172:175], v[52:55]
    s_add_u32 s38, s34, 12288
    v_mfma_f32_16x16x32_bf16 v[52:55], v[148:151], a[176:179], v[52:55]
    ds_read_b128 a[208:211], v0 offset:256
    v_mfma_f32_16x16x32_bf16 v[52:55], v[172:175], a[180:183], v[52:55]
    s_cmp_eq_u32 s38, 86016
    s_cselect_b32 s38, 0, s38
    v_mfma_f32_16x16x32_bf16 v[52:55], v[196:199], a[184:187], v[52:55]
    s_sub_u32 s33, s38, s34
    v_mfma_f32_16x16x32_bf16 v[52:55], v[220:223], a[188:191], v[52:55]
    s_mov_b32 s34, s38
    v_mfma_f32_16x16x32_bf16 v[56:59], a[8:11], a[144:147], v[32:35]
    s_waitcnt lgkmcnt(7)
    buffer_store_dwordx4 a[240:243], v16, s[24:27], s31 offen offset:0 sc0 sc1
    v_mfma_f32_16x16x32_bf16 v[56:59], a[32:35], a[148:151], v[56:59]
    ds_read_b128 a[212:215], v1 offset:256
    v_mfma_f32_16x16x32_bf16 v[56:59], a[56:59], a[152:155], v[56:59]
    v_cvt_pk_bf16_f32 v80, v80, v81
    v_mfma_f32_16x16x32_bf16 v[56:59], a[80:83], a[156:159], v[56:59]
    s_waitcnt lgkmcnt(6)
    buffer_store_dwordx4 a[244:247], v16, s[24:27], s31 offen offset:1024 sc0 sc1
    v_mfma_f32_16x16x32_bf16 v[56:59], a[104:107], a[160:163], v[56:59]
    v_cvt_pk_bf16_f32 v81, v82, v83
    v_mfma_f32_16x16x32_bf16 v[56:59], a[128:131], a[164:167], v[56:59]
    ds_write_b64 v12, v[80:81] offset:12608
    v_mfma_f32_16x16x32_bf16 v[56:59], v[104:107], a[168:171], v[56:59]
    s_waitcnt lgkmcnt(5)
    buffer_store_dwordx4 a[248:251], v16, s[24:27], s31 offen offset:2048 sc0 sc1
    v_mfma_f32_16x16x32_bf16 v[56:59], v[128:131], a[172:175], v[56:59]
    ds_read_b128 a[216:219], v2 offset:256
    v_mfma_f32_16x16x32_bf16 v[56:59], v[152:155], a[176:179], v[56:59]
    v_cvt_pk_bf16_f32 v84, v84, v85
    v_mfma_f32_16x16x32_bf16 v[56:59], v[176:179], a[180:183], v[56:59]
    buffer_load_dwordx4 v4, s[12:15], s30 offen offset:0 nt lds
    v_mfma_f32_16x16x32_bf16 v[56:59], v[200:203], a[184:187], v[56:59]
    v_cvt_pk_bf16_f32 v85, v86, v87
    v_mfma_f32_16x16x32_bf16 v[56:59], v[224:227], a[188:191], v[56:59]
    ds_read_b128 a[220:223], v3 offset:256
    v_mfma_f32_16x16x32_bf16 v[60:63], a[12:15], a[144:147], v[36:39]
    buffer_load_dwordx4 v5, s[12:15], s30 offen offset:1024 nt lds
    v_mfma_f32_16x16x32_bf16 v[60:63], a[36:39], a[148:151], v[60:63]
    ds_write_b64 v12, v[84:85] offset:12640
    v_mfma_f32_16x16x32_bf16 v[60:63], a[60:63], a[152:155], v[60:63]
    v_mfma_f32_16x16x32_bf16 v[60:63], a[84:87], a[156:159], v[60:63]
    buffer_load_dwordx4 v6, s[12:15], s30 offen offset:2048 nt lds
    v_mfma_f32_16x16x32_bf16 v[60:63], a[108:111], a[160:163], v[60:63]
    ds_read_b128 a[224:227], v0 offset:512
    v_mfma_f32_16x16x32_bf16 v[60:63], a[132:135], a[164:167], v[60:63]
    s_add_u32 s30, s30, 393216
    v_mfma_f32_16x16x32_bf16 v[60:63], v[108:111], a[168:171], v[60:63]
    s_add_u32 s42, s42, 12288
    v_mfma_f32_16x16x32_bf16 v[60:63], v[132:135], a[172:175], v[60:63]
    s_cmp_eq_u32 s42, 86016
    s_cselect_b32 s42, 0, s42
    v_mfma_f32_16x16x32_bf16 v[60:63], v[156:159], a[176:179], v[60:63]
    s_add_u32 m0, s42, s41
    v_mfma_f32_16x16x32_bf16 v[60:63], v[180:183], a[180:183], v[60:63]
    ds_read_b128 a[228:231], v1 offset:512
    v_mfma_f32_16x16x32_bf16 v[60:63], v[204:207], a[184:187], v[60:63]
    s_add_u32 s29, s29, 1
    v_mfma_f32_16x16x32_bf16 v[60:63], v[228:231], a[188:191], v[60:63]
    s_cmp_lt_u32 s29, s43
    s_cselect_b32 s14, s40, 0
    v_mfma_f32_16x16x32_bf16 v[64:67], a[16:19], a[144:147], v[40:43]
    v_cvt_pk_bf16_f32 v88, v88, v89
    v_mfma_f32_16x16x32_bf16 v[64:67], a[40:43], a[148:151], v[64:67]
    v_cvt_pk_bf16_f32 v89, v90, v91
    v_mfma_f32_16x16x32_bf16 v[64:67], a[64:67], a[152:155], v[64:67]
    ds_read_b128 a[232:235], v2 offset:512
    v_mfma_f32_16x16x32_bf16 v[64:67], a[88:91], a[156:159], v[64:67]
    ds_write_b64 v12, v[88:89] offset:12672
    v_mfma_f32_16x16x32_bf16 v[64:67], a[112:115], a[160:163], v[64:67]
    v_cvt_pk_bf16_f32 v92, v92, v93
    v_mfma_f32_16x16x32_bf16 v[64:67], a[136:139], a[164:167], v[64:67]
    v_cvt_pk_bf16_f32 v93, v94, v95
    v_mfma_f32_16x16x32_bf16 v[64:67], v[112:115], a[168:171], v[64:67]
    ds_write_b64 v12, v[92:93] offset:12704
    v_mfma_f32_16x16x32_bf16 v[64:67], v[136:139], a[172:175], v[64:67]
    ds_read_b128 a[236:239], v3 offset:512
    v_mfma_f32_16x16x32_bf16 v[64:67], v[160:163], a[176:179], v[64:67]
    v_add_u32 v0, s33, v0
    v_mfma_f32_16x16x32_bf16 v[64:67], v[184:187], a[180:183], v[64:67]
    v_add_u32 v1, s33, v1
    v_mfma_f32_16x16x32_bf16 v[64:67], v[208:211], a[184:187], v[64:67]
    v_add_u32 v2, s33, v2
    v_mfma_f32_16x16x32_bf16 v[64:67], v[232:235], a[188:191], v[64:67]
    v_add_u32 v3, s33, v3
    v_mfma_f32_16x16x32_bf16 v[68:71], a[20:23], a[144:147], v[44:47]
    v_mfma_f32_16x16x32_bf16 v[68:71], a[44:47], a[148:151], v[68:71]
    v_mfma_f32_16x16x32_bf16 v[68:71], a[68:71], a[152:155], v[68:71]
    v_mfma_f32_16x16x32_bf16 v[68:71], a[92:95], a[156:159], v[68:71]
    v_mfma_f32_16x16x32_bf16 v[68:71], a[116:119], a[160:163], v[68:71]
    v_mfma_f32_16x16x32_bf16 v[68:71], a[140:143], a[164:167], v[68:71]
    v_mfma_f32_16x16x32_bf16 v[68:71], v[116:119], a[168:171], v[68:71]
    v_mfma_f32_16x16x32_bf16 v[68:71], v[140:143], a[172:175], v[68:71]
    v_mfma_f32_16x16x32_bf16 v[68:71], v[164:167], a[176:179], v[68:71]
    v_mfma_f32_16x16x32_bf16 v[68:71], v[188:191], a[180:183], v[68:71]
    v_mfma_f32_16x16x32_bf16 v[68:71], v[212:215], a[184:187], v[68:71]
    v_mfma_f32_16x16x32_bf16 v[68:71], v[236:239], a[188:191], v[68:71]
    s_cmp_ge_u32 s29, s37
    s_cbranch_scc1 L_drain0
    s_waitcnt vmcnt(6) lgkmcnt(0)
    s_barrier
    v_mfma_f32_16x16x32_bf16 v[72:75], a[0:3], a[192:195], v[24:27]
    ds_read_b128 a[144:147], v0 offset:0
    v_mfma_f32_16x16x32_bf16 v[72:75], a[24:27], a[196:199], v[72:75]
    s_add_u32 s31, s31, 393216
    v_mfma_f32_16x16x32_bf16 v[72:75], a[48:51], a[200:203], v[72:75]
    v_mfma_f32_16x16x32_bf16 v[72:75], a[72:75], a[204:207], v[72:75]
    v_mfma_f32_16x16x32_bf16 v[72:75], a[96:99], a[208:211], v[72:75]
    v_mfma_f32_16x16x32_bf16 v[72:75], a[120:123], a[212:215], v[72:75]
    ds_read_b128 a[148:151], v1 offset:0
    v_mfma_f32_16x16x32_bf16 v[72:75], v[96:99], a[216:219], v[72:75]
    v_mfma_f32_16x16x32_bf16 v[72:75], v[120:123], a[220:223], v[72:75]
    v_mfma_f32_16x16x32_bf16 v[72:75], v[144:147], a[224:227], v[72:75]
    ds_read_b128 a[240:243], v13 offset:12544
    v_mfma_f32_16x16x32_bf16 v[72:75], v[168:171], a[228:231], v[72:75]
    v_cvt_pk_bf16_f32 v48, v48, v49
    v_mfma_f32_16x16x32_bf16 v[72:75], v[192:195], a[232:235], v[72:75]
    ds_read_b128 a[152:155], v2 offset:0
    v_mfma_f32_16x16x32_bf16 v[72:75], v[216:219], a[236:239], v[72:75]
    ds_read_b128 a[244:247], v14 offset:12544
    v_mfma_f32_16x16x32_bf16 v[76:79], a[4:7], a[192:195], v[28:31]
    v_cvt_pk_bf16_f32 v49, v50, v51
    v_mfma_f32_16x16x32_bf16 v[76:79], a[28:31], a[196:199], v[76:79]
    ds_write_b64 v12, v[48:49] offset:0
    v_mfma_f32_16x16x32_bf16 v[76:79], a[52:55], a[200:203], v[76:79]
    ds_read_b128 a[248:251], v15 offset:12544
    v_mfma_f32_16x16x32_bf16 v[76:79], a[76:79], a[204:207], v[76:79]
    ds_read_b128 a[156:159], v3 offset:0
    v_mfma_f32_16x16x32_bf16 v[76:79], a[100:103], a[208:211], v[76:79]
    v_cvt_pk_bf16_f32 v52, v52, v53
    v_mfma_f32_16x16x32_bf16 v[76:79], a[124:127], a[212:215], v[76:79]
    v_cvt_pk_bf16_f32 v53, v54, v55
    v_mfma_f32_16x16x32_bf16 v[76:79], v[100:103], a[216:219], v[76:79]
    ds_write_b64 v12, v[52:53] offset:32
    v_mfma_f32_16x16x32_bf16 v[76:79], v[124:127], a[220:223], v[76:79]
    s_add_u32 s38, s34, 12288
    v_mfma_f32_16x16x32_bf16 v[76:79], v[148:151], a[224:227], v[76:79]
    ds_read_b128 a[160:163], v0 offset:256
    v_mfma_f32_16x16x32_bf16 v[76:79], v[172:175], a[228:231], v[76:79]
    s_cmp_eq_u32 s38, 86016
    s_cselect_b32 s38, 0, s38
    v_mfma_f32_16x16x32_bf16 v[76:79], v[196:199], a[232:235], v[76:79]
    s_sub_u32 s33, s38, s34
    v_mfma_f32_16x16x32_bf16 v[76:79], v[220:223], a[236:239], v[76:79]
    s_mov_b32 s34, s38
    v_mfma_f32_16x16x32_bf16 v[80:83], a[8:11], a[192:195], v[32:35]
    s_waitcnt lgkmcnt(7)
    buffer_store_dwordx4 a[240:243], v16, s[24:27], s31 offen offset:0 sc0 sc1
    v_mfma_f32_16x16x32_bf16 v[80:83], a[32:35], a[196:199], v[80:83]
    ds_read_b128 a[164:167], v1 offset:256
    v_mfma_f32_16x16x32_bf16 v[80:83], a[56:59], a[200:203], v[80:83]
    v_cvt_pk_bf16_f32 v56, v56, v57
    v_mfma_f32_16x16x32_bf16 v[80:83], a[80:83], a[204:207], v[80:83]
    s_waitcnt lgkmcnt(6)
    buffer_store_dwordx4 a[244:247], v16, s[24:27], s31 offen offset:1024 sc0 sc1
    v_mfma_f32_16x16x32_bf16 v[80:83], a[104:107], a[208:211], v[80:83]
    v_cvt_pk_bf16_f32 v57, v58, v59
    v_mfma_f32_16x16x32_bf16 v[80:83], a[128:131], a[212:215], v[80:83]
    ds_write_b64 v12, v[56:57] offset:64
    v_mfma_f32_16x16x32_bf16 v[80:83], v[104:107], a[216:219], v[80:83]
    s_waitcnt lgkmcnt(5)
    buffer_store_dwordx4 a[248:251], v16, s[24:27], s31 offen offset:2048 sc0 sc1
    v_mfma_f32_16x16x32_bf16 v[80:83], v[128:131], a[220:223], v[80:83]
    ds_read_b128 a[168:171], v2 offset:256
    v_mfma_f32_16x16x32_bf16 v[80:83], v[152:155], a[224:227], v[80:83]
    v_cvt_pk_bf16_f32 v60, v60, v61
    v_mfma_f32_16x16x32_bf16 v[80:83], v[176:179], a[228:231], v[80:83]
    buffer_load_dwordx4 v4, s[12:15], s30 offen offset:0 nt lds
    v_mfma_f32_16x16x32_bf16 v[80:83], v[200:203], a[232:235], v[80:83]
    v_cvt_pk_bf16_f32 v61, v62, v63
    v_mfma_f32_16x16x32_bf16 v[80:83], v[224:227], a[236:239], v[80:83]
    ds_read_b128 a[172:175], v3 offset:256
    v_mfma_f32_16x16x32_bf16 v[84:87], a[12:15], a[192:195], v[36:39]
    buffer_load_dwordx4 v5, s[12:15], s30 offen offset:1024 nt lds
    v_mfma_f32_16x16x32_bf16 v[84:87], a[36:39], a[196:199], v[84:87]
    ds_write_b64 v12, v[60:61] offset:96
    v_mfma_f32_16x16x32_bf16 v[84:87], a[60:63], a[200:203], v[84:87]
    v_mfma_f32_16x16x32_bf16 v[84:87], a[84:87], a[204:207], v[84:87]
    buffer_load_dwordx4 v6, s[12:15], s30 offen offset:2048 nt lds
    v_mfma_f32_16x16x32_bf16 v[84:87], a[108:111], a[208:211], v[84:87]
    ds_read_b128 a[176:179], v0 offset:512
    v_mfma_f32_16x16x32_bf16 v[84:87], a[132:135], a[212:215], v[84:87]
    s_add_u32 s30, s30, 393216
    v_mfma_f32_16x16x32_bf16 v[84:87], v[108:111], a[216:219], v[84:87]
    s_add_u32 s42, s42, 12288
    v_mfma_f32_16x16x32_bf16 v[84:87], v[132:135], a[220:223], v[84:87]
    s_cmp_eq_u32 s42, 86016
    s_cselect_b32 s42, 0, s42
    v_mfma_f32_16x16x32_bf16 v[84:87], v[156:159], a[224:227], v[84:87]
    s_add_u32 m0, s42, s41
    v_mfma_f32_16x16x32_bf16 v[84:87], v[180:183], a[228:231], v[84:87]
    ds_read_b128 a[180:183], v1 offset:512
    v_mfma_f32_16x16x32_bf16 v[84:87], v[204:207], a[232:235], v[84:87]
    s_add_u32 s29, s29, 1
    v_mfma_f32_16x16x32_bf16 v[84:87], v[228:231], a[236:239], v[84:87]
    s_cmp_lt_u32 s29, s43
    s_cselect_b32 s14, s40, 0
    v_mfma_f32_16x16x32_bf16 v[88:91], a[16:19], a[192:195], v[40:43]
    v_cvt_pk_bf16_f32 v64, v64, v65
    v_mfma_f32_16x16x32_bf16 v[88:91], a[40:43], a[196:199], v[88:91]
    v_cvt_pk_bf16_f32 v65, v66, v67
    v_mfma_f32_16x16x32_bf16 v[88:91], a[64:67], a[200:203], v[88:91]
    ds_read_b128 a[184:187], v2 offset:512
    v_mfma_f32_16x16x32_bf16 v[88:91], a[88:91], a[204:207], v[88:91]
    ds_write_b64 v12, v[64:65] offset:128
    v_mfma_f32_16x16x32_bf16 v[88:91], a[112:115], a[208:211], v[88:91]
    v_cvt_pk_bf16_f32 v68, v68, v69
    v_mfma_f32_16x16x32_bf16 v[88:91], a[136:139], a[212:215], v[88:91]
    v_cvt_pk_bf16_f32 v69, v70, v71
    v_mfma_f32_16x16x32_bf16 v[88:91], v[112:115], a[216:219], v[88:91]
    ds_write_b64 v12, v[68:69] offset:160
    v_mfma_f32_16x16x32_bf16 v[88:91], v[136:139], a[220:223], v[88:91]
    ds_read_b128 a[188:191], v3 offset:512
    v_mfma_f32_16x16x32_bf16 v[88:91], v[160:163], a[224:227], v[88:91]
    v_add_u32 v0, s33, v0
    v_mfma_f32_16x16x32_bf16 v[88:91], v[184:187], a[228:231], v[88:91]
    v_add_u32 v1, s33, v1
    v_mfma_f32_16x16x32_bf16 v[88:91], v[208:211], a[232:235], v[88:91]
    v_add_u32 v2, s33, v2
    v_mfma_f32_16x16x32_bf16 v[88:91], v[232:235], a[236:239], v[88:91]
    v_add_u32 v3, s33, v3
    v_mfma_f32_16x16x32_bf16 v[92:95], a[20:23], a[192:195], v[44:47]
    v_mfma_f32_16x16x32_bf16 v[92:95], a[44:47], a[196:199], v[92:95]
    v_mfma_f32_16x16x32_bf16 v[92:95], a[68:71], a[200:203], v[92:95]
    v_mfma_f32_16x16x32_bf16 v[92:95], a[92:95], a[204:207], v[92:95]
    v_mfma_f32_16x16x32_bf16 v[92:95], a[116:119], a[208:211], v[92:95]
    v_mfma_f32_16x16x32_bf16 v[92:95], a[140:143], a[212:215], v[92:95]
    v_mfma_f32_16x16x32_bf16 v[92:95], v[116:119], a[216:219], v[92:95]
    v_mfma_f32_16x16x32_bf16 v[92:95], v[140:143], a[220:223], v[92:95]
    v_mfma_f32_16x16x32_bf16 v[92:95], v[164:167], a[224:227], v[92:95]
    v_mfma_f32_16x16x32_bf16 v[92:95], v[188:191], a[228:231], v[92:95]
    v_mfma_f32_16x16x32_bf16 v[92:95], v[212:215], a[232:235], v[92:95]
    v_mfma_f32_16x16x32_bf16 v[92:95], v[236:239], a[236:239], v[92:95]
    s_cmp_lt_u32 s29, s37
    s_cbranch_scc1 L_loop0
L_drain1:
    s_waitcnt lgkmcnt(0)
    s_barrier
    s_add_u32 s31, s31, 393216
    s_nop 4
    ds_read_b128 a[240:243], v13 offset:0
    ds_read_b128 a[244:247], v14 offset:0
    ds_read_b128 a[248:251], v15 offset:0
    v_cvt_pk_bf16_f32 v72, v72, v73
    v_cvt_pk_bf16_f32 v73, v74, v75
    ds_write_b64 v12, v[72:73] offset:12544
    v_cvt_pk_bf16_f32 v76, v76, v77
    v_cvt_pk_bf16_f32 v77, v78, v79
    ds_write_b64 v12, v[76:77] offset:12576
    v_cvt_pk_bf16_f32 v80, v80, v81
    v_cvt_pk_bf16_f32 v81, v82, v83
    ds_write_b64 v12, v[80:81] offset:12608
    v_cvt_pk_bf16_f32 v84, v84, v85
    v_cvt_pk_bf16_f32 v85, v86, v87
    ds_write_b64 v12, v[84:85] offset:12640
    v_cvt_pk_bf16_f32 v88, v88, v89
    v_cvt_pk_bf16_f32 v89, v90, v91
    ds_write_b64 v12, v[88:89] offset:12672
    v_cvt_pk_bf16_f32 v92, v92, v93
    v_cvt_pk_bf16_f32 v93, v94, v95
    ds_write_b64 v12, v[92:93] offset:12704
    s_waitcnt lgkmcnt(8)
    buffer_store_dwordx4 a[240:243], v16, s[24:27], s31 offen offset:0 sc0 sc1
    s_waitcnt lgkmcnt(7)
    buffer_store_dwordx4 a[244:247], v16, s[24:27], s31 offen offset:1024 sc0 sc1
    s_waitcnt lgkmcnt(6)
    buffer_store_dwordx4 a[248:251], v16, s[24:27], s31 offen offset:2048 sc0 sc1
    s_add_u32 s31, s31, 393216
    s_waitcnt lgkmcnt(0)
    s_barrier
    ds_read_b128 a[144:147], v13 offset:12544
    ds_read_b128 a[148:151], v14 offset:12544
    ds_read_b128 a[152:155], v15 offset:12544
    s_waitcnt lgkmcnt(2)
    buffer_store_dwordx4 a[144:147], v16, s[24:27], s31 offen offset:0 sc0 sc1
    s_waitcnt lgkmcnt(1)
    buffer_store_dwordx4 a[148:151], v16, s[24:27], s31 offen offset:1024 sc0 sc1
    s_waitcnt lgkmcnt(0)
    buffer_store_dwordx4 a[152:155], v16, s[24:27], s31 offen offset:2048 sc0 sc1
    s_branch L_end
L_drain0:
    s_waitcnt lgkmcnt(0)
    s_barrier
    s_add_u32 s31, s31, 393216
    s_nop 4
    ds_read_b128 a[240:243], v13 offset:12544
    ds_read_b128 a[244:247], v14 offset:12544
    ds_read_b128 a[248:251], v15 offset:12544
    v_cvt_pk_bf16_f32 v48, v48, v49
    v_cvt_pk_bf16_f32 v49, v50, v51
    ds_write_b64 v12, v[48:49] offset:0
    v_cvt_pk_bf16_f32 v52, v52, v53
    v_cvt_pk_bf16_f32 v53, v54, v55
    ds_write_b64 v12, v[52:53] offset:32
    v_cvt_pk_bf16_f32 v56, v56, v57
    v_cvt_pk_bf16_f32 v57, v58, v59
    ds_write_b64 v12, v[56:57] offset:64
    v_cvt_pk_bf16_f32 v60, v60, v61
    v_cvt_pk_bf16_f32 v61, v62, v63
    ds_write_b64 v12, v[60:61] offset:96
    v_cvt_pk_bf16_f32 v64, v64, v65
    v_cvt_pk_bf16_f32 v65, v66, v67
    ds_write_b64 v12, v[64:65] offset:128
    v_cvt_pk_bf16_f32 v68, v68, v69
    v_cvt_pk_bf16_f32 v69, v70, v71
    ds_write_b64 v12, v[68:69] offset:160
    s_waitcnt lgkmcnt(8)
    buffer_store_dwordx4 a[240:243], v16, s[24:27], s31 offen offset:0 sc0 sc1
    s_waitcnt lgkmcnt(7)
    buffer_store_dwordx4 a[244:247], v16, s[24:27], s31 offen offset:1024 sc0 sc1
    s_waitcnt lgkmcnt(6)
    buffer_store_dwordx4 a[248:251], v16, s[24:27], s31 offen offset:2048 sc0 sc1
    s_add_u32 s31, s31, 393216
    s_waitcnt lgkmcnt(0)
    s_barrier
    ds_read_b128 a[144:147], v13 offset:0
    ds_read_b128 a[148:151], v14 offset:0
    ds_read_b128 a[152:155], v15 offset:0
    s_waitcnt lgkmcnt(2)
    buffer_store_dwordx4 a[144:147], v16, s[24:27], s31 offen offset:0 sc0 sc1
    s_waitcnt lgkmcnt(1)
    buffer_store_dwordx4 a[148:151], v16, s[24:27], s31 offen offset:1024 sc0 sc1
    s_waitcnt lgkmcnt(0)
    buffer_store_dwordx4 a[152:155], v16, s[24:27], s31 offen offset:2048 sc0 sc1
L_end:
L_done:
    s_endpgm
.section .rodata,"a"
.p2align 6
.amdhsa_kernel standalone__standard_2d_1d_3d_conv__vision_kernel
  .amdhsa_next_free_vgpr 512
  .amdhsa_next_free_sgpr 96
  .amdhsa_accum_offset 256
  .amdhsa_group_segment_fixed_size 0
  .amdhsa_kernarg_size 48
  .amdhsa_user_sgpr_count 2
  .amdhsa_user_sgpr_kernarg_segment_ptr 1
  .amdhsa_system_sgpr_workgroup_id_x 1
.end_amdhsa_kernel
```

```asm
; @launch grid=(256,1,1) block=(256,1,1) lds=159744
.amdgcn_target "amdgcn-amd-amdhsa--gfx950"
.text
.globl standalone__standard_2d_1d_3d_conv__vision_kernel
.p2align 8
.type standalone__standard_2d_1d_3d_conv__vision_kernel,@function
standalone__standard_2d_1d_3d_conv__vision_kernel:
    s_load_dwordx8 s[4:11], s[0:1], 0
    s_cmp_ge_u32 s2, 256
    s_cbranch_scc1 L_done
    v_lshrrev_b32 v18, 6, v0
    v_and_b32 v19, 63, v0
    v_readfirstlane_b32 s28, v18
    s_lshr_b32 s39, s2, 3
    s_and_b32 s39, s39, 31
    s_lshl_b32 s39, s39, 8
    v_add_u32 v255, s39, v0
    v_mul_u32_u24 v255, 36, v255
    v_and_b32 v20, 15, v0
    v_bfe_u32 v21, v0, 4, 2
    v_mul_u32_u24 v22, 3072, v18
    v_add_u32 v23, 16, v19
    v_lshrrev_b32 v23, 6, v23
    v_lshl_add_u32 v23, v18, 2, v23
    v_xor_b32 v23, v23, v19
    v_lshl_add_u32 v4, v23, 4, v22
    v_lshrrev_b32 v23, 5, v19
    v_add_u32 v23, 1, v23
    v_lshl_add_u32 v23, v18, 2, v23
    v_xor_b32 v23, v23, v19
    v_lshl_add_u32 v5, v23, 4, v22
    v_add_u32 v23, 48, v19
    v_lshrrev_b32 v23, 6, v23
    v_add_u32 v23, 2, v23
    v_lshl_add_u32 v23, v18, 2, v23
    v_xor_b32 v23, v23, v19
    v_lshl_add_u32 v6, v23, 4, v22
    s_and_b32 s39, s2, 7
    s_mul_i32 s39, s39, 1152
    s_bitcmp1_b32 s2, 0
    s_cselect_b32 s38, 32, 0
    s_add_u32 s39, s39, s38
    s_lshr_b32 s30, s2, 3
    s_add_u32 s30, s30, s39
    s_mul_i32 s30, s30, 12288
    s_sub_u32 s31, s30, 393216
    s_mul_i32 s41, s28, 3072
    s_mov_b32 s42, 0
    s_mov_b32 s14, 113246208
    s_mov_b32 s15, 0x20000
    s_mov_b32 s18, 294912
    s_mov_b32 s19, 0x20000
    s_waitcnt lgkmcnt(0)
    s_mov_b32 s12, s4
    s_and_b32 s13, s5, 0xffff
    s_mov_b32 s16, s6
    s_and_b32 s17, s7, 0xffff
L_g0:
    buffer_load_dword v254, v255, s[16:19], 0 offen
    s_add_u32 m0, s42, s41
    s_add_u32 s42, s42, 12288
    buffer_load_dwordx4 v4, s[12:15], s30 offen offset:0 nt lds
    buffer_load_dwordx4 v5, s[12:15], s30 offen offset:1024 nt lds
    buffer_load_dwordx4 v6, s[12:15], s30 offen offset:2048 nt lds
    s_add_u32 s30, s30, 393216
    s_add_u32 m0, s42, s41
    s_add_u32 s42, s42, 12288
    buffer_load_dwordx4 v4, s[12:15], s30 offen offset:0 nt lds
    buffer_load_dwordx4 v5, s[12:15], s30 offen offset:1024 nt lds
    buffer_load_dwordx4 v6, s[12:15], s30 offen offset:2048 nt lds
    s_add_u32 s30, s30, 393216
    s_mul_i32 s32, s28, 6144
    s_bitcmp1_b32 s2, 0
    s_mov_b32 s37, 37
    s_cselect_b32 s37, 35, s37
    s_sub_u32 s43, s37, 4
    v_mul_u32_u24 v22, 192, v18
    v_add_u32 v240, 0, v19
    v_mul_u32_u24 v241, 171, v240
    v_lshrrev_b32 v241, 11, v241
    v_mul_u32_u24 v242, 12, v241
    v_sub_u32 v240, v240, v242
    v_bfe_u32 v242, v241, 3, 1
    v_lshlrev_b32 v242, 1, v242
    v_xor_b32 v240, v240, v242
    v_lshl_add_u32 v240, v240, 4, v22
    v_mul_u32_u24 v241, 768, v241
    v_add_u32 v240, v240, v241
    v_subrev_u32 v7, 0, v240
    v_add_u32 v240, 64, v19
    v_mul_u32_u24 v241, 171, v240
    v_lshrrev_b32 v241, 11, v241
    v_mul_u32_u24 v242, 12, v241
    v_sub_u32 v240, v240, v242
    v_bfe_u32 v242, v241, 3, 1
    v_lshlrev_b32 v242, 1, v242
    v_xor_b32 v240, v240, v242
    v_lshl_add_u32 v240, v240, 4, v22
    v_mul_u32_u24 v241, 768, v241
    v_add_u32 v240, v240, v241
    v_subrev_u32 v8, 1024, v240
    v_add_u32 v240, 128, v19
    v_mul_u32_u24 v241, 171, v240
    v_lshrrev_b32 v241, 11, v241
    v_mul_u32_u24 v242, 12, v241
    v_sub_u32 v240, v240, v242
    v_bfe_u32 v242, v241, 3, 1
    v_lshlrev_b32 v242, 1, v242
    v_xor_b32 v240, v240, v242
    v_lshl_add_u32 v240, v240, 4, v22
    v_mul_u32_u24 v241, 768, v241
    v_add_u32 v240, v240, v241
    v_subrev_u32 v9, 2048, v240
    s_mov_b32 s24, s10
    s_and_b32 s25, s11, 0xffff
    s_mov_b32 s26, 0
    s_mov_b32 s27, 0x20000
    s_add_u32 m0, s32, 86016
    s_mov_b32 s35, 0
    buffer_load_dwordx4 v7, s[16:19], s35 offen offset:0 lds
    buffer_load_dwordx4 v8, s[16:19], s35 offen offset:1024 lds
    buffer_load_dwordx4 v9, s[16:19], s35 offen offset:2048 lds
    s_add_u32 m0, s32, 89088
    s_mov_b32 s35, 12288
    buffer_load_dwordx4 v7, s[16:19], s35 offen offset:0 lds
    buffer_load_dwordx4 v8, s[16:19], s35 offen offset:1024 lds
    buffer_load_dwordx4 v9, s[16:19], s35 offen offset:2048 lds
    v_mul_u32_u24 v22, 192, v18
    v_lshl_add_u32 v17, v21, 3, v22
    s_mov_b32 s20, s8
    s_and_b32 s21, s9, 0xffff
    s_mov_b32 s22, 768
    s_mov_b32 s23, 0x20000
    buffer_load_dwordx2 a[240:241], v17, s[20:23], 0 offen offset:0
    buffer_load_dwordx2 a[242:243], v17, s[20:23], 0 offen offset:32
    buffer_load_dwordx2 a[244:245], v17, s[20:23], 0 offen offset:64
    buffer_load_dwordx2 a[246:247], v17, s[20:23], 0 offen offset:96
    buffer_load_dwordx2 a[248:249], v17, s[20:23], 0 offen offset:128
    buffer_load_dwordx2 a[250:251], v17, s[20:23], 0 offen offset:160
    v_mul_u32_u24 v22, 768, v20
    v_add_u32 v23, 0, v21
    v_xor_b32 v23, v23, v20
    v_lshl_add_u32 v0, v23, 4, v22
    v_add_u32 v23, 4, v21
    v_xor_b32 v23, v23, v20
    v_lshl_add_u32 v1, v23, 4, v22
    v_add_u32 v23, 8, v21
    v_xor_b32 v23, v23, v20
    v_lshl_add_u32 v2, v23, 4, v22
    v_add_u32 v23, 12, v21
    v_xor_b32 v23, v23, v20
    v_lshl_add_u32 v3, v23, 4, v22
    v_lshrrev_b32 v22, 2, v20
    v_lshl_add_u32 v22, v21, 3, v22
    v_mul_u32_u24 v22, 192, v22
    v_and_b32 v23, 3, v20
    v_lshl_add_u32 v22, v23, 3, v22
    v_mul_u32_u24 v23, 6144, v18
    v_add_u32 v22, v22, v23
    v_add_u32 v22, 61440, v22
    v_and_b32 v23, 1, v21
    v_lshlrev_b32 v23, 5, v23
    v_add_u32 v10, v22, v23
    v_sub_u32 v11, v22, v23
    v_add_u32 v252, 49152, v10
    v_add_u32 v253, 49152, v11
    v_mul_u32_u24 v12, 784, v20
    v_add_u32 v12, v12, v17
    v_add_u32 v12, 86016, v12
    v_mul_u32_u24 v16, 3072, v18
    v_lshl_add_u32 v16, v19, 4, v16
    v_mul_u32_u24 v22, 3136, v18
    v_add_u32 v22, 86016, v22
    v_add_u32 v23, 16, v19
    v_lshrrev_b32 v23, 6, v23
    v_add_u32 v23, v23, v19
    v_lshl_add_u32 v23, v23, 4, v22
    v_add_u32 v13, 0, v23
    v_lshrrev_b32 v23, 5, v19
    v_add_u32 v23, 1, v23
    v_add_u32 v23, v23, v19
    v_lshl_add_u32 v23, v23, 4, v22
    v_add_u32 v14, 1024, v23
    v_add_u32 v23, 48, v19
    v_lshrrev_b32 v23, 6, v23
    v_add_u32 v23, 2, v23
    v_add_u32 v23, v23, v19
    v_lshl_add_u32 v23, v23, 4, v22
    v_add_u32 v15, 2048, v23
    s_mov_b32 s40, 113246208
    s_add_u32 m0, s32, 110592
    s_mov_b32 s35, 24576
    buffer_load_dwordx4 v7, s[16:19], s35 offen offset:0 lds
    buffer_load_dwordx4 v8, s[16:19], s35 offen offset:1024 lds
    buffer_load_dwordx4 v9, s[16:19], s35 offen offset:2048 lds
    s_add_u32 m0, s32, 113664
    s_mov_b32 s35, 36864
    buffer_load_dwordx4 v7, s[16:19], s35 offen offset:0 lds
    buffer_load_dwordx4 v8, s[16:19], s35 offen offset:1024 lds
    buffer_load_dwordx4 v9, s[16:19], s35 offen offset:2048 lds
    s_add_u32 m0, s32, 135168
    s_mov_b32 s35, 49152
    buffer_load_dwordx4 v7, s[16:19], s35 offen offset:0 lds
    buffer_load_dwordx4 v8, s[16:19], s35 offen offset:1024 lds
    buffer_load_dwordx4 v9, s[16:19], s35 offen offset:2048 lds
    s_add_u32 m0, s32, 138240
    s_mov_b32 s35, 61440
    buffer_load_dwordx4 v7, s[16:19], s35 offen offset:0 lds
    buffer_load_dwordx4 v8, s[16:19], s35 offen offset:1024 lds
    buffer_load_dwordx4 v9, s[16:19], s35 offen offset:2048 lds
    s_add_u32 m0, s32, 61440
    s_mov_b32 s35, 73728
    buffer_load_dwordx4 v7, s[16:19], s35 offen offset:0 lds
    buffer_load_dwordx4 v8, s[16:19], s35 offen offset:1024 lds
    buffer_load_dwordx4 v9, s[16:19], s35 offen offset:2048 lds
    s_add_u32 m0, s32, 64512
    s_mov_b32 s35, 86016
    buffer_load_dwordx4 v7, s[16:19], s35 offen offset:0 lds
    buffer_load_dwordx4 v8, s[16:19], s35 offen offset:1024 lds
    buffer_load_dwordx4 v9, s[16:19], s35 offen offset:2048 lds
    s_waitcnt vmcnt(30)
    s_barrier
    ds_read_b128 a[144:147], v0 offset:0
    ds_read_b128 a[192:195], v0 offset:12288
    s_waitcnt vmcnt(24)
    ds_read_b64_tr_b16 a[0:1], v10 offset:24576
    ds_read_b64_tr_b16 a[2:3], v10 offset:25344
    ds_read_b64_tr_b16 a[4:5], v11 offset:24608
    ds_read_b64_tr_b16 a[6:7], v11 offset:25376
    ds_read_b64_tr_b16 a[8:9], v10 offset:24640
    ds_read_b64_tr_b16 a[10:11], v10 offset:25408
    ds_read_b64_tr_b16 a[12:13], v11 offset:24672
    ds_read_b64_tr_b16 a[14:15], v11 offset:25440
    ds_read_b64_tr_b16 a[16:17], v10 offset:24704
    ds_read_b64_tr_b16 a[18:19], v10 offset:25472
    ds_read_b64_tr_b16 a[20:21], v11 offset:24736
    ds_read_b64_tr_b16 a[22:23], v11 offset:25504
    s_waitcnt vmcnt(18)
    v_accvgpr_read_b32 v240, a240
    v_accvgpr_read_b32 v241, a241
    v_accvgpr_read_b32 v242, a242
    v_accvgpr_read_b32 v243, a243
    v_accvgpr_read_b32 v244, a244
    v_accvgpr_read_b32 v245, a245
    v_accvgpr_read_b32 v246, a246
    v_accvgpr_read_b32 v247, a247
    v_accvgpr_read_b32 v248, a248
    v_accvgpr_read_b32 v249, a249
    v_accvgpr_read_b32 v250, a250
    v_accvgpr_read_b32 v251, a251
    v_lshlrev_b32 v24, 16, v240
    v_and_b32 v25, 0xffff0000, v240
    v_lshlrev_b32 v26, 16, v241
    v_and_b32 v27, 0xffff0000, v241
    v_lshlrev_b32 v28, 16, v242
    v_and_b32 v29, 0xffff0000, v242
    v_lshlrev_b32 v30, 16, v243
    v_and_b32 v31, 0xffff0000, v243
    v_lshlrev_b32 v32, 16, v244
    v_and_b32 v33, 0xffff0000, v244
    v_lshlrev_b32 v34, 16, v245
    v_and_b32 v35, 0xffff0000, v245
    v_lshlrev_b32 v36, 16, v246
    v_and_b32 v37, 0xffff0000, v246
    v_lshlrev_b32 v38, 16, v247
    v_and_b32 v39, 0xffff0000, v247
    v_lshlrev_b32 v40, 16, v248
    v_and_b32 v41, 0xffff0000, v248
    v_lshlrev_b32 v42, 16, v249
    v_and_b32 v43, 0xffff0000, v249
    v_lshlrev_b32 v44, 16, v250
    v_and_b32 v45, 0xffff0000, v250
    v_lshlrev_b32 v46, 16, v251
    v_and_b32 v47, 0xffff0000, v251
    s_waitcnt lgkmcnt(0)
    s_waitcnt vmcnt(12)
    v_mfma_f32_16x16x32_bf16 v[48:51], a[0:3], a[144:147], v[24:27]
    ds_read_b128 a[148:151], v1 offset:0
    ds_read_b128 a[196:199], v1 offset:12288
    s_add_u32 m0, s32, 86016
    s_mov_b32 s35, 98304
    buffer_load_dwordx4 v7, s[16:19], s35 offen offset:0 lds
    v_mfma_f32_16x16x32_bf16 v[52:55], a[4:7], a[144:147], v[28:31]
    ds_read_b64_tr_b16 a[24:25], v252 offset:0
    ds_read_b64_tr_b16 a[26:27], v252 offset:768
    v_mfma_f32_16x16x32_bf16 v[56:59], a[8:11], a[144:147], v[32:35]
    ds_read_b64_tr_b16 a[28:29], v253 offset:32
    ds_read_b64_tr_b16 a[30:31], v253 offset:800
    buffer_load_dwordx4 v8, s[16:19], s35 offen offset:1024 lds
    v_mfma_f32_16x16x32_bf16 v[60:63], a[12:15], a[144:147], v[36:39]
    ds_read_b64_tr_b16 a[32:33], v252 offset:64
    ds_read_b64_tr_b16 a[34:35], v252 offset:832
    v_mfma_f32_16x16x32_bf16 v[64:67], a[16:19], a[144:147], v[40:43]
    ds_read_b64_tr_b16 a[36:37], v253 offset:96
    ds_read_b64_tr_b16 a[38:39], v253 offset:864
    buffer_load_dwordx4 v9, s[16:19], s35 offen offset:2048 lds
    v_mfma_f32_16x16x32_bf16 v[68:71], a[20:23], a[144:147], v[44:47]
    ds_read_b64_tr_b16 a[40:41], v252 offset:128
    ds_read_b64_tr_b16 a[42:43], v252 offset:896
    v_mfma_f32_16x16x32_bf16 v[72:75], a[0:3], a[192:195], v[24:27]
    ds_read_b64_tr_b16 a[44:45], v253 offset:160
    ds_read_b64_tr_b16 a[46:47], v253 offset:928
    s_add_u32 m0, s32, 89088
    s_mov_b32 s35, 110592
    buffer_load_dwordx4 v7, s[16:19], s35 offen offset:0 lds
    v_mfma_f32_16x16x32_bf16 v[76:79], a[4:7], a[192:195], v[28:31]
    v_mfma_f32_16x16x32_bf16 v[80:83], a[8:11], a[192:195], v[32:35]
    buffer_load_dwordx4 v8, s[16:19], s35 offen offset:1024 lds
    v_mfma_f32_16x16x32_bf16 v[84:87], a[12:15], a[192:195], v[36:39]
    v_mfma_f32_16x16x32_bf16 v[88:91], a[16:19], a[192:195], v[40:43]
    buffer_load_dwordx4 v9, s[16:19], s35 offen offset:2048 lds
    v_mfma_f32_16x16x32_bf16 v[92:95], a[20:23], a[192:195], v[44:47]
    s_waitcnt lgkmcnt(0)
    s_waitcnt vmcnt(12)
    v_mfma_f32_16x16x32_bf16 v[48:51], a[24:27], a[148:151], v[48:51]
    ds_read_b128 a[152:155], v2 offset:0
    ds_read_b128 a[200:203], v2 offset:12288
    s_add_u32 m0, s32, 110592
    s_mov_b32 s35, 122880
    buffer_load_dwordx4 v7, s[16:19], s35 offen offset:0 lds
    v_mfma_f32_16x16x32_bf16 v[52:55], a[28:31], a[148:151], v[52:55]
    ds_read_b64_tr_b16 a[48:49], v252 offset:24576
    ds_read_b64_tr_b16 a[50:51], v252 offset:25344
    v_mfma_f32_16x16x32_bf16 v[56:59], a[32:35], a[148:151], v[56:59]
    ds_read_b64_tr_b16 a[52:53], v253 offset:24608
    ds_read_b64_tr_b16 a[54:55], v253 offset:25376
    buffer_load_dwordx4 v8, s[16:19], s35 offen offset:1024 lds
    v_mfma_f32_16x16x32_bf16 v[60:63], a[36:39], a[148:151], v[60:63]
    ds_read_b64_tr_b16 a[56:57], v252 offset:24640
    ds_read_b64_tr_b16 a[58:59], v252 offset:25408
    v_mfma_f32_16x16x32_bf16 v[64:67], a[40:43], a[148:151], v[64:67]
    ds_read_b64_tr_b16 a[60:61], v253 offset:24672
    ds_read_b64_tr_b16 a[62:63], v253 offset:25440
    buffer_load_dwordx4 v9, s[16:19], s35 offen offset:2048 lds
    v_mfma_f32_16x16x32_bf16 v[68:71], a[44:47], a[148:151], v[68:71]
    ds_read_b64_tr_b16 a[64:65], v252 offset:24704
    ds_read_b64_tr_b16 a[66:67], v252 offset:25472
    v_mfma_f32_16x16x32_bf16 v[72:75], a[24:27], a[196:199], v[72:75]
    ds_read_b64_tr_b16 a[68:69], v253 offset:24736
    ds_read_b64_tr_b16 a[70:71], v253 offset:25504
    s_add_u32 m0, s32, 113664
    s_mov_b32 s35, 135168
    buffer_load_dwordx4 v7, s[16:19], s35 offen offset:0 lds
    v_mfma_f32_16x16x32_bf16 v[76:79], a[28:31], a[196:199], v[76:79]
    v_mfma_f32_16x16x32_bf16 v[80:83], a[32:35], a[196:199], v[80:83]
    buffer_load_dwordx4 v8, s[16:19], s35 offen offset:1024 lds
    v_mfma_f32_16x16x32_bf16 v[84:87], a[36:39], a[196:199], v[84:87]
    v_mfma_f32_16x16x32_bf16 v[88:91], a[40:43], a[196:199], v[88:91]
    buffer_load_dwordx4 v9, s[16:19], s35 offen offset:2048 lds
    v_mfma_f32_16x16x32_bf16 v[92:95], a[44:47], a[196:199], v[92:95]
    s_waitcnt lgkmcnt(0)
    s_waitcnt vmcnt(12)
    v_mfma_f32_16x16x32_bf16 v[48:51], a[48:51], a[152:155], v[48:51]
    ds_read_b128 a[156:159], v3 offset:0
    ds_read_b128 a[204:207], v3 offset:12288
    s_add_u32 m0, s32, 135168
    s_mov_b32 s35, 147456
    buffer_load_dwordx4 v7, s[16:19], s35 offen offset:0 lds
    v_mfma_f32_16x16x32_bf16 v[52:55], a[52:55], a[152:155], v[52:55]
    ds_read_b64_tr_b16 a[72:73], v10 offset:0
    ds_read_b64_tr_b16 a[74:75], v10 offset:768
    v_mfma_f32_16x16x32_bf16 v[56:59], a[56:59], a[152:155], v[56:59]
    ds_read_b64_tr_b16 a[76:77], v11 offset:32
    ds_read_b64_tr_b16 a[78:79], v11 offset:800
    buffer_load_dwordx4 v8, s[16:19], s35 offen offset:1024 lds
    v_mfma_f32_16x16x32_bf16 v[60:63], a[60:63], a[152:155], v[60:63]
    ds_read_b64_tr_b16 a[80:81], v10 offset:64
    ds_read_b64_tr_b16 a[82:83], v10 offset:832
    v_mfma_f32_16x16x32_bf16 v[64:67], a[64:67], a[152:155], v[64:67]
    ds_read_b64_tr_b16 a[84:85], v11 offset:96
    ds_read_b64_tr_b16 a[86:87], v11 offset:864
    buffer_load_dwordx4 v9, s[16:19], s35 offen offset:2048 lds
    v_mfma_f32_16x16x32_bf16 v[68:71], a[68:71], a[152:155], v[68:71]
    ds_read_b64_tr_b16 a[88:89], v10 offset:128
    ds_read_b64_tr_b16 a[90:91], v10 offset:896
    v_mfma_f32_16x16x32_bf16 v[72:75], a[48:51], a[200:203], v[72:75]
    ds_read_b64_tr_b16 a[92:93], v11 offset:160
    ds_read_b64_tr_b16 a[94:95], v11 offset:928
    s_add_u32 m0, s32, 138240
    s_mov_b32 s35, 159744
    buffer_load_dwordx4 v7, s[16:19], s35 offen offset:0 lds
    v_mfma_f32_16x16x32_bf16 v[76:79], a[52:55], a[200:203], v[76:79]
    v_mfma_f32_16x16x32_bf16 v[80:83], a[56:59], a[200:203], v[80:83]
    buffer_load_dwordx4 v8, s[16:19], s35 offen offset:1024 lds
    v_mfma_f32_16x16x32_bf16 v[84:87], a[60:63], a[200:203], v[84:87]
    v_mfma_f32_16x16x32_bf16 v[88:91], a[64:67], a[200:203], v[88:91]
    buffer_load_dwordx4 v9, s[16:19], s35 offen offset:2048 lds
    v_mfma_f32_16x16x32_bf16 v[92:95], a[68:71], a[200:203], v[92:95]
    s_waitcnt lgkmcnt(0)
    s_waitcnt vmcnt(12)
    v_mfma_f32_16x16x32_bf16 v[48:51], a[72:75], a[156:159], v[48:51]
    ds_read_b128 a[160:163], v0 offset:256
    ds_read_b128 a[208:211], v0 offset:12544
    s_add_u32 m0, s32, 61440
    s_mov_b32 s35, 172032
    buffer_load_dwordx4 v7, s[16:19], s35 offen offset:0 lds
    v_mfma_f32_16x16x32_bf16 v[52:55], a[76:79], a[156:159], v[52:55]
    ds_read_b64_tr_b16 a[96:97], v10 offset:24576
    ds_read_b64_tr_b16 a[98:99], v10 offset:25344
    v_mfma_f32_16x16x32_bf16 v[56:59], a[80:83], a[156:159], v[56:59]
    ds_read_b64_tr_b16 a[100:101], v11 offset:24608
    ds_read_b64_tr_b16 a[102:103], v11 offset:25376
    buffer_load_dwordx4 v8, s[16:19], s35 offen offset:1024 lds
    v_mfma_f32_16x16x32_bf16 v[60:63], a[84:87], a[156:159], v[60:63]
    ds_read_b64_tr_b16 a[104:105], v10 offset:24640
    ds_read_b64_tr_b16 a[106:107], v10 offset:25408
    v_mfma_f32_16x16x32_bf16 v[64:67], a[88:91], a[156:159], v[64:67]
    ds_read_b64_tr_b16 a[108:109], v11 offset:24672
    ds_read_b64_tr_b16 a[110:111], v11 offset:25440
    buffer_load_dwordx4 v9, s[16:19], s35 offen offset:2048 lds
    v_mfma_f32_16x16x32_bf16 v[68:71], a[92:95], a[156:159], v[68:71]
    ds_read_b64_tr_b16 a[112:113], v10 offset:24704
    ds_read_b64_tr_b16 a[114:115], v10 offset:25472
    v_mfma_f32_16x16x32_bf16 v[72:75], a[72:75], a[204:207], v[72:75]
    ds_read_b64_tr_b16 a[116:117], v11 offset:24736
    ds_read_b64_tr_b16 a[118:119], v11 offset:25504
    s_add_u32 m0, s32, 64512
    s_mov_b32 s35, 184320
    buffer_load_dwordx4 v7, s[16:19], s35 offen offset:0 lds
    v_mfma_f32_16x16x32_bf16 v[76:79], a[76:79], a[204:207], v[76:79]
    v_mfma_f32_16x16x32_bf16 v[80:83], a[80:83], a[204:207], v[80:83]
    buffer_load_dwordx4 v8, s[16:19], s35 offen offset:1024 lds
    v_mfma_f32_16x16x32_bf16 v[84:87], a[84:87], a[204:207], v[84:87]
    v_mfma_f32_16x16x32_bf16 v[88:91], a[88:91], a[204:207], v[88:91]
    buffer_load_dwordx4 v9, s[16:19], s35 offen offset:2048 lds
    v_mfma_f32_16x16x32_bf16 v[92:95], a[92:95], a[204:207], v[92:95]
    s_add_u32 m0, s42, s41
    s_add_u32 s42, s42, 12288
    buffer_load_dwordx4 v4, s[12:15], s30 offen offset:0 nt lds
    buffer_load_dwordx4 v5, s[12:15], s30 offen offset:1024 nt lds
    buffer_load_dwordx4 v6, s[12:15], s30 offen offset:2048 nt lds
    s_add_u32 s30, s30, 393216
    s_waitcnt lgkmcnt(0)
    s_waitcnt vmcnt(15)
    v_mfma_f32_16x16x32_bf16 v[48:51], a[96:99], a[160:163], v[48:51]
    ds_read_b128 a[164:167], v1 offset:256
    ds_read_b128 a[212:215], v1 offset:12544
    s_add_u32 m0, s32, 86016
    s_mov_b32 s35, 196608
    buffer_load_dwordx4 v7, s[16:19], s35 offen offset:0 lds
    v_mfma_f32_16x16x32_bf16 v[52:55], a[100:103], a[160:163], v[52:55]
    ds_read_b64_tr_b16 a[120:121], v252 offset:0
    ds_read_b64_tr_b16 a[122:123], v252 offset:768
    v_mfma_f32_16x16x32_bf16 v[56:59], a[104:107], a[160:163], v[56:59]
    ds_read_b64_tr_b16 a[124:125], v253 offset:32
    ds_read_b64_tr_b16 a[126:127], v253 offset:800
    buffer_load_dwordx4 v8, s[16:19], s35 offen offset:1024 lds
    v_mfma_f32_16x16x32_bf16 v[60:63], a[108:111], a[160:163], v[60:63]
    ds_read_b64_tr_b16 a[128:129], v252 offset:64
    ds_read_b64_tr_b16 a[130:131], v252 offset:832
    v_mfma_f32_16x16x32_bf16 v[64:67], a[112:115], a[160:163], v[64:67]
    ds_read_b64_tr_b16 a[132:133], v253 offset:96
    ds_read_b64_tr_b16 a[134:135], v253 offset:864
    buffer_load_dwordx4 v9, s[16:19], s35 offen offset:2048 lds
    v_mfma_f32_16x16x32_bf16 v[68:71], a[116:119], a[160:163], v[68:71]
    ds_read_b64_tr_b16 a[136:137], v252 offset:128
    ds_read_b64_tr_b16 a[138:139], v252 offset:896
    v_mfma_f32_16x16x32_bf16 v[72:75], a[96:99], a[208:211], v[72:75]
    ds_read_b64_tr_b16 a[140:141], v253 offset:160
    ds_read_b64_tr_b16 a[142:143], v253 offset:928
    s_add_u32 m0, s32, 89088
    s_mov_b32 s35, 208896
    buffer_load_dwordx4 v7, s[16:19], s35 offen offset:0 lds
    v_mfma_f32_16x16x32_bf16 v[76:79], a[100:103], a[208:211], v[76:79]
    v_mfma_f32_16x16x32_bf16 v[80:83], a[104:107], a[208:211], v[80:83]
    buffer_load_dwordx4 v8, s[16:19], s35 offen offset:1024 lds
    v_mfma_f32_16x16x32_bf16 v[84:87], a[108:111], a[208:211], v[84:87]
    v_mfma_f32_16x16x32_bf16 v[88:91], a[112:115], a[208:211], v[88:91]
    buffer_load_dwordx4 v9, s[16:19], s35 offen offset:2048 lds
    v_mfma_f32_16x16x32_bf16 v[92:95], a[116:119], a[208:211], v[92:95]
    s_waitcnt lgkmcnt(0)
    s_waitcnt vmcnt(15)
    v_mfma_f32_16x16x32_bf16 v[48:51], a[120:123], a[164:167], v[48:51]
    ds_read_b128 a[168:171], v2 offset:256
    ds_read_b128 a[216:219], v2 offset:12544
    s_add_u32 m0, s32, 110592
    s_mov_b32 s35, 221184
    buffer_load_dwordx4 v7, s[16:19], s35 offen offset:0 lds
    v_mfma_f32_16x16x32_bf16 v[52:55], a[124:127], a[164:167], v[52:55]
    ds_read_b64_tr_b16 v[96:97], v252 offset:24576
    ds_read_b64_tr_b16 v[98:99], v252 offset:25344
    v_mfma_f32_16x16x32_bf16 v[56:59], a[128:131], a[164:167], v[56:59]
    ds_read_b64_tr_b16 v[100:101], v253 offset:24608
    ds_read_b64_tr_b16 v[102:103], v253 offset:25376
    buffer_load_dwordx4 v8, s[16:19], s35 offen offset:1024 lds
    v_mfma_f32_16x16x32_bf16 v[60:63], a[132:135], a[164:167], v[60:63]
    ds_read_b64_tr_b16 v[104:105], v252 offset:24640
    ds_read_b64_tr_b16 v[106:107], v252 offset:25408
    v_mfma_f32_16x16x32_bf16 v[64:67], a[136:139], a[164:167], v[64:67]
    ds_read_b64_tr_b16 v[108:109], v253 offset:24672
    ds_read_b64_tr_b16 v[110:111], v253 offset:25440
    buffer_load_dwordx4 v9, s[16:19], s35 offen offset:2048 lds
    v_mfma_f32_16x16x32_bf16 v[68:71], a[140:143], a[164:167], v[68:71]
    ds_read_b64_tr_b16 v[112:113], v252 offset:24704
    ds_read_b64_tr_b16 v[114:115], v252 offset:25472
    v_mfma_f32_16x16x32_bf16 v[72:75], a[120:123], a[212:215], v[72:75]
    ds_read_b64_tr_b16 v[116:117], v253 offset:24736
    ds_read_b64_tr_b16 v[118:119], v253 offset:25504
    s_add_u32 m0, s32, 113664
    s_mov_b32 s35, 233472
    buffer_load_dwordx4 v7, s[16:19], s35 offen offset:0 lds
    v_mfma_f32_16x16x32_bf16 v[76:79], a[124:127], a[212:215], v[76:79]
    v_mfma_f32_16x16x32_bf16 v[80:83], a[128:131], a[212:215], v[80:83]
    buffer_load_dwordx4 v8, s[16:19], s35 offen offset:1024 lds
    v_mfma_f32_16x16x32_bf16 v[84:87], a[132:135], a[212:215], v[84:87]
    v_mfma_f32_16x16x32_bf16 v[88:91], a[136:139], a[212:215], v[88:91]
    buffer_load_dwordx4 v9, s[16:19], s35 offen offset:2048 lds
    v_mfma_f32_16x16x32_bf16 v[92:95], a[140:143], a[212:215], v[92:95]
    s_waitcnt lgkmcnt(0)
    s_waitcnt vmcnt(15)
    v_mfma_f32_16x16x32_bf16 v[48:51], v[96:99], a[168:171], v[48:51]
    ds_read_b128 a[172:175], v3 offset:256
    ds_read_b128 a[220:223], v3 offset:12544
    s_add_u32 m0, s32, 135168
    s_mov_b32 s35, 245760
    buffer_load_dwordx4 v7, s[16:19], s35 offen offset:0 lds
    v_mfma_f32_16x16x32_bf16 v[52:55], v[100:103], a[168:171], v[52:55]
    ds_read_b64_tr_b16 v[120:121], v10 offset:0
    ds_read_b64_tr_b16 v[122:123], v10 offset:768
    v_mfma_f32_16x16x32_bf16 v[56:59], v[104:107], a[168:171], v[56:59]
    ds_read_b64_tr_b16 v[124:125], v11 offset:32
    ds_read_b64_tr_b16 v[126:127], v11 offset:800
    buffer_load_dwordx4 v8, s[16:19], s35 offen offset:1024 lds
    v_mfma_f32_16x16x32_bf16 v[60:63], v[108:111], a[168:171], v[60:63]
    ds_read_b64_tr_b16 v[128:129], v10 offset:64
    ds_read_b64_tr_b16 v[130:131], v10 offset:832
    v_mfma_f32_16x16x32_bf16 v[64:67], v[112:115], a[168:171], v[64:67]
    ds_read_b64_tr_b16 v[132:133], v11 offset:96
    ds_read_b64_tr_b16 v[134:135], v11 offset:864
    buffer_load_dwordx4 v9, s[16:19], s35 offen offset:2048 lds
    v_mfma_f32_16x16x32_bf16 v[68:71], v[116:119], a[168:171], v[68:71]
    ds_read_b64_tr_b16 v[136:137], v10 offset:128
    ds_read_b64_tr_b16 v[138:139], v10 offset:896
    v_mfma_f32_16x16x32_bf16 v[72:75], v[96:99], a[216:219], v[72:75]
    ds_read_b64_tr_b16 v[140:141], v11 offset:160
    ds_read_b64_tr_b16 v[142:143], v11 offset:928
    s_add_u32 m0, s32, 138240
    s_mov_b32 s35, 258048
    buffer_load_dwordx4 v7, s[16:19], s35 offen offset:0 lds
    v_mfma_f32_16x16x32_bf16 v[76:79], v[100:103], a[216:219], v[76:79]
    v_mfma_f32_16x16x32_bf16 v[80:83], v[104:107], a[216:219], v[80:83]
    buffer_load_dwordx4 v8, s[16:19], s35 offen offset:1024 lds
    v_mfma_f32_16x16x32_bf16 v[84:87], v[108:111], a[216:219], v[84:87]
    v_mfma_f32_16x16x32_bf16 v[88:91], v[112:115], a[216:219], v[88:91]
    buffer_load_dwordx4 v9, s[16:19], s35 offen offset:2048 lds
    v_mfma_f32_16x16x32_bf16 v[92:95], v[116:119], a[216:219], v[92:95]
    s_waitcnt lgkmcnt(0)
    s_waitcnt vmcnt(12)
    v_mfma_f32_16x16x32_bf16 v[48:51], v[120:123], a[172:175], v[48:51]
    ds_read_b128 a[176:179], v0 offset:512
    ds_read_b128 a[224:227], v0 offset:12800
    s_add_u32 m0, s32, 61440
    s_mov_b32 s35, 270336
    buffer_load_dwordx4 v7, s[16:19], s35 offen offset:0 lds
    v_mfma_f32_16x16x32_bf16 v[52:55], v[124:127], a[172:175], v[52:55]
    ds_read_b64_tr_b16 v[144:145], v10 offset:24576
    ds_read_b64_tr_b16 v[146:147], v10 offset:25344
    v_mfma_f32_16x16x32_bf16 v[56:59], v[128:131], a[172:175], v[56:59]
    ds_read_b64_tr_b16 v[148:149], v11 offset:24608
    ds_read_b64_tr_b16 v[150:151], v11 offset:25376
    buffer_load_dwordx4 v8, s[16:19], s35 offen offset:1024 lds
    v_mfma_f32_16x16x32_bf16 v[60:63], v[132:135], a[172:175], v[60:63]
    ds_read_b64_tr_b16 v[152:153], v10 offset:24640
    ds_read_b64_tr_b16 v[154:155], v10 offset:25408
    v_mfma_f32_16x16x32_bf16 v[64:67], v[136:139], a[172:175], v[64:67]
    ds_read_b64_tr_b16 v[156:157], v11 offset:24672
    ds_read_b64_tr_b16 v[158:159], v11 offset:25440
    buffer_load_dwordx4 v9, s[16:19], s35 offen offset:2048 lds
    v_mfma_f32_16x16x32_bf16 v[68:71], v[140:143], a[172:175], v[68:71]
    ds_read_b64_tr_b16 v[160:161], v10 offset:24704
    ds_read_b64_tr_b16 v[162:163], v10 offset:25472
    v_mfma_f32_16x16x32_bf16 v[72:75], v[120:123], a[220:223], v[72:75]
    ds_read_b64_tr_b16 v[164:165], v11 offset:24736
    ds_read_b64_tr_b16 v[166:167], v11 offset:25504
    s_add_u32 m0, s32, 64512
    s_mov_b32 s35, 282624
    buffer_load_dwordx4 v7, s[16:19], s35 offen offset:0 lds
    v_mfma_f32_16x16x32_bf16 v[76:79], v[124:127], a[220:223], v[76:79]
    v_mfma_f32_16x16x32_bf16 v[80:83], v[128:131], a[220:223], v[80:83]
    buffer_load_dwordx4 v8, s[16:19], s35 offen offset:1024 lds
    v_mfma_f32_16x16x32_bf16 v[84:87], v[132:135], a[220:223], v[84:87]
    v_mfma_f32_16x16x32_bf16 v[88:91], v[136:139], a[220:223], v[88:91]
    buffer_load_dwordx4 v9, s[16:19], s35 offen offset:2048 lds
    v_mfma_f32_16x16x32_bf16 v[92:95], v[140:143], a[220:223], v[92:95]
    s_waitcnt lgkmcnt(0)
    s_waitcnt vmcnt(12)
    v_mfma_f32_16x16x32_bf16 v[48:51], v[144:147], a[176:179], v[48:51]
    ds_read_b128 a[180:183], v1 offset:512
    ds_read_b128 a[228:231], v1 offset:12800
    s_add_u32 m0, s42, s41
    s_add_u32 s42, s42, 12288
    buffer_store_dwordx4 a[240:243], v16, s[24:27], 0 offen offset:0 sc0 sc1
    buffer_store_dwordx4 a[244:247], v16, s[24:27], 0 offen offset:1024 sc0 sc1
    buffer_store_dwordx4 a[248:251], v16, s[24:27], 0 offen offset:2048 sc0 sc1
    buffer_load_dwordx4 v4, s[12:15], s30 offen offset:0 nt lds
    buffer_load_dwordx4 v5, s[12:15], s30 offen offset:1024 nt lds
    buffer_load_dwordx4 v6, s[12:15], s30 offen offset:2048 nt lds
    s_add_u32 s30, s30, 393216
    v_mfma_f32_16x16x32_bf16 v[52:55], v[148:151], a[176:179], v[52:55]
    ds_read_b64_tr_b16 v[168:169], v252 offset:0
    ds_read_b64_tr_b16 v[170:171], v252 offset:768
    v_mfma_f32_16x16x32_bf16 v[56:59], v[152:155], a[176:179], v[56:59]
    ds_read_b64_tr_b16 v[172:173], v253 offset:32
    ds_read_b64_tr_b16 v[174:175], v253 offset:800
    v_mfma_f32_16x16x32_bf16 v[60:63], v[156:159], a[176:179], v[60:63]
    ds_read_b64_tr_b16 v[176:177], v252 offset:64
    ds_read_b64_tr_b16 v[178:179], v252 offset:832
    v_mfma_f32_16x16x32_bf16 v[64:67], v[160:163], a[176:179], v[64:67]
    ds_read_b64_tr_b16 v[180:181], v253 offset:96
    ds_read_b64_tr_b16 v[182:183], v253 offset:864
    v_mfma_f32_16x16x32_bf16 v[68:71], v[164:167], a[176:179], v[68:71]
    ds_read_b64_tr_b16 v[184:185], v252 offset:128
    ds_read_b64_tr_b16 v[186:187], v252 offset:896
    v_mfma_f32_16x16x32_bf16 v[72:75], v[144:147], a[224:227], v[72:75]
    ds_read_b64_tr_b16 v[188:189], v253 offset:160
    ds_read_b64_tr_b16 v[190:191], v253 offset:928
    v_mfma_f32_16x16x32_bf16 v[76:79], v[148:151], a[224:227], v[76:79]
    v_mfma_f32_16x16x32_bf16 v[80:83], v[152:155], a[224:227], v[80:83]
    v_mfma_f32_16x16x32_bf16 v[84:87], v[156:159], a[224:227], v[84:87]
    v_mfma_f32_16x16x32_bf16 v[88:91], v[160:163], a[224:227], v[88:91]
    v_mfma_f32_16x16x32_bf16 v[92:95], v[164:167], a[224:227], v[92:95]
    s_waitcnt lgkmcnt(0)
    s_waitcnt vmcnt(12)
    v_mfma_f32_16x16x32_bf16 v[48:51], v[168:171], a[180:183], v[48:51]
    ds_read_b128 a[184:187], v2 offset:512
    ds_read_b128 a[232:235], v2 offset:12800
    s_add_u32 m0, s42, s41
    s_add_u32 s42, s42, 12288
    buffer_store_dwordx4 a[240:243], v16, s[24:27], 0 offen offset:0 sc0 sc1
    buffer_store_dwordx4 a[244:247], v16, s[24:27], 0 offen offset:1024 sc0 sc1
    buffer_store_dwordx4 a[248:251], v16, s[24:27], 0 offen offset:2048 sc0 sc1
    buffer_load_dwordx4 v4, s[12:15], s30 offen offset:0 nt lds
    buffer_load_dwordx4 v5, s[12:15], s30 offen offset:1024 nt lds
    buffer_load_dwordx4 v6, s[12:15], s30 offen offset:2048 nt lds
    s_add_u32 s30, s30, 393216
    v_mfma_f32_16x16x32_bf16 v[52:55], v[172:175], a[180:183], v[52:55]
    ds_read_b64_tr_b16 v[192:193], v252 offset:24576
    ds_read_b64_tr_b16 v[194:195], v252 offset:25344
    v_mfma_f32_16x16x32_bf16 v[56:59], v[176:179], a[180:183], v[56:59]
    ds_read_b64_tr_b16 v[196:197], v253 offset:24608
    ds_read_b64_tr_b16 v[198:199], v253 offset:25376
    v_mfma_f32_16x16x32_bf16 v[60:63], v[180:183], a[180:183], v[60:63]
    ds_read_b64_tr_b16 v[200:201], v252 offset:24640
    ds_read_b64_tr_b16 v[202:203], v252 offset:25408
    v_mfma_f32_16x16x32_bf16 v[64:67], v[184:187], a[180:183], v[64:67]
    ds_read_b64_tr_b16 v[204:205], v253 offset:24672
    ds_read_b64_tr_b16 v[206:207], v253 offset:25440
    v_mfma_f32_16x16x32_bf16 v[68:71], v[188:191], a[180:183], v[68:71]
    ds_read_b64_tr_b16 v[208:209], v252 offset:24704
    ds_read_b64_tr_b16 v[210:211], v252 offset:25472
    v_mfma_f32_16x16x32_bf16 v[72:75], v[168:171], a[228:231], v[72:75]
    ds_read_b64_tr_b16 v[212:213], v253 offset:24736
    ds_read_b64_tr_b16 v[214:215], v253 offset:25504
    v_mfma_f32_16x16x32_bf16 v[76:79], v[172:175], a[228:231], v[76:79]
    v_mfma_f32_16x16x32_bf16 v[80:83], v[176:179], a[228:231], v[80:83]
    v_mfma_f32_16x16x32_bf16 v[84:87], v[180:183], a[228:231], v[84:87]
    v_mfma_f32_16x16x32_bf16 v[88:91], v[184:187], a[228:231], v[88:91]
    v_mfma_f32_16x16x32_bf16 v[92:95], v[188:191], a[228:231], v[92:95]
    s_waitcnt lgkmcnt(0)
    s_waitcnt vmcnt(12)
    v_mfma_f32_16x16x32_bf16 v[48:51], v[192:195], a[184:187], v[48:51]
    ds_read_b128 a[188:191], v3 offset:512
    ds_read_b128 a[236:239], v3 offset:12800
    v_mfma_f32_16x16x32_bf16 v[52:55], v[196:199], a[184:187], v[52:55]
    ds_read_b64_tr_b16 v[216:217], v10 offset:0
    ds_read_b64_tr_b16 v[218:219], v10 offset:768
    v_mfma_f32_16x16x32_bf16 v[56:59], v[200:203], a[184:187], v[56:59]
    ds_read_b64_tr_b16 v[220:221], v11 offset:32
    ds_read_b64_tr_b16 v[222:223], v11 offset:800
    v_mfma_f32_16x16x32_bf16 v[60:63], v[204:207], a[184:187], v[60:63]
    ds_read_b64_tr_b16 v[224:225], v10 offset:64
    ds_read_b64_tr_b16 v[226:227], v10 offset:832
    v_mfma_f32_16x16x32_bf16 v[64:67], v[208:211], a[184:187], v[64:67]
    ds_read_b64_tr_b16 v[228:229], v11 offset:96
    ds_read_b64_tr_b16 v[230:231], v11 offset:864
    v_mfma_f32_16x16x32_bf16 v[68:71], v[212:215], a[184:187], v[68:71]
    ds_read_b64_tr_b16 v[232:233], v10 offset:128
    ds_read_b64_tr_b16 v[234:235], v10 offset:896
    v_mfma_f32_16x16x32_bf16 v[72:75], v[192:195], a[232:235], v[72:75]
    ds_read_b64_tr_b16 v[236:237], v11 offset:160
    ds_read_b64_tr_b16 v[238:239], v11 offset:928
    v_mfma_f32_16x16x32_bf16 v[76:79], v[196:199], a[232:235], v[76:79]
    v_mfma_f32_16x16x32_bf16 v[80:83], v[200:203], a[232:235], v[80:83]
    v_mfma_f32_16x16x32_bf16 v[84:87], v[204:207], a[232:235], v[84:87]
    v_mfma_f32_16x16x32_bf16 v[88:91], v[208:211], a[232:235], v[88:91]
    v_mfma_f32_16x16x32_bf16 v[92:95], v[212:215], a[232:235], v[92:95]
    s_waitcnt lgkmcnt(0)
    s_barrier
    v_mfma_f32_16x16x32_bf16 v[48:51], v[216:219], a[188:191], v[48:51]
    ds_read_b128 a[144:147], v0 offset:24576
    v_mfma_f32_16x16x32_bf16 v[52:55], v[220:223], a[188:191], v[52:55]
    ds_read_b128 a[148:151], v1 offset:24576
    v_mfma_f32_16x16x32_bf16 v[56:59], v[224:227], a[188:191], v[56:59]
    ds_read_b128 a[152:155], v2 offset:24576
    v_mfma_f32_16x16x32_bf16 v[60:63], v[228:231], a[188:191], v[60:63]
    ds_read_b128 a[156:159], v3 offset:24576
    v_mfma_f32_16x16x32_bf16 v[64:67], v[232:235], a[188:191], v[64:67]
    ds_read_b128 a[160:163], v0 offset:24832
    v_mfma_f32_16x16x32_bf16 v[68:71], v[236:239], a[188:191], v[68:71]
    ds_read_b128 a[164:167], v1 offset:24832
    v_mfma_f32_16x16x32_bf16 v[72:75], v[216:219], a[236:239], v[72:75]
    ds_read_b128 a[168:171], v2 offset:24832
    v_mfma_f32_16x16x32_bf16 v[76:79], v[220:223], a[236:239], v[76:79]
    ds_read_b128 a[172:175], v3 offset:24832
    v_mfma_f32_16x16x32_bf16 v[80:83], v[224:227], a[236:239], v[80:83]
    ds_read_b128 a[176:179], v0 offset:25088
    v_mfma_f32_16x16x32_bf16 v[84:87], v[228:231], a[236:239], v[84:87]
    ds_read_b128 a[180:183], v1 offset:25088
    v_mfma_f32_16x16x32_bf16 v[88:91], v[232:235], a[236:239], v[88:91]
    ds_read_b128 a[184:187], v2 offset:25088
    v_mfma_f32_16x16x32_bf16 v[92:95], v[236:239], a[236:239], v[92:95]
    ds_read_b128 a[188:191], v3 offset:25088
    s_add_u32 m0, s42, s41
    s_add_u32 s42, s42, 12288
    buffer_store_dwordx4 a[240:243], v16, s[24:27], 0 offen offset:0 sc0 sc1
    buffer_store_dwordx4 a[244:247], v16, s[24:27], 0 offen offset:1024 sc0 sc1
    buffer_store_dwordx4 a[248:251], v16, s[24:27], 0 offen offset:2048 sc0 sc1
    buffer_load_dwordx4 v4, s[12:15], s30 offen offset:0 nt lds
    buffer_load_dwordx4 v5, s[12:15], s30 offen offset:1024 nt lds
    buffer_load_dwordx4 v6, s[12:15], s30 offen offset:2048 nt lds
    s_add_u32 s30, s30, 393216
    s_waitcnt lgkmcnt(0)
    s_nop 1
    v_cvt_pk_bf16_f32 v48, v48, v49
    v_cvt_pk_bf16_f32 v49, v50, v51
    ds_write_b64 v12, v[48:49] offset:0
    v_cvt_pk_bf16_f32 v52, v52, v53
    v_cvt_pk_bf16_f32 v53, v54, v55
    ds_write_b64 v12, v[52:53] offset:32
    v_cvt_pk_bf16_f32 v56, v56, v57
    v_cvt_pk_bf16_f32 v57, v58, v59
    ds_write_b64 v12, v[56:57] offset:64
    v_cvt_pk_bf16_f32 v60, v60, v61
    v_cvt_pk_bf16_f32 v61, v62, v63
    ds_write_b64 v12, v[60:61] offset:96
    v_cvt_pk_bf16_f32 v64, v64, v65
    v_cvt_pk_bf16_f32 v65, v66, v67
    ds_write_b64 v12, v[64:65] offset:128
    v_cvt_pk_bf16_f32 v68, v68, v69
    v_cvt_pk_bf16_f32 v69, v70, v71
    ds_write_b64 v12, v[68:69] offset:160
    v_add_u32 v0, 36864, v0
    v_add_u32 v1, 36864, v1
    v_add_u32 v2, 36864, v2
    v_add_u32 v3, 36864, v3
    s_mov_b32 s34, 36864
    s_mov_b32 s29, 2
    s_add_u32 m0, s42, s41
    s_mov_b32 s26, 113246208
L_enter:
.p2align 6
L_loop0:
    s_waitcnt vmcnt(12) lgkmcnt(0)
    s_barrier
    v_mfma_f32_16x16x32_bf16 v[48:51], a[0:3], a[144:147], v[24:27]
    ds_read_b128 a[192:195], v0 offset:0
    v_mfma_f32_16x16x32_bf16 v[48:51], a[24:27], a[148:151], v[48:51]
    s_add_u32 s31, s31, 393216
    v_mfma_f32_16x16x32_bf16 v[48:51], a[48:51], a[152:155], v[48:51]
    v_mfma_f32_16x16x32_bf16 v[48:51], a[72:75], a[156:159], v[48:51]
    v_mfma_f32_16x16x32_bf16 v[48:51], a[96:99], a[160:163], v[48:51]
    v_mfma_f32_16x16x32_bf16 v[48:51], a[120:123], a[164:167], v[48:51]
    ds_read_b128 a[196:199], v1 offset:0
    v_mfma_f32_16x16x32_bf16 v[48:51], v[96:99], a[168:171], v[48:51]
    v_mfma_f32_16x16x32_bf16 v[48:51], v[120:123], a[172:175], v[48:51]
    v_mfma_f32_16x16x32_bf16 v[48:51], v[144:147], a[176:179], v[48:51]
    ds_read_b128 a[240:243], v13 offset:0
    v_mfma_f32_16x16x32_bf16 v[48:51], v[168:171], a[180:183], v[48:51]
    v_cvt_pk_bf16_f32 v72, v72, v73
    v_mfma_f32_16x16x32_bf16 v[48:51], v[192:195], a[184:187], v[48:51]
    ds_read_b128 a[200:203], v2 offset:0
    v_mfma_f32_16x16x32_bf16 v[48:51], v[216:219], a[188:191], v[48:51]
    ds_read_b128 a[244:247], v14 offset:0
    v_mfma_f32_16x16x32_bf16 v[52:55], a[4:7], a[144:147], v[28:31]
    v_cvt_pk_bf16_f32 v73, v74, v75
    v_mfma_f32_16x16x32_bf16 v[52:55], a[28:31], a[148:151], v[52:55]
    ds_write_b64 v12, v[72:73] offset:12544
    v_mfma_f32_16x16x32_bf16 v[52:55], a[52:55], a[152:155], v[52:55]
    ds_read_b128 a[248:251], v15 offset:0
    v_mfma_f32_16x16x32_bf16 v[52:55], a[76:79], a[156:159], v[52:55]
    ds_read_b128 a[204:207], v3 offset:0
    v_mfma_f32_16x16x32_bf16 v[52:55], a[100:103], a[160:163], v[52:55]
    v_cvt_pk_bf16_f32 v76, v76, v77
    v_mfma_f32_16x16x32_bf16 v[52:55], a[124:127], a[164:167], v[52:55]
    v_cvt_pk_bf16_f32 v77, v78, v79
    v_mfma_f32_16x16x32_bf16 v[52:55], v[100:103], a[168:171], v[52:55]
    ds_write_b64 v12, v[76:77] offset:12576
    v_mfma_f32_16x16x32_bf16 v[52:55], v[124:127], a[172:175], v[52:55]
    s_add_u32 s38, s34, 12288
    v_mfma_f32_16x16x32_bf16 v[52:55], v[148:151], a[176:179], v[52:55]
    ds_read_b128 a[208:211], v0 offset:256
    v_mfma_f32_16x16x32_bf16 v[52:55], v[172:175], a[180:183], v[52:55]
    s_cmp_eq_u32 s38, 86016
    s_cselect_b32 s38, 0, s38
    v_mfma_f32_16x16x32_bf16 v[52:55], v[196:199], a[184:187], v[52:55]
    s_sub_u32 s33, s38, s34
    v_mfma_f32_16x16x32_bf16 v[52:55], v[220:223], a[188:191], v[52:55]
    s_mov_b32 s34, s38
    v_mfma_f32_16x16x32_bf16 v[56:59], a[8:11], a[144:147], v[32:35]
    s_waitcnt lgkmcnt(7)
    buffer_store_dwordx4 a[240:243], v16, s[24:27], s31 offen offset:0 sc0 sc1
    v_mfma_f32_16x16x32_bf16 v[56:59], a[32:35], a[148:151], v[56:59]
    ds_read_b128 a[212:215], v1 offset:256
    v_mfma_f32_16x16x32_bf16 v[56:59], a[56:59], a[152:155], v[56:59]
    v_cvt_pk_bf16_f32 v80, v80, v81
    v_mfma_f32_16x16x32_bf16 v[56:59], a[80:83], a[156:159], v[56:59]
    s_waitcnt lgkmcnt(6)
    buffer_store_dwordx4 a[244:247], v16, s[24:27], s31 offen offset:1024 sc0 sc1
    v_mfma_f32_16x16x32_bf16 v[56:59], a[104:107], a[160:163], v[56:59]
    v_cvt_pk_bf16_f32 v81, v82, v83
    v_mfma_f32_16x16x32_bf16 v[56:59], a[128:131], a[164:167], v[56:59]
    ds_write_b64 v12, v[80:81] offset:12608
    v_mfma_f32_16x16x32_bf16 v[56:59], v[104:107], a[168:171], v[56:59]
    s_waitcnt lgkmcnt(5)
    buffer_store_dwordx4 a[248:251], v16, s[24:27], s31 offen offset:2048 sc0 sc1
    v_mfma_f32_16x16x32_bf16 v[56:59], v[128:131], a[172:175], v[56:59]
    ds_read_b128 a[216:219], v2 offset:256
    v_mfma_f32_16x16x32_bf16 v[56:59], v[152:155], a[176:179], v[56:59]
    v_cvt_pk_bf16_f32 v84, v84, v85
    v_mfma_f32_16x16x32_bf16 v[56:59], v[176:179], a[180:183], v[56:59]
    buffer_load_dwordx4 v4, s[12:15], s30 offen offset:0 nt lds
    v_mfma_f32_16x16x32_bf16 v[56:59], v[200:203], a[184:187], v[56:59]
    v_cvt_pk_bf16_f32 v85, v86, v87
    v_mfma_f32_16x16x32_bf16 v[56:59], v[224:227], a[188:191], v[56:59]
    ds_read_b128 a[220:223], v3 offset:256
    v_mfma_f32_16x16x32_bf16 v[60:63], a[12:15], a[144:147], v[36:39]
    buffer_load_dwordx4 v5, s[12:15], s30 offen offset:1024 nt lds
    v_mfma_f32_16x16x32_bf16 v[60:63], a[36:39], a[148:151], v[60:63]
    ds_write_b64 v12, v[84:85] offset:12640
    v_mfma_f32_16x16x32_bf16 v[60:63], a[60:63], a[152:155], v[60:63]
    v_mfma_f32_16x16x32_bf16 v[60:63], a[84:87], a[156:159], v[60:63]
    buffer_load_dwordx4 v6, s[12:15], s30 offen offset:2048 nt lds
    v_mfma_f32_16x16x32_bf16 v[60:63], a[108:111], a[160:163], v[60:63]
    ds_read_b128 a[224:227], v0 offset:512
    v_mfma_f32_16x16x32_bf16 v[60:63], a[132:135], a[164:167], v[60:63]
    s_add_u32 s30, s30, 393216
    v_mfma_f32_16x16x32_bf16 v[60:63], v[108:111], a[168:171], v[60:63]
    s_add_u32 s42, s42, 12288
    v_mfma_f32_16x16x32_bf16 v[60:63], v[132:135], a[172:175], v[60:63]
    s_cmp_eq_u32 s42, 86016
    s_cselect_b32 s42, 0, s42
    v_mfma_f32_16x16x32_bf16 v[60:63], v[156:159], a[176:179], v[60:63]
    s_add_u32 m0, s42, s41
    v_mfma_f32_16x16x32_bf16 v[60:63], v[180:183], a[180:183], v[60:63]
    ds_read_b128 a[228:231], v1 offset:512
    v_mfma_f32_16x16x32_bf16 v[60:63], v[204:207], a[184:187], v[60:63]
    s_add_u32 s29, s29, 1
    v_mfma_f32_16x16x32_bf16 v[60:63], v[228:231], a[188:191], v[60:63]
    s_cmp_lt_u32 s29, s43
    s_cselect_b32 s14, s40, 0
    v_mfma_f32_16x16x32_bf16 v[64:67], a[16:19], a[144:147], v[40:43]
    v_cvt_pk_bf16_f32 v88, v88, v89
    v_mfma_f32_16x16x32_bf16 v[64:67], a[40:43], a[148:151], v[64:67]
    v_cvt_pk_bf16_f32 v89, v90, v91
    v_mfma_f32_16x16x32_bf16 v[64:67], a[64:67], a[152:155], v[64:67]
    ds_read_b128 a[232:235], v2 offset:512
    v_mfma_f32_16x16x32_bf16 v[64:67], a[88:91], a[156:159], v[64:67]
    ds_write_b64 v12, v[88:89] offset:12672
    v_mfma_f32_16x16x32_bf16 v[64:67], a[112:115], a[160:163], v[64:67]
    v_cvt_pk_bf16_f32 v92, v92, v93
    v_mfma_f32_16x16x32_bf16 v[64:67], a[136:139], a[164:167], v[64:67]
    v_cvt_pk_bf16_f32 v93, v94, v95
    v_mfma_f32_16x16x32_bf16 v[64:67], v[112:115], a[168:171], v[64:67]
    ds_write_b64 v12, v[92:93] offset:12704
    v_mfma_f32_16x16x32_bf16 v[64:67], v[136:139], a[172:175], v[64:67]
    ds_read_b128 a[236:239], v3 offset:512
    v_mfma_f32_16x16x32_bf16 v[64:67], v[160:163], a[176:179], v[64:67]
    v_add_u32 v0, s33, v0
    v_mfma_f32_16x16x32_bf16 v[64:67], v[184:187], a[180:183], v[64:67]
    v_add_u32 v1, s33, v1
    v_mfma_f32_16x16x32_bf16 v[64:67], v[208:211], a[184:187], v[64:67]
    v_add_u32 v2, s33, v2
    v_mfma_f32_16x16x32_bf16 v[64:67], v[232:235], a[188:191], v[64:67]
    v_add_u32 v3, s33, v3
    v_mfma_f32_16x16x32_bf16 v[68:71], a[20:23], a[144:147], v[44:47]
    v_mfma_f32_16x16x32_bf16 v[68:71], a[44:47], a[148:151], v[68:71]
    v_mfma_f32_16x16x32_bf16 v[68:71], a[68:71], a[152:155], v[68:71]
    v_mfma_f32_16x16x32_bf16 v[68:71], a[92:95], a[156:159], v[68:71]
    v_mfma_f32_16x16x32_bf16 v[68:71], a[116:119], a[160:163], v[68:71]
    v_mfma_f32_16x16x32_bf16 v[68:71], a[140:143], a[164:167], v[68:71]
    v_mfma_f32_16x16x32_bf16 v[68:71], v[116:119], a[168:171], v[68:71]
    v_mfma_f32_16x16x32_bf16 v[68:71], v[140:143], a[172:175], v[68:71]
    v_mfma_f32_16x16x32_bf16 v[68:71], v[164:167], a[176:179], v[68:71]
    v_mfma_f32_16x16x32_bf16 v[68:71], v[188:191], a[180:183], v[68:71]
    v_mfma_f32_16x16x32_bf16 v[68:71], v[212:215], a[184:187], v[68:71]
    v_mfma_f32_16x16x32_bf16 v[68:71], v[236:239], a[188:191], v[68:71]
    s_cmp_ge_u32 s29, s37
    s_cbranch_scc1 L_drain0
    s_waitcnt vmcnt(12) lgkmcnt(0)
    s_barrier
    v_mfma_f32_16x16x32_bf16 v[72:75], a[0:3], a[192:195], v[24:27]
    ds_read_b128 a[144:147], v0 offset:0
    v_mfma_f32_16x16x32_bf16 v[72:75], a[24:27], a[196:199], v[72:75]
    s_add_u32 s31, s31, 393216
    v_mfma_f32_16x16x32_bf16 v[72:75], a[48:51], a[200:203], v[72:75]
    v_mfma_f32_16x16x32_bf16 v[72:75], a[72:75], a[204:207], v[72:75]
    v_mfma_f32_16x16x32_bf16 v[72:75], a[96:99], a[208:211], v[72:75]
    v_mfma_f32_16x16x32_bf16 v[72:75], a[120:123], a[212:215], v[72:75]
    ds_read_b128 a[148:151], v1 offset:0
    v_mfma_f32_16x16x32_bf16 v[72:75], v[96:99], a[216:219], v[72:75]
    v_mfma_f32_16x16x32_bf16 v[72:75], v[120:123], a[220:223], v[72:75]
    v_mfma_f32_16x16x32_bf16 v[72:75], v[144:147], a[224:227], v[72:75]
    ds_read_b128 a[240:243], v13 offset:12544
    v_mfma_f32_16x16x32_bf16 v[72:75], v[168:171], a[228:231], v[72:75]
    v_cvt_pk_bf16_f32 v48, v48, v49
    v_mfma_f32_16x16x32_bf16 v[72:75], v[192:195], a[232:235], v[72:75]
    ds_read_b128 a[152:155], v2 offset:0
    v_mfma_f32_16x16x32_bf16 v[72:75], v[216:219], a[236:239], v[72:75]
    ds_read_b128 a[244:247], v14 offset:12544
    v_mfma_f32_16x16x32_bf16 v[76:79], a[4:7], a[192:195], v[28:31]
    v_cvt_pk_bf16_f32 v49, v50, v51
    v_mfma_f32_16x16x32_bf16 v[76:79], a[28:31], a[196:199], v[76:79]
    ds_write_b64 v12, v[48:49] offset:0
    v_mfma_f32_16x16x32_bf16 v[76:79], a[52:55], a[200:203], v[76:79]
    ds_read_b128 a[248:251], v15 offset:12544
    v_mfma_f32_16x16x32_bf16 v[76:79], a[76:79], a[204:207], v[76:79]
    ds_read_b128 a[156:159], v3 offset:0
    v_mfma_f32_16x16x32_bf16 v[76:79], a[100:103], a[208:211], v[76:79]
    v_cvt_pk_bf16_f32 v52, v52, v53
    v_mfma_f32_16x16x32_bf16 v[76:79], a[124:127], a[212:215], v[76:79]
    v_cvt_pk_bf16_f32 v53, v54, v55
    v_mfma_f32_16x16x32_bf16 v[76:79], v[100:103], a[216:219], v[76:79]
    ds_write_b64 v12, v[52:53] offset:32
    v_mfma_f32_16x16x32_bf16 v[76:79], v[124:127], a[220:223], v[76:79]
    s_add_u32 s38, s34, 12288
    v_mfma_f32_16x16x32_bf16 v[76:79], v[148:151], a[224:227], v[76:79]
    ds_read_b128 a[160:163], v0 offset:256
    v_mfma_f32_16x16x32_bf16 v[76:79], v[172:175], a[228:231], v[76:79]
    s_cmp_eq_u32 s38, 86016
    s_cselect_b32 s38, 0, s38
    v_mfma_f32_16x16x32_bf16 v[76:79], v[196:199], a[232:235], v[76:79]
    s_sub_u32 s33, s38, s34
    v_mfma_f32_16x16x32_bf16 v[76:79], v[220:223], a[236:239], v[76:79]
    s_mov_b32 s34, s38
    v_mfma_f32_16x16x32_bf16 v[80:83], a[8:11], a[192:195], v[32:35]
    s_waitcnt lgkmcnt(7)
    buffer_store_dwordx4 a[240:243], v16, s[24:27], s31 offen offset:0 sc0 sc1
    v_mfma_f32_16x16x32_bf16 v[80:83], a[32:35], a[196:199], v[80:83]
    ds_read_b128 a[164:167], v1 offset:256
    v_mfma_f32_16x16x32_bf16 v[80:83], a[56:59], a[200:203], v[80:83]
    v_cvt_pk_bf16_f32 v56, v56, v57
    v_mfma_f32_16x16x32_bf16 v[80:83], a[80:83], a[204:207], v[80:83]
    s_waitcnt lgkmcnt(6)
    buffer_store_dwordx4 a[244:247], v16, s[24:27], s31 offen offset:1024 sc0 sc1
    v_mfma_f32_16x16x32_bf16 v[80:83], a[104:107], a[208:211], v[80:83]
    v_cvt_pk_bf16_f32 v57, v58, v59
    v_mfma_f32_16x16x32_bf16 v[80:83], a[128:131], a[212:215], v[80:83]
    ds_write_b64 v12, v[56:57] offset:64
    v_mfma_f32_16x16x32_bf16 v[80:83], v[104:107], a[216:219], v[80:83]
    s_waitcnt lgkmcnt(5)
    buffer_store_dwordx4 a[248:251], v16, s[24:27], s31 offen offset:2048 sc0 sc1
    v_mfma_f32_16x16x32_bf16 v[80:83], v[128:131], a[220:223], v[80:83]
    ds_read_b128 a[168:171], v2 offset:256
    v_mfma_f32_16x16x32_bf16 v[80:83], v[152:155], a[224:227], v[80:83]
    v_cvt_pk_bf16_f32 v60, v60, v61
    v_mfma_f32_16x16x32_bf16 v[80:83], v[176:179], a[228:231], v[80:83]
    buffer_load_dwordx4 v4, s[12:15], s30 offen offset:0 nt lds
    v_mfma_f32_16x16x32_bf16 v[80:83], v[200:203], a[232:235], v[80:83]
    v_cvt_pk_bf16_f32 v61, v62, v63
    v_mfma_f32_16x16x32_bf16 v[80:83], v[224:227], a[236:239], v[80:83]
    ds_read_b128 a[172:175], v3 offset:256
    v_mfma_f32_16x16x32_bf16 v[84:87], a[12:15], a[192:195], v[36:39]
    buffer_load_dwordx4 v5, s[12:15], s30 offen offset:1024 nt lds
    v_mfma_f32_16x16x32_bf16 v[84:87], a[36:39], a[196:199], v[84:87]
    ds_write_b64 v12, v[60:61] offset:96
    v_mfma_f32_16x16x32_bf16 v[84:87], a[60:63], a[200:203], v[84:87]
    v_mfma_f32_16x16x32_bf16 v[84:87], a[84:87], a[204:207], v[84:87]
    buffer_load_dwordx4 v6, s[12:15], s30 offen offset:2048 nt lds
    v_mfma_f32_16x16x32_bf16 v[84:87], a[108:111], a[208:211], v[84:87]
    ds_read_b128 a[176:179], v0 offset:512
    v_mfma_f32_16x16x32_bf16 v[84:87], a[132:135], a[212:215], v[84:87]
    s_add_u32 s30, s30, 393216
    v_mfma_f32_16x16x32_bf16 v[84:87], v[108:111], a[216:219], v[84:87]
    s_add_u32 s42, s42, 12288
    v_mfma_f32_16x16x32_bf16 v[84:87], v[132:135], a[220:223], v[84:87]
    s_cmp_eq_u32 s42, 86016
    s_cselect_b32 s42, 0, s42
    v_mfma_f32_16x16x32_bf16 v[84:87], v[156:159], a[224:227], v[84:87]
    s_add_u32 m0, s42, s41
    v_mfma_f32_16x16x32_bf16 v[84:87], v[180:183], a[228:231], v[84:87]
    ds_read_b128 a[180:183], v1 offset:512
    v_mfma_f32_16x16x32_bf16 v[84:87], v[204:207], a[232:235], v[84:87]
    s_add_u32 s29, s29, 1
    v_mfma_f32_16x16x32_bf16 v[84:87], v[228:231], a[236:239], v[84:87]
    s_cmp_lt_u32 s29, s43
    s_cselect_b32 s14, s40, 0
    v_mfma_f32_16x16x32_bf16 v[88:91], a[16:19], a[192:195], v[40:43]
    v_cvt_pk_bf16_f32 v64, v64, v65
    v_mfma_f32_16x16x32_bf16 v[88:91], a[40:43], a[196:199], v[88:91]
    v_cvt_pk_bf16_f32 v65, v66, v67
    v_mfma_f32_16x16x32_bf16 v[88:91], a[64:67], a[200:203], v[88:91]
    ds_read_b128 a[184:187], v2 offset:512
    v_mfma_f32_16x16x32_bf16 v[88:91], a[88:91], a[204:207], v[88:91]
    ds_write_b64 v12, v[64:65] offset:128
    v_mfma_f32_16x16x32_bf16 v[88:91], a[112:115], a[208:211], v[88:91]
    v_cvt_pk_bf16_f32 v68, v68, v69
    v_mfma_f32_16x16x32_bf16 v[88:91], a[136:139], a[212:215], v[88:91]
    v_cvt_pk_bf16_f32 v69, v70, v71
    v_mfma_f32_16x16x32_bf16 v[88:91], v[112:115], a[216:219], v[88:91]
    ds_write_b64 v12, v[68:69] offset:160
    v_mfma_f32_16x16x32_bf16 v[88:91], v[136:139], a[220:223], v[88:91]
    ds_read_b128 a[188:191], v3 offset:512
    v_mfma_f32_16x16x32_bf16 v[88:91], v[160:163], a[224:227], v[88:91]
    v_add_u32 v0, s33, v0
    v_mfma_f32_16x16x32_bf16 v[88:91], v[184:187], a[228:231], v[88:91]
    v_add_u32 v1, s33, v1
    v_mfma_f32_16x16x32_bf16 v[88:91], v[208:211], a[232:235], v[88:91]
    v_add_u32 v2, s33, v2
    v_mfma_f32_16x16x32_bf16 v[88:91], v[232:235], a[236:239], v[88:91]
    v_add_u32 v3, s33, v3
    v_mfma_f32_16x16x32_bf16 v[92:95], a[20:23], a[192:195], v[44:47]
    v_mfma_f32_16x16x32_bf16 v[92:95], a[44:47], a[196:199], v[92:95]
    v_mfma_f32_16x16x32_bf16 v[92:95], a[68:71], a[200:203], v[92:95]
    v_mfma_f32_16x16x32_bf16 v[92:95], a[92:95], a[204:207], v[92:95]
    v_mfma_f32_16x16x32_bf16 v[92:95], a[116:119], a[208:211], v[92:95]
    v_mfma_f32_16x16x32_bf16 v[92:95], a[140:143], a[212:215], v[92:95]
    v_mfma_f32_16x16x32_bf16 v[92:95], v[116:119], a[216:219], v[92:95]
    v_mfma_f32_16x16x32_bf16 v[92:95], v[140:143], a[220:223], v[92:95]
    v_mfma_f32_16x16x32_bf16 v[92:95], v[164:167], a[224:227], v[92:95]
    v_mfma_f32_16x16x32_bf16 v[92:95], v[188:191], a[228:231], v[92:95]
    v_mfma_f32_16x16x32_bf16 v[92:95], v[212:215], a[232:235], v[92:95]
    v_mfma_f32_16x16x32_bf16 v[92:95], v[236:239], a[236:239], v[92:95]
    s_cmp_lt_u32 s29, s37
    s_cbranch_scc1 L_loop0
L_drain1:
    s_waitcnt lgkmcnt(0)
    s_barrier
    s_add_u32 s31, s31, 393216
    s_nop 4
    ds_read_b128 a[240:243], v13 offset:0
    ds_read_b128 a[244:247], v14 offset:0
    ds_read_b128 a[248:251], v15 offset:0
    v_cvt_pk_bf16_f32 v72, v72, v73
    v_cvt_pk_bf16_f32 v73, v74, v75
    ds_write_b64 v12, v[72:73] offset:12544
    v_cvt_pk_bf16_f32 v76, v76, v77
    v_cvt_pk_bf16_f32 v77, v78, v79
    ds_write_b64 v12, v[76:77] offset:12576
    v_cvt_pk_bf16_f32 v80, v80, v81
    v_cvt_pk_bf16_f32 v81, v82, v83
    ds_write_b64 v12, v[80:81] offset:12608
    v_cvt_pk_bf16_f32 v84, v84, v85
    v_cvt_pk_bf16_f32 v85, v86, v87
    ds_write_b64 v12, v[84:85] offset:12640
    v_cvt_pk_bf16_f32 v88, v88, v89
    v_cvt_pk_bf16_f32 v89, v90, v91
    ds_write_b64 v12, v[88:89] offset:12672
    v_cvt_pk_bf16_f32 v92, v92, v93
    v_cvt_pk_bf16_f32 v93, v94, v95
    ds_write_b64 v12, v[92:93] offset:12704
    s_waitcnt lgkmcnt(8)
    buffer_store_dwordx4 a[240:243], v16, s[24:27], s31 offen offset:0 sc0 sc1
    s_waitcnt lgkmcnt(7)
    buffer_store_dwordx4 a[244:247], v16, s[24:27], s31 offen offset:1024 sc0 sc1
    s_waitcnt lgkmcnt(6)
    buffer_store_dwordx4 a[248:251], v16, s[24:27], s31 offen offset:2048 sc0 sc1
    s_add_u32 s31, s31, 393216
    s_waitcnt lgkmcnt(0)
    s_barrier
    ds_read_b128 a[144:147], v13 offset:12544
    ds_read_b128 a[148:151], v14 offset:12544
    ds_read_b128 a[152:155], v15 offset:12544
    s_waitcnt lgkmcnt(2)
    buffer_store_dwordx4 a[144:147], v16, s[24:27], s31 offen offset:0 sc0 sc1
    s_waitcnt lgkmcnt(1)
    buffer_store_dwordx4 a[148:151], v16, s[24:27], s31 offen offset:1024 sc0 sc1
    s_waitcnt lgkmcnt(0)
    buffer_store_dwordx4 a[152:155], v16, s[24:27], s31 offen offset:2048 sc0 sc1
    s_branch L_end
L_drain0:
    s_waitcnt lgkmcnt(0)
    s_barrier
    s_add_u32 s31, s31, 393216
    s_nop 4
    ds_read_b128 a[240:243], v13 offset:12544
    ds_read_b128 a[244:247], v14 offset:12544
    ds_read_b128 a[248:251], v15 offset:12544
    v_cvt_pk_bf16_f32 v48, v48, v49
    v_cvt_pk_bf16_f32 v49, v50, v51
    ds_write_b64 v12, v[48:49] offset:0
    v_cvt_pk_bf16_f32 v52, v52, v53
    v_cvt_pk_bf16_f32 v53, v54, v55
    ds_write_b64 v12, v[52:53] offset:32
    v_cvt_pk_bf16_f32 v56, v56, v57
    v_cvt_pk_bf16_f32 v57, v58, v59
    ds_write_b64 v12, v[56:57] offset:64
    v_cvt_pk_bf16_f32 v60, v60, v61
    v_cvt_pk_bf16_f32 v61, v62, v63
    ds_write_b64 v12, v[60:61] offset:96
    v_cvt_pk_bf16_f32 v64, v64, v65
    v_cvt_pk_bf16_f32 v65, v66, v67
    ds_write_b64 v12, v[64:65] offset:128
    v_cvt_pk_bf16_f32 v68, v68, v69
    v_cvt_pk_bf16_f32 v69, v70, v71
    ds_write_b64 v12, v[68:69] offset:160
    s_waitcnt lgkmcnt(8)
    buffer_store_dwordx4 a[240:243], v16, s[24:27], s31 offen offset:0 sc0 sc1
    s_waitcnt lgkmcnt(7)
    buffer_store_dwordx4 a[244:247], v16, s[24:27], s31 offen offset:1024 sc0 sc1
    s_waitcnt lgkmcnt(6)
    buffer_store_dwordx4 a[248:251], v16, s[24:27], s31 offen offset:2048 sc0 sc1
    s_add_u32 s31, s31, 393216
    s_waitcnt lgkmcnt(0)
    s_barrier
    ds_read_b128 a[144:147], v13 offset:0
    ds_read_b128 a[148:151], v14 offset:0
    ds_read_b128 a[152:155], v15 offset:0
    s_waitcnt lgkmcnt(2)
    buffer_store_dwordx4 a[144:147], v16, s[24:27], s31 offen offset:0 sc0 sc1
    s_waitcnt lgkmcnt(1)
    buffer_store_dwordx4 a[148:151], v16, s[24:27], s31 offen offset:1024 sc0 sc1
    s_waitcnt lgkmcnt(0)
    buffer_store_dwordx4 a[152:155], v16, s[24:27], s31 offen offset:2048 sc0 sc1
L_end:
L_done:
    s_endpgm
.section .rodata,"a"
.p2align 6
.amdhsa_kernel standalone__standard_2d_1d_3d_conv__vision_kernel
  .amdhsa_next_free_vgpr 512
  .amdhsa_next_free_sgpr 96
  .amdhsa_accum_offset 256
  .amdhsa_group_segment_fixed_size 0
  .amdhsa_kernarg_size 48
  .amdhsa_user_sgpr_count 2
  .amdhsa_user_sgpr_kernarg_segment_ptr 1
  .amdhsa_system_sgpr_workgroup_id_x 1
.end_amdhsa_kernel
```

```asm
; @launch grid=(256,1,1) block=(256,1,1) lds=159744
.amdgcn_target "amdgcn-amd-amdhsa--gfx950"
.text
.globl standalone__standard_2d_1d_3d_conv__vision_kernel
.p2align 8
.type standalone__standard_2d_1d_3d_conv__vision_kernel,@function
standalone__standard_2d_1d_3d_conv__vision_kernel:
    s_load_dwordx8 s[4:11], s[0:1], 0
    s_cmp_ge_u32 s2, 256
    s_cbranch_scc1 L_done
    v_lshrrev_b32 v18, 6, v0
    v_and_b32 v19, 63, v0
    v_readfirstlane_b32 s28, v18
    s_lshr_b32 s39, s2, 3
    s_and_b32 s39, s39, 31
    s_lshl_b32 s39, s39, 8
    v_add_u32 v255, s39, v0
    v_mul_u32_u24 v255, 36, v255
    v_and_b32 v20, 15, v0
    v_bfe_u32 v21, v0, 4, 2
    v_mul_u32_u24 v22, 3072, v18
    v_add_u32 v23, 16, v19
    v_lshrrev_b32 v23, 6, v23
    v_lshl_add_u32 v23, v18, 2, v23
    v_xor_b32 v23, v23, v19
    v_lshl_add_u32 v4, v23, 4, v22
    v_lshrrev_b32 v23, 5, v19
    v_add_u32 v23, 1, v23
    v_lshl_add_u32 v23, v18, 2, v23
    v_xor_b32 v23, v23, v19
    v_lshl_add_u32 v5, v23, 4, v22
    v_add_u32 v23, 48, v19
    v_lshrrev_b32 v23, 6, v23
    v_add_u32 v23, 2, v23
    v_lshl_add_u32 v23, v18, 2, v23
    v_xor_b32 v23, v23, v19
    v_lshl_add_u32 v6, v23, 4, v22
    s_and_b32 s39, s2, 7
    s_mul_i32 s39, s39, 1152
    s_bitcmp1_b32 s2, 0
    s_cselect_b32 s38, 32, 0
    s_add_u32 s39, s39, s38
    s_lshr_b32 s30, s2, 3
    s_add_u32 s30, s30, s39
    s_mul_i32 s30, s30, 12288
    s_sub_u32 s31, s30, 393216
    s_mul_i32 s41, s28, 3072
    s_mov_b32 s42, 0
    s_mov_b32 s14, 113246208
    s_mov_b32 s15, 0x20000
    s_mov_b32 s18, 294912
    s_mov_b32 s19, 0x20000
    s_waitcnt lgkmcnt(0)
    s_mov_b32 s12, s4
    s_and_b32 s13, s5, 0xffff
    s_mov_b32 s16, s6
    s_and_b32 s17, s7, 0xffff
L_g0:
    buffer_load_dword v254, v255, s[16:19], 0 offen
    s_add_u32 m0, s42, s41
    s_add_u32 s42, s42, 12288
    buffer_load_dwordx4 v4, s[12:15], s30 offen offset:0 nt lds
    buffer_load_dwordx4 v5, s[12:15], s30 offen offset:1024 nt lds
    buffer_load_dwordx4 v6, s[12:15], s30 offen offset:2048 nt lds
    s_add_u32 s30, s30, 393216
    s_add_u32 m0, s42, s41
    s_add_u32 s42, s42, 12288
    buffer_load_dwordx4 v4, s[12:15], s30 offen offset:0 nt lds
    buffer_load_dwordx4 v5, s[12:15], s30 offen offset:1024 nt lds
    buffer_load_dwordx4 v6, s[12:15], s30 offen offset:2048 nt lds
    s_add_u32 s30, s30, 393216
    s_mul_i32 s32, s28, 6144
    s_bitcmp1_b32 s2, 0
    s_mov_b32 s37, 37
    s_cselect_b32 s37, 35, s37
    s_sub_u32 s43, s37, 3
    v_mul_u32_u24 v22, 192, v18
    v_add_u32 v240, 0, v19
    v_mul_u32_u24 v241, 171, v240
    v_lshrrev_b32 v241, 11, v241
    v_mul_u32_u24 v242, 12, v241
    v_sub_u32 v240, v240, v242
    v_bfe_u32 v242, v241, 3, 1
    v_lshlrev_b32 v242, 1, v242
    v_xor_b32 v240, v240, v242
    v_lshl_add_u32 v240, v240, 4, v22
    v_mul_u32_u24 v241, 768, v241
    v_add_u32 v240, v240, v241
    v_subrev_u32 v7, 0, v240
    v_add_u32 v240, 64, v19
    v_mul_u32_u24 v241, 171, v240
    v_lshrrev_b32 v241, 11, v241
    v_mul_u32_u24 v242, 12, v241
    v_sub_u32 v240, v240, v242
    v_bfe_u32 v242, v241, 3, 1
    v_lshlrev_b32 v242, 1, v242
    v_xor_b32 v240, v240, v242
    v_lshl_add_u32 v240, v240, 4, v22
    v_mul_u32_u24 v241, 768, v241
    v_add_u32 v240, v240, v241
    v_subrev_u32 v8, 1024, v240
    v_add_u32 v240, 128, v19
    v_mul_u32_u24 v241, 171, v240
    v_lshrrev_b32 v241, 11, v241
    v_mul_u32_u24 v242, 12, v241
    v_sub_u32 v240, v240, v242
    v_bfe_u32 v242, v241, 3, 1
    v_lshlrev_b32 v242, 1, v242
    v_xor_b32 v240, v240, v242
    v_lshl_add_u32 v240, v240, 4, v22
    v_mul_u32_u24 v241, 768, v241
    v_add_u32 v240, v240, v241
    v_subrev_u32 v9, 2048, v240
    s_mov_b32 s24, s10
    s_and_b32 s25, s11, 0xffff
    s_mov_b32 s26, 0
    s_mov_b32 s27, 0x20000
    s_add_u32 m0, s32, 86016
    s_mov_b32 s35, 0
    buffer_load_dwordx4 v7, s[16:19], s35 offen offset:0 lds
    buffer_load_dwordx4 v8, s[16:19], s35 offen offset:1024 lds
    buffer_load_dwordx4 v9, s[16:19], s35 offen offset:2048 lds
    s_add_u32 m0, s32, 89088
    s_mov_b32 s35, 12288
    buffer_load_dwordx4 v7, s[16:19], s35 offen offset:0 lds
    buffer_load_dwordx4 v8, s[16:19], s35 offen offset:1024 lds
    buffer_load_dwordx4 v9, s[16:19], s35 offen offset:2048 lds
    v_mul_u32_u24 v22, 192, v18
    v_lshl_add_u32 v17, v21, 3, v22
    s_mov_b32 s20, s8
    s_and_b32 s21, s9, 0xffff
    s_mov_b32 s22, 768
    s_mov_b32 s23, 0x20000
    buffer_load_dwordx2 a[240:241], v17, s[20:23], 0 offen offset:0
    buffer_load_dwordx2 a[242:243], v17, s[20:23], 0 offen offset:32
    buffer_load_dwordx2 a[244:245], v17, s[20:23], 0 offen offset:64
    buffer_load_dwordx2 a[246:247], v17, s[20:23], 0 offen offset:96
    buffer_load_dwordx2 a[248:249], v17, s[20:23], 0 offen offset:128
    buffer_load_dwordx2 a[250:251], v17, s[20:23], 0 offen offset:160
    v_mul_u32_u24 v22, 768, v20
    v_add_u32 v23, 0, v21
    v_xor_b32 v23, v23, v20
    v_lshl_add_u32 v0, v23, 4, v22
    v_add_u32 v23, 4, v21
    v_xor_b32 v23, v23, v20
    v_lshl_add_u32 v1, v23, 4, v22
    v_add_u32 v23, 8, v21
    v_xor_b32 v23, v23, v20
    v_lshl_add_u32 v2, v23, 4, v22
    v_add_u32 v23, 12, v21
    v_xor_b32 v23, v23, v20
    v_lshl_add_u32 v3, v23, 4, v22
    v_lshrrev_b32 v22, 2, v20
    v_lshl_add_u32 v22, v21, 3, v22
    v_mul_u32_u24 v22, 192, v22
    v_and_b32 v23, 3, v20
    v_lshl_add_u32 v22, v23, 3, v22
    v_mul_u32_u24 v23, 6144, v18
    v_add_u32 v22, v22, v23
    v_add_u32 v22, 61440, v22
    v_and_b32 v23, 1, v21
    v_lshlrev_b32 v23, 5, v23
    v_add_u32 v10, v22, v23
    v_sub_u32 v11, v22, v23
    v_add_u32 v252, 49152, v10
    v_add_u32 v253, 49152, v11
    v_mul_u32_u24 v12, 784, v20
    v_add_u32 v12, v12, v17
    v_add_u32 v12, 86016, v12
    v_mul_u32_u24 v16, 3072, v18
    v_lshl_add_u32 v16, v19, 4, v16
    v_mul_u32_u24 v22, 3136, v18
    v_add_u32 v22, 86016, v22
    v_add_u32 v23, 16, v19
    v_lshrrev_b32 v23, 6, v23
    v_add_u32 v23, v23, v19
    v_lshl_add_u32 v23, v23, 4, v22
    v_add_u32 v13, 0, v23
    v_lshrrev_b32 v23, 5, v19
    v_add_u32 v23, 1, v23
    v_add_u32 v23, v23, v19
    v_lshl_add_u32 v23, v23, 4, v22
    v_add_u32 v14, 1024, v23
    v_add_u32 v23, 48, v19
    v_lshrrev_b32 v23, 6, v23
    v_add_u32 v23, 2, v23
    v_add_u32 v23, v23, v19
    v_lshl_add_u32 v23, v23, 4, v22
    v_add_u32 v15, 2048, v23
    s_mov_b32 s40, 113246208
    s_add_u32 m0, s32, 110592
    s_mov_b32 s35, 24576
    buffer_load_dwordx4 v7, s[16:19], s35 offen offset:0 lds
    buffer_load_dwordx4 v8, s[16:19], s35 offen offset:1024 lds
    buffer_load_dwordx4 v9, s[16:19], s35 offen offset:2048 lds
    s_add_u32 m0, s32, 113664
    s_mov_b32 s35, 36864
    buffer_load_dwordx4 v7, s[16:19], s35 offen offset:0 lds
    buffer_load_dwordx4 v8, s[16:19], s35 offen offset:1024 lds
    buffer_load_dwordx4 v9, s[16:19], s35 offen offset:2048 lds
    s_add_u32 m0, s32, 135168
    s_mov_b32 s35, 49152
    buffer_load_dwordx4 v7, s[16:19], s35 offen offset:0 lds
    buffer_load_dwordx4 v8, s[16:19], s35 offen offset:1024 lds
    buffer_load_dwordx4 v9, s[16:19], s35 offen offset:2048 lds
    s_add_u32 m0, s32, 138240
    s_mov_b32 s35, 61440
    buffer_load_dwordx4 v7, s[16:19], s35 offen offset:0 lds
    buffer_load_dwordx4 v8, s[16:19], s35 offen offset:1024 lds
    buffer_load_dwordx4 v9, s[16:19], s35 offen offset:2048 lds
    s_add_u32 m0, s32, 61440
    s_mov_b32 s35, 73728
    buffer_load_dwordx4 v7, s[16:19], s35 offen offset:0 lds
    buffer_load_dwordx4 v8, s[16:19], s35 offen offset:1024 lds
    buffer_load_dwordx4 v9, s[16:19], s35 offen offset:2048 lds
    s_add_u32 m0, s32, 64512
    s_mov_b32 s35, 86016
    buffer_load_dwordx4 v7, s[16:19], s35 offen offset:0 lds
    buffer_load_dwordx4 v8, s[16:19], s35 offen offset:1024 lds
    buffer_load_dwordx4 v9, s[16:19], s35 offen offset:2048 lds
    s_waitcnt vmcnt(30)
    s_barrier
    ds_read_b128 a[144:147], v0 offset:0
    ds_read_b128 a[192:195], v0 offset:12288
    s_waitcnt vmcnt(24)
    ds_read_b64_tr_b16 a[0:1], v10 offset:24576
    ds_read_b64_tr_b16 a[2:3], v10 offset:25344
    ds_read_b64_tr_b16 a[4:5], v11 offset:24608
    ds_read_b64_tr_b16 a[6:7], v11 offset:25376
    ds_read_b64_tr_b16 a[8:9], v10 offset:24640
    ds_read_b64_tr_b16 a[10:11], v10 offset:25408
    ds_read_b64_tr_b16 a[12:13], v11 offset:24672
    ds_read_b64_tr_b16 a[14:15], v11 offset:25440
    ds_read_b64_tr_b16 a[16:17], v10 offset:24704
    ds_read_b64_tr_b16 a[18:19], v10 offset:25472
    ds_read_b64_tr_b16 a[20:21], v11 offset:24736
    ds_read_b64_tr_b16 a[22:23], v11 offset:25504
    s_waitcnt vmcnt(18)
    v_accvgpr_read_b32 v240, a240
    v_accvgpr_read_b32 v241, a241
    v_accvgpr_read_b32 v242, a242
    v_accvgpr_read_b32 v243, a243
    v_accvgpr_read_b32 v244, a244
    v_accvgpr_read_b32 v245, a245
    v_accvgpr_read_b32 v246, a246
    v_accvgpr_read_b32 v247, a247
    v_accvgpr_read_b32 v248, a248
    v_accvgpr_read_b32 v249, a249
    v_accvgpr_read_b32 v250, a250
    v_accvgpr_read_b32 v251, a251
    v_lshlrev_b32 v24, 16, v240
    v_and_b32 v25, 0xffff0000, v240
    v_lshlrev_b32 v26, 16, v241
    v_and_b32 v27, 0xffff0000, v241
    v_lshlrev_b32 v28, 16, v242
    v_and_b32 v29, 0xffff0000, v242
    v_lshlrev_b32 v30, 16, v243
    v_and_b32 v31, 0xffff0000, v243
    v_lshlrev_b32 v32, 16, v244
    v_and_b32 v33, 0xffff0000, v244
    v_lshlrev_b32 v34, 16, v245
    v_and_b32 v35, 0xffff0000, v245
    v_lshlrev_b32 v36, 16, v246
    v_and_b32 v37, 0xffff0000, v246
    v_lshlrev_b32 v38, 16, v247
    v_and_b32 v39, 0xffff0000, v247
    v_lshlrev_b32 v40, 16, v248
    v_and_b32 v41, 0xffff0000, v248
    v_lshlrev_b32 v42, 16, v249
    v_and_b32 v43, 0xffff0000, v249
    v_lshlrev_b32 v44, 16, v250
    v_and_b32 v45, 0xffff0000, v250
    v_lshlrev_b32 v46, 16, v251
    v_and_b32 v47, 0xffff0000, v251
    s_waitcnt lgkmcnt(0)
    s_waitcnt vmcnt(12)
    v_mfma_f32_16x16x32_bf16 v[48:51], a[0:3], a[144:147], v[24:27]
    ds_read_b128 a[148:151], v1 offset:0
    ds_read_b128 a[196:199], v1 offset:12288
    s_add_u32 m0, s32, 86016
    s_mov_b32 s35, 98304
    buffer_load_dwordx4 v7, s[16:19], s35 offen offset:0 lds
    v_mfma_f32_16x16x32_bf16 v[52:55], a[4:7], a[144:147], v[28:31]
    ds_read_b64_tr_b16 a[24:25], v252 offset:0
    ds_read_b64_tr_b16 a[26:27], v252 offset:768
    v_mfma_f32_16x16x32_bf16 v[56:59], a[8:11], a[144:147], v[32:35]
    ds_read_b64_tr_b16 a[28:29], v253 offset:32
    ds_read_b64_tr_b16 a[30:31], v253 offset:800
    buffer_load_dwordx4 v8, s[16:19], s35 offen offset:1024 lds
    v_mfma_f32_16x16x32_bf16 v[60:63], a[12:15], a[144:147], v[36:39]
    ds_read_b64_tr_b16 a[32:33], v252 offset:64
    ds_read_b64_tr_b16 a[34:35], v252 offset:832
    v_mfma_f32_16x16x32_bf16 v[64:67], a[16:19], a[144:147], v[40:43]
    ds_read_b64_tr_b16 a[36:37], v253 offset:96
    ds_read_b64_tr_b16 a[38:39], v253 offset:864
    buffer_load_dwordx4 v9, s[16:19], s35 offen offset:2048 lds
    v_mfma_f32_16x16x32_bf16 v[68:71], a[20:23], a[144:147], v[44:47]
    ds_read_b64_tr_b16 a[40:41], v252 offset:128
    ds_read_b64_tr_b16 a[42:43], v252 offset:896
    v_mfma_f32_16x16x32_bf16 v[72:75], a[0:3], a[192:195], v[24:27]
    ds_read_b64_tr_b16 a[44:45], v253 offset:160
    ds_read_b64_tr_b16 a[46:47], v253 offset:928
    s_add_u32 m0, s32, 89088
    s_mov_b32 s35, 110592
    buffer_load_dwordx4 v7, s[16:19], s35 offen offset:0 lds
    v_mfma_f32_16x16x32_bf16 v[76:79], a[4:7], a[192:195], v[28:31]
    v_mfma_f32_16x16x32_bf16 v[80:83], a[8:11], a[192:195], v[32:35]
    buffer_load_dwordx4 v8, s[16:19], s35 offen offset:1024 lds
    v_mfma_f32_16x16x32_bf16 v[84:87], a[12:15], a[192:195], v[36:39]
    v_mfma_f32_16x16x32_bf16 v[88:91], a[16:19], a[192:195], v[40:43]
    buffer_load_dwordx4 v9, s[16:19], s35 offen offset:2048 lds
    v_mfma_f32_16x16x32_bf16 v[92:95], a[20:23], a[192:195], v[44:47]
    s_waitcnt lgkmcnt(0)
    s_waitcnt vmcnt(12)
    v_mfma_f32_16x16x32_bf16 v[48:51], a[24:27], a[148:151], v[48:51]
    ds_read_b128 a[152:155], v2 offset:0
    ds_read_b128 a[200:203], v2 offset:12288
    s_add_u32 m0, s32, 110592
    s_mov_b32 s35, 122880
    buffer_load_dwordx4 v7, s[16:19], s35 offen offset:0 lds
    v_mfma_f32_16x16x32_bf16 v[52:55], a[28:31], a[148:151], v[52:55]
    ds_read_b64_tr_b16 a[48:49], v252 offset:24576
    ds_read_b64_tr_b16 a[50:51], v252 offset:25344
    v_mfma_f32_16x16x32_bf16 v[56:59], a[32:35], a[148:151], v[56:59]
    ds_read_b64_tr_b16 a[52:53], v253 offset:24608
    ds_read_b64_tr_b16 a[54:55], v253 offset:25376
    buffer_load_dwordx4 v8, s[16:19], s35 offen offset:1024 lds
    v_mfma_f32_16x16x32_bf16 v[60:63], a[36:39], a[148:151], v[60:63]
    ds_read_b64_tr_b16 a[56:57], v252 offset:24640
    ds_read_b64_tr_b16 a[58:59], v252 offset:25408
    v_mfma_f32_16x16x32_bf16 v[64:67], a[40:43], a[148:151], v[64:67]
    ds_read_b64_tr_b16 a[60:61], v253 offset:24672
    ds_read_b64_tr_b16 a[62:63], v253 offset:25440
    buffer_load_dwordx4 v9, s[16:19], s35 offen offset:2048 lds
    v_mfma_f32_16x16x32_bf16 v[68:71], a[44:47], a[148:151], v[68:71]
    ds_read_b64_tr_b16 a[64:65], v252 offset:24704
    ds_read_b64_tr_b16 a[66:67], v252 offset:25472
    v_mfma_f32_16x16x32_bf16 v[72:75], a[24:27], a[196:199], v[72:75]
    ds_read_b64_tr_b16 a[68:69], v253 offset:24736
    ds_read_b64_tr_b16 a[70:71], v253 offset:25504
    s_add_u32 m0, s32, 113664
    s_mov_b32 s35, 135168
    buffer_load_dwordx4 v7, s[16:19], s35 offen offset:0 lds
    v_mfma_f32_16x16x32_bf16 v[76:79], a[28:31], a[196:199], v[76:79]
    v_mfma_f32_16x16x32_bf16 v[80:83], a[32:35], a[196:199], v[80:83]
    buffer_load_dwordx4 v8, s[16:19], s35 offen offset:1024 lds
    v_mfma_f32_16x16x32_bf16 v[84:87], a[36:39], a[196:199], v[84:87]
    v_mfma_f32_16x16x32_bf16 v[88:91], a[40:43], a[196:199], v[88:91]
    buffer_load_dwordx4 v9, s[16:19], s35 offen offset:2048 lds
    v_mfma_f32_16x16x32_bf16 v[92:95], a[44:47], a[196:199], v[92:95]
    s_waitcnt lgkmcnt(0)
    s_waitcnt vmcnt(12)
    v_mfma_f32_16x16x32_bf16 v[48:51], a[48:51], a[152:155], v[48:51]
    ds_read_b128 a[156:159], v3 offset:0
    ds_read_b128 a[204:207], v3 offset:12288
    s_add_u32 m0, s32, 135168
    s_mov_b32 s35, 147456
    buffer_load_dwordx4 v7, s[16:19], s35 offen offset:0 lds
    v_mfma_f32_16x16x32_bf16 v[52:55], a[52:55], a[152:155], v[52:55]
    ds_read_b64_tr_b16 a[72:73], v10 offset:0
    ds_read_b64_tr_b16 a[74:75], v10 offset:768
    v_mfma_f32_16x16x32_bf16 v[56:59], a[56:59], a[152:155], v[56:59]
    ds_read_b64_tr_b16 a[76:77], v11 offset:32
    ds_read_b64_tr_b16 a[78:79], v11 offset:800
    buffer_load_dwordx4 v8, s[16:19], s35 offen offset:1024 lds
    v_mfma_f32_16x16x32_bf16 v[60:63], a[60:63], a[152:155], v[60:63]
    ds_read_b64_tr_b16 a[80:81], v10 offset:64
    ds_read_b64_tr_b16 a[82:83], v10 offset:832
    v_mfma_f32_16x16x32_bf16 v[64:67], a[64:67], a[152:155], v[64:67]
    ds_read_b64_tr_b16 a[84:85], v11 offset:96
    ds_read_b64_tr_b16 a[86:87], v11 offset:864
    buffer_load_dwordx4 v9, s[16:19], s35 offen offset:2048 lds
    v_mfma_f32_16x16x32_bf16 v[68:71], a[68:71], a[152:155], v[68:71]
    ds_read_b64_tr_b16 a[88:89], v10 offset:128
    ds_read_b64_tr_b16 a[90:91], v10 offset:896
    v_mfma_f32_16x16x32_bf16 v[72:75], a[48:51], a[200:203], v[72:75]
    ds_read_b64_tr_b16 a[92:93], v11 offset:160
    ds_read_b64_tr_b16 a[94:95], v11 offset:928
    s_add_u32 m0, s32, 138240
    s_mov_b32 s35, 159744
    buffer_load_dwordx4 v7, s[16:19], s35 offen offset:0 lds
    v_mfma_f32_16x16x32_bf16 v[76:79], a[52:55], a[200:203], v[76:79]
    v_mfma_f32_16x16x32_bf16 v[80:83], a[56:59], a[200:203], v[80:83]
    buffer_load_dwordx4 v8, s[16:19], s35 offen offset:1024 lds
    v_mfma_f32_16x16x32_bf16 v[84:87], a[60:63], a[200:203], v[84:87]
    v_mfma_f32_16x16x32_bf16 v[88:91], a[64:67], a[200:203], v[88:91]
    buffer_load_dwordx4 v9, s[16:19], s35 offen offset:2048 lds
    v_mfma_f32_16x16x32_bf16 v[92:95], a[68:71], a[200:203], v[92:95]
    s_waitcnt lgkmcnt(0)
    s_waitcnt vmcnt(12)
    v_mfma_f32_16x16x32_bf16 v[48:51], a[72:75], a[156:159], v[48:51]
    ds_read_b128 a[160:163], v0 offset:256
    ds_read_b128 a[208:211], v0 offset:12544
    s_add_u32 m0, s32, 61440
    s_mov_b32 s35, 172032
    buffer_load_dwordx4 v7, s[16:19], s35 offen offset:0 lds
    v_mfma_f32_16x16x32_bf16 v[52:55], a[76:79], a[156:159], v[52:55]
    ds_read_b64_tr_b16 a[96:97], v10 offset:24576
    ds_read_b64_tr_b16 a[98:99], v10 offset:25344
    v_mfma_f32_16x16x32_bf16 v[56:59], a[80:83], a[156:159], v[56:59]
    ds_read_b64_tr_b16 a[100:101], v11 offset:24608
    ds_read_b64_tr_b16 a[102:103], v11 offset:25376
    buffer_load_dwordx4 v8, s[16:19], s35 offen offset:1024 lds
    v_mfma_f32_16x16x32_bf16 v[60:63], a[84:87], a[156:159], v[60:63]
    ds_read_b64_tr_b16 a[104:105], v10 offset:24640
    ds_read_b64_tr_b16 a[106:107], v10 offset:25408
    v_mfma_f32_16x16x32_bf16 v[64:67], a[88:91], a[156:159], v[64:67]
    ds_read_b64_tr_b16 a[108:109], v11 offset:24672
    ds_read_b64_tr_b16 a[110:111], v11 offset:25440
    buffer_load_dwordx4 v9, s[16:19], s35 offen offset:2048 lds
    v_mfma_f32_16x16x32_bf16 v[68:71], a[92:95], a[156:159], v[68:71]
    ds_read_b64_tr_b16 a[112:113], v10 offset:24704
    ds_read_b64_tr_b16 a[114:115], v10 offset:25472
    v_mfma_f32_16x16x32_bf16 v[72:75], a[72:75], a[204:207], v[72:75]
    ds_read_b64_tr_b16 a[116:117], v11 offset:24736
    ds_read_b64_tr_b16 a[118:119], v11 offset:25504
    s_add_u32 m0, s32, 64512
    s_mov_b32 s35, 184320
    buffer_load_dwordx4 v7, s[16:19], s35 offen offset:0 lds
    v_mfma_f32_16x16x32_bf16 v[76:79], a[76:79], a[204:207], v[76:79]
    v_mfma_f32_16x16x32_bf16 v[80:83], a[80:83], a[204:207], v[80:83]
    buffer_load_dwordx4 v8, s[16:19], s35 offen offset:1024 lds
    v_mfma_f32_16x16x32_bf16 v[84:87], a[84:87], a[204:207], v[84:87]
    v_mfma_f32_16x16x32_bf16 v[88:91], a[88:91], a[204:207], v[88:91]
    buffer_load_dwordx4 v9, s[16:19], s35 offen offset:2048 lds
    v_mfma_f32_16x16x32_bf16 v[92:95], a[92:95], a[204:207], v[92:95]
    s_add_u32 m0, s42, s41
    s_add_u32 s42, s42, 12288
    buffer_load_dwordx4 v4, s[12:15], s30 offen offset:0 nt lds
    buffer_load_dwordx4 v5, s[12:15], s30 offen offset:1024 nt lds
    buffer_load_dwordx4 v6, s[12:15], s30 offen offset:2048 nt lds
    s_add_u32 s30, s30, 393216
    s_waitcnt lgkmcnt(0)
    s_waitcnt vmcnt(15)
    v_mfma_f32_16x16x32_bf16 v[48:51], a[96:99], a[160:163], v[48:51]
    ds_read_b128 a[164:167], v1 offset:256
    ds_read_b128 a[212:215], v1 offset:12544
    s_add_u32 m0, s32, 86016
    s_mov_b32 s35, 196608
    buffer_load_dwordx4 v7, s[16:19], s35 offen offset:0 lds
    v_mfma_f32_16x16x32_bf16 v[52:55], a[100:103], a[160:163], v[52:55]
    ds_read_b64_tr_b16 a[120:121], v252 offset:0
    ds_read_b64_tr_b16 a[122:123], v252 offset:768
    v_mfma_f32_16x16x32_bf16 v[56:59], a[104:107], a[160:163], v[56:59]
    ds_read_b64_tr_b16 a[124:125], v253 offset:32
    ds_read_b64_tr_b16 a[126:127], v253 offset:800
    buffer_load_dwordx4 v8, s[16:19], s35 offen offset:1024 lds
    v_mfma_f32_16x16x32_bf16 v[60:63], a[108:111], a[160:163], v[60:63]
    ds_read_b64_tr_b16 a[128:129], v252 offset:64
    ds_read_b64_tr_b16 a[130:131], v252 offset:832
    v_mfma_f32_16x16x32_bf16 v[64:67], a[112:115], a[160:163], v[64:67]
    ds_read_b64_tr_b16 a[132:133], v253 offset:96
    ds_read_b64_tr_b16 a[134:135], v253 offset:864
    buffer_load_dwordx4 v9, s[16:19], s35 offen offset:2048 lds
    v_mfma_f32_16x16x32_bf16 v[68:71], a[116:119], a[160:163], v[68:71]
    ds_read_b64_tr_b16 a[136:137], v252 offset:128
    ds_read_b64_tr_b16 a[138:139], v252 offset:896
    v_mfma_f32_16x16x32_bf16 v[72:75], a[96:99], a[208:211], v[72:75]
    ds_read_b64_tr_b16 a[140:141], v253 offset:160
    ds_read_b64_tr_b16 a[142:143], v253 offset:928
    s_add_u32 m0, s32, 89088
    s_mov_b32 s35, 208896
    buffer_load_dwordx4 v7, s[16:19], s35 offen offset:0 lds
    v_mfma_f32_16x16x32_bf16 v[76:79], a[100:103], a[208:211], v[76:79]
    v_mfma_f32_16x16x32_bf16 v[80:83], a[104:107], a[208:211], v[80:83]
    buffer_load_dwordx4 v8, s[16:19], s35 offen offset:1024 lds
    v_mfma_f32_16x16x32_bf16 v[84:87], a[108:111], a[208:211], v[84:87]
    v_mfma_f32_16x16x32_bf16 v[88:91], a[112:115], a[208:211], v[88:91]
    buffer_load_dwordx4 v9, s[16:19], s35 offen offset:2048 lds
    v_mfma_f32_16x16x32_bf16 v[92:95], a[116:119], a[208:211], v[92:95]
    s_waitcnt lgkmcnt(0)
    s_waitcnt vmcnt(15)
    v_mfma_f32_16x16x32_bf16 v[48:51], a[120:123], a[164:167], v[48:51]
    ds_read_b128 a[168:171], v2 offset:256
    ds_read_b128 a[216:219], v2 offset:12544
    s_add_u32 m0, s32, 110592
    s_mov_b32 s35, 221184
    buffer_load_dwordx4 v7, s[16:19], s35 offen offset:0 lds
    v_mfma_f32_16x16x32_bf16 v[52:55], a[124:127], a[164:167], v[52:55]
    ds_read_b64_tr_b16 v[96:97], v252 offset:24576
    ds_read_b64_tr_b16 v[98:99], v252 offset:25344
    v_mfma_f32_16x16x32_bf16 v[56:59], a[128:131], a[164:167], v[56:59]
    ds_read_b64_tr_b16 v[100:101], v253 offset:24608
    ds_read_b64_tr_b16 v[102:103], v253 offset:25376
    buffer_load_dwordx4 v8, s[16:19], s35 offen offset:1024 lds
    v_mfma_f32_16x16x32_bf16 v[60:63], a[132:135], a[164:167], v[60:63]
    ds_read_b64_tr_b16 v[104:105], v252 offset:24640
    ds_read_b64_tr_b16 v[106:107], v252 offset:25408
    v_mfma_f32_16x16x32_bf16 v[64:67], a[136:139], a[164:167], v[64:67]
    ds_read_b64_tr_b16 v[108:109], v253 offset:24672
    ds_read_b64_tr_b16 v[110:111], v253 offset:25440
    buffer_load_dwordx4 v9, s[16:19], s35 offen offset:2048 lds
    v_mfma_f32_16x16x32_bf16 v[68:71], a[140:143], a[164:167], v[68:71]
    ds_read_b64_tr_b16 v[112:113], v252 offset:24704
    ds_read_b64_tr_b16 v[114:115], v252 offset:25472
    v_mfma_f32_16x16x32_bf16 v[72:75], a[120:123], a[212:215], v[72:75]
    ds_read_b64_tr_b16 v[116:117], v253 offset:24736
    ds_read_b64_tr_b16 v[118:119], v253 offset:25504
    s_add_u32 m0, s32, 113664
    s_mov_b32 s35, 233472
    buffer_load_dwordx4 v7, s[16:19], s35 offen offset:0 lds
    v_mfma_f32_16x16x32_bf16 v[76:79], a[124:127], a[212:215], v[76:79]
    v_mfma_f32_16x16x32_bf16 v[80:83], a[128:131], a[212:215], v[80:83]
    buffer_load_dwordx4 v8, s[16:19], s35 offen offset:1024 lds
    v_mfma_f32_16x16x32_bf16 v[84:87], a[132:135], a[212:215], v[84:87]
    v_mfma_f32_16x16x32_bf16 v[88:91], a[136:139], a[212:215], v[88:91]
    buffer_load_dwordx4 v9, s[16:19], s35 offen offset:2048 lds
    v_mfma_f32_16x16x32_bf16 v[92:95], a[140:143], a[212:215], v[92:95]
    s_waitcnt lgkmcnt(0)
    s_waitcnt vmcnt(15)
    v_mfma_f32_16x16x32_bf16 v[48:51], v[96:99], a[168:171], v[48:51]
    ds_read_b128 a[172:175], v3 offset:256
    ds_read_b128 a[220:223], v3 offset:12544
    s_add_u32 m0, s32, 135168
    s_mov_b32 s35, 245760
    buffer_load_dwordx4 v7, s[16:19], s35 offen offset:0 lds
    v_mfma_f32_16x16x32_bf16 v[52:55], v[100:103], a[168:171], v[52:55]
    ds_read_b64_tr_b16 v[120:121], v10 offset:0
    ds_read_b64_tr_b16 v[122:123], v10 offset:768
    v_mfma_f32_16x16x32_bf16 v[56:59], v[104:107], a[168:171], v[56:59]
    ds_read_b64_tr_b16 v[124:125], v11 offset:32
    ds_read_b64_tr_b16 v[126:127], v11 offset:800
    buffer_load_dwordx4 v8, s[16:19], s35 offen offset:1024 lds
    v_mfma_f32_16x16x32_bf16 v[60:63], v[108:111], a[168:171], v[60:63]
    ds_read_b64_tr_b16 v[128:129], v10 offset:64
    ds_read_b64_tr_b16 v[130:131], v10 offset:832
    v_mfma_f32_16x16x32_bf16 v[64:67], v[112:115], a[168:171], v[64:67]
    ds_read_b64_tr_b16 v[132:133], v11 offset:96
    ds_read_b64_tr_b16 v[134:135], v11 offset:864
    buffer_load_dwordx4 v9, s[16:19], s35 offen offset:2048 lds
    v_mfma_f32_16x16x32_bf16 v[68:71], v[116:119], a[168:171], v[68:71]
    ds_read_b64_tr_b16 v[136:137], v10 offset:128
    ds_read_b64_tr_b16 v[138:139], v10 offset:896
    v_mfma_f32_16x16x32_bf16 v[72:75], v[96:99], a[216:219], v[72:75]
    ds_read_b64_tr_b16 v[140:141], v11 offset:160
    ds_read_b64_tr_b16 v[142:143], v11 offset:928
    s_add_u32 m0, s32, 138240
    s_mov_b32 s35, 258048
    buffer_load_dwordx4 v7, s[16:19], s35 offen offset:0 lds
    v_mfma_f32_16x16x32_bf16 v[76:79], v[100:103], a[216:219], v[76:79]
    v_mfma_f32_16x16x32_bf16 v[80:83], v[104:107], a[216:219], v[80:83]
    buffer_load_dwordx4 v8, s[16:19], s35 offen offset:1024 lds
    v_mfma_f32_16x16x32_bf16 v[84:87], v[108:111], a[216:219], v[84:87]
    v_mfma_f32_16x16x32_bf16 v[88:91], v[112:115], a[216:219], v[88:91]
    buffer_load_dwordx4 v9, s[16:19], s35 offen offset:2048 lds
    v_mfma_f32_16x16x32_bf16 v[92:95], v[116:119], a[216:219], v[92:95]
    s_waitcnt lgkmcnt(0)
    s_waitcnt vmcnt(12)
    v_mfma_f32_16x16x32_bf16 v[48:51], v[120:123], a[172:175], v[48:51]
    ds_read_b128 a[176:179], v0 offset:512
    ds_read_b128 a[224:227], v0 offset:12800
    s_add_u32 m0, s32, 61440
    s_mov_b32 s35, 270336
    buffer_load_dwordx4 v7, s[16:19], s35 offen offset:0 lds
    v_mfma_f32_16x16x32_bf16 v[52:55], v[124:127], a[172:175], v[52:55]
    ds_read_b64_tr_b16 v[144:145], v10 offset:24576
    ds_read_b64_tr_b16 v[146:147], v10 offset:25344
    v_mfma_f32_16x16x32_bf16 v[56:59], v[128:131], a[172:175], v[56:59]
    ds_read_b64_tr_b16 v[148:149], v11 offset:24608
    ds_read_b64_tr_b16 v[150:151], v11 offset:25376
    buffer_load_dwordx4 v8, s[16:19], s35 offen offset:1024 lds
    v_mfma_f32_16x16x32_bf16 v[60:63], v[132:135], a[172:175], v[60:63]
    ds_read_b64_tr_b16 v[152:153], v10 offset:24640
    ds_read_b64_tr_b16 v[154:155], v10 offset:25408
    v_mfma_f32_16x16x32_bf16 v[64:67], v[136:139], a[172:175], v[64:67]
    ds_read_b64_tr_b16 v[156:157], v11 offset:24672
    ds_read_b64_tr_b16 v[158:159], v11 offset:25440
    buffer_load_dwordx4 v9, s[16:19], s35 offen offset:2048 lds
    v_mfma_f32_16x16x32_bf16 v[68:71], v[140:143], a[172:175], v[68:71]
    ds_read_b64_tr_b16 v[160:161], v10 offset:24704
    ds_read_b64_tr_b16 v[162:163], v10 offset:25472
    v_mfma_f32_16x16x32_bf16 v[72:75], v[120:123], a[220:223], v[72:75]
    ds_read_b64_tr_b16 v[164:165], v11 offset:24736
    ds_read_b64_tr_b16 v[166:167], v11 offset:25504
    s_add_u32 m0, s32, 64512
    s_mov_b32 s35, 282624
    buffer_load_dwordx4 v7, s[16:19], s35 offen offset:0 lds
    v_mfma_f32_16x16x32_bf16 v[76:79], v[124:127], a[220:223], v[76:79]
    v_mfma_f32_16x16x32_bf16 v[80:83], v[128:131], a[220:223], v[80:83]
    buffer_load_dwordx4 v8, s[16:19], s35 offen offset:1024 lds
    v_mfma_f32_16x16x32_bf16 v[84:87], v[132:135], a[220:223], v[84:87]
    v_mfma_f32_16x16x32_bf16 v[88:91], v[136:139], a[220:223], v[88:91]
    buffer_load_dwordx4 v9, s[16:19], s35 offen offset:2048 lds
    v_mfma_f32_16x16x32_bf16 v[92:95], v[140:143], a[220:223], v[92:95]
    s_waitcnt lgkmcnt(0)
    s_waitcnt vmcnt(12)
    v_mfma_f32_16x16x32_bf16 v[48:51], v[144:147], a[176:179], v[48:51]
    ds_read_b128 a[180:183], v1 offset:512
    ds_read_b128 a[228:231], v1 offset:12800
    s_add_u32 m0, s42, s41
    s_add_u32 s42, s42, 12288
    buffer_store_dwordx4 a[240:243], v16, s[24:27], 0 offen offset:0 sc0 sc1
    buffer_store_dwordx4 a[244:247], v16, s[24:27], 0 offen offset:1024 sc0 sc1
    buffer_store_dwordx4 a[248:251], v16, s[24:27], 0 offen offset:2048 sc0 sc1
    buffer_load_dwordx4 v4, s[12:15], s30 offen offset:0 nt lds
    buffer_load_dwordx4 v5, s[12:15], s30 offen offset:1024 nt lds
    buffer_load_dwordx4 v6, s[12:15], s30 offen offset:2048 nt lds
    s_add_u32 s30, s30, 393216
    v_mfma_f32_16x16x32_bf16 v[52:55], v[148:151], a[176:179], v[52:55]
    ds_read_b64_tr_b16 v[168:169], v252 offset:0
    ds_read_b64_tr_b16 v[170:171], v252 offset:768
    v_mfma_f32_16x16x32_bf16 v[56:59], v[152:155], a[176:179], v[56:59]
    ds_read_b64_tr_b16 v[172:173], v253 offset:32
    ds_read_b64_tr_b16 v[174:175], v253 offset:800
    v_mfma_f32_16x16x32_bf16 v[60:63], v[156:159], a[176:179], v[60:63]
    ds_read_b64_tr_b16 v[176:177], v252 offset:64
    ds_read_b64_tr_b16 v[178:179], v252 offset:832
    v_mfma_f32_16x16x32_bf16 v[64:67], v[160:163], a[176:179], v[64:67]
    ds_read_b64_tr_b16 v[180:181], v253 offset:96
    ds_read_b64_tr_b16 v[182:183], v253 offset:864
    v_mfma_f32_16x16x32_bf16 v[68:71], v[164:167], a[176:179], v[68:71]
    ds_read_b64_tr_b16 v[184:185], v252 offset:128
    ds_read_b64_tr_b16 v[186:187], v252 offset:896
    v_mfma_f32_16x16x32_bf16 v[72:75], v[144:147], a[224:227], v[72:75]
    ds_read_b64_tr_b16 v[188:189], v253 offset:160
    ds_read_b64_tr_b16 v[190:191], v253 offset:928
    v_mfma_f32_16x16x32_bf16 v[76:79], v[148:151], a[224:227], v[76:79]
    v_mfma_f32_16x16x32_bf16 v[80:83], v[152:155], a[224:227], v[80:83]
    v_mfma_f32_16x16x32_bf16 v[84:87], v[156:159], a[224:227], v[84:87]
    v_mfma_f32_16x16x32_bf16 v[88:91], v[160:163], a[224:227], v[88:91]
    v_mfma_f32_16x16x32_bf16 v[92:95], v[164:167], a[224:227], v[92:95]
    s_waitcnt lgkmcnt(0)
    s_waitcnt vmcnt(12)
    v_mfma_f32_16x16x32_bf16 v[48:51], v[168:171], a[180:183], v[48:51]
    ds_read_b128 a[184:187], v2 offset:512
    ds_read_b128 a[232:235], v2 offset:12800
    s_add_u32 m0, s42, s41
    s_add_u32 s42, s42, 12288
    buffer_store_dwordx4 a[240:243], v16, s[24:27], 0 offen offset:0 sc0 sc1
    buffer_store_dwordx4 a[244:247], v16, s[24:27], 0 offen offset:1024 sc0 sc1
    buffer_store_dwordx4 a[248:251], v16, s[24:27], 0 offen offset:2048 sc0 sc1
    buffer_load_dwordx4 v4, s[12:15], s30 offen offset:0 nt lds
    buffer_load_dwordx4 v5, s[12:15], s30 offen offset:1024 nt lds
    buffer_load_dwordx4 v6, s[12:15], s30 offen offset:2048 nt lds
    s_add_u32 s30, s30, 393216
    v_mfma_f32_16x16x32_bf16 v[52:55], v[172:175], a[180:183], v[52:55]
    ds_read_b64_tr_b16 v[192:193], v252 offset:24576
    ds_read_b64_tr_b16 v[194:195], v252 offset:25344
    v_mfma_f32_16x16x32_bf16 v[56:59], v[176:179], a[180:183], v[56:59]
    ds_read_b64_tr_b16 v[196:197], v253 offset:24608
    ds_read_b64_tr_b16 v[198:199], v253 offset:25376
    v_mfma_f32_16x16x32_bf16 v[60:63], v[180:183], a[180:183], v[60:63]
    ds_read_b64_tr_b16 v[200:201], v252 offset:24640
    ds_read_b64_tr_b16 v[202:203], v252 offset:25408
    v_mfma_f32_16x16x32_bf16 v[64:67], v[184:187], a[180:183], v[64:67]
    ds_read_b64_tr_b16 v[204:205], v253 offset:24672
    ds_read_b64_tr_b16 v[206:207], v253 offset:25440
    v_mfma_f32_16x16x32_bf16 v[68:71], v[188:191], a[180:183], v[68:71]
    ds_read_b64_tr_b16 v[208:209], v252 offset:24704
    ds_read_b64_tr_b16 v[210:211], v252 offset:25472
    v_mfma_f32_16x16x32_bf16 v[72:75], v[168:171], a[228:231], v[72:75]
    ds_read_b64_tr_b16 v[212:213], v253 offset:24736
    ds_read_b64_tr_b16 v[214:215], v253 offset:25504
    v_mfma_f32_16x16x32_bf16 v[76:79], v[172:175], a[228:231], v[76:79]
    v_mfma_f32_16x16x32_bf16 v[80:83], v[176:179], a[228:231], v[80:83]
    v_mfma_f32_16x16x32_bf16 v[84:87], v[180:183], a[228:231], v[84:87]
    v_mfma_f32_16x16x32_bf16 v[88:91], v[184:187], a[228:231], v[88:91]
    v_mfma_f32_16x16x32_bf16 v[92:95], v[188:191], a[228:231], v[92:95]
    s_waitcnt lgkmcnt(0)
    s_waitcnt vmcnt(12)
    v_mfma_f32_16x16x32_bf16 v[48:51], v[192:195], a[184:187], v[48:51]
    ds_read_b128 a[188:191], v3 offset:512
    ds_read_b128 a[236:239], v3 offset:12800
    v_mfma_f32_16x16x32_bf16 v[52:55], v[196:199], a[184:187], v[52:55]
    ds_read_b64_tr_b16 v[216:217], v10 offset:0
    ds_read_b64_tr_b16 v[218:219], v10 offset:768
    v_mfma_f32_16x16x32_bf16 v[56:59], v[200:203], a[184:187], v[56:59]
    ds_read_b64_tr_b16 v[220:221], v11 offset:32
    ds_read_b64_tr_b16 v[222:223], v11 offset:800
    v_mfma_f32_16x16x32_bf16 v[60:63], v[204:207], a[184:187], v[60:63]
    ds_read_b64_tr_b16 v[224:225], v10 offset:64
    ds_read_b64_tr_b16 v[226:227], v10 offset:832
    v_mfma_f32_16x16x32_bf16 v[64:67], v[208:211], a[184:187], v[64:67]
    ds_read_b64_tr_b16 v[228:229], v11 offset:96
    ds_read_b64_tr_b16 v[230:231], v11 offset:864
    v_mfma_f32_16x16x32_bf16 v[68:71], v[212:215], a[184:187], v[68:71]
    ds_read_b64_tr_b16 v[232:233], v10 offset:128
    ds_read_b64_tr_b16 v[234:235], v10 offset:896
    v_mfma_f32_16x16x32_bf16 v[72:75], v[192:195], a[232:235], v[72:75]
    ds_read_b64_tr_b16 v[236:237], v11 offset:160
    ds_read_b64_tr_b16 v[238:239], v11 offset:928
    v_mfma_f32_16x16x32_bf16 v[76:79], v[196:199], a[232:235], v[76:79]
    v_mfma_f32_16x16x32_bf16 v[80:83], v[200:203], a[232:235], v[80:83]
    v_mfma_f32_16x16x32_bf16 v[84:87], v[204:207], a[232:235], v[84:87]
    v_mfma_f32_16x16x32_bf16 v[88:91], v[208:211], a[232:235], v[88:91]
    v_mfma_f32_16x16x32_bf16 v[92:95], v[212:215], a[232:235], v[92:95]
    s_waitcnt lgkmcnt(0)
    s_barrier
    v_mfma_f32_16x16x32_bf16 v[48:51], v[216:219], a[188:191], v[48:51]
    ds_read_b128 a[144:147], v0 offset:24576
    v_mfma_f32_16x16x32_bf16 v[52:55], v[220:223], a[188:191], v[52:55]
    ds_read_b128 a[148:151], v1 offset:24576
    v_mfma_f32_16x16x32_bf16 v[56:59], v[224:227], a[188:191], v[56:59]
    ds_read_b128 a[152:155], v2 offset:24576
    v_mfma_f32_16x16x32_bf16 v[60:63], v[228:231], a[188:191], v[60:63]
    ds_read_b128 a[156:159], v3 offset:24576
    v_mfma_f32_16x16x32_bf16 v[64:67], v[232:235], a[188:191], v[64:67]
    ds_read_b128 a[160:163], v0 offset:24832
    v_mfma_f32_16x16x32_bf16 v[68:71], v[236:239], a[188:191], v[68:71]
    ds_read_b128 a[164:167], v1 offset:24832
    v_mfma_f32_16x16x32_bf16 v[72:75], v[216:219], a[236:239], v[72:75]
    ds_read_b128 a[168:171], v2 offset:24832
    v_mfma_f32_16x16x32_bf16 v[76:79], v[220:223], a[236:239], v[76:79]
    ds_read_b128 a[172:175], v3 offset:24832
    v_mfma_f32_16x16x32_bf16 v[80:83], v[224:227], a[236:239], v[80:83]
    ds_read_b128 a[176:179], v0 offset:25088
    v_mfma_f32_16x16x32_bf16 v[84:87], v[228:231], a[236:239], v[84:87]
    ds_read_b128 a[180:183], v1 offset:25088
    v_mfma_f32_16x16x32_bf16 v[88:91], v[232:235], a[236:239], v[88:91]
    ds_read_b128 a[184:187], v2 offset:25088
    v_mfma_f32_16x16x32_bf16 v[92:95], v[236:239], a[236:239], v[92:95]
    ds_read_b128 a[188:191], v3 offset:25088
    s_waitcnt lgkmcnt(0)
    s_nop 1
    v_cvt_pk_bf16_f32 v48, v48, v49
    v_cvt_pk_bf16_f32 v49, v50, v51
    ds_write_b64 v12, v[48:49] offset:0
    v_cvt_pk_bf16_f32 v52, v52, v53
    v_cvt_pk_bf16_f32 v53, v54, v55
    ds_write_b64 v12, v[52:53] offset:32
    v_cvt_pk_bf16_f32 v56, v56, v57
    v_cvt_pk_bf16_f32 v57, v58, v59
    ds_write_b64 v12, v[56:57] offset:64
    v_cvt_pk_bf16_f32 v60, v60, v61
    v_cvt_pk_bf16_f32 v61, v62, v63
    ds_write_b64 v12, v[60:61] offset:96
    v_cvt_pk_bf16_f32 v64, v64, v65
    v_cvt_pk_bf16_f32 v65, v66, v67
    ds_write_b64 v12, v[64:65] offset:128
    v_cvt_pk_bf16_f32 v68, v68, v69
    v_cvt_pk_bf16_f32 v69, v70, v71
    ds_write_b64 v12, v[68:69] offset:160
    v_add_u32 v0, 36864, v0
    v_add_u32 v1, 36864, v1
    v_add_u32 v2, 36864, v2
    v_add_u32 v3, 36864, v3
    s_mov_b32 s34, 36864
    s_mov_b32 s29, 2
    s_add_u32 m0, s42, s41
    s_mov_b32 s26, 113246208
L_enter:
.p2align 6
L_loop0:
    s_waitcnt vmcnt(6) lgkmcnt(0)
    s_barrier
    v_mfma_f32_16x16x32_bf16 v[48:51], a[0:3], a[144:147], v[24:27]
    ds_read_b128 a[192:195], v0 offset:0
    v_mfma_f32_16x16x32_bf16 v[48:51], a[24:27], a[148:151], v[48:51]
    s_add_u32 s31, s31, 393216
    v_mfma_f32_16x16x32_bf16 v[48:51], a[48:51], a[152:155], v[48:51]
    ds_read_b128 a[240:243], v13 offset:0
    v_mfma_f32_16x16x32_bf16 v[48:51], a[72:75], a[156:159], v[48:51]
    ds_read_b128 a[244:247], v14 offset:0
    v_mfma_f32_16x16x32_bf16 v[48:51], a[96:99], a[160:163], v[48:51]
    ds_read_b128 a[248:251], v15 offset:0
    v_mfma_f32_16x16x32_bf16 v[48:51], a[120:123], a[164:167], v[48:51]
    ds_read_b128 a[196:199], v1 offset:0
    v_mfma_f32_16x16x32_bf16 v[48:51], v[96:99], a[168:171], v[48:51]
    v_mfma_f32_16x16x32_bf16 v[48:51], v[120:123], a[172:175], v[48:51]
    v_mfma_f32_16x16x32_bf16 v[48:51], v[144:147], a[176:179], v[48:51]
    v_cvt_pk_bf16_f32 v72, v72, v73
    v_mfma_f32_16x16x32_bf16 v[48:51], v[168:171], a[180:183], v[48:51]
    v_cvt_pk_bf16_f32 v73, v74, v75
    v_mfma_f32_16x16x32_bf16 v[48:51], v[192:195], a[184:187], v[48:51]
    ds_read_b128 a[200:203], v2 offset:0
    v_mfma_f32_16x16x32_bf16 v[48:51], v[216:219], a[188:191], v[48:51]
    ds_write_b64 v12, v[72:73] offset:12544
    v_mfma_f32_16x16x32_bf16 v[52:55], a[4:7], a[144:147], v[28:31]
    s_waitcnt lgkmcnt(5)
    buffer_store_dwordx4 a[240:243], v16, s[24:27], s31 offen offset:0 sc0 sc1
    v_mfma_f32_16x16x32_bf16 v[52:55], a[28:31], a[148:151], v[52:55]
    s_add_u32 s38, s34, 12288
    v_mfma_f32_16x16x32_bf16 v[52:55], a[52:55], a[152:155], v[52:55]
    s_cmp_eq_u32 s38, 86016
    s_cselect_b32 s38, 0, s38
    v_mfma_f32_16x16x32_bf16 v[52:55], a[76:79], a[156:159], v[52:55]
    s_waitcnt lgkmcnt(4)
    buffer_store_dwordx4 a[244:247], v16, s[24:27], s31 offen offset:1024 sc0 sc1
    v_mfma_f32_16x16x32_bf16 v[52:55], a[100:103], a[160:163], v[52:55]
    ds_read_b128 a[204:207], v3 offset:0
    v_mfma_f32_16x16x32_bf16 v[52:55], a[124:127], a[164:167], v[52:55]
    v_cvt_pk_bf16_f32 v76, v76, v77
    v_mfma_f32_16x16x32_bf16 v[52:55], v[100:103], a[168:171], v[52:55]
    s_waitcnt lgkmcnt(4)
    buffer_store_dwordx4 a[248:251], v16, s[24:27], s31 offen offset:2048 sc0 sc1
    v_mfma_f32_16x16x32_bf16 v[52:55], v[124:127], a[172:175], v[52:55]
    v_cvt_pk_bf16_f32 v77, v78, v79
    v_mfma_f32_16x16x32_bf16 v[52:55], v[148:151], a[176:179], v[52:55]
    ds_read_b128 a[208:211], v0 offset:256
    v_mfma_f32_16x16x32_bf16 v[52:55], v[172:175], a[180:183], v[52:55]
    buffer_load_dwordx4 v4, s[12:15], s30 offen offset:0 nt lds
    v_mfma_f32_16x16x32_bf16 v[52:55], v[196:199], a[184:187], v[52:55]
    ds_write_b64 v12, v[76:77] offset:12576
    v_mfma_f32_16x16x32_bf16 v[52:55], v[220:223], a[188:191], v[52:55]
    s_sub_u32 s33, s38, s34
    v_mfma_f32_16x16x32_bf16 v[56:59], a[8:11], a[144:147], v[32:35]
    buffer_load_dwordx4 v5, s[12:15], s30 offen offset:1024 nt lds
    v_mfma_f32_16x16x32_bf16 v[56:59], a[32:35], a[148:151], v[56:59]
    ds_read_b128 a[212:215], v1 offset:256
    v_mfma_f32_16x16x32_bf16 v[56:59], a[56:59], a[152:155], v[56:59]
    v_cvt_pk_bf16_f32 v80, v80, v81
    v_mfma_f32_16x16x32_bf16 v[56:59], a[80:83], a[156:159], v[56:59]
    buffer_load_dwordx4 v6, s[12:15], s30 offen offset:2048 nt lds
    v_mfma_f32_16x16x32_bf16 v[56:59], a[104:107], a[160:163], v[56:59]
    s_add_u32 s30, s30, 393216
    v_mfma_f32_16x16x32_bf16 v[56:59], a[128:131], a[164:167], v[56:59]
    s_add_u32 s42, s42, 12288
    v_mfma_f32_16x16x32_bf16 v[56:59], v[104:107], a[168:171], v[56:59]
    ds_read_b128 a[216:219], v2 offset:256
    v_mfma_f32_16x16x32_bf16 v[56:59], v[128:131], a[172:175], v[56:59]
    s_cmp_eq_u32 s42, 86016
    s_cselect_b32 s42, 0, s42
    v_mfma_f32_16x16x32_bf16 v[56:59], v[152:155], a[176:179], v[56:59]
    s_add_u32 m0, s42, s41
    v_mfma_f32_16x16x32_bf16 v[56:59], v[176:179], a[180:183], v[56:59]
    v_cvt_pk_bf16_f32 v81, v82, v83
    v_mfma_f32_16x16x32_bf16 v[56:59], v[200:203], a[184:187], v[56:59]
    ds_write_b64 v12, v[80:81] offset:12608
    v_mfma_f32_16x16x32_bf16 v[56:59], v[224:227], a[188:191], v[56:59]
    ds_read_b128 a[220:223], v3 offset:256
    v_mfma_f32_16x16x32_bf16 v[60:63], a[12:15], a[144:147], v[36:39]
    v_cvt_pk_bf16_f32 v84, v84, v85
    v_mfma_f32_16x16x32_bf16 v[60:63], a[36:39], a[148:151], v[60:63]
    v_cvt_pk_bf16_f32 v85, v86, v87
    v_mfma_f32_16x16x32_bf16 v[60:63], a[60:63], a[152:155], v[60:63]
    ds_write_b64 v12, v[84:85] offset:12640
    v_mfma_f32_16x16x32_bf16 v[60:63], a[84:87], a[156:159], v[60:63]
    s_mov_b32 s34, s38
    v_mfma_f32_16x16x32_bf16 v[60:63], a[108:111], a[160:163], v[60:63]
    ds_read_b128 a[224:227], v0 offset:512
    v_mfma_f32_16x16x32_bf16 v[60:63], a[132:135], a[164:167], v[60:63]
    s_add_u32 s29, s29, 1
    v_mfma_f32_16x16x32_bf16 v[60:63], v[108:111], a[168:171], v[60:63]
    s_cmp_lt_u32 s29, s43
    s_cselect_b32 s14, s40, 0
    v_mfma_f32_16x16x32_bf16 v[60:63], v[132:135], a[172:175], v[60:63]
    v_cvt_pk_bf16_f32 v88, v88, v89
    v_mfma_f32_16x16x32_bf16 v[60:63], v[156:159], a[176:179], v[60:63]
    v_cvt_pk_bf16_f32 v89, v90, v91
    v_mfma_f32_16x16x32_bf16 v[60:63], v[180:183], a[180:183], v[60:63]
    ds_read_b128 a[228:231], v1 offset:512
    v_mfma_f32_16x16x32_bf16 v[60:63], v[204:207], a[184:187], v[60:63]
    ds_write_b64 v12, v[88:89] offset:12672
    v_mfma_f32_16x16x32_bf16 v[60:63], v[228:231], a[188:191], v[60:63]
    v_add_u32 v0, s33, v0
    v_mfma_f32_16x16x32_bf16 v[64:67], a[16:19], a[144:147], v[40:43]
    v_cvt_pk_bf16_f32 v92, v92, v93
    v_mfma_f32_16x16x32_bf16 v[64:67], a[40:43], a[148:151], v[64:67]
    v_cvt_pk_bf16_f32 v93, v94, v95
    v_mfma_f32_16x16x32_bf16 v[64:67], a[64:67], a[152:155], v[64:67]
    ds_read_b128 a[232:235], v2 offset:512
    v_mfma_f32_16x16x32_bf16 v[64:67], a[88:91], a[156:159], v[64:67]
    s_waitcnt lgkmcnt(14)
    ds_write_b64 v12, v[92:93] offset:12704
    v_mfma_f32_16x16x32_bf16 v[64:67], a[112:115], a[160:163], v[64:67]
    v_add_u32 v1, s33, v1
    v_mfma_f32_16x16x32_bf16 v[64:67], a[136:139], a[164:167], v[64:67]
    v_add_u32 v2, s33, v2
    v_mfma_f32_16x16x32_bf16 v[64:67], v[112:115], a[168:171], v[64:67]
    v_mfma_f32_16x16x32_bf16 v[64:67], v[136:139], a[172:175], v[64:67]
    s_waitcnt lgkmcnt(14)
    ds_read_b128 a[236:239], v3 offset:512
    v_mfma_f32_16x16x32_bf16 v[64:67], v[160:163], a[176:179], v[64:67]
    v_add_u32 v3, s33, v3
    v_mfma_f32_16x16x32_bf16 v[64:67], v[184:187], a[180:183], v[64:67]
    v_mfma_f32_16x16x32_bf16 v[64:67], v[208:211], a[184:187], v[64:67]
    v_mfma_f32_16x16x32_bf16 v[64:67], v[232:235], a[188:191], v[64:67]
    v_mfma_f32_16x16x32_bf16 v[68:71], a[20:23], a[144:147], v[44:47]
    v_mfma_f32_16x16x32_bf16 v[68:71], a[44:47], a[148:151], v[68:71]
    v_mfma_f32_16x16x32_bf16 v[68:71], a[68:71], a[152:155], v[68:71]
    v_mfma_f32_16x16x32_bf16 v[68:71], a[92:95], a[156:159], v[68:71]
    v_mfma_f32_16x16x32_bf16 v[68:71], a[116:119], a[160:163], v[68:71]
    v_mfma_f32_16x16x32_bf16 v[68:71], a[140:143], a[164:167], v[68:71]
    v_mfma_f32_16x16x32_bf16 v[68:71], v[116:119], a[168:171], v[68:71]
    v_mfma_f32_16x16x32_bf16 v[68:71], v[140:143], a[172:175], v[68:71]
    v_mfma_f32_16x16x32_bf16 v[68:71], v[164:167], a[176:179], v[68:71]
    v_mfma_f32_16x16x32_bf16 v[68:71], v[188:191], a[180:183], v[68:71]
    v_mfma_f32_16x16x32_bf16 v[68:71], v[212:215], a[184:187], v[68:71]
    v_mfma_f32_16x16x32_bf16 v[68:71], v[236:239], a[188:191], v[68:71]
    s_cmp_ge_u32 s29, s37
    s_cbranch_scc1 L_drain0
    s_waitcnt vmcnt(6) lgkmcnt(0)
    s_barrier
    v_mfma_f32_16x16x32_bf16 v[72:75], a[0:3], a[192:195], v[24:27]
    ds_read_b128 a[144:147], v0 offset:0
    v_mfma_f32_16x16x32_bf16 v[72:75], a[24:27], a[196:199], v[72:75]
    s_add_u32 s31, s31, 393216
    v_mfma_f32_16x16x32_bf16 v[72:75], a[48:51], a[200:203], v[72:75]
    ds_read_b128 a[240:243], v13 offset:12544
    v_mfma_f32_16x16x32_bf16 v[72:75], a[72:75], a[204:207], v[72:75]
    ds_read_b128 a[244:247], v14 offset:12544
    v_mfma_f32_16x16x32_bf16 v[72:75], a[96:99], a[208:211], v[72:75]
    ds_read_b128 a[248:251], v15 offset:12544
    v_mfma_f32_16x16x32_bf16 v[72:75], a[120:123], a[212:215], v[72:75]
    ds_read_b128 a[148:151], v1 offset:0
    v_mfma_f32_16x16x32_bf16 v[72:75], v[96:99], a[216:219], v[72:75]
    v_mfma_f32_16x16x32_bf16 v[72:75], v[120:123], a[220:223], v[72:75]
    v_mfma_f32_16x16x32_bf16 v[72:75], v[144:147], a[224:227], v[72:75]
    v_cvt_pk_bf16_f32 v48, v48, v49
    v_mfma_f32_16x16x32_bf16 v[72:75], v[168:171], a[228:231], v[72:75]
    v_cvt_pk_bf16_f32 v49, v50, v51
    v_mfma_f32_16x16x32_bf16 v[72:75], v[192:195], a[232:235], v[72:75]
    ds_read_b128 a[152:155], v2 offset:0
    v_mfma_f32_16x16x32_bf16 v[72:75], v[216:219], a[236:239], v[72:75]
    ds_write_b64 v12, v[48:49] offset:0
    v_mfma_f32_16x16x32_bf16 v[76:79], a[4:7], a[192:195], v[28:31]
    s_waitcnt lgkmcnt(5)
    buffer_store_dwordx4 a[240:243], v16, s[24:27], s31 offen offset:0 sc0 sc1
    v_mfma_f32_16x16x32_bf16 v[76:79], a[28:31], a[196:199], v[76:79]
    s_add_u32 s38, s34, 12288
    v_mfma_f32_16x16x32_bf16 v[76:79], a[52:55], a[200:203], v[76:79]
    s_cmp_eq_u32 s38, 86016
    s_cselect_b32 s38, 0, s38
    v_mfma_f32_16x16x32_bf16 v[76:79], a[76:79], a[204:207], v[76:79]
    s_waitcnt lgkmcnt(4)
    buffer_store_dwordx4 a[244:247], v16, s[24:27], s31 offen offset:1024 sc0 sc1
    v_mfma_f32_16x16x32_bf16 v[76:79], a[100:103], a[208:211], v[76:79]
    ds_read_b128 a[156:159], v3 offset:0
    v_mfma_f32_16x16x32_bf16 v[76:79], a[124:127], a[212:215], v[76:79]
    v_cvt_pk_bf16_f32 v52, v52, v53
    v_mfma_f32_16x16x32_bf16 v[76:79], v[100:103], a[216:219], v[76:79]
    s_waitcnt lgkmcnt(4)
    buffer_store_dwordx4 a[248:251], v16, s[24:27], s31 offen offset:2048 sc0 sc1
    v_mfma_f32_16x16x32_bf16 v[76:79], v[124:127], a[220:223], v[76:79]
    v_cvt_pk_bf16_f32 v53, v54, v55
    v_mfma_f32_16x16x32_bf16 v[76:79], v[148:151], a[224:227], v[76:79]
    ds_read_b128 a[160:163], v0 offset:256
    v_mfma_f32_16x16x32_bf16 v[76:79], v[172:175], a[228:231], v[76:79]
    buffer_load_dwordx4 v4, s[12:15], s30 offen offset:0 nt lds
    v_mfma_f32_16x16x32_bf16 v[76:79], v[196:199], a[232:235], v[76:79]
    ds_write_b64 v12, v[52:53] offset:32
    v_mfma_f32_16x16x32_bf16 v[76:79], v[220:223], a[236:239], v[76:79]
    s_sub_u32 s33, s38, s34
    v_mfma_f32_16x16x32_bf16 v[80:83], a[8:11], a[192:195], v[32:35]
    buffer_load_dwordx4 v5, s[12:15], s30 offen offset:1024 nt lds
    v_mfma_f32_16x16x32_bf16 v[80:83], a[32:35], a[196:199], v[80:83]
    ds_read_b128 a[164:167], v1 offset:256
    v_mfma_f32_16x16x32_bf16 v[80:83], a[56:59], a[200:203], v[80:83]
    v_cvt_pk_bf16_f32 v56, v56, v57
    v_mfma_f32_16x16x32_bf16 v[80:83], a[80:83], a[204:207], v[80:83]
    buffer_load_dwordx4 v6, s[12:15], s30 offen offset:2048 nt lds
    v_mfma_f32_16x16x32_bf16 v[80:83], a[104:107], a[208:211], v[80:83]
    s_add_u32 s30, s30, 393216
    v_mfma_f32_16x16x32_bf16 v[80:83], a[128:131], a[212:215], v[80:83]
    s_add_u32 s42, s42, 12288
    v_mfma_f32_16x16x32_bf16 v[80:83], v[104:107], a[216:219], v[80:83]
    ds_read_b128 a[168:171], v2 offset:256
    v_mfma_f32_16x16x32_bf16 v[80:83], v[128:131], a[220:223], v[80:83]
    s_cmp_eq_u32 s42, 86016
    s_cselect_b32 s42, 0, s42
    v_mfma_f32_16x16x32_bf16 v[80:83], v[152:155], a[224:227], v[80:83]
    s_add_u32 m0, s42, s41
    v_mfma_f32_16x16x32_bf16 v[80:83], v[176:179], a[228:231], v[80:83]
    v_cvt_pk_bf16_f32 v57, v58, v59
    v_mfma_f32_16x16x32_bf16 v[80:83], v[200:203], a[232:235], v[80:83]
    ds_write_b64 v12, v[56:57] offset:64
    v_mfma_f32_16x16x32_bf16 v[80:83], v[224:227], a[236:239], v[80:83]
    ds_read_b128 a[172:175], v3 offset:256
    v_mfma_f32_16x16x32_bf16 v[84:87], a[12:15], a[192:195], v[36:39]
    v_cvt_pk_bf16_f32 v60, v60, v61
    v_mfma_f32_16x16x32_bf16 v[84:87], a[36:39], a[196:199], v[84:87]
    v_cvt_pk_bf16_f32 v61, v62, v63
    v_mfma_f32_16x16x32_bf16 v[84:87], a[60:63], a[200:203], v[84:87]
    ds_write_b64 v12, v[60:61] offset:96
    v_mfma_f32_16x16x32_bf16 v[84:87], a[84:87], a[204:207], v[84:87]
    s_mov_b32 s34, s38
    v_mfma_f32_16x16x32_bf16 v[84:87], a[108:111], a[208:211], v[84:87]
    ds_read_b128 a[176:179], v0 offset:512
    v_mfma_f32_16x16x32_bf16 v[84:87], a[132:135], a[212:215], v[84:87]
    s_add_u32 s29, s29, 1
    v_mfma_f32_16x16x32_bf16 v[84:87], v[108:111], a[216:219], v[84:87]
    s_cmp_lt_u32 s29, s43
    s_cselect_b32 s14, s40, 0
    v_mfma_f32_16x16x32_bf16 v[84:87], v[132:135], a[220:223], v[84:87]
    v_cvt_pk_bf16_f32 v64, v64, v65
    v_mfma_f32_16x16x32_bf16 v[84:87], v[156:159], a[224:227], v[84:87]
    v_cvt_pk_bf16_f32 v65, v66, v67
    v_mfma_f32_16x16x32_bf16 v[84:87], v[180:183], a[228:231], v[84:87]
    ds_read_b128 a[180:183], v1 offset:512
    v_mfma_f32_16x16x32_bf16 v[84:87], v[204:207], a[232:235], v[84:87]
    ds_write_b64 v12, v[64:65] offset:128
    v_mfma_f32_16x16x32_bf16 v[84:87], v[228:231], a[236:239], v[84:87]
    v_add_u32 v0, s33, v0
    v_mfma_f32_16x16x32_bf16 v[88:91], a[16:19], a[192:195], v[40:43]
    v_cvt_pk_bf16_f32 v68, v68, v69
    v_mfma_f32_16x16x32_bf16 v[88:91], a[40:43], a[196:199], v[88:91]
    v_cvt_pk_bf16_f32 v69, v70, v71
    v_mfma_f32_16x16x32_bf16 v[88:91], a[64:67], a[200:203], v[88:91]
    ds_read_b128 a[184:187], v2 offset:512
    v_mfma_f32_16x16x32_bf16 v[88:91], a[88:91], a[204:207], v[88:91]
    s_waitcnt lgkmcnt(14)
    ds_write_b64 v12, v[68:69] offset:160
    v_mfma_f32_16x16x32_bf16 v[88:91], a[112:115], a[208:211], v[88:91]
    v_add_u32 v1, s33, v1
    v_mfma_f32_16x16x32_bf16 v[88:91], a[136:139], a[212:215], v[88:91]
    v_add_u32 v2, s33, v2
    v_mfma_f32_16x16x32_bf16 v[88:91], v[112:115], a[216:219], v[88:91]
    v_mfma_f32_16x16x32_bf16 v[88:91], v[136:139], a[220:223], v[88:91]
    s_waitcnt lgkmcnt(14)
    ds_read_b128 a[188:191], v3 offset:512
    v_mfma_f32_16x16x32_bf16 v[88:91], v[160:163], a[224:227], v[88:91]
    v_add_u32 v3, s33, v3
    v_mfma_f32_16x16x32_bf16 v[88:91], v[184:187], a[228:231], v[88:91]
    v_mfma_f32_16x16x32_bf16 v[88:91], v[208:211], a[232:235], v[88:91]
    v_mfma_f32_16x16x32_bf16 v[88:91], v[232:235], a[236:239], v[88:91]
    v_mfma_f32_16x16x32_bf16 v[92:95], a[20:23], a[192:195], v[44:47]
    v_mfma_f32_16x16x32_bf16 v[92:95], a[44:47], a[196:199], v[92:95]
    v_mfma_f32_16x16x32_bf16 v[92:95], a[68:71], a[200:203], v[92:95]
    v_mfma_f32_16x16x32_bf16 v[92:95], a[92:95], a[204:207], v[92:95]
    v_mfma_f32_16x16x32_bf16 v[92:95], a[116:119], a[208:211], v[92:95]
    v_mfma_f32_16x16x32_bf16 v[92:95], a[140:143], a[212:215], v[92:95]
    v_mfma_f32_16x16x32_bf16 v[92:95], v[116:119], a[216:219], v[92:95]
    v_mfma_f32_16x16x32_bf16 v[92:95], v[140:143], a[220:223], v[92:95]
    v_mfma_f32_16x16x32_bf16 v[92:95], v[164:167], a[224:227], v[92:95]
    v_mfma_f32_16x16x32_bf16 v[92:95], v[188:191], a[228:231], v[92:95]
    v_mfma_f32_16x16x32_bf16 v[92:95], v[212:215], a[232:235], v[92:95]
    v_mfma_f32_16x16x32_bf16 v[92:95], v[236:239], a[236:239], v[92:95]
    s_cmp_lt_u32 s29, s37
    s_cbranch_scc1 L_loop0
L_drain1:
    s_waitcnt lgkmcnt(0)
    s_barrier
    s_add_u32 s31, s31, 393216
    s_nop 4
    ds_read_b128 a[240:243], v13 offset:0
    ds_read_b128 a[244:247], v14 offset:0
    ds_read_b128 a[248:251], v15 offset:0
    v_cvt_pk_bf16_f32 v72, v72, v73
    v_cvt_pk_bf16_f32 v73, v74, v75
    ds_write_b64 v12, v[72:73] offset:12544
    v_cvt_pk_bf16_f32 v76, v76, v77
    v_cvt_pk_bf16_f32 v77, v78, v79
    ds_write_b64 v12, v[76:77] offset:12576
    v_cvt_pk_bf16_f32 v80, v80, v81
    v_cvt_pk_bf16_f32 v81, v82, v83
    ds_write_b64 v12, v[80:81] offset:12608
    v_cvt_pk_bf16_f32 v84, v84, v85
    v_cvt_pk_bf16_f32 v85, v86, v87
    ds_write_b64 v12, v[84:85] offset:12640
    v_cvt_pk_bf16_f32 v88, v88, v89
    v_cvt_pk_bf16_f32 v89, v90, v91
    ds_write_b64 v12, v[88:89] offset:12672
    v_cvt_pk_bf16_f32 v92, v92, v93
    v_cvt_pk_bf16_f32 v93, v94, v95
    ds_write_b64 v12, v[92:93] offset:12704
    s_waitcnt lgkmcnt(8)
    buffer_store_dwordx4 a[240:243], v16, s[24:27], s31 offen offset:0 sc0 sc1
    s_waitcnt lgkmcnt(7)
    buffer_store_dwordx4 a[244:247], v16, s[24:27], s31 offen offset:1024 sc0 sc1
    s_waitcnt lgkmcnt(6)
    buffer_store_dwordx4 a[248:251], v16, s[24:27], s31 offen offset:2048 sc0 sc1
    s_add_u32 s31, s31, 393216
    s_waitcnt lgkmcnt(0)
    s_barrier
    ds_read_b128 a[144:147], v13 offset:12544
    ds_read_b128 a[148:151], v14 offset:12544
    ds_read_b128 a[152:155], v15 offset:12544
    s_waitcnt lgkmcnt(2)
    buffer_store_dwordx4 a[144:147], v16, s[24:27], s31 offen offset:0 sc0 sc1
    s_waitcnt lgkmcnt(1)
    buffer_store_dwordx4 a[148:151], v16, s[24:27], s31 offen offset:1024 sc0 sc1
    s_waitcnt lgkmcnt(0)
    buffer_store_dwordx4 a[152:155], v16, s[24:27], s31 offen offset:2048 sc0 sc1
    s_branch L_end
L_drain0:
    s_waitcnt lgkmcnt(0)
    s_barrier
    s_add_u32 s31, s31, 393216
    s_nop 4
    ds_read_b128 a[240:243], v13 offset:12544
    ds_read_b128 a[244:247], v14 offset:12544
    ds_read_b128 a[248:251], v15 offset:12544
    v_cvt_pk_bf16_f32 v48, v48, v49
    v_cvt_pk_bf16_f32 v49, v50, v51
    ds_write_b64 v12, v[48:49] offset:0
    v_cvt_pk_bf16_f32 v52, v52, v53
    v_cvt_pk_bf16_f32 v53, v54, v55
    ds_write_b64 v12, v[52:53] offset:32
    v_cvt_pk_bf16_f32 v56, v56, v57
    v_cvt_pk_bf16_f32 v57, v58, v59
    ds_write_b64 v12, v[56:57] offset:64
    v_cvt_pk_bf16_f32 v60, v60, v61
    v_cvt_pk_bf16_f32 v61, v62, v63
    ds_write_b64 v12, v[60:61] offset:96
    v_cvt_pk_bf16_f32 v64, v64, v65
    v_cvt_pk_bf16_f32 v65, v66, v67
    ds_write_b64 v12, v[64:65] offset:128
    v_cvt_pk_bf16_f32 v68, v68, v69
    v_cvt_pk_bf16_f32 v69, v70, v71
    ds_write_b64 v12, v[68:69] offset:160
    s_waitcnt lgkmcnt(8)
    buffer_store_dwordx4 a[240:243], v16, s[24:27], s31 offen offset:0 sc0 sc1
    s_waitcnt lgkmcnt(7)
    buffer_store_dwordx4 a[244:247], v16, s[24:27], s31 offen offset:1024 sc0 sc1
    s_waitcnt lgkmcnt(6)
    buffer_store_dwordx4 a[248:251], v16, s[24:27], s31 offen offset:2048 sc0 sc1
    s_add_u32 s31, s31, 393216
    s_waitcnt lgkmcnt(0)
    s_barrier
    ds_read_b128 a[144:147], v13 offset:0
    ds_read_b128 a[148:151], v14 offset:0
    ds_read_b128 a[152:155], v15 offset:0
    s_waitcnt lgkmcnt(2)
    buffer_store_dwordx4 a[144:147], v16, s[24:27], s31 offen offset:0 sc0 sc1
    s_waitcnt lgkmcnt(1)
    buffer_store_dwordx4 a[148:151], v16, s[24:27], s31 offen offset:1024 sc0 sc1
    s_waitcnt lgkmcnt(0)
    buffer_store_dwordx4 a[152:155], v16, s[24:27], s31 offen offset:2048 sc0 sc1
L_end:
L_done:
    s_endpgm
.section .rodata,"a"
.p2align 6
.amdhsa_kernel standalone__standard_2d_1d_3d_conv__vision_kernel
  .amdhsa_next_free_vgpr 512
  .amdhsa_next_free_sgpr 96
  .amdhsa_accum_offset 256
  .amdhsa_group_segment_fixed_size 0
  .amdhsa_kernarg_size 48
  .amdhsa_user_sgpr_count 2
  .amdhsa_user_sgpr_kernarg_segment_ptr 1
  .amdhsa_system_sgpr_workgroup_id_x 1
.end_amdhsa_kernel
```
